```python
import torch

def _softmax(x, axis=-1):
    return torch.softmax(x, dim=axis)
def _gelu(x):
    return torch.nn.functional.gelu(x, approximate="tanh")
def _silu(x):
    return torch.nn.functional.silu(x)
def _sigmoid(x):
    return torch.sigmoid(x)
def _layernorm(x, axis=-1, eps=1e-5):
    m = x.mean(dim=axis, keepdim=True)
    v = x.var(dim=axis, keepdim=True, unbiased=False)
    return (x - m) / torch.sqrt(v + eps)
def _scatter_add(tgt, idx, src, axis=0):
    return tgt.clone().index_add_(axis, idx, src)
def _segment_sum(src, seg, n):
    out = torch.zeros((n,) + src.shape[1:], dtype=src.dtype)
    return out.index_add_(0, seg, src)
def _pad(x, pw):
    flat = tuple(v for pair in reversed(pw) for v in pair)
    return torch.nn.functional.pad(x, flat)

kernel_name = 'concat_heads__mha_block_cached__gqa_block_cached__near_ridge'

def setup_inputs():

    _w = (lambda a: (lambda t: t.to(torch.bfloat16) if t.is_floating_point() else t)(torch.as_tensor(a)))
    def _A_setup():
        B, Sq, D = 16, 160, 640
        H, Sk, Dh = 32, 512, 192
        return {
            "x": _w((lambda *s: torch.randn(*s, dtype=torch.bfloat16) * 0.8)(B, Sq, D)),
            "k_cache": _w((lambda *s: torch.randn(*s, dtype=torch.bfloat16) * 0.8)(B, H, Sk, Dh)),
            "v_cache": _w((lambda *s: torch.randn(*s, dtype=torch.bfloat16) * 0.05)(B, H, Sk, Dh)),
            "wq": _w((lambda *s: torch.randn(*s, dtype=torch.bfloat16) * 0.8)(D, H * Dh) * (D ** -0.5)),
            "wo": _w((lambda *s: torch.randn(*s, dtype=torch.bfloat16) * 0.05)(H * Dh, D) * ((H * Dh) ** -0.5)),
        }
    _A_in = _A_setup()

    def _B_setup():
        B, Sq, D = 16, 160, 640
        Hq, Hkv, Sk, Dh = 32, 32, 512, 192
        assert Hq % Hkv == 0, (Hq, Hkv)
        return {
            "x": _w((lambda *s: torch.randn(*s, dtype=torch.bfloat16) * 0.8)(B, Sq, D)),
            "k_cache": _w((lambda *s: torch.randn(*s, dtype=torch.bfloat16) * 0.8)(B, Hkv, Sk, Dh)),
            "v_cache": _w((lambda *s: torch.randn(*s, dtype=torch.bfloat16) * 0.05)(B, Hkv, Sk, Dh)),
            "wq": _w((lambda *s: torch.randn(*s, dtype=torch.bfloat16) * 0.8)(D, Hq * Dh) * (D ** -0.5)),
            "wo": _w((lambda *s: torch.randn(*s, dtype=torch.bfloat16) * 0.05)(Hq * Dh, D) * ((Hq * Dh) ** -0.5)),
        }
    _B_in = _B_setup()

    return {
        "A_x": _A_in["x"],
        "A_k_cache": _A_in["k_cache"],
        "A_v_cache": _A_in["v_cache"],
        "A_wq": _A_in["wq"],
        "A_wo": _A_in["wo"],
        "B_x": _B_in["x"],
        "B_k_cache": _B_in["k_cache"],
        "B_v_cache": _B_in["v_cache"],
        "B_wq": _B_in["wq"],
        "B_wo": _B_in["wo"],
    }

def reference(A_x, A_k_cache, A_v_cache, A_wq, A_wo, B_x, B_k_cache, B_v_cache, B_wq, B_wo):
    def _A_ref(x, k_cache, v_cache, wq, wo):
        B, Sq, D = x.shape
        H, Dh = 32, 192
        q = (lambda x, *d: x.permute(*d))((x @ wq).reshape(B, Sq, H, Dh), 0, 2, 1, 3)
        scores = torch.einsum("bhqd,bhkd->bhqk", q, k_cache) * (Dh ** -0.5)
        p = _softmax(scores, axis=-1)
        o = torch.einsum("bhqk,bhkd->bhqd", p, v_cache)
        return (lambda x, *d: x.permute(*d))(o, 0, 2, 1, 3).reshape(B, Sq, H * Dh) @ wo

    def _B_ref(x, k_cache, v_cache, wq, wo):
        B, Sq, D = x.shape
        Hq, Dh = 32, 192
        Hkv = k_cache.shape[1]
        rep = Hq // Hkv
        q = (lambda x, *d: x.permute(*d))((x @ wq).reshape(B, Sq, Hq, Dh), 0, 2, 1, 3)
        k = (lambda x, n, axis: torch.repeat_interleave(x, n, dim=axis))(k_cache, rep, axis=1)
        v = (lambda x, n, axis: torch.repeat_interleave(x, n, dim=axis))(v_cache, rep, axis=1)
        scores = torch.einsum("bhqd,bhkd->bhqk", q, k) * (Dh ** -0.5)
        p = _softmax(scores, axis=-1)
        o = torch.einsum("bhqk,bhkd->bhqd", p, v)
        return (lambda x, *d: x.permute(*d))(o, 0, 2, 1, 3).reshape(B, Sq, Hq * Dh) @ wo

    a = _A_ref(A_x, A_k_cache, A_v_cache, A_wq, A_wo)
    b = _B_ref(B_x, B_k_cache, B_v_cache, B_wq, B_wo)
    return torch.concatenate([a, b], axis=-1)
```

```asm
; @launch grid=(256,1,1) block=(256,1,1) lds=163840
.amdgcn_target "amdgcn-amd-amdhsa--gfx950"
.text
.globl concat_heads__mha_block_cached__gqa_block_cached__near_ridge_kernel
.p2align 8
.type concat_heads__mha_block_cached__gqa_block_cached__near_ridge_kernel,@function
concat_heads__mha_block_cached__gqa_block_cached__near_ridge_kernel:
    s_cmp_ge_u32 s2, 256
    s_cbranch_scc1 L_exit
    s_load_dwordx2 s[6:7], s[0:1], 88
    s_load_dwordx16 s[8:23], s[0:1], 0
    s_load_dwordx4 s[24:27], s[0:1], 64
    s_load_dwordx2 s[28:29], s[0:1], 96
    s_load_dwordx2 s[30:31], s[0:1], 80
    s_waitcnt lgkmcnt(0)
    s_mov_b32 s84, s6
    s_mov_b32 s85, s7
    s_mov_b32 s86, 256
    s_mov_b32 s87, 0x00020000
    s_and_b32 s3, s2, 7
    s_cmp_ge_u32 s3, 4
    s_cselect_b32 s32, s18, s8
    s_cselect_b32 s33, s19, s9
    s_mov_b32 s34, 3276800
    s_mov_b32 s35, 0x00020000
    s_cselect_b32 s40, s20, s10
    s_cselect_b32 s41, s21, s11
    s_mov_b32 s42, 100663296
    s_mov_b32 s43, 0x00020000
    s_cselect_b32 s44, s22, s12
    s_cselect_b32 s45, s23, s13
    s_mov_b32 s46, 100663296
    s_mov_b32 s47, 0x00020000
    s_cselect_b32 s36, s24, s14
    s_cselect_b32 s37, s25, s15
    s_mov_b32 s38, 7864320
    s_mov_b32 s39, 0x00020000
    s_cselect_b32 s88, s26, s16
    s_cselect_b32 s89, s27, s17
    s_mov_b32 s90, 7864320
    s_mov_b32 s91, 0x00020000
    s_mov_b32 s48, s28
    s_mov_b32 s49, s29
    s_mov_b32 s50, 134217728
    s_mov_b32 s51, 0x00020000
    s_mov_b32 s92, s30
    s_mov_b32 s93, s31
    s_mov_b32 s94, 6553600
    s_mov_b32 s95, 0x00020000
    v_lshrrev_b32 v1, 6, v0
    s_nop 0
    v_readfirstlane_b32 s56, v1
    v_and_b32 v235, 63, v0
    s_getpc_b64 s[78:79]
    s_lshr_b32 s4, s2, 3
    s_lshl_b32 s4, s4, 2
    s_add_u32 s4, s4, s56
    s_and_b32 s4, s4, 15
    s_min_u32 s4, s4, 4
    s_lshl_b32 s4, s4, 13
    s_add_u32 s78, s78, s4
    s_addc_u32 s79, s79, 0
    v_lshlrev_b32 v2, 7, v235
    v_mov_b32 v3, s79
    v_add_co_u32 v2, vcc, s78, v2
    s_nop 1
    v_addc_co_u32 v3, vcc, 0, v3, vcc
    global_load_dword v4, v[2:3], off
    s_and_b32 s9, s56, 1
    s_lshr_b32 s10, s56, 1
    s_lshr_b32 s4, s2, 4
    s_bfe_u32 s5, s2, 0x10003
    s_lshl_b32 s63, s5, 3
    s_and_b32 s6, s3, 1
    s_lshl_b32 s6, s6, 2
    s_and_b32 s7, s4, 3
    s_add_u32 s98, s6, s7
    s_mov_b32 s101, s7
    s_lshr_b32 s4, s4, 2
    s_lshr_b32 s6, s3, 1
    s_lshl_b32 s6, s6, 3
    s_lshl_b32 s99, s4, 1
    s_add_u32 s99, s99, s6
    s_add_u32 s99, s99, s10
    s_lshl_b32 s6, s3, 2
    s_add_u32 s100, s6, s4
    s_lshl_b32 s75, s4, 1
    s_add_u32 s75, s75, s7
    s_lshl_b32 s5, s5, 2
    s_add_u32 s75, s75, s5
    s_cmp_ge_u32 s75, 10
    s_cselect_b32 s5, 10, 0
    s_sub_u32 s75, s75, s5
    s_add_u32 s16, s4, s7
    s_lshr_b32 s4, s2, 5
    s_bfe_u32 s101, s2, 0x20003
    s_lshr_b32 s5, s3, 1
    s_lshl_b32 s5, s5, 3
    s_add_u32 s100, s5, s4
    s_add_u32 s16, s4, s101
    s_mov_b32 s72, 0x3dd53b95
    s_mov_b32 s73, 0x3dd53b95
    s_mov_b32 s76, 0x53800000
    s_mul_i32 s6, s10, 81920
    s_mul_i32 s69, s9, 6144
    s_add_u32 s69, s69, s6
    s_mul_i32 s70, s9, 10240
    s_add_u32 s70, s70, s6
    s_mul_i32 s8, s56, 3072
    s_mul_i32 s14, s56, 5120
    s_mul_i32 s67, s75, 786432
    s_lshl_b32 s68, s75, 7
    s_and_b32 s4, s99, 15
    s_mul_i32 s53, s4, 204800
    s_mul_i32 s4, s9, 102400
    s_add_u32 s53, s53, s4
    s_mov_b32 s74, s53
    s_mov_b32 s96, 0x7f000000
    s_mov_b32 s55, 0x7f000000
    s_mul_i32 s25, s100, 4352
    s_add_u32 s25, s25, 133169152
    s_mov_b32 s97, 0
    s_cmp_eq_u32 s63, 0
    s_cbranch_scc1 L_init_even
    s_add_u32 s3, s98, 16
    s_mul_i32 s71, s3, 384
    s_lshl_b32 s3, s9, 4
    s_lshl_b32 s4, s10, 2
    s_add_u32 s3, s3, s4
    s_mul_i32 s3, s3, 12288
    s_add_u32 s71, s71, s3
    s_add_u32 s3, s98, 16
    s_and_b32 s4, s99, 14
    s_lshl_b32 s4, s4, 5
    s_add_u32 s4, s4, s3
    s_mul_i32 s77, s4, 196608
    s_mul_i32 s4, s9, 6144
    s_add_u32 s77, s77, s8
    s_add_u32 s7, s77, 196608
    s_mov_b32 s4, 0
    s_mov_b32 s80, s4
    s_add_u32 s65, s77, s4
    s_mov_b32 s66, s65
    s_mul_i32 s4, s99, 192
    s_mul_i32 s3, s3, 6
    s_add_u32 s4, s4, s3
    s_mul_i32 s54, s4, 10240
    s_and_b32 s3, s98, 4
    s_lshl_b32 s52, 65536, s3
    s_branch L_init_done
L_init_even:
    s_add_u32 s3, s98, 0
    s_mul_i32 s71, s3, 384
    s_lshl_b32 s3, s9, 4
    s_lshl_b32 s4, s10, 2
    s_add_u32 s3, s3, s4
    s_mul_i32 s3, s3, 12288
    s_add_u32 s71, s71, s3
    s_add_u32 s3, s98, 0
    s_and_b32 s4, s99, 14
    s_lshl_b32 s4, s4, 5
    s_add_u32 s4, s4, s3
    s_mul_i32 s77, s4, 196608
    s_mul_i32 s4, s9, 6144
    s_add_u32 s77, s77, s8
    s_add_u32 s7, s77, 196608
    s_mov_b32 s4, 0
    s_mov_b32 s80, s4
    s_add_u32 s65, s77, s4
    s_mov_b32 s66, s65
    s_mul_i32 s4, s99, 192
    s_mul_i32 s3, s3, 6
    s_add_u32 s4, s4, s3
    s_mul_i32 s54, s4, 10240
    s_and_b32 s3, s98, 4
    s_lshl_b32 s52, 1, s3
L_init_done:
    v_lshrrev_b32 v250, 3, v235
    v_and_b32 v251, 7, v235
    v_add_u32 v247, 0, v250
    v_mul_u32_u24 v245, 43, v247
    v_lshrrev_b32 v245, 7, v245
    v_mul_u32_u24 v246, 3, v245
    v_sub_u32 v246, v247, v246
    v_lshrrev_b32 v247, 2, v245
    v_lshlrev_b32 v247, 3, v247
    v_and_b32 v248, 3, v245
    v_add_u32 v247, v247, v248
    v_mul_u32_u24 v227, 12288, v247
    v_lshl_add_u32 v227, v246, 7, v227
    v_xor_b32 v247, v251, v245
    v_lshl_add_u32 v227, v247, 4, v227
    v_lshlrev_b32 v224, 7, v250
    v_lshl_add_u32 v224, v247, 4, v224
    v_add_u32 v247, 8, v250
    v_mul_u32_u24 v245, 43, v247
    v_lshrrev_b32 v245, 7, v245
    v_mul_u32_u24 v246, 3, v245
    v_sub_u32 v246, v247, v246
    v_lshrrev_b32 v247, 2, v245
    v_lshlrev_b32 v247, 3, v247
    v_and_b32 v248, 3, v245
    v_add_u32 v247, v247, v248
    v_mul_u32_u24 v228, 12288, v247
    v_lshl_add_u32 v228, v246, 7, v228
    v_xor_b32 v247, v251, v245
    v_lshl_add_u32 v228, v247, 4, v228
    v_subrev_u32 v228, 1024, v228
    v_lshlrev_b32 v225, 7, v250
    v_lshl_add_u32 v225, v247, 4, v225
    v_add_u32 v247, 16, v250
    v_mul_u32_u24 v245, 43, v247
    v_lshrrev_b32 v245, 7, v245
    v_mul_u32_u24 v246, 3, v245
    v_sub_u32 v246, v247, v246
    v_lshrrev_b32 v247, 2, v245
    v_lshlrev_b32 v247, 3, v247
    v_and_b32 v248, 3, v245
    v_add_u32 v247, v247, v248
    v_mul_u32_u24 v229, 12288, v247
    v_lshl_add_u32 v229, v246, 7, v229
    v_xor_b32 v247, v251, v245
    v_lshl_add_u32 v229, v247, 4, v229
    v_subrev_u32 v229, 2048, v229
    v_lshlrev_b32 v226, 7, v250
    v_lshl_add_u32 v226, v247, 4, v226
    v_mul_u32_u24 v230, 1280, v250
    v_xor_b32 v247, v251, v250
    v_lshl_add_u32 v230, v247, 4, v230
    v_add_u32 v231, 9216, v230
    v_add_u32 v232, 18432, v230
    v_add_u32 v233, 27648, v230
    s_add_u32 s58, s71, s67
    s_add_u32 m0, s8, 53248
    s_nop 0
    buffer_load_dwordx4 v227, s[36:39], s58 offen offset:0 lds
    buffer_load_dwordx4 v228, s[36:39], s58 offen offset:1024 lds
    buffer_load_dwordx4 v229, s[36:39], s58 offen offset:2048 lds
    s_add_u32 s67, s67, 393216
    s_cmp_ge_u32 s67, 7864320
    s_cselect_b32 s67, 0, s67
    s_add_u32 s59, s74, s68
    s_add_u32 m0, s70, 0
    s_nop 0
    buffer_load_dwordx4 v230, s[32:35], s59 offen offset:0 lds
    buffer_load_dwordx4 v231, s[32:35], s59 offen offset:1024 lds
    buffer_load_dwordx4 v232, s[32:35], s59 offen offset:2048 lds
    buffer_load_dwordx4 v233, s[32:35], s59 offen offset:3072 lds
    s_add_u32 s59, s59, 40960
    s_add_u32 m0, s70, 4096
    s_nop 0
    buffer_load_dwordx4 v230, s[32:35], s59 offen offset:0 lds
    buffer_load_dwordx4 v231, s[32:35], s59 offen offset:1024 lds
    buffer_load_dwordx4 v232, s[32:35], s59 offen offset:2048 lds
    buffer_load_dwordx4 v233, s[32:35], s59 offen offset:3072 lds
    s_add_u32 s59, s59, 40960
    s_add_u32 m0, s70, 8192
    s_nop 0
    buffer_load_dwordx4 v230, s[32:35], s59 offen offset:0 lds
    buffer_load_dwordx4 v231, s[32:35], s59 offen offset:1024 lds
    s_add_u32 s68, s68, 128
    s_cmp_ge_u32 s68, 1280
    s_cselect_b32 s68, 0, s68
    s_add_u32 s58, s71, s67
    s_add_u32 m0, s8, 65536
    s_nop 0
    buffer_load_dwordx4 v227, s[36:39], s58 offen offset:0 lds
    buffer_load_dwordx4 v228, s[36:39], s58 offen offset:1024 lds
    buffer_load_dwordx4 v229, s[36:39], s58 offen offset:2048 lds
    s_add_u32 s67, s67, 393216
    s_cmp_ge_u32 s67, 7864320
    s_cselect_b32 s67, 0, s67
    s_add_u32 s58, s71, s67
    s_add_u32 m0, s8, 40960
    s_nop 0
    buffer_load_dwordx4 v227, s[36:39], s58 offen offset:0 lds
    buffer_load_dwordx4 v228, s[36:39], s58 offen offset:1024 lds
    buffer_load_dwordx4 v229, s[36:39], s58 offen offset:2048 lds
    s_add_u32 s67, s67, 393216
    s_cmp_ge_u32 s67, 7864320
    s_cselect_b32 s67, 0, s67
    s_add_u32 s59, s74, s68
    s_add_u32 m0, s70, 20480
    s_nop 0
    buffer_load_dwordx4 v230, s[32:35], s59 offen offset:0 lds
    buffer_load_dwordx4 v231, s[32:35], s59 offen offset:1024 lds
    buffer_load_dwordx4 v232, s[32:35], s59 offen offset:2048 lds
    buffer_load_dwordx4 v233, s[32:35], s59 offen offset:3072 lds
    s_add_u32 s59, s59, 40960
    s_add_u32 m0, s70, 24576
    s_nop 0
    buffer_load_dwordx4 v230, s[32:35], s59 offen offset:0 lds
    buffer_load_dwordx4 v231, s[32:35], s59 offen offset:1024 lds
    buffer_load_dwordx4 v232, s[32:35], s59 offen offset:2048 lds
    buffer_load_dwordx4 v233, s[32:35], s59 offen offset:3072 lds
    s_add_u32 s59, s59, 40960
    s_add_u32 m0, s70, 28672
    s_nop 0
    buffer_load_dwordx4 v230, s[32:35], s59 offen offset:0 lds
    buffer_load_dwordx4 v231, s[32:35], s59 offen offset:1024 lds
    s_add_u32 s68, s68, 128
    s_cmp_ge_u32 s68, 1280
    s_cselect_b32 s68, 0, s68
    v_lshrrev_b32 v245, 2, v235
    v_mul_u32_u24 v241, 384, v245
    v_and_b32 v245, 7, v245
    v_bfe_u32 v246, v235, 1, 1
    v_add_u32 v246, 0, v246
    v_xor_b32 v246, v246, v245
    v_lshl_add_u32 v241, v246, 4, v241
    v_and_b32 v247, 1, v235
    v_lshl_add_u32 v241, v247, 3, v241
    v_add_u32 v241, 40960, v241
    v_add_u32 v218, s6, v241
    v_lshrrev_b32 v245, 2, v235
    v_mul_u32_u24 v242, 384, v245
    v_and_b32 v245, 7, v245
    v_bfe_u32 v246, v235, 1, 1
    v_add_u32 v246, 2, v246
    v_xor_b32 v246, v246, v245
    v_lshl_add_u32 v242, v246, 4, v242
    v_and_b32 v247, 1, v235
    v_lshl_add_u32 v242, v247, 3, v242
    v_add_u32 v242, 40960, v242
    v_add_u32 v219, s6, v242
    v_lshrrev_b32 v245, 2, v235
    v_mul_u32_u24 v243, 384, v245
    v_and_b32 v245, 7, v245
    v_bfe_u32 v246, v235, 1, 1
    v_add_u32 v246, 4, v246
    v_xor_b32 v246, v246, v245
    v_lshl_add_u32 v243, v246, 4, v243
    v_and_b32 v247, 1, v235
    v_lshl_add_u32 v243, v247, 3, v243
    v_add_u32 v243, 40960, v243
    v_add_u32 v220, s6, v243
    v_lshrrev_b32 v245, 2, v235
    v_mul_u32_u24 v244, 384, v245
    v_and_b32 v245, 7, v245
    v_bfe_u32 v246, v235, 1, 1
    v_add_u32 v246, 6, v246
    v_xor_b32 v246, v246, v245
    v_lshl_add_u32 v244, v246, 4, v244
    v_and_b32 v247, 1, v235
    v_lshl_add_u32 v244, v247, 3, v244
    v_add_u32 v244, 40960, v244
    v_add_u32 v221, s6, v244
    v_and_b32 v245, 15, v235
    v_mul_u32_u24 v222, 128, v245
    v_lshrrev_b32 v245, 4, v235
    v_add_u32 v245, 0, v245
    v_and_b32 v246, 7, v235
    v_xor_b32 v245, v245, v246
    v_lshl_add_u32 v222, v245, 4, v222
    v_add_u32 v222, s70, v222
    v_and_b32 v245, 15, v235
    v_mul_u32_u24 v216, 384, v245
    v_lshrrev_b32 v245, 4, v235
    v_add_u32 v245, 0, v245
    v_and_b32 v246, 7, v235
    v_xor_b32 v245, v245, v246
    v_lshl_add_u32 v216, v245, 4, v216
    v_add_u32 v216, s6, v216
    v_and_b32 v245, 15, v235
    v_mul_u32_u24 v223, 128, v245
    v_lshrrev_b32 v245, 4, v235
    v_add_u32 v245, 4, v245
    v_and_b32 v246, 7, v235
    v_xor_b32 v245, v245, v246
    v_lshl_add_u32 v223, v245, 4, v223
    v_add_u32 v223, s70, v223
    v_and_b32 v245, 15, v235
    v_mul_u32_u24 v217, 384, v245
    v_lshrrev_b32 v245, 4, v235
    v_add_u32 v245, 4, v245
    v_and_b32 v246, 7, v235
    v_xor_b32 v245, v245, v246
    v_lshl_add_u32 v217, v245, 4, v217
    v_add_u32 v217, s6, v217
    v_lshlrev_b32 v234, 4, v235
    s_mul_i32 s4, s9, 5120
    v_add_u32 v234, s4, v234
    v_cmp_eq_u32 vcc, 0, v235
    v_mov_b32 v205, 0x7f000000
    s_nop 0
    v_cndmask_b32 v205, v205, 0, vcc
    s_or_b32 s3, s2, s56
    s_cmp_lg_u32 s3, 0
    s_cbranch_scc1 L_qp_wait
    v_mul_u32_u24 v245, 4352, v235
    v_mov_b32 v246, 0
    s_mov_b32 s3, 133169152
    buffer_store_dword v246, v245, s[48:51], s3 offen sc1
    v_mov_b32 v206, 1
    s_waitcnt vmcnt(0) lgkmcnt(0)
    buffer_atomic_add v206, v205, s[84:87], 0 offen sc1
L_qp_wait:
    s_waitcnt vmcnt(0) lgkmcnt(0)
L_qp_go:
    s_barrier
    ds_read_b128 v[120:123], v222 offset:0
    ds_read_b128 v[124:127], v222 offset:2048
    ds_read_b128 v[128:131], v222 offset:4096
    ds_read_b128 v[132:135], v222 offset:6144
    ds_read_b128 v[136:139], v222 offset:8192
    ds_read_b64_tr_b16 a[240:241], v241 offset:12288
    ds_read_b64_tr_b16 a[242:243], v241 offset:18432
    ds_read_b64_tr_b16 a[244:245], v242 offset:12288
    ds_read_b64_tr_b16 a[246:247], v242 offset:18432
    ds_read_b64_tr_b16 a[248:249], v243 offset:12288
    ds_read_b64_tr_b16 a[250:251], v243 offset:18432
    ds_read_b64_tr_b16 a[252:253], v244 offset:12288
    ds_read_b64_tr_b16 a[254:255], v244 offset:18432
    s_waitcnt lgkmcnt(4)
    v_mfma_f32_16x16x32_bf16 v[0:3], a[240:243], v[120:123], 0
    ds_read_b64_tr_b16 v[208:209], v241 offset:12416
    v_mfma_f32_16x16x32_bf16 v[8:11], a[240:243], v[124:127], 0
    v_mfma_f32_16x16x32_bf16 v[16:19], a[240:243], v[128:131], 0
    ds_read_b64_tr_b16 v[210:211], v241 offset:18560
    v_mfma_f32_16x16x32_bf16 v[24:27], a[240:243], v[132:135], 0
    v_mfma_f32_16x16x32_bf16 v[32:35], a[240:243], v[136:139], 0
    ds_read_b64_tr_b16 v[212:213], v242 offset:12416
    v_mfma_f32_16x16x32_bf16 v[4:7], a[244:247], v[120:123], 0
    v_mfma_f32_16x16x32_bf16 v[12:15], a[244:247], v[124:127], 0
    ds_read_b64_tr_b16 v[214:215], v242 offset:18560
    v_mfma_f32_16x16x32_bf16 v[20:23], a[244:247], v[128:131], 0
    v_mfma_f32_16x16x32_bf16 v[28:31], a[244:247], v[132:135], 0
    v_mfma_f32_16x16x32_bf16 v[36:39], a[244:247], v[136:139], 0
    s_waitcnt lgkmcnt(4)
    v_mfma_f32_16x16x32_bf16 v[40:43], a[248:251], v[120:123], 0
    ds_read_b64_tr_b16 a[240:241], v243 offset:12416
    v_mfma_f32_16x16x32_bf16 v[48:51], a[248:251], v[124:127], 0
    v_mfma_f32_16x16x32_bf16 v[56:59], a[248:251], v[128:131], 0
    ds_read_b64_tr_b16 a[242:243], v243 offset:18560
    v_mfma_f32_16x16x32_bf16 v[64:67], a[248:251], v[132:135], 0
    v_mfma_f32_16x16x32_bf16 v[72:75], a[248:251], v[136:139], 0
    ds_read_b64_tr_b16 a[244:245], v244 offset:12416
    v_mfma_f32_16x16x32_bf16 v[44:47], a[252:255], v[120:123], 0
    v_mfma_f32_16x16x32_bf16 v[52:55], a[252:255], v[124:127], 0
    ds_read_b64_tr_b16 a[246:247], v244 offset:18560
    v_mfma_f32_16x16x32_bf16 v[60:63], a[252:255], v[128:131], 0
    v_mfma_f32_16x16x32_bf16 v[68:71], a[252:255], v[132:135], 0
    v_mfma_f32_16x16x32_bf16 v[76:79], a[252:255], v[136:139], 0
    s_waitcnt lgkmcnt(4)
    v_mfma_f32_16x16x32_bf16 v[80:83], v[208:211], v[120:123], 0
    ds_read_b64_tr_b16 a[248:249], v241 offset:12544
    v_mfma_f32_16x16x32_bf16 v[88:91], v[208:211], v[124:127], 0
    v_mfma_f32_16x16x32_bf16 v[96:99], v[208:211], v[128:131], 0
    ds_read_b64_tr_b16 a[250:251], v241 offset:18688
    v_mfma_f32_16x16x32_bf16 v[104:107], v[208:211], v[132:135], 0
    v_mfma_f32_16x16x32_bf16 v[112:115], v[208:211], v[136:139], 0
    ds_read_b64_tr_b16 a[252:253], v242 offset:12544
    v_mfma_f32_16x16x32_bf16 v[84:87], v[212:215], v[120:123], 0
    v_mfma_f32_16x16x32_bf16 v[92:95], v[212:215], v[124:127], 0
    ds_read_b64_tr_b16 a[254:255], v242 offset:18688
    v_mfma_f32_16x16x32_bf16 v[100:103], v[212:215], v[128:131], 0
    v_mfma_f32_16x16x32_bf16 v[108:111], v[212:215], v[132:135], 0
    v_mfma_f32_16x16x32_bf16 v[116:119], v[212:215], v[136:139], 0
    s_waitcnt lgkmcnt(4)
    v_mfma_f32_16x16x32_bf16 a[0:3], a[240:243], v[120:123], 0
    ds_read_b64_tr_b16 v[208:209], v243 offset:12544
    v_mfma_f32_16x16x32_bf16 a[4:7], a[240:243], v[124:127], 0
    ds_read_b64_tr_b16 v[210:211], v243 offset:18688
    v_mfma_f32_16x16x32_bf16 a[8:11], a[240:243], v[128:131], 0
    ds_read_b64_tr_b16 v[212:213], v244 offset:12544
    v_mfma_f32_16x16x32_bf16 a[12:15], a[240:243], v[132:135], 0
    ds_read_b64_tr_b16 v[214:215], v244 offset:18688
    v_mfma_f32_16x16x32_bf16 a[16:19], a[240:243], v[136:139], 0
    v_mfma_f32_16x16x32_bf16 a[20:23], a[244:247], v[120:123], 0
    v_mfma_f32_16x16x32_bf16 a[24:27], a[244:247], v[124:127], 0
    v_mfma_f32_16x16x32_bf16 a[28:31], a[244:247], v[128:131], 0
    v_mfma_f32_16x16x32_bf16 a[32:35], a[244:247], v[132:135], 0
    v_mfma_f32_16x16x32_bf16 a[36:39], a[244:247], v[136:139], 0
    s_waitcnt vmcnt(43) lgkmcnt(0)
    s_barrier
    v_mfma_f32_16x16x32_bf16 a[40:43], a[248:251], v[120:123], 0
    ds_read_b64_tr_b16 a[240:241], v241 offset:24576
    s_add_u32 s58, s71, s67
    v_mfma_f32_16x16x32_bf16 a[44:47], a[248:251], v[124:127], 0
    ds_read_b128 v[140:143], v223 offset:0
    s_add_u32 m0, s8, 53248
    v_mfma_f32_16x16x32_bf16 a[48:51], a[248:251], v[128:131], 0
    ds_read_b64_tr_b16 a[242:243], v241 offset:30720
    v_mfma_f32_16x16x32_bf16 a[52:55], a[248:251], v[132:135], 0
    ds_read_b128 v[144:147], v223 offset:2048
    v_mfma_f32_16x16x32_bf16 a[56:59], a[248:251], v[136:139], 0
    ds_read_b64_tr_b16 a[244:245], v242 offset:24576
    v_mfma_f32_16x16x32_bf16 a[60:63], a[252:255], v[120:123], 0
    ds_read_b128 v[148:151], v223 offset:4096
    v_mfma_f32_16x16x32_bf16 a[64:67], a[252:255], v[124:127], 0
    ds_read_b64_tr_b16 a[246:247], v242 offset:30720
    v_mfma_f32_16x16x32_bf16 a[68:71], a[252:255], v[128:131], 0
    ds_read_b128 v[152:155], v223 offset:6144
    v_mfma_f32_16x16x32_bf16 a[72:75], a[252:255], v[132:135], 0
    ds_read_b128 v[156:159], v223 offset:8192
    v_mfma_f32_16x16x32_bf16 a[76:79], a[252:255], v[136:139], 0
    buffer_load_dwordx4 v227, s[36:39], s58 offen offset:0 lds
    v_mfma_f32_16x16x32_bf16 a[80:83], v[208:211], v[120:123], 0
    ds_read_b64_tr_b16 a[248:249], v243 offset:24576
    v_mfma_f32_16x16x32_bf16 a[84:87], v[208:211], v[124:127], 0
    v_mfma_f32_16x16x32_bf16 a[88:91], v[208:211], v[128:131], 0
    ds_read_b64_tr_b16 a[250:251], v243 offset:30720
    v_mfma_f32_16x16x32_bf16 a[92:95], v[208:211], v[132:135], 0
    buffer_load_dwordx4 v228, s[36:39], s58 offen offset:1024 lds
    v_mfma_f32_16x16x32_bf16 a[96:99], v[208:211], v[136:139], 0
    ds_read_b64_tr_b16 a[252:253], v244 offset:24576
    v_mfma_f32_16x16x32_bf16 a[100:103], v[212:215], v[120:123], 0
    v_mfma_f32_16x16x32_bf16 a[104:107], v[212:215], v[124:127], 0
    ds_read_b64_tr_b16 a[254:255], v244 offset:30720
    v_mfma_f32_16x16x32_bf16 a[108:111], v[212:215], v[128:131], 0
    buffer_load_dwordx4 v229, s[36:39], s58 offen offset:2048 lds
    v_mfma_f32_16x16x32_bf16 a[112:115], v[212:215], v[132:135], 0
    s_add_u32 s67, s67, 393216
    s_cmp_ge_u32 s67, 7864320
    s_cselect_b32 s67, 0, s67
    v_mfma_f32_16x16x32_bf16 a[116:119], v[212:215], v[136:139], 0
    s_waitcnt lgkmcnt(6)
    v_mfma_f32_16x16x32_bf16 v[0:3], a[240:243], v[140:143], v[0:3]
    ds_read_b64_tr_b16 v[208:209], v241 offset:24704
    v_mfma_f32_16x16x32_bf16 v[8:11], a[240:243], v[144:147], v[8:11]
    v_mfma_f32_16x16x32_bf16 v[16:19], a[240:243], v[148:151], v[16:19]
    ds_read_b64_tr_b16 v[210:211], v241 offset:30848
    s_waitcnt lgkmcnt(7)
    v_mfma_f32_16x16x32_bf16 v[24:27], a[240:243], v[152:155], v[24:27]
    s_waitcnt lgkmcnt(6)
    v_mfma_f32_16x16x32_bf16 v[32:35], a[240:243], v[156:159], v[32:35]
    ds_read_b64_tr_b16 v[212:213], v242 offset:24704
    v_mfma_f32_16x16x32_bf16 v[4:7], a[244:247], v[140:143], v[4:7]
    v_mfma_f32_16x16x32_bf16 v[12:15], a[244:247], v[144:147], v[12:15]
    ds_read_b64_tr_b16 v[214:215], v242 offset:30848
    v_mfma_f32_16x16x32_bf16 v[20:23], a[244:247], v[148:151], v[20:23]
    v_mfma_f32_16x16x32_bf16 v[28:31], a[244:247], v[152:155], v[28:31]
    v_mfma_f32_16x16x32_bf16 v[36:39], a[244:247], v[156:159], v[36:39]
    s_waitcnt lgkmcnt(4)
    v_mfma_f32_16x16x32_bf16 v[40:43], a[248:251], v[140:143], v[40:43]
    ds_read_b64_tr_b16 a[240:241], v243 offset:24704
    v_mfma_f32_16x16x32_bf16 v[48:51], a[248:251], v[144:147], v[48:51]
    v_mfma_f32_16x16x32_bf16 v[56:59], a[248:251], v[148:151], v[56:59]
    ds_read_b64_tr_b16 a[242:243], v243 offset:30848
    v_mfma_f32_16x16x32_bf16 v[64:67], a[248:251], v[152:155], v[64:67]
    v_mfma_f32_16x16x32_bf16 v[72:75], a[248:251], v[156:159], v[72:75]
    ds_read_b64_tr_b16 a[244:245], v244 offset:24704
    v_mfma_f32_16x16x32_bf16 v[44:47], a[252:255], v[140:143], v[44:47]
    v_mfma_f32_16x16x32_bf16 v[52:55], a[252:255], v[144:147], v[52:55]
    ds_read_b64_tr_b16 a[246:247], v244 offset:30848
    v_mfma_f32_16x16x32_bf16 v[60:63], a[252:255], v[148:151], v[60:63]
    v_mfma_f32_16x16x32_bf16 v[68:71], a[252:255], v[152:155], v[68:71]
    v_mfma_f32_16x16x32_bf16 v[76:79], a[252:255], v[156:159], v[76:79]
    s_waitcnt lgkmcnt(4)
    v_mfma_f32_16x16x32_bf16 v[80:83], v[208:211], v[140:143], v[80:83]
    ds_read_b64_tr_b16 a[248:249], v241 offset:24832
    v_mfma_f32_16x16x32_bf16 v[88:91], v[208:211], v[144:147], v[88:91]
    v_mfma_f32_16x16x32_bf16 v[96:99], v[208:211], v[148:151], v[96:99]
    ds_read_b64_tr_b16 a[250:251], v241 offset:30976
    v_mfma_f32_16x16x32_bf16 v[104:107], v[208:211], v[152:155], v[104:107]
    v_mfma_f32_16x16x32_bf16 v[112:115], v[208:211], v[156:159], v[112:115]
    ds_read_b64_tr_b16 a[252:253], v242 offset:24832
    v_mfma_f32_16x16x32_bf16 v[84:87], v[212:215], v[140:143], v[84:87]
    v_mfma_f32_16x16x32_bf16 v[92:95], v[212:215], v[144:147], v[92:95]
    ds_read_b64_tr_b16 a[254:255], v242 offset:30976
    v_mfma_f32_16x16x32_bf16 v[100:103], v[212:215], v[148:151], v[100:103]
    v_mfma_f32_16x16x32_bf16 v[108:111], v[212:215], v[152:155], v[108:111]
    v_mfma_f32_16x16x32_bf16 v[116:119], v[212:215], v[156:159], v[116:119]
    s_waitcnt lgkmcnt(4)
    v_mfma_f32_16x16x32_bf16 a[0:3], a[240:243], v[140:143], a[0:3]
    ds_read_b64_tr_b16 v[208:209], v243 offset:24832
    v_mfma_f32_16x16x32_bf16 a[4:7], a[240:243], v[144:147], a[4:7]
    ds_read_b64_tr_b16 v[210:211], v243 offset:30976
    v_mfma_f32_16x16x32_bf16 a[8:11], a[240:243], v[148:151], a[8:11]
    ds_read_b64_tr_b16 v[212:213], v244 offset:24832
    v_mfma_f32_16x16x32_bf16 a[12:15], a[240:243], v[152:155], a[12:15]
    ds_read_b64_tr_b16 v[214:215], v244 offset:30976
    v_mfma_f32_16x16x32_bf16 a[16:19], a[240:243], v[156:159], a[16:19]
    v_mfma_f32_16x16x32_bf16 a[20:23], a[244:247], v[140:143], a[20:23]
    v_mfma_f32_16x16x32_bf16 a[24:27], a[244:247], v[144:147], a[24:27]
    v_mfma_f32_16x16x32_bf16 a[28:31], a[244:247], v[148:151], a[28:31]
    v_mfma_f32_16x16x32_bf16 a[32:35], a[244:247], v[152:155], a[32:35]
    v_mfma_f32_16x16x32_bf16 a[36:39], a[244:247], v[156:159], a[36:39]
    s_waitcnt vmcnt(33) lgkmcnt(0)
    s_barrier
    v_mfma_f32_16x16x32_bf16 a[40:43], a[248:251], v[140:143], a[40:43]
    ds_read_b64_tr_b16 a[240:241], v241 offset:0
    s_add_u32 s58, s71, s67
    v_mfma_f32_16x16x32_bf16 a[44:47], a[248:251], v[144:147], a[44:47]
    ds_read_b128 v[120:123], v222 offset:20480
    s_add_u32 m0, s8, 65536
    v_mfma_f32_16x16x32_bf16 a[48:51], a[248:251], v[148:151], a[48:51]
    ds_read_b64_tr_b16 a[242:243], v241 offset:6144
    v_mfma_f32_16x16x32_bf16 a[52:55], a[248:251], v[152:155], a[52:55]
    ds_read_b128 v[124:127], v222 offset:22528
    v_mfma_f32_16x16x32_bf16 a[56:59], a[248:251], v[156:159], a[56:59]
    ds_read_b64_tr_b16 a[244:245], v242 offset:0
    v_mfma_f32_16x16x32_bf16 a[60:63], a[252:255], v[140:143], a[60:63]
    ds_read_b128 v[128:131], v222 offset:24576
    v_mfma_f32_16x16x32_bf16 a[64:67], a[252:255], v[144:147], a[64:67]
    ds_read_b64_tr_b16 a[246:247], v242 offset:6144
    v_mfma_f32_16x16x32_bf16 a[68:71], a[252:255], v[148:151], a[68:71]
    ds_read_b128 v[132:135], v222 offset:26624
    v_mfma_f32_16x16x32_bf16 a[72:75], a[252:255], v[152:155], a[72:75]
    ds_read_b128 v[136:139], v222 offset:28672
    v_mfma_f32_16x16x32_bf16 a[76:79], a[252:255], v[156:159], a[76:79]
    buffer_load_dwordx4 v227, s[36:39], s58 offen offset:0 lds
    v_mfma_f32_16x16x32_bf16 a[80:83], v[208:211], v[140:143], a[80:83]
    ds_read_b64_tr_b16 a[248:249], v243 offset:0
    v_mfma_f32_16x16x32_bf16 a[84:87], v[208:211], v[144:147], a[84:87]
    v_mfma_f32_16x16x32_bf16 a[88:91], v[208:211], v[148:151], a[88:91]
    ds_read_b64_tr_b16 a[250:251], v243 offset:6144
    v_mfma_f32_16x16x32_bf16 a[92:95], v[208:211], v[152:155], a[92:95]
    v_mfma_f32_16x16x32_bf16 a[96:99], v[208:211], v[156:159], a[96:99]
    ds_read_b64_tr_b16 a[252:253], v244 offset:0
    v_mfma_f32_16x16x32_bf16 a[100:103], v[212:215], v[140:143], a[100:103]
    buffer_load_dwordx4 v228, s[36:39], s58 offen offset:1024 lds
    v_mfma_f32_16x16x32_bf16 a[104:107], v[212:215], v[144:147], a[104:107]
    ds_read_b64_tr_b16 a[254:255], v244 offset:6144
    v_mfma_f32_16x16x32_bf16 a[108:111], v[212:215], v[148:151], a[108:111]
    v_mfma_f32_16x16x32_bf16 a[112:115], v[212:215], v[152:155], a[112:115]
    v_mfma_f32_16x16x32_bf16 a[116:119], v[212:215], v[156:159], a[116:119]
    s_waitcnt lgkmcnt(6)
    v_mfma_f32_16x16x32_bf16 v[0:3], a[240:243], v[120:123], v[0:3]
    ds_read_b64_tr_b16 v[208:209], v241 offset:128
    v_mfma_f32_16x16x32_bf16 v[8:11], a[240:243], v[124:127], v[8:11]
    buffer_load_dwordx4 v229, s[36:39], s58 offen offset:2048 lds
    v_mfma_f32_16x16x32_bf16 v[16:19], a[240:243], v[128:131], v[16:19]
    ds_read_b64_tr_b16 v[210:211], v241 offset:6272
    s_waitcnt lgkmcnt(7)
    v_mfma_f32_16x16x32_bf16 v[24:27], a[240:243], v[132:135], v[24:27]
    s_add_u32 s67, s67, 393216
    s_cmp_ge_u32 s67, 7864320
    s_cselect_b32 s67, 0, s67
    s_waitcnt lgkmcnt(6)
    v_mfma_f32_16x16x32_bf16 v[32:35], a[240:243], v[136:139], v[32:35]
    ds_read_b64_tr_b16 v[212:213], v242 offset:128
    s_add_u32 s59, s74, s68
    v_mfma_f32_16x16x32_bf16 v[4:7], a[244:247], v[120:123], v[4:7]
    s_add_u32 m0, s70, 0
    v_mfma_f32_16x16x32_bf16 v[12:15], a[244:247], v[124:127], v[12:15]
    ds_read_b64_tr_b16 v[214:215], v242 offset:6272
    v_mfma_f32_16x16x32_bf16 v[20:23], a[244:247], v[128:131], v[20:23]
    buffer_load_dwordx4 v230, s[32:35], s59 offen offset:0 lds
    v_mfma_f32_16x16x32_bf16 v[28:31], a[244:247], v[132:135], v[28:31]
    v_mfma_f32_16x16x32_bf16 v[36:39], a[244:247], v[136:139], v[36:39]
    s_waitcnt lgkmcnt(4)
    v_mfma_f32_16x16x32_bf16 v[40:43], a[248:251], v[120:123], v[40:43]
    ds_read_b64_tr_b16 a[240:241], v243 offset:128
    v_mfma_f32_16x16x32_bf16 v[48:51], a[248:251], v[124:127], v[48:51]
    v_mfma_f32_16x16x32_bf16 v[56:59], a[248:251], v[128:131], v[56:59]
    ds_read_b64_tr_b16 a[242:243], v243 offset:6272
    v_mfma_f32_16x16x32_bf16 v[64:67], a[248:251], v[132:135], v[64:67]
    buffer_load_dwordx4 v231, s[32:35], s59 offen offset:1024 lds
    v_mfma_f32_16x16x32_bf16 v[72:75], a[248:251], v[136:139], v[72:75]
    ds_read_b64_tr_b16 a[244:245], v244 offset:128
    v_mfma_f32_16x16x32_bf16 v[44:47], a[252:255], v[120:123], v[44:47]
    v_mfma_f32_16x16x32_bf16 v[52:55], a[252:255], v[124:127], v[52:55]
    ds_read_b64_tr_b16 a[246:247], v244 offset:6272
    v_mfma_f32_16x16x32_bf16 v[60:63], a[252:255], v[128:131], v[60:63]
    v_mfma_f32_16x16x32_bf16 v[68:71], a[252:255], v[132:135], v[68:71]
    buffer_load_dwordx4 v232, s[32:35], s59 offen offset:2048 lds
    v_mfma_f32_16x16x32_bf16 v[76:79], a[252:255], v[136:139], v[76:79]
    s_waitcnt lgkmcnt(4)
    v_mfma_f32_16x16x32_bf16 v[80:83], v[208:211], v[120:123], v[80:83]
    ds_read_b64_tr_b16 a[248:249], v241 offset:256
    v_mfma_f32_16x16x32_bf16 v[88:91], v[208:211], v[124:127], v[88:91]
    v_mfma_f32_16x16x32_bf16 v[96:99], v[208:211], v[128:131], v[96:99]
    ds_read_b64_tr_b16 a[250:251], v241 offset:6400
    v_mfma_f32_16x16x32_bf16 v[104:107], v[208:211], v[132:135], v[104:107]
    buffer_load_dwordx4 v233, s[32:35], s59 offen offset:3072 lds
    s_add_u32 s59, s59, 40960
    v_mfma_f32_16x16x32_bf16 v[112:115], v[208:211], v[136:139], v[112:115]
    ds_read_b64_tr_b16 a[252:253], v242 offset:256
    v_mfma_f32_16x16x32_bf16 v[84:87], v[212:215], v[120:123], v[84:87]
    v_mfma_f32_16x16x32_bf16 v[92:95], v[212:215], v[124:127], v[92:95]
    ds_read_b64_tr_b16 a[254:255], v242 offset:6400
    v_mfma_f32_16x16x32_bf16 v[100:103], v[212:215], v[128:131], v[100:103]
    v_mfma_f32_16x16x32_bf16 v[108:111], v[212:215], v[132:135], v[108:111]
    v_mfma_f32_16x16x32_bf16 v[116:119], v[212:215], v[136:139], v[116:119]
    s_waitcnt lgkmcnt(4)
    v_mfma_f32_16x16x32_bf16 a[0:3], a[240:243], v[120:123], a[0:3]
    ds_read_b64_tr_b16 v[208:209], v243 offset:256
    v_mfma_f32_16x16x32_bf16 a[4:7], a[240:243], v[124:127], a[4:7]
    ds_read_b64_tr_b16 v[210:211], v243 offset:6400
    v_mfma_f32_16x16x32_bf16 a[8:11], a[240:243], v[128:131], a[8:11]
    ds_read_b64_tr_b16 v[212:213], v244 offset:256
    v_mfma_f32_16x16x32_bf16 a[12:15], a[240:243], v[132:135], a[12:15]
    ds_read_b64_tr_b16 v[214:215], v244 offset:6400
    v_mfma_f32_16x16x32_bf16 a[16:19], a[240:243], v[136:139], a[16:19]
    v_mfma_f32_16x16x32_bf16 a[20:23], a[244:247], v[120:123], a[20:23]
    v_mfma_f32_16x16x32_bf16 a[24:27], a[244:247], v[124:127], a[24:27]
    v_mfma_f32_16x16x32_bf16 a[28:31], a[244:247], v[128:131], a[28:31]
    v_mfma_f32_16x16x32_bf16 a[32:35], a[244:247], v[132:135], a[32:35]
    v_mfma_f32_16x16x32_bf16 a[36:39], a[244:247], v[136:139], a[36:39]
    s_waitcnt vmcnt(7) lgkmcnt(0)
    s_barrier
    v_mfma_f32_16x16x32_bf16 a[40:43], a[248:251], v[120:123], a[40:43]
    ds_read_b64_tr_b16 a[240:241], v241 offset:12288
    s_add_u32 m0, s70, 4096
    v_mfma_f32_16x16x32_bf16 a[44:47], a[248:251], v[124:127], a[44:47]
    ds_read_b128 v[140:143], v223 offset:20480
    v_mfma_f32_16x16x32_bf16 a[48:51], a[248:251], v[128:131], a[48:51]
    ds_read_b64_tr_b16 a[242:243], v241 offset:18432
    v_mfma_f32_16x16x32_bf16 a[52:55], a[248:251], v[132:135], a[52:55]
    ds_read_b128 v[144:147], v223 offset:22528
    v_mfma_f32_16x16x32_bf16 a[56:59], a[248:251], v[136:139], a[56:59]
    ds_read_b64_tr_b16 a[244:245], v242 offset:12288
    v_mfma_f32_16x16x32_bf16 a[60:63], a[252:255], v[120:123], a[60:63]
    ds_read_b128 v[148:151], v223 offset:24576
    v_mfma_f32_16x16x32_bf16 a[64:67], a[252:255], v[124:127], a[64:67]
    ds_read_b64_tr_b16 a[246:247], v242 offset:18432
    v_mfma_f32_16x16x32_bf16 a[68:71], a[252:255], v[128:131], a[68:71]
    ds_read_b128 v[152:155], v223 offset:26624
    v_mfma_f32_16x16x32_bf16 a[72:75], a[252:255], v[132:135], a[72:75]
    ds_read_b128 v[156:159], v223 offset:28672
    v_mfma_f32_16x16x32_bf16 a[76:79], a[252:255], v[136:139], a[76:79]
    buffer_load_dwordx4 v230, s[32:35], s59 offen offset:0 lds
    v_mfma_f32_16x16x32_bf16 a[80:83], v[208:211], v[120:123], a[80:83]
    ds_read_b64_tr_b16 a[248:249], v243 offset:12288
    v_mfma_f32_16x16x32_bf16 a[84:87], v[208:211], v[124:127], a[84:87]
    v_mfma_f32_16x16x32_bf16 a[88:91], v[208:211], v[128:131], a[88:91]
    ds_read_b64_tr_b16 a[250:251], v243 offset:18432
    v_mfma_f32_16x16x32_bf16 a[92:95], v[208:211], v[132:135], a[92:95]
    v_mfma_f32_16x16x32_bf16 a[96:99], v[208:211], v[136:139], a[96:99]
    ds_read_b64_tr_b16 a[252:253], v244 offset:12288
    v_mfma_f32_16x16x32_bf16 a[100:103], v[212:215], v[120:123], a[100:103]
    buffer_load_dwordx4 v231, s[32:35], s59 offen offset:1024 lds
    v_mfma_f32_16x16x32_bf16 a[104:107], v[212:215], v[124:127], a[104:107]
    ds_read_b64_tr_b16 a[254:255], v244 offset:18432
    v_mfma_f32_16x16x32_bf16 a[108:111], v[212:215], v[128:131], a[108:111]
    v_mfma_f32_16x16x32_bf16 a[112:115], v[212:215], v[132:135], a[112:115]
    v_mfma_f32_16x16x32_bf16 a[116:119], v[212:215], v[136:139], a[116:119]
    s_waitcnt lgkmcnt(6)
    v_mfma_f32_16x16x32_bf16 v[0:3], a[240:243], v[140:143], v[0:3]
    ds_read_b64_tr_b16 v[208:209], v241 offset:12416
    v_mfma_f32_16x16x32_bf16 v[8:11], a[240:243], v[144:147], v[8:11]
    buffer_load_dwordx4 v232, s[32:35], s59 offen offset:2048 lds
    v_mfma_f32_16x16x32_bf16 v[16:19], a[240:243], v[148:151], v[16:19]
    ds_read_b64_tr_b16 v[210:211], v241 offset:18560
    s_waitcnt lgkmcnt(7)
    v_mfma_f32_16x16x32_bf16 v[24:27], a[240:243], v[152:155], v[24:27]
    s_waitcnt lgkmcnt(6)
    v_mfma_f32_16x16x32_bf16 v[32:35], a[240:243], v[156:159], v[32:35]
    ds_read_b64_tr_b16 v[212:213], v242 offset:12416
    v_mfma_f32_16x16x32_bf16 v[4:7], a[244:247], v[140:143], v[4:7]
    v_mfma_f32_16x16x32_bf16 v[12:15], a[244:247], v[144:147], v[12:15]
    ds_read_b64_tr_b16 v[214:215], v242 offset:18560
    v_mfma_f32_16x16x32_bf16 v[20:23], a[244:247], v[148:151], v[20:23]
    buffer_load_dwordx4 v233, s[32:35], s59 offen offset:3072 lds
    s_add_u32 s59, s59, 40960
    v_mfma_f32_16x16x32_bf16 v[28:31], a[244:247], v[152:155], v[28:31]
    s_add_u32 m0, s70, 8192
    v_mfma_f32_16x16x32_bf16 v[36:39], a[244:247], v[156:159], v[36:39]
    s_waitcnt lgkmcnt(4)
    v_mfma_f32_16x16x32_bf16 v[40:43], a[248:251], v[140:143], v[40:43]
    ds_read_b64_tr_b16 a[240:241], v243 offset:12416
    v_mfma_f32_16x16x32_bf16 v[48:51], a[248:251], v[144:147], v[48:51]
    v_mfma_f32_16x16x32_bf16 v[56:59], a[248:251], v[148:151], v[56:59]
    ds_read_b64_tr_b16 a[242:243], v243 offset:18560
    v_mfma_f32_16x16x32_bf16 v[64:67], a[248:251], v[152:155], v[64:67]
    buffer_load_dwordx4 v230, s[32:35], s59 offen offset:0 lds
    v_mfma_f32_16x16x32_bf16 v[72:75], a[248:251], v[156:159], v[72:75]
    ds_read_b64_tr_b16 a[244:245], v244 offset:12416
    v_mfma_f32_16x16x32_bf16 v[44:47], a[252:255], v[140:143], v[44:47]
    v_mfma_f32_16x16x32_bf16 v[52:55], a[252:255], v[144:147], v[52:55]
    ds_read_b64_tr_b16 a[246:247], v244 offset:18560
    v_mfma_f32_16x16x32_bf16 v[60:63], a[252:255], v[148:151], v[60:63]
    v_mfma_f32_16x16x32_bf16 v[68:71], a[252:255], v[152:155], v[68:71]
    buffer_load_dwordx4 v231, s[32:35], s59 offen offset:1024 lds
    v_mfma_f32_16x16x32_bf16 v[76:79], a[252:255], v[156:159], v[76:79]
    s_waitcnt lgkmcnt(4)
    v_mfma_f32_16x16x32_bf16 v[80:83], v[208:211], v[140:143], v[80:83]
    ds_read_b64_tr_b16 a[248:249], v241 offset:12544
    v_mfma_f32_16x16x32_bf16 v[88:91], v[208:211], v[144:147], v[88:91]
    s_add_u32 s68, s68, 128
    s_cmp_ge_u32 s68, 1280
    s_cselect_b32 s68, 0, s68
    v_mfma_f32_16x16x32_bf16 v[96:99], v[208:211], v[148:151], v[96:99]
    ds_read_b64_tr_b16 a[250:251], v241 offset:18688
    s_add_u32 s58, s71, s67
    v_mfma_f32_16x16x32_bf16 v[104:107], v[208:211], v[152:155], v[104:107]
    s_add_u32 m0, s8, 40960
    v_mfma_f32_16x16x32_bf16 v[112:115], v[208:211], v[156:159], v[112:115]
    ds_read_b64_tr_b16 a[252:253], v242 offset:12544
    v_mfma_f32_16x16x32_bf16 v[84:87], v[212:215], v[140:143], v[84:87]
    buffer_load_dwordx4 v227, s[36:39], s58 offen offset:0 lds
    v_mfma_f32_16x16x32_bf16 v[92:95], v[212:215], v[144:147], v[92:95]
    ds_read_b64_tr_b16 a[254:255], v242 offset:18688
    v_mfma_f32_16x16x32_bf16 v[100:103], v[212:215], v[148:151], v[100:103]
    v_mfma_f32_16x16x32_bf16 v[108:111], v[212:215], v[152:155], v[108:111]
    v_mfma_f32_16x16x32_bf16 v[116:119], v[212:215], v[156:159], v[116:119]
    s_waitcnt lgkmcnt(4)
    v_mfma_f32_16x16x32_bf16 a[0:3], a[240:243], v[140:143], a[0:3]
    ds_read_b64_tr_b16 v[208:209], v243 offset:12544
    v_mfma_f32_16x16x32_bf16 a[4:7], a[240:243], v[144:147], a[4:7]
    ds_read_b64_tr_b16 v[210:211], v243 offset:18688
    v_mfma_f32_16x16x32_bf16 a[8:11], a[240:243], v[148:151], a[8:11]
    ds_read_b64_tr_b16 v[212:213], v244 offset:12544
    v_mfma_f32_16x16x32_bf16 a[12:15], a[240:243], v[152:155], a[12:15]
    ds_read_b64_tr_b16 v[214:215], v244 offset:18688
    v_mfma_f32_16x16x32_bf16 a[16:19], a[240:243], v[156:159], a[16:19]
    buffer_load_dwordx4 v228, s[36:39], s58 offen offset:1024 lds
    v_mfma_f32_16x16x32_bf16 a[20:23], a[244:247], v[140:143], a[20:23]
    v_mfma_f32_16x16x32_bf16 a[24:27], a[244:247], v[144:147], a[24:27]
    v_mfma_f32_16x16x32_bf16 a[28:31], a[244:247], v[148:151], a[28:31]
    v_mfma_f32_16x16x32_bf16 a[32:35], a[244:247], v[152:155], a[32:35]
    v_mfma_f32_16x16x32_bf16 a[36:39], a[244:247], v[156:159], a[36:39]
    buffer_load_dwordx4 v229, s[36:39], s58 offen offset:2048 lds
    s_add_u32 s67, s67, 393216
    s_cmp_ge_u32 s67, 7864320
    s_cselect_b32 s67, 0, s67
    s_waitcnt vmcnt(3) lgkmcnt(0)
    s_barrier
    v_mfma_f32_16x16x32_bf16 a[40:43], a[248:251], v[140:143], a[40:43]
    ds_read_b64_tr_b16 a[240:241], v241 offset:24576
    v_mov_b32 v206, s97
    v_mfma_f32_16x16x32_bf16 a[44:47], a[248:251], v[144:147], a[44:47]
    ds_read_b128 v[120:123], v222 offset:0
    v_mfma_f32_16x16x32_bf16 a[48:51], a[248:251], v[148:151], a[48:51]
    ds_read_b64_tr_b16 a[242:243], v241 offset:30720
    v_mfma_f32_16x16x32_bf16 a[52:55], a[248:251], v[152:155], a[52:55]
    ds_read_b128 v[124:127], v222 offset:2048
    v_mfma_f32_16x16x32_bf16 a[56:59], a[248:251], v[156:159], a[56:59]
    ds_read_b64_tr_b16 a[244:245], v242 offset:24576
    v_mfma_f32_16x16x32_bf16 a[60:63], a[252:255], v[140:143], a[60:63]
    ds_read_b128 v[128:131], v222 offset:4096
    v_mfma_f32_16x16x32_bf16 a[64:67], a[252:255], v[144:147], a[64:67]
    ds_read_b64_tr_b16 a[246:247], v242 offset:30720
    v_mfma_f32_16x16x32_bf16 a[68:71], a[252:255], v[148:151], a[68:71]
    ds_read_b128 v[132:135], v222 offset:6144
    v_mfma_f32_16x16x32_bf16 a[72:75], a[252:255], v[152:155], a[72:75]
    ds_read_b128 v[136:139], v222 offset:8192
    v_mfma_f32_16x16x32_bf16 a[76:79], a[252:255], v[156:159], a[76:79]
    buffer_atomic_add v206, v205, s[48:51], s96 offen sc1
    v_mfma_f32_16x16x32_bf16 a[80:83], v[208:211], v[140:143], a[80:83]
    ds_read_b64_tr_b16 a[248:249], v243 offset:24576
    s_mov_b32 s96, 0x7f000000
    v_mfma_f32_16x16x32_bf16 a[84:87], v[208:211], v[144:147], a[84:87]
    s_add_u32 s58, s71, s67
    s_add_u32 m0, s8, 53248
    v_mfma_f32_16x16x32_bf16 a[88:91], v[208:211], v[148:151], a[88:91]
    ds_read_b64_tr_b16 a[250:251], v243 offset:30720
    v_mfma_f32_16x16x32_bf16 a[92:95], v[208:211], v[152:155], a[92:95]
    v_mfma_f32_16x16x32_bf16 a[96:99], v[208:211], v[156:159], a[96:99]
    ds_read_b64_tr_b16 a[252:253], v244 offset:24576
    v_mfma_f32_16x16x32_bf16 a[100:103], v[212:215], v[140:143], a[100:103]
    buffer_load_dwordx4 v227, s[36:39], s58 offen offset:0 lds
    v_mfma_f32_16x16x32_bf16 a[104:107], v[212:215], v[144:147], a[104:107]
    ds_read_b64_tr_b16 a[254:255], v244 offset:30720
    v_mfma_f32_16x16x32_bf16 a[108:111], v[212:215], v[148:151], a[108:111]
    v_mfma_f32_16x16x32_bf16 a[112:115], v[212:215], v[152:155], a[112:115]
    v_mfma_f32_16x16x32_bf16 a[116:119], v[212:215], v[156:159], a[116:119]
    s_waitcnt lgkmcnt(6)
    v_mfma_f32_16x16x32_bf16 v[0:3], a[240:243], v[120:123], v[0:3]
    ds_read_b64_tr_b16 v[208:209], v241 offset:24704
    v_mfma_f32_16x16x32_bf16 v[8:11], a[240:243], v[124:127], v[8:11]
    buffer_load_dwordx4 v228, s[36:39], s58 offen offset:1024 lds
    v_mfma_f32_16x16x32_bf16 v[16:19], a[240:243], v[128:131], v[16:19]
    ds_read_b64_tr_b16 v[210:211], v241 offset:30848
    s_waitcnt lgkmcnt(7)
    v_mfma_f32_16x16x32_bf16 v[24:27], a[240:243], v[132:135], v[24:27]
    s_waitcnt lgkmcnt(6)
    v_mfma_f32_16x16x32_bf16 v[32:35], a[240:243], v[136:139], v[32:35]
    ds_read_b64_tr_b16 v[212:213], v242 offset:24704
    v_mfma_f32_16x16x32_bf16 v[4:7], a[244:247], v[120:123], v[4:7]
    v_mfma_f32_16x16x32_bf16 v[12:15], a[244:247], v[124:127], v[12:15]
    ds_read_b64_tr_b16 v[214:215], v242 offset:30848
    v_mfma_f32_16x16x32_bf16 v[20:23], a[244:247], v[128:131], v[20:23]
    buffer_load_dwordx4 v229, s[36:39], s58 offen offset:2048 lds
    v_mfma_f32_16x16x32_bf16 v[28:31], a[244:247], v[132:135], v[28:31]
    s_add_u32 s67, s67, 393216
    s_cmp_ge_u32 s67, 7864320
    s_cselect_b32 s67, 0, s67
    v_mfma_f32_16x16x32_bf16 v[36:39], a[244:247], v[136:139], v[36:39]
    s_add_u32 s59, s74, s68
    s_waitcnt lgkmcnt(4)
    v_mfma_f32_16x16x32_bf16 v[40:43], a[248:251], v[120:123], v[40:43]
    ds_read_b64_tr_b16 a[240:241], v243 offset:24704
    s_add_u32 m0, s70, 20480
    v_mfma_f32_16x16x32_bf16 v[48:51], a[248:251], v[124:127], v[48:51]
    v_mfma_f32_16x16x32_bf16 v[56:59], a[248:251], v[128:131], v[56:59]
    ds_read_b64_tr_b16 a[242:243], v243 offset:30848
    v_mfma_f32_16x16x32_bf16 v[64:67], a[248:251], v[132:135], v[64:67]
    buffer_load_dwordx4 v230, s[32:35], s59 offen offset:0 lds
    v_mfma_f32_16x16x32_bf16 v[72:75], a[248:251], v[136:139], v[72:75]
    ds_read_b64_tr_b16 a[244:245], v244 offset:24704
    v_mfma_f32_16x16x32_bf16 v[44:47], a[252:255], v[120:123], v[44:47]
    v_mfma_f32_16x16x32_bf16 v[52:55], a[252:255], v[124:127], v[52:55]
    ds_read_b64_tr_b16 a[246:247], v244 offset:30848
    v_mfma_f32_16x16x32_bf16 v[60:63], a[252:255], v[128:131], v[60:63]
    v_mfma_f32_16x16x32_bf16 v[68:71], a[252:255], v[132:135], v[68:71]
    buffer_load_dwordx4 v231, s[32:35], s59 offen offset:1024 lds
    v_mfma_f32_16x16x32_bf16 v[76:79], a[252:255], v[136:139], v[76:79]
    s_waitcnt lgkmcnt(4)
    v_mfma_f32_16x16x32_bf16 v[80:83], v[208:211], v[120:123], v[80:83]
    ds_read_b64_tr_b16 a[248:249], v241 offset:24832
    v_mfma_f32_16x16x32_bf16 v[88:91], v[208:211], v[124:127], v[88:91]
    v_mfma_f32_16x16x32_bf16 v[96:99], v[208:211], v[128:131], v[96:99]
    ds_read_b64_tr_b16 a[250:251], v241 offset:30976
    v_mfma_f32_16x16x32_bf16 v[104:107], v[208:211], v[132:135], v[104:107]
    buffer_load_dwordx4 v232, s[32:35], s59 offen offset:2048 lds
    v_mfma_f32_16x16x32_bf16 v[112:115], v[208:211], v[136:139], v[112:115]
    ds_read_b64_tr_b16 a[252:253], v242 offset:24832
    v_mfma_f32_16x16x32_bf16 v[84:87], v[212:215], v[120:123], v[84:87]
    v_mfma_f32_16x16x32_bf16 v[92:95], v[212:215], v[124:127], v[92:95]
    ds_read_b64_tr_b16 a[254:255], v242 offset:30976
    v_mfma_f32_16x16x32_bf16 v[100:103], v[212:215], v[128:131], v[100:103]
    v_mfma_f32_16x16x32_bf16 v[108:111], v[212:215], v[132:135], v[108:111]
    buffer_load_dwordx4 v233, s[32:35], s59 offen offset:3072 lds
    s_add_u32 s59, s59, 40960
    v_mfma_f32_16x16x32_bf16 v[116:119], v[212:215], v[136:139], v[116:119]
    s_waitcnt lgkmcnt(4)
    v_mfma_f32_16x16x32_bf16 a[0:3], a[240:243], v[120:123], a[0:3]
    ds_read_b64_tr_b16 v[208:209], v243 offset:24832
    v_mfma_f32_16x16x32_bf16 a[4:7], a[240:243], v[124:127], a[4:7]
    ds_read_b64_tr_b16 v[210:211], v243 offset:30976
    v_mfma_f32_16x16x32_bf16 a[8:11], a[240:243], v[128:131], a[8:11]
    ds_read_b64_tr_b16 v[212:213], v244 offset:24832
    v_mfma_f32_16x16x32_bf16 a[12:15], a[240:243], v[132:135], a[12:15]
    ds_read_b64_tr_b16 v[214:215], v244 offset:30976
    v_mfma_f32_16x16x32_bf16 a[16:19], a[240:243], v[136:139], a[16:19]
    v_mfma_f32_16x16x32_bf16 a[20:23], a[244:247], v[120:123], a[20:23]
    v_mfma_f32_16x16x32_bf16 a[24:27], a[244:247], v[124:127], a[24:27]
    v_mfma_f32_16x16x32_bf16 a[28:31], a[244:247], v[128:131], a[28:31]
    v_mfma_f32_16x16x32_bf16 a[32:35], a[244:247], v[132:135], a[32:35]
    v_mfma_f32_16x16x32_bf16 a[36:39], a[244:247], v[136:139], a[36:39]
    s_waitcnt vmcnt(8) lgkmcnt(0)
    s_barrier
    v_mfma_f32_16x16x32_bf16 a[40:43], a[248:251], v[120:123], a[40:43]
    ds_read_b64_tr_b16 a[240:241], v241 offset:0
    s_add_u32 m0, s70, 24576
    v_mfma_f32_16x16x32_bf16 a[44:47], a[248:251], v[124:127], a[44:47]
    ds_read_b128 v[140:143], v223 offset:0
    v_mfma_f32_16x16x32_bf16 a[48:51], a[248:251], v[128:131], a[48:51]
    ds_read_b64_tr_b16 a[242:243], v241 offset:6144
    v_mfma_f32_16x16x32_bf16 a[52:55], a[248:251], v[132:135], a[52:55]
    ds_read_b128 v[144:147], v223 offset:2048
    v_mfma_f32_16x16x32_bf16 a[56:59], a[248:251], v[136:139], a[56:59]
    ds_read_b64_tr_b16 a[244:245], v242 offset:0
    v_mfma_f32_16x16x32_bf16 a[60:63], a[252:255], v[120:123], a[60:63]
    ds_read_b128 v[148:151], v223 offset:4096
    v_mfma_f32_16x16x32_bf16 a[64:67], a[252:255], v[124:127], a[64:67]
    ds_read_b64_tr_b16 a[246:247], v242 offset:6144
    v_mfma_f32_16x16x32_bf16 a[68:71], a[252:255], v[128:131], a[68:71]
    ds_read_b128 v[152:155], v223 offset:6144
    v_mfma_f32_16x16x32_bf16 a[72:75], a[252:255], v[132:135], a[72:75]
    ds_read_b128 v[156:159], v223 offset:8192
    v_mfma_f32_16x16x32_bf16 a[76:79], a[252:255], v[136:139], a[76:79]
    buffer_load_dwordx4 v230, s[32:35], s59 offen offset:0 lds
    v_mfma_f32_16x16x32_bf16 a[80:83], v[208:211], v[120:123], a[80:83]
    ds_read_b64_tr_b16 a[248:249], v243 offset:0
    v_mfma_f32_16x16x32_bf16 a[84:87], v[208:211], v[124:127], a[84:87]
    v_mfma_f32_16x16x32_bf16 a[88:91], v[208:211], v[128:131], a[88:91]
    ds_read_b64_tr_b16 a[250:251], v243 offset:6144
    v_mfma_f32_16x16x32_bf16 a[92:95], v[208:211], v[132:135], a[92:95]
    v_mfma_f32_16x16x32_bf16 a[96:99], v[208:211], v[136:139], a[96:99]
    ds_read_b64_tr_b16 a[252:253], v244 offset:0
    v_mfma_f32_16x16x32_bf16 a[100:103], v[212:215], v[120:123], a[100:103]
    buffer_load_dwordx4 v231, s[32:35], s59 offen offset:1024 lds
    v_mfma_f32_16x16x32_bf16 a[104:107], v[212:215], v[124:127], a[104:107]
    ds_read_b64_tr_b16 a[254:255], v244 offset:6144
    v_mfma_f32_16x16x32_bf16 a[108:111], v[212:215], v[128:131], a[108:111]
    v_mfma_f32_16x16x32_bf16 a[112:115], v[212:215], v[132:135], a[112:115]
    v_mfma_f32_16x16x32_bf16 a[116:119], v[212:215], v[136:139], a[116:119]
    s_waitcnt lgkmcnt(6)
    v_mfma_f32_16x16x32_bf16 v[0:3], a[240:243], v[140:143], v[0:3]
    ds_read_b64_tr_b16 v[208:209], v241 offset:128
    v_mfma_f32_16x16x32_bf16 v[8:11], a[240:243], v[144:147], v[8:11]
    buffer_load_dwordx4 v232, s[32:35], s59 offen offset:2048 lds
    v_mfma_f32_16x16x32_bf16 v[16:19], a[240:243], v[148:151], v[16:19]
    ds_read_b64_tr_b16 v[210:211], v241 offset:6272
    s_waitcnt lgkmcnt(7)
    v_mfma_f32_16x16x32_bf16 v[24:27], a[240:243], v[152:155], v[24:27]
    s_waitcnt lgkmcnt(6)
    v_mfma_f32_16x16x32_bf16 v[32:35], a[240:243], v[156:159], v[32:35]
    ds_read_b64_tr_b16 v[212:213], v242 offset:128
    v_mfma_f32_16x16x32_bf16 v[4:7], a[244:247], v[140:143], v[4:7]
    v_mfma_f32_16x16x32_bf16 v[12:15], a[244:247], v[144:147], v[12:15]
    ds_read_b64_tr_b16 v[214:215], v242 offset:6272
    v_mfma_f32_16x16x32_bf16 v[20:23], a[244:247], v[148:151], v[20:23]
    buffer_load_dwordx4 v233, s[32:35], s59 offen offset:3072 lds
    s_add_u32 s59, s59, 40960
    v_mfma_f32_16x16x32_bf16 v[28:31], a[244:247], v[152:155], v[28:31]
    s_add_u32 m0, s70, 28672
    v_mfma_f32_16x16x32_bf16 v[36:39], a[244:247], v[156:159], v[36:39]
    s_waitcnt lgkmcnt(4)
    v_mfma_f32_16x16x32_bf16 v[40:43], a[248:251], v[140:143], v[40:43]
    ds_read_b64_tr_b16 a[240:241], v243 offset:128
    v_mfma_f32_16x16x32_bf16 v[48:51], a[248:251], v[144:147], v[48:51]
    v_mfma_f32_16x16x32_bf16 v[56:59], a[248:251], v[148:151], v[56:59]
    ds_read_b64_tr_b16 a[242:243], v243 offset:6272
    v_mfma_f32_16x16x32_bf16 v[64:67], a[248:251], v[152:155], v[64:67]
    buffer_load_dwordx4 v230, s[32:35], s59 offen offset:0 lds
    v_mfma_f32_16x16x32_bf16 v[72:75], a[248:251], v[156:159], v[72:75]
    ds_read_b64_tr_b16 a[244:245], v244 offset:128
    v_mfma_f32_16x16x32_bf16 v[44:47], a[252:255], v[140:143], v[44:47]
    v_mfma_f32_16x16x32_bf16 v[52:55], a[252:255], v[144:147], v[52:55]
    ds_read_b64_tr_b16 a[246:247], v244 offset:6272
    v_mfma_f32_16x16x32_bf16 v[60:63], a[252:255], v[148:151], v[60:63]
    v_mfma_f32_16x16x32_bf16 v[68:71], a[252:255], v[152:155], v[68:71]
    buffer_load_dwordx4 v231, s[32:35], s59 offen offset:1024 lds
    v_mfma_f32_16x16x32_bf16 v[76:79], a[252:255], v[156:159], v[76:79]
    s_waitcnt lgkmcnt(4)
    v_mfma_f32_16x16x32_bf16 v[80:83], v[208:211], v[140:143], v[80:83]
    ds_read_b64_tr_b16 a[248:249], v241 offset:256
    v_mfma_f32_16x16x32_bf16 v[88:91], v[208:211], v[144:147], v[88:91]
    s_add_u32 s68, s68, 128
    s_cmp_ge_u32 s68, 1280
    s_cselect_b32 s68, 0, s68
    v_mfma_f32_16x16x32_bf16 v[96:99], v[208:211], v[148:151], v[96:99]
    ds_read_b64_tr_b16 a[250:251], v241 offset:6400
    s_add_u32 s58, s71, s67
    v_mfma_f32_16x16x32_bf16 v[104:107], v[208:211], v[152:155], v[104:107]
    s_add_u32 m0, s8, 65536
    v_mfma_f32_16x16x32_bf16 v[112:115], v[208:211], v[156:159], v[112:115]
    ds_read_b64_tr_b16 a[252:253], v242 offset:256
    v_mfma_f32_16x16x32_bf16 v[84:87], v[212:215], v[140:143], v[84:87]
    buffer_load_dwordx4 v227, s[36:39], s58 offen offset:0 lds
    v_mfma_f32_16x16x32_bf16 v[92:95], v[212:215], v[144:147], v[92:95]
    ds_read_b64_tr_b16 a[254:255], v242 offset:6400
    v_mfma_f32_16x16x32_bf16 v[100:103], v[212:215], v[148:151], v[100:103]
    v_mfma_f32_16x16x32_bf16 v[108:111], v[212:215], v[152:155], v[108:111]
    v_mfma_f32_16x16x32_bf16 v[116:119], v[212:215], v[156:159], v[116:119]
    s_waitcnt lgkmcnt(4)
    v_mfma_f32_16x16x32_bf16 a[0:3], a[240:243], v[140:143], a[0:3]
    ds_read_b64_tr_b16 v[208:209], v243 offset:256
    v_mfma_f32_16x16x32_bf16 a[4:7], a[240:243], v[144:147], a[4:7]
    ds_read_b64_tr_b16 v[210:211], v243 offset:6400
    v_mfma_f32_16x16x32_bf16 a[8:11], a[240:243], v[148:151], a[8:11]
    ds_read_b64_tr_b16 v[212:213], v244 offset:256
    v_mfma_f32_16x16x32_bf16 a[12:15], a[240:243], v[152:155], a[12:15]
    ds_read_b64_tr_b16 v[214:215], v244 offset:6400
    v_mfma_f32_16x16x32_bf16 a[16:19], a[240:243], v[156:159], a[16:19]
    buffer_load_dwordx4 v228, s[36:39], s58 offen offset:1024 lds
    v_mfma_f32_16x16x32_bf16 a[20:23], a[244:247], v[140:143], a[20:23]
    v_mfma_f32_16x16x32_bf16 a[24:27], a[244:247], v[144:147], a[24:27]
    v_mfma_f32_16x16x32_bf16 a[28:31], a[244:247], v[148:151], a[28:31]
    v_mfma_f32_16x16x32_bf16 a[32:35], a[244:247], v[152:155], a[32:35]
    v_mfma_f32_16x16x32_bf16 a[36:39], a[244:247], v[156:159], a[36:39]
    buffer_load_dwordx4 v229, s[36:39], s58 offen offset:2048 lds
    s_add_u32 s67, s67, 393216
    s_cmp_ge_u32 s67, 7864320
    s_cselect_b32 s67, 0, s67
    s_waitcnt vmcnt(3) lgkmcnt(0)
    s_barrier
    v_mfma_f32_16x16x32_bf16 a[40:43], a[248:251], v[140:143], a[40:43]
    ds_read_b64_tr_b16 a[240:241], v241 offset:12288
    s_add_u32 s58, s71, s67
    v_mfma_f32_16x16x32_bf16 a[44:47], a[248:251], v[144:147], a[44:47]
    ds_read_b128 v[120:123], v222 offset:20480
    s_add_u32 m0, s8, 40960
    v_mfma_f32_16x16x32_bf16 a[48:51], a[248:251], v[148:151], a[48:51]
    ds_read_b64_tr_b16 a[242:243], v241 offset:18432
    v_mfma_f32_16x16x32_bf16 a[52:55], a[248:251], v[152:155], a[52:55]
    ds_read_b128 v[124:127], v222 offset:22528
    v_mfma_f32_16x16x32_bf16 a[56:59], a[248:251], v[156:159], a[56:59]
    ds_read_b64_tr_b16 a[244:245], v242 offset:12288
    v_mfma_f32_16x16x32_bf16 a[60:63], a[252:255], v[140:143], a[60:63]
    ds_read_b128 v[128:131], v222 offset:24576
    v_mfma_f32_16x16x32_bf16 a[64:67], a[252:255], v[144:147], a[64:67]
    ds_read_b64_tr_b16 a[246:247], v242 offset:18432
    v_mfma_f32_16x16x32_bf16 a[68:71], a[252:255], v[148:151], a[68:71]
    ds_read_b128 v[132:135], v222 offset:26624
    v_mfma_f32_16x16x32_bf16 a[72:75], a[252:255], v[152:155], a[72:75]
    ds_read_b128 v[136:139], v222 offset:28672
    v_mfma_f32_16x16x32_bf16 a[76:79], a[252:255], v[156:159], a[76:79]
    buffer_load_dwordx4 v227, s[36:39], s58 offen offset:0 lds
    v_mfma_f32_16x16x32_bf16 a[80:83], v[208:211], v[140:143], a[80:83]
    ds_read_b64_tr_b16 a[248:249], v243 offset:12288
    v_mfma_f32_16x16x32_bf16 a[84:87], v[208:211], v[144:147], a[84:87]
    v_mfma_f32_16x16x32_bf16 a[88:91], v[208:211], v[148:151], a[88:91]
    ds_read_b64_tr_b16 a[250:251], v243 offset:18432
    v_mfma_f32_16x16x32_bf16 a[92:95], v[208:211], v[152:155], a[92:95]
    v_mfma_f32_16x16x32_bf16 a[96:99], v[208:211], v[156:159], a[96:99]
    ds_read_b64_tr_b16 a[252:253], v244 offset:12288
    v_mfma_f32_16x16x32_bf16 a[100:103], v[212:215], v[140:143], a[100:103]
    buffer_load_dwordx4 v228, s[36:39], s58 offen offset:1024 lds
    v_mfma_f32_16x16x32_bf16 a[104:107], v[212:215], v[144:147], a[104:107]
    ds_read_b64_tr_b16 a[254:255], v244 offset:18432
    v_mfma_f32_16x16x32_bf16 a[108:111], v[212:215], v[148:151], a[108:111]
    v_mfma_f32_16x16x32_bf16 a[112:115], v[212:215], v[152:155], a[112:115]
    v_mfma_f32_16x16x32_bf16 a[116:119], v[212:215], v[156:159], a[116:119]
    s_waitcnt lgkmcnt(6)
    v_mfma_f32_16x16x32_bf16 v[0:3], a[240:243], v[120:123], v[0:3]
    ds_read_b64_tr_b16 v[208:209], v241 offset:12416
    v_mfma_f32_16x16x32_bf16 v[8:11], a[240:243], v[124:127], v[8:11]
    buffer_load_dwordx4 v229, s[36:39], s58 offen offset:2048 lds
    v_mfma_f32_16x16x32_bf16 v[16:19], a[240:243], v[128:131], v[16:19]
    ds_read_b64_tr_b16 v[210:211], v241 offset:18560
    s_waitcnt lgkmcnt(7)
    v_mfma_f32_16x16x32_bf16 v[24:27], a[240:243], v[132:135], v[24:27]
    s_add_u32 s67, s67, 393216
    s_cmp_ge_u32 s67, 7864320
    s_cselect_b32 s67, 0, s67
    s_waitcnt lgkmcnt(6)
    v_mfma_f32_16x16x32_bf16 v[32:35], a[240:243], v[136:139], v[32:35]
    ds_read_b64_tr_b16 v[212:213], v242 offset:12416
    s_add_u32 s59, s74, s68
    v_mfma_f32_16x16x32_bf16 v[4:7], a[244:247], v[120:123], v[4:7]
    s_add_u32 m0, s70, 0
    v_mfma_f32_16x16x32_bf16 v[12:15], a[244:247], v[124:127], v[12:15]
    ds_read_b64_tr_b16 v[214:215], v242 offset:18560
    v_mfma_f32_16x16x32_bf16 v[20:23], a[244:247], v[128:131], v[20:23]
    buffer_load_dwordx4 v230, s[32:35], s59 offen offset:0 lds
    v_mfma_f32_16x16x32_bf16 v[28:31], a[244:247], v[132:135], v[28:31]
    v_mfma_f32_16x16x32_bf16 v[36:39], a[244:247], v[136:139], v[36:39]
    s_waitcnt lgkmcnt(4)
    v_mfma_f32_16x16x32_bf16 v[40:43], a[248:251], v[120:123], v[40:43]
    ds_read_b64_tr_b16 a[240:241], v243 offset:12416
    v_mfma_f32_16x16x32_bf16 v[48:51], a[248:251], v[124:127], v[48:51]
    v_mfma_f32_16x16x32_bf16 v[56:59], a[248:251], v[128:131], v[56:59]
    ds_read_b64_tr_b16 a[242:243], v243 offset:18560
    v_mfma_f32_16x16x32_bf16 v[64:67], a[248:251], v[132:135], v[64:67]
    buffer_load_dwordx4 v231, s[32:35], s59 offen offset:1024 lds
    v_mfma_f32_16x16x32_bf16 v[72:75], a[248:251], v[136:139], v[72:75]
    ds_read_b64_tr_b16 a[244:245], v244 offset:12416
    v_mfma_f32_16x16x32_bf16 v[44:47], a[252:255], v[120:123], v[44:47]
    v_mfma_f32_16x16x32_bf16 v[52:55], a[252:255], v[124:127], v[52:55]
    ds_read_b64_tr_b16 a[246:247], v244 offset:18560
    v_mfma_f32_16x16x32_bf16 v[60:63], a[252:255], v[128:131], v[60:63]
    v_mfma_f32_16x16x32_bf16 v[68:71], a[252:255], v[132:135], v[68:71]
    buffer_load_dwordx4 v232, s[32:35], s59 offen offset:2048 lds
    v_mfma_f32_16x16x32_bf16 v[76:79], a[252:255], v[136:139], v[76:79]
    s_waitcnt lgkmcnt(4)
    v_mfma_f32_16x16x32_bf16 v[80:83], v[208:211], v[120:123], v[80:83]
    ds_read_b64_tr_b16 a[248:249], v241 offset:12544
    v_mfma_f32_16x16x32_bf16 v[88:91], v[208:211], v[124:127], v[88:91]
    v_mfma_f32_16x16x32_bf16 v[96:99], v[208:211], v[128:131], v[96:99]
    ds_read_b64_tr_b16 a[250:251], v241 offset:18688
    v_mfma_f32_16x16x32_bf16 v[104:107], v[208:211], v[132:135], v[104:107]
    buffer_load_dwordx4 v233, s[32:35], s59 offen offset:3072 lds
    s_add_u32 s59, s59, 40960
    v_mfma_f32_16x16x32_bf16 v[112:115], v[208:211], v[136:139], v[112:115]
    ds_read_b64_tr_b16 a[252:253], v242 offset:12544
    v_mfma_f32_16x16x32_bf16 v[84:87], v[212:215], v[120:123], v[84:87]
    v_mfma_f32_16x16x32_bf16 v[92:95], v[212:215], v[124:127], v[92:95]
    ds_read_b64_tr_b16 a[254:255], v242 offset:18688
    v_mfma_f32_16x16x32_bf16 v[100:103], v[212:215], v[128:131], v[100:103]
    v_mfma_f32_16x16x32_bf16 v[108:111], v[212:215], v[132:135], v[108:111]
    v_mfma_f32_16x16x32_bf16 v[116:119], v[212:215], v[136:139], v[116:119]
    s_waitcnt lgkmcnt(4)
    v_mfma_f32_16x16x32_bf16 a[0:3], a[240:243], v[120:123], a[0:3]
    ds_read_b64_tr_b16 v[208:209], v243 offset:12544
    v_mfma_f32_16x16x32_bf16 a[4:7], a[240:243], v[124:127], a[4:7]
    ds_read_b64_tr_b16 v[210:211], v243 offset:18688
    v_mfma_f32_16x16x32_bf16 a[8:11], a[240:243], v[128:131], a[8:11]
    ds_read_b64_tr_b16 v[212:213], v244 offset:12544
    v_mfma_f32_16x16x32_bf16 a[12:15], a[240:243], v[132:135], a[12:15]
    ds_read_b64_tr_b16 v[214:215], v244 offset:18688
    v_mfma_f32_16x16x32_bf16 a[16:19], a[240:243], v[136:139], a[16:19]
    v_mfma_f32_16x16x32_bf16 a[20:23], a[244:247], v[120:123], a[20:23]
    v_mfma_f32_16x16x32_bf16 a[24:27], a[244:247], v[124:127], a[24:27]
    v_mfma_f32_16x16x32_bf16 a[28:31], a[244:247], v[128:131], a[28:31]
    v_mfma_f32_16x16x32_bf16 a[32:35], a[244:247], v[132:135], a[32:35]
    v_mfma_f32_16x16x32_bf16 a[36:39], a[244:247], v[136:139], a[36:39]
    s_waitcnt vmcnt(7) lgkmcnt(0)
    s_barrier
    v_mfma_f32_16x16x32_bf16 a[40:43], a[248:251], v[120:123], a[40:43]
    ds_read_b64_tr_b16 a[240:241], v241 offset:24576
    s_add_u32 m0, s70, 4096
    v_mfma_f32_16x16x32_bf16 a[44:47], a[248:251], v[124:127], a[44:47]
    ds_read_b128 v[140:143], v223 offset:20480
    v_mfma_f32_16x16x32_bf16 a[48:51], a[248:251], v[128:131], a[48:51]
    ds_read_b64_tr_b16 a[242:243], v241 offset:30720
    v_mfma_f32_16x16x32_bf16 a[52:55], a[248:251], v[132:135], a[52:55]
    ds_read_b128 v[144:147], v223 offset:22528
    v_mfma_f32_16x16x32_bf16 a[56:59], a[248:251], v[136:139], a[56:59]
    ds_read_b64_tr_b16 a[244:245], v242 offset:24576
    v_mfma_f32_16x16x32_bf16 a[60:63], a[252:255], v[120:123], a[60:63]
    ds_read_b128 v[148:151], v223 offset:24576
    v_mfma_f32_16x16x32_bf16 a[64:67], a[252:255], v[124:127], a[64:67]
    ds_read_b64_tr_b16 a[246:247], v242 offset:30720
    v_mfma_f32_16x16x32_bf16 a[68:71], a[252:255], v[128:131], a[68:71]
    ds_read_b128 v[152:155], v223 offset:26624
    v_mfma_f32_16x16x32_bf16 a[72:75], a[252:255], v[132:135], a[72:75]
    ds_read_b128 v[156:159], v223 offset:28672
    v_mfma_f32_16x16x32_bf16 a[76:79], a[252:255], v[136:139], a[76:79]
    buffer_load_dwordx4 v230, s[32:35], s59 offen offset:0 lds
    v_mfma_f32_16x16x32_bf16 a[80:83], v[208:211], v[120:123], a[80:83]
    ds_read_b64_tr_b16 a[248:249], v243 offset:24576
    v_mfma_f32_16x16x32_bf16 a[84:87], v[208:211], v[124:127], a[84:87]
    v_mfma_f32_16x16x32_bf16 a[88:91], v[208:211], v[128:131], a[88:91]
    ds_read_b64_tr_b16 a[250:251], v243 offset:30720
    v_mfma_f32_16x16x32_bf16 a[92:95], v[208:211], v[132:135], a[92:95]
    v_mfma_f32_16x16x32_bf16 a[96:99], v[208:211], v[136:139], a[96:99]
    ds_read_b64_tr_b16 a[252:253], v244 offset:24576
    v_mfma_f32_16x16x32_bf16 a[100:103], v[212:215], v[120:123], a[100:103]
    buffer_load_dwordx4 v231, s[32:35], s59 offen offset:1024 lds
    v_mfma_f32_16x16x32_bf16 a[104:107], v[212:215], v[124:127], a[104:107]
    ds_read_b64_tr_b16 a[254:255], v244 offset:30720
    v_mfma_f32_16x16x32_bf16 a[108:111], v[212:215], v[128:131], a[108:111]
    v_mfma_f32_16x16x32_bf16 a[112:115], v[212:215], v[132:135], a[112:115]
    v_mfma_f32_16x16x32_bf16 a[116:119], v[212:215], v[136:139], a[116:119]
    s_waitcnt lgkmcnt(6)
    v_mfma_f32_16x16x32_bf16 v[0:3], a[240:243], v[140:143], v[0:3]
    ds_read_b64_tr_b16 v[208:209], v241 offset:24704
    v_mfma_f32_16x16x32_bf16 v[8:11], a[240:243], v[144:147], v[8:11]
    buffer_load_dwordx4 v232, s[32:35], s59 offen offset:2048 lds
    v_mfma_f32_16x16x32_bf16 v[16:19], a[240:243], v[148:151], v[16:19]
    ds_read_b64_tr_b16 v[210:211], v241 offset:30848
    s_waitcnt lgkmcnt(7)
    v_mfma_f32_16x16x32_bf16 v[24:27], a[240:243], v[152:155], v[24:27]
    s_waitcnt lgkmcnt(6)
    v_mfma_f32_16x16x32_bf16 v[32:35], a[240:243], v[156:159], v[32:35]
    ds_read_b64_tr_b16 v[212:213], v242 offset:24704
    v_mfma_f32_16x16x32_bf16 v[4:7], a[244:247], v[140:143], v[4:7]
    v_mfma_f32_16x16x32_bf16 v[12:15], a[244:247], v[144:147], v[12:15]
    ds_read_b64_tr_b16 v[214:215], v242 offset:30848
    v_mfma_f32_16x16x32_bf16 v[20:23], a[244:247], v[148:151], v[20:23]
    buffer_load_dwordx4 v233, s[32:35], s59 offen offset:3072 lds
    s_add_u32 s59, s59, 40960
    v_mfma_f32_16x16x32_bf16 v[28:31], a[244:247], v[152:155], v[28:31]
    s_add_u32 m0, s70, 8192
    v_mfma_f32_16x16x32_bf16 v[36:39], a[244:247], v[156:159], v[36:39]
    s_waitcnt lgkmcnt(4)
    v_mfma_f32_16x16x32_bf16 v[40:43], a[248:251], v[140:143], v[40:43]
    ds_read_b64_tr_b16 a[240:241], v243 offset:24704
    v_mfma_f32_16x16x32_bf16 v[48:51], a[248:251], v[144:147], v[48:51]
    v_mfma_f32_16x16x32_bf16 v[56:59], a[248:251], v[148:151], v[56:59]
    ds_read_b64_tr_b16 a[242:243], v243 offset:30848
    v_mfma_f32_16x16x32_bf16 v[64:67], a[248:251], v[152:155], v[64:67]
    buffer_load_dwordx4 v230, s[32:35], s59 offen offset:0 lds
    v_mfma_f32_16x16x32_bf16 v[72:75], a[248:251], v[156:159], v[72:75]
    ds_read_b64_tr_b16 a[244:245], v244 offset:24704
    v_mfma_f32_16x16x32_bf16 v[44:47], a[252:255], v[140:143], v[44:47]
    v_mfma_f32_16x16x32_bf16 v[52:55], a[252:255], v[144:147], v[52:55]
    ds_read_b64_tr_b16 a[246:247], v244 offset:30848
    v_mfma_f32_16x16x32_bf16 v[60:63], a[252:255], v[148:151], v[60:63]
    v_mfma_f32_16x16x32_bf16 v[68:71], a[252:255], v[152:155], v[68:71]
    buffer_load_dwordx4 v231, s[32:35], s59 offen offset:1024 lds
    v_mfma_f32_16x16x32_bf16 v[76:79], a[252:255], v[156:159], v[76:79]
    s_waitcnt lgkmcnt(4)
    v_mfma_f32_16x16x32_bf16 v[80:83], v[208:211], v[140:143], v[80:83]
    ds_read_b64_tr_b16 a[248:249], v241 offset:24832
    v_mfma_f32_16x16x32_bf16 v[88:91], v[208:211], v[144:147], v[88:91]
    s_add_u32 s68, s68, 128
    s_cmp_ge_u32 s68, 1280
    s_cselect_b32 s68, 0, s68
    v_mfma_f32_16x16x32_bf16 v[96:99], v[208:211], v[148:151], v[96:99]
    ds_read_b64_tr_b16 a[250:251], v241 offset:30976
    s_add_u32 s58, s71, s67
    v_mfma_f32_16x16x32_bf16 v[104:107], v[208:211], v[152:155], v[104:107]
    s_add_u32 m0, s8, 53248
    v_mfma_f32_16x16x32_bf16 v[112:115], v[208:211], v[156:159], v[112:115]
    ds_read_b64_tr_b16 a[252:253], v242 offset:24832
    v_mfma_f32_16x16x32_bf16 v[84:87], v[212:215], v[140:143], v[84:87]
    buffer_load_dwordx4 v227, s[36:39], s58 offen offset:0 lds
    v_mfma_f32_16x16x32_bf16 v[92:95], v[212:215], v[144:147], v[92:95]
    ds_read_b64_tr_b16 a[254:255], v242 offset:30976
    v_mfma_f32_16x16x32_bf16 v[100:103], v[212:215], v[148:151], v[100:103]
    v_mfma_f32_16x16x32_bf16 v[108:111], v[212:215], v[152:155], v[108:111]
    v_mfma_f32_16x16x32_bf16 v[116:119], v[212:215], v[156:159], v[116:119]
    s_waitcnt lgkmcnt(4)
    v_mfma_f32_16x16x32_bf16 a[0:3], a[240:243], v[140:143], a[0:3]
    ds_read_b64_tr_b16 v[208:209], v243 offset:24832
    v_mfma_f32_16x16x32_bf16 a[4:7], a[240:243], v[144:147], a[4:7]
    ds_read_b64_tr_b16 v[210:211], v243 offset:30976
    v_mfma_f32_16x16x32_bf16 a[8:11], a[240:243], v[148:151], a[8:11]
    ds_read_b64_tr_b16 v[212:213], v244 offset:24832
    v_mfma_f32_16x16x32_bf16 a[12:15], a[240:243], v[152:155], a[12:15]
    ds_read_b64_tr_b16 v[214:215], v244 offset:30976
    v_mfma_f32_16x16x32_bf16 a[16:19], a[240:243], v[156:159], a[16:19]
    buffer_load_dwordx4 v228, s[36:39], s58 offen offset:1024 lds
    v_mfma_f32_16x16x32_bf16 a[20:23], a[244:247], v[140:143], a[20:23]
    v_mfma_f32_16x16x32_bf16 a[24:27], a[244:247], v[144:147], a[24:27]
    v_mfma_f32_16x16x32_bf16 a[28:31], a[244:247], v[148:151], a[28:31]
    v_mfma_f32_16x16x32_bf16 a[32:35], a[244:247], v[152:155], a[32:35]
    v_mfma_f32_16x16x32_bf16 a[36:39], a[244:247], v[156:159], a[36:39]
    buffer_load_dwordx4 v229, s[36:39], s58 offen offset:2048 lds
    s_add_u32 s67, s67, 393216
    s_cmp_ge_u32 s67, 7864320
    s_cselect_b32 s67, 0, s67
    s_waitcnt vmcnt(3) lgkmcnt(0)
    s_barrier
    v_mfma_f32_16x16x32_bf16 a[40:43], a[248:251], v[140:143], a[40:43]
    ds_read_b64_tr_b16 a[240:241], v241 offset:0
    s_add_u32 s58, s71, s67
    v_mfma_f32_16x16x32_bf16 a[44:47], a[248:251], v[144:147], a[44:47]
    ds_read_b128 v[120:123], v222 offset:0
    s_add_u32 m0, s8, 65536
    v_mfma_f32_16x16x32_bf16 a[48:51], a[248:251], v[148:151], a[48:51]
    ds_read_b64_tr_b16 a[242:243], v241 offset:6144
    v_mfma_f32_16x16x32_bf16 a[52:55], a[248:251], v[152:155], a[52:55]
    ds_read_b128 v[124:127], v222 offset:2048
    v_mfma_f32_16x16x32_bf16 a[56:59], a[248:251], v[156:159], a[56:59]
    ds_read_b64_tr_b16 a[244:245], v242 offset:0
    v_mfma_f32_16x16x32_bf16 a[60:63], a[252:255], v[140:143], a[60:63]
    ds_read_b128 v[128:131], v222 offset:4096
    v_mfma_f32_16x16x32_bf16 a[64:67], a[252:255], v[144:147], a[64:67]
    ds_read_b64_tr_b16 a[246:247], v242 offset:6144
    v_mfma_f32_16x16x32_bf16 a[68:71], a[252:255], v[148:151], a[68:71]
    ds_read_b128 v[132:135], v222 offset:6144
    v_mfma_f32_16x16x32_bf16 a[72:75], a[252:255], v[152:155], a[72:75]
    ds_read_b128 v[136:139], v222 offset:8192
    v_mfma_f32_16x16x32_bf16 a[76:79], a[252:255], v[156:159], a[76:79]
    buffer_load_dwordx4 v227, s[36:39], s58 offen offset:0 lds
    v_mfma_f32_16x16x32_bf16 a[80:83], v[208:211], v[140:143], a[80:83]
    ds_read_b64_tr_b16 a[248:249], v243 offset:0
    v_mfma_f32_16x16x32_bf16 a[84:87], v[208:211], v[144:147], a[84:87]
    v_mfma_f32_16x16x32_bf16 a[88:91], v[208:211], v[148:151], a[88:91]
    ds_read_b64_tr_b16 a[250:251], v243 offset:6144
    v_mfma_f32_16x16x32_bf16 a[92:95], v[208:211], v[152:155], a[92:95]
    v_mfma_f32_16x16x32_bf16 a[96:99], v[208:211], v[156:159], a[96:99]
    ds_read_b64_tr_b16 a[252:253], v244 offset:0
    v_mfma_f32_16x16x32_bf16 a[100:103], v[212:215], v[140:143], a[100:103]
    buffer_load_dwordx4 v228, s[36:39], s58 offen offset:1024 lds
    v_mfma_f32_16x16x32_bf16 a[104:107], v[212:215], v[144:147], a[104:107]
    ds_read_b64_tr_b16 a[254:255], v244 offset:6144
    v_mfma_f32_16x16x32_bf16 a[108:111], v[212:215], v[148:151], a[108:111]
    v_mfma_f32_16x16x32_bf16 a[112:115], v[212:215], v[152:155], a[112:115]
    v_mfma_f32_16x16x32_bf16 a[116:119], v[212:215], v[156:159], a[116:119]
    s_waitcnt lgkmcnt(6)
    v_mfma_f32_16x16x32_bf16 v[0:3], a[240:243], v[120:123], v[0:3]
    ds_read_b64_tr_b16 v[208:209], v241 offset:128
    v_mfma_f32_16x16x32_bf16 v[8:11], a[240:243], v[124:127], v[8:11]
    buffer_load_dwordx4 v229, s[36:39], s58 offen offset:2048 lds
    v_mfma_f32_16x16x32_bf16 v[16:19], a[240:243], v[128:131], v[16:19]
    ds_read_b64_tr_b16 v[210:211], v241 offset:6272
    s_waitcnt lgkmcnt(7)
    v_mfma_f32_16x16x32_bf16 v[24:27], a[240:243], v[132:135], v[24:27]
    s_add_u32 s67, s67, 393216
    s_cmp_ge_u32 s67, 7864320
    s_cselect_b32 s67, 0, s67
    s_waitcnt lgkmcnt(6)
    v_mfma_f32_16x16x32_bf16 v[32:35], a[240:243], v[136:139], v[32:35]
    ds_read_b64_tr_b16 v[212:213], v242 offset:128
    s_add_u32 s59, s74, s68
    v_mfma_f32_16x16x32_bf16 v[4:7], a[244:247], v[120:123], v[4:7]
    s_add_u32 m0, s70, 20480
    v_mfma_f32_16x16x32_bf16 v[12:15], a[244:247], v[124:127], v[12:15]
    ds_read_b64_tr_b16 v[214:215], v242 offset:6272
    v_mfma_f32_16x16x32_bf16 v[20:23], a[244:247], v[128:131], v[20:23]
    buffer_load_dwordx4 v230, s[32:35], s59 offen offset:0 lds
    v_mfma_f32_16x16x32_bf16 v[28:31], a[244:247], v[132:135], v[28:31]
    v_mfma_f32_16x16x32_bf16 v[36:39], a[244:247], v[136:139], v[36:39]
    s_waitcnt lgkmcnt(4)
    v_mfma_f32_16x16x32_bf16 v[40:43], a[248:251], v[120:123], v[40:43]
    ds_read_b64_tr_b16 a[240:241], v243 offset:128
    v_mfma_f32_16x16x32_bf16 v[48:51], a[248:251], v[124:127], v[48:51]
    v_mfma_f32_16x16x32_bf16 v[56:59], a[248:251], v[128:131], v[56:59]
    ds_read_b64_tr_b16 a[242:243], v243 offset:6272
    v_mfma_f32_16x16x32_bf16 v[64:67], a[248:251], v[132:135], v[64:67]
    buffer_load_dwordx4 v231, s[32:35], s59 offen offset:1024 lds
    v_mfma_f32_16x16x32_bf16 v[72:75], a[248:251], v[136:139], v[72:75]
    ds_read_b64_tr_b16 a[244:245], v244 offset:128
    v_mfma_f32_16x16x32_bf16 v[44:47], a[252:255], v[120:123], v[44:47]
    v_mfma_f32_16x16x32_bf16 v[52:55], a[252:255], v[124:127], v[52:55]
    ds_read_b64_tr_b16 a[246:247], v244 offset:6272
    v_mfma_f32_16x16x32_bf16 v[60:63], a[252:255], v[128:131], v[60:63]
    v_mfma_f32_16x16x32_bf16 v[68:71], a[252:255], v[132:135], v[68:71]
    buffer_load_dwordx4 v232, s[32:35], s59 offen offset:2048 lds
    v_mfma_f32_16x16x32_bf16 v[76:79], a[252:255], v[136:139], v[76:79]
    s_waitcnt lgkmcnt(4)
    v_mfma_f32_16x16x32_bf16 v[80:83], v[208:211], v[120:123], v[80:83]
    ds_read_b64_tr_b16 a[248:249], v241 offset:256
    v_mfma_f32_16x16x32_bf16 v[88:91], v[208:211], v[124:127], v[88:91]
    v_mfma_f32_16x16x32_bf16 v[96:99], v[208:211], v[128:131], v[96:99]
    ds_read_b64_tr_b16 a[250:251], v241 offset:6400
    v_mfma_f32_16x16x32_bf16 v[104:107], v[208:211], v[132:135], v[104:107]
    buffer_load_dwordx4 v233, s[32:35], s59 offen offset:3072 lds
    s_add_u32 s59, s59, 40960
    v_mfma_f32_16x16x32_bf16 v[112:115], v[208:211], v[136:139], v[112:115]
    ds_read_b64_tr_b16 a[252:253], v242 offset:256
    v_mfma_f32_16x16x32_bf16 v[84:87], v[212:215], v[120:123], v[84:87]
    v_mfma_f32_16x16x32_bf16 v[92:95], v[212:215], v[124:127], v[92:95]
    ds_read_b64_tr_b16 a[254:255], v242 offset:6400
    v_mfma_f32_16x16x32_bf16 v[100:103], v[212:215], v[128:131], v[100:103]
    v_mfma_f32_16x16x32_bf16 v[108:111], v[212:215], v[132:135], v[108:111]
    v_mfma_f32_16x16x32_bf16 v[116:119], v[212:215], v[136:139], v[116:119]
    s_waitcnt lgkmcnt(4)
    v_mfma_f32_16x16x32_bf16 a[0:3], a[240:243], v[120:123], a[0:3]
    ds_read_b64_tr_b16 v[208:209], v243 offset:256
    v_mfma_f32_16x16x32_bf16 a[4:7], a[240:243], v[124:127], a[4:7]
    ds_read_b64_tr_b16 v[210:211], v243 offset:6400
    v_mfma_f32_16x16x32_bf16 a[8:11], a[240:243], v[128:131], a[8:11]
    ds_read_b64_tr_b16 v[212:213], v244 offset:256
    v_mfma_f32_16x16x32_bf16 a[12:15], a[240:243], v[132:135], a[12:15]
    ds_read_b64_tr_b16 v[214:215], v244 offset:6400
    v_mfma_f32_16x16x32_bf16 a[16:19], a[240:243], v[136:139], a[16:19]
    v_mfma_f32_16x16x32_bf16 a[20:23], a[244:247], v[120:123], a[20:23]
    v_mfma_f32_16x16x32_bf16 a[24:27], a[244:247], v[124:127], a[24:27]
    v_mfma_f32_16x16x32_bf16 a[28:31], a[244:247], v[128:131], a[28:31]
    v_mfma_f32_16x16x32_bf16 a[32:35], a[244:247], v[132:135], a[32:35]
    v_mfma_f32_16x16x32_bf16 a[36:39], a[244:247], v[136:139], a[36:39]
    s_waitcnt vmcnt(7) lgkmcnt(0)
    s_barrier
    v_mfma_f32_16x16x32_bf16 a[40:43], a[248:251], v[120:123], a[40:43]
    ds_read_b64_tr_b16 a[240:241], v241 offset:12288
    s_add_u32 m0, s70, 24576
    v_mfma_f32_16x16x32_bf16 a[44:47], a[248:251], v[124:127], a[44:47]
    ds_read_b128 v[140:143], v223 offset:0
    v_mfma_f32_16x16x32_bf16 a[48:51], a[248:251], v[128:131], a[48:51]
    ds_read_b64_tr_b16 a[242:243], v241 offset:18432
    v_mfma_f32_16x16x32_bf16 a[52:55], a[248:251], v[132:135], a[52:55]
    ds_read_b128 v[144:147], v223 offset:2048
    v_mfma_f32_16x16x32_bf16 a[56:59], a[248:251], v[136:139], a[56:59]
    ds_read_b64_tr_b16 a[244:245], v242 offset:12288
    v_mfma_f32_16x16x32_bf16 a[60:63], a[252:255], v[120:123], a[60:63]
    ds_read_b128 v[148:151], v223 offset:4096
    v_mfma_f32_16x16x32_bf16 a[64:67], a[252:255], v[124:127], a[64:67]
    ds_read_b64_tr_b16 a[246:247], v242 offset:18432
    v_mfma_f32_16x16x32_bf16 a[68:71], a[252:255], v[128:131], a[68:71]
    ds_read_b128 v[152:155], v223 offset:6144
    v_mfma_f32_16x16x32_bf16 a[72:75], a[252:255], v[132:135], a[72:75]
    ds_read_b128 v[156:159], v223 offset:8192
    v_mfma_f32_16x16x32_bf16 a[76:79], a[252:255], v[136:139], a[76:79]
    buffer_load_dwordx4 v230, s[32:35], s59 offen offset:0 lds
    v_mfma_f32_16x16x32_bf16 a[80:83], v[208:211], v[120:123], a[80:83]
    ds_read_b64_tr_b16 a[248:249], v243 offset:12288
    v_mfma_f32_16x16x32_bf16 a[84:87], v[208:211], v[124:127], a[84:87]
    v_mfma_f32_16x16x32_bf16 a[88:91], v[208:211], v[128:131], a[88:91]
    ds_read_b64_tr_b16 a[250:251], v243 offset:18432
    v_mfma_f32_16x16x32_bf16 a[92:95], v[208:211], v[132:135], a[92:95]
    v_mfma_f32_16x16x32_bf16 a[96:99], v[208:211], v[136:139], a[96:99]
    ds_read_b64_tr_b16 a[252:253], v244 offset:12288
    v_mfma_f32_16x16x32_bf16 a[100:103], v[212:215], v[120:123], a[100:103]
    buffer_load_dwordx4 v231, s[32:35], s59 offen offset:1024 lds
    v_mfma_f32_16x16x32_bf16 a[104:107], v[212:215], v[124:127], a[104:107]
    ds_read_b64_tr_b16 a[254:255], v244 offset:18432
    v_mfma_f32_16x16x32_bf16 a[108:111], v[212:215], v[128:131], a[108:111]
    v_mfma_f32_16x16x32_bf16 a[112:115], v[212:215], v[132:135], a[112:115]
    v_mfma_f32_16x16x32_bf16 a[116:119], v[212:215], v[136:139], a[116:119]
    s_waitcnt lgkmcnt(6)
    v_mfma_f32_16x16x32_bf16 v[0:3], a[240:243], v[140:143], v[0:3]
    ds_read_b64_tr_b16 v[208:209], v241 offset:12416
    v_mfma_f32_16x16x32_bf16 v[8:11], a[240:243], v[144:147], v[8:11]
    buffer_load_dwordx4 v232, s[32:35], s59 offen offset:2048 lds
    v_mfma_f32_16x16x32_bf16 v[16:19], a[240:243], v[148:151], v[16:19]
    ds_read_b64_tr_b16 v[210:211], v241 offset:18560
    s_waitcnt lgkmcnt(7)
    v_mfma_f32_16x16x32_bf16 v[24:27], a[240:243], v[152:155], v[24:27]
    s_waitcnt lgkmcnt(6)
    v_mfma_f32_16x16x32_bf16 v[32:35], a[240:243], v[156:159], v[32:35]
    ds_read_b64_tr_b16 v[212:213], v242 offset:12416
    v_mfma_f32_16x16x32_bf16 v[4:7], a[244:247], v[140:143], v[4:7]
    v_mfma_f32_16x16x32_bf16 v[12:15], a[244:247], v[144:147], v[12:15]
    ds_read_b64_tr_b16 v[214:215], v242 offset:18560
    v_mfma_f32_16x16x32_bf16 v[20:23], a[244:247], v[148:151], v[20:23]
    buffer_load_dwordx4 v233, s[32:35], s59 offen offset:3072 lds
    s_add_u32 s59, s59, 40960
    v_mfma_f32_16x16x32_bf16 v[28:31], a[244:247], v[152:155], v[28:31]
    s_add_u32 m0, s70, 28672
    v_mfma_f32_16x16x32_bf16 v[36:39], a[244:247], v[156:159], v[36:39]
    s_waitcnt lgkmcnt(4)
    v_mfma_f32_16x16x32_bf16 v[40:43], a[248:251], v[140:143], v[40:43]
    ds_read_b64_tr_b16 a[240:241], v243 offset:12416
    v_mfma_f32_16x16x32_bf16 v[48:51], a[248:251], v[144:147], v[48:51]
    v_mfma_f32_16x16x32_bf16 v[56:59], a[248:251], v[148:151], v[56:59]
    ds_read_b64_tr_b16 a[242:243], v243 offset:18560
    v_mfma_f32_16x16x32_bf16 v[64:67], a[248:251], v[152:155], v[64:67]
    buffer_load_dwordx4 v230, s[32:35], s59 offen offset:0 lds
    v_mfma_f32_16x16x32_bf16 v[72:75], a[248:251], v[156:159], v[72:75]
    ds_read_b64_tr_b16 a[244:245], v244 offset:12416
    v_mfma_f32_16x16x32_bf16 v[44:47], a[252:255], v[140:143], v[44:47]
    v_mfma_f32_16x16x32_bf16 v[52:55], a[252:255], v[144:147], v[52:55]
    ds_read_b64_tr_b16 a[246:247], v244 offset:18560
    v_mfma_f32_16x16x32_bf16 v[60:63], a[252:255], v[148:151], v[60:63]
    v_mfma_f32_16x16x32_bf16 v[68:71], a[252:255], v[152:155], v[68:71]
    buffer_load_dwordx4 v231, s[32:35], s59 offen offset:1024 lds
    v_mfma_f32_16x16x32_bf16 v[76:79], a[252:255], v[156:159], v[76:79]
    s_waitcnt lgkmcnt(4)
    v_mfma_f32_16x16x32_bf16 v[80:83], v[208:211], v[140:143], v[80:83]
    ds_read_b64_tr_b16 a[248:249], v241 offset:12544
    v_mfma_f32_16x16x32_bf16 v[88:91], v[208:211], v[144:147], v[88:91]
    s_add_u32 s68, s68, 128
    s_cmp_ge_u32 s68, 1280
    s_cselect_b32 s68, 0, s68
    v_mfma_f32_16x16x32_bf16 v[96:99], v[208:211], v[148:151], v[96:99]
    ds_read_b64_tr_b16 a[250:251], v241 offset:18688
    s_add_u32 s58, s71, s67
    v_mfma_f32_16x16x32_bf16 v[104:107], v[208:211], v[152:155], v[104:107]
    s_add_u32 m0, s8, 40960
    v_mfma_f32_16x16x32_bf16 v[112:115], v[208:211], v[156:159], v[112:115]
    ds_read_b64_tr_b16 a[252:253], v242 offset:12544
    v_mfma_f32_16x16x32_bf16 v[84:87], v[212:215], v[140:143], v[84:87]
    buffer_load_dwordx4 v227, s[36:39], s58 offen offset:0 lds
    v_mfma_f32_16x16x32_bf16 v[92:95], v[212:215], v[144:147], v[92:95]
    ds_read_b64_tr_b16 a[254:255], v242 offset:18688
    v_mfma_f32_16x16x32_bf16 v[100:103], v[212:215], v[148:151], v[100:103]
    v_mfma_f32_16x16x32_bf16 v[108:111], v[212:215], v[152:155], v[108:111]
    v_mfma_f32_16x16x32_bf16 v[116:119], v[212:215], v[156:159], v[116:119]
    s_waitcnt lgkmcnt(4)
    v_mfma_f32_16x16x32_bf16 a[0:3], a[240:243], v[140:143], a[0:3]
    ds_read_b64_tr_b16 v[208:209], v243 offset:12544
    v_mfma_f32_16x16x32_bf16 a[4:7], a[240:243], v[144:147], a[4:7]
    ds_read_b64_tr_b16 v[210:211], v243 offset:18688
    v_mfma_f32_16x16x32_bf16 a[8:11], a[240:243], v[148:151], a[8:11]
    ds_read_b64_tr_b16 v[212:213], v244 offset:12544
    v_mfma_f32_16x16x32_bf16 a[12:15], a[240:243], v[152:155], a[12:15]
    ds_read_b64_tr_b16 v[214:215], v244 offset:18688
    v_mfma_f32_16x16x32_bf16 a[16:19], a[240:243], v[156:159], a[16:19]
    buffer_load_dwordx4 v228, s[36:39], s58 offen offset:1024 lds
    v_mfma_f32_16x16x32_bf16 a[20:23], a[244:247], v[140:143], a[20:23]
    v_mfma_f32_16x16x32_bf16 a[24:27], a[244:247], v[144:147], a[24:27]
    v_mfma_f32_16x16x32_bf16 a[28:31], a[244:247], v[148:151], a[28:31]
    v_mfma_f32_16x16x32_bf16 a[32:35], a[244:247], v[152:155], a[32:35]
    v_mfma_f32_16x16x32_bf16 a[36:39], a[244:247], v[156:159], a[36:39]
    buffer_load_dwordx4 v229, s[36:39], s58 offen offset:2048 lds
    s_add_u32 s67, s67, 393216
    s_cmp_ge_u32 s67, 7864320
    s_cselect_b32 s67, 0, s67
    s_waitcnt vmcnt(3) lgkmcnt(0)
    s_barrier
    v_mfma_f32_16x16x32_bf16 a[40:43], a[248:251], v[140:143], a[40:43]
    ds_read_b64_tr_b16 a[240:241], v241 offset:24576
    s_add_u32 s58, s71, s67
    v_mfma_f32_16x16x32_bf16 a[44:47], a[248:251], v[144:147], a[44:47]
    ds_read_b128 v[120:123], v222 offset:20480
    s_add_u32 m0, s8, 53248
    v_mfma_f32_16x16x32_bf16 a[48:51], a[248:251], v[148:151], a[48:51]
    ds_read_b64_tr_b16 a[242:243], v241 offset:30720
    v_mfma_f32_16x16x32_bf16 a[52:55], a[248:251], v[152:155], a[52:55]
    ds_read_b128 v[124:127], v222 offset:22528
    v_mfma_f32_16x16x32_bf16 a[56:59], a[248:251], v[156:159], a[56:59]
    ds_read_b64_tr_b16 a[244:245], v242 offset:24576
    v_mfma_f32_16x16x32_bf16 a[60:63], a[252:255], v[140:143], a[60:63]
    ds_read_b128 v[128:131], v222 offset:24576
    v_mfma_f32_16x16x32_bf16 a[64:67], a[252:255], v[144:147], a[64:67]
    ds_read_b64_tr_b16 a[246:247], v242 offset:30720
    v_mfma_f32_16x16x32_bf16 a[68:71], a[252:255], v[148:151], a[68:71]
    ds_read_b128 v[132:135], v222 offset:26624
    v_mfma_f32_16x16x32_bf16 a[72:75], a[252:255], v[152:155], a[72:75]
    ds_read_b128 v[136:139], v222 offset:28672
    v_mfma_f32_16x16x32_bf16 a[76:79], a[252:255], v[156:159], a[76:79]
    buffer_load_dwordx4 v227, s[36:39], s58 offen offset:0 lds
    v_mfma_f32_16x16x32_bf16 a[80:83], v[208:211], v[140:143], a[80:83]
    ds_read_b64_tr_b16 a[248:249], v243 offset:24576
    v_mfma_f32_16x16x32_bf16 a[84:87], v[208:211], v[144:147], a[84:87]
    v_mfma_f32_16x16x32_bf16 a[88:91], v[208:211], v[148:151], a[88:91]
    ds_read_b64_tr_b16 a[250:251], v243 offset:30720
    v_mfma_f32_16x16x32_bf16 a[92:95], v[208:211], v[152:155], a[92:95]
    v_mfma_f32_16x16x32_bf16 a[96:99], v[208:211], v[156:159], a[96:99]
    ds_read_b64_tr_b16 a[252:253], v244 offset:24576
    v_mfma_f32_16x16x32_bf16 a[100:103], v[212:215], v[140:143], a[100:103]
    buffer_load_dwordx4 v228, s[36:39], s58 offen offset:1024 lds
    v_mfma_f32_16x16x32_bf16 a[104:107], v[212:215], v[144:147], a[104:107]
    ds_read_b64_tr_b16 a[254:255], v244 offset:30720
    v_mfma_f32_16x16x32_bf16 a[108:111], v[212:215], v[148:151], a[108:111]
    v_mfma_f32_16x16x32_bf16 a[112:115], v[212:215], v[152:155], a[112:115]
    v_mfma_f32_16x16x32_bf16 a[116:119], v[212:215], v[156:159], a[116:119]
    s_waitcnt lgkmcnt(6)
    v_mfma_f32_16x16x32_bf16 v[0:3], a[240:243], v[120:123], v[0:3]
    ds_read_b64_tr_b16 v[208:209], v241 offset:24704
    v_mfma_f32_16x16x32_bf16 v[8:11], a[240:243], v[124:127], v[8:11]
    buffer_load_dwordx4 v229, s[36:39], s58 offen offset:2048 lds
    v_mfma_f32_16x16x32_bf16 v[16:19], a[240:243], v[128:131], v[16:19]
    ds_read_b64_tr_b16 v[210:211], v241 offset:30848
    s_waitcnt lgkmcnt(7)
    v_mfma_f32_16x16x32_bf16 v[24:27], a[240:243], v[132:135], v[24:27]
    s_add_u32 s67, s67, 393216
    s_cmp_ge_u32 s67, 7864320
    s_cselect_b32 s67, 0, s67
    s_waitcnt lgkmcnt(6)
    v_mfma_f32_16x16x32_bf16 v[32:35], a[240:243], v[136:139], v[32:35]
    ds_read_b64_tr_b16 v[212:213], v242 offset:24704
    s_add_u32 s59, s74, s68
    v_mfma_f32_16x16x32_bf16 v[4:7], a[244:247], v[120:123], v[4:7]
    s_add_u32 m0, s70, 0
    v_mfma_f32_16x16x32_bf16 v[12:15], a[244:247], v[124:127], v[12:15]
    ds_read_b64_tr_b16 v[214:215], v242 offset:30848
    v_mfma_f32_16x16x32_bf16 v[20:23], a[244:247], v[128:131], v[20:23]
    buffer_load_dwordx4 v230, s[32:35], s59 offen offset:0 lds
    v_mfma_f32_16x16x32_bf16 v[28:31], a[244:247], v[132:135], v[28:31]
    v_mfma_f32_16x16x32_bf16 v[36:39], a[244:247], v[136:139], v[36:39]
    s_waitcnt lgkmcnt(4)
    v_mfma_f32_16x16x32_bf16 v[40:43], a[248:251], v[120:123], v[40:43]
    ds_read_b64_tr_b16 a[240:241], v243 offset:24704
    v_mfma_f32_16x16x32_bf16 v[48:51], a[248:251], v[124:127], v[48:51]
    v_mfma_f32_16x16x32_bf16 v[56:59], a[248:251], v[128:131], v[56:59]
    ds_read_b64_tr_b16 a[242:243], v243 offset:30848
    v_mfma_f32_16x16x32_bf16 v[64:67], a[248:251], v[132:135], v[64:67]
    buffer_load_dwordx4 v231, s[32:35], s59 offen offset:1024 lds
    v_mfma_f32_16x16x32_bf16 v[72:75], a[248:251], v[136:139], v[72:75]
    ds_read_b64_tr_b16 a[244:245], v244 offset:24704
    v_mfma_f32_16x16x32_bf16 v[44:47], a[252:255], v[120:123], v[44:47]
    v_mfma_f32_16x16x32_bf16 v[52:55], a[252:255], v[124:127], v[52:55]
    ds_read_b64_tr_b16 a[246:247], v244 offset:30848
    v_mfma_f32_16x16x32_bf16 v[60:63], a[252:255], v[128:131], v[60:63]
    v_mfma_f32_16x16x32_bf16 v[68:71], a[252:255], v[132:135], v[68:71]
    buffer_load_dwordx4 v232, s[32:35], s59 offen offset:2048 lds
    v_mfma_f32_16x16x32_bf16 v[76:79], a[252:255], v[136:139], v[76:79]
    s_waitcnt lgkmcnt(4)
    v_mfma_f32_16x16x32_bf16 v[80:83], v[208:211], v[120:123], v[80:83]
    ds_read_b64_tr_b16 a[248:249], v241 offset:24832
    v_mfma_f32_16x16x32_bf16 v[88:91], v[208:211], v[124:127], v[88:91]
    v_mfma_f32_16x16x32_bf16 v[96:99], v[208:211], v[128:131], v[96:99]
    ds_read_b64_tr_b16 a[250:251], v241 offset:30976
    v_mfma_f32_16x16x32_bf16 v[104:107], v[208:211], v[132:135], v[104:107]
    buffer_load_dwordx4 v233, s[32:35], s59 offen offset:3072 lds
    s_add_u32 s59, s59, 40960
    v_mfma_f32_16x16x32_bf16 v[112:115], v[208:211], v[136:139], v[112:115]
    ds_read_b64_tr_b16 a[252:253], v242 offset:24832
    v_mfma_f32_16x16x32_bf16 v[84:87], v[212:215], v[120:123], v[84:87]
    v_mfma_f32_16x16x32_bf16 v[92:95], v[212:215], v[124:127], v[92:95]
    ds_read_b64_tr_b16 a[254:255], v242 offset:30976
    v_mfma_f32_16x16x32_bf16 v[100:103], v[212:215], v[128:131], v[100:103]
    v_mfma_f32_16x16x32_bf16 v[108:111], v[212:215], v[132:135], v[108:111]
    v_mfma_f32_16x16x32_bf16 v[116:119], v[212:215], v[136:139], v[116:119]
    s_waitcnt lgkmcnt(4)
    v_mfma_f32_16x16x32_bf16 a[0:3], a[240:243], v[120:123], a[0:3]
    ds_read_b64_tr_b16 v[208:209], v243 offset:24832
    v_mfma_f32_16x16x32_bf16 a[4:7], a[240:243], v[124:127], a[4:7]
    ds_read_b64_tr_b16 v[210:211], v243 offset:30976
    v_mfma_f32_16x16x32_bf16 a[8:11], a[240:243], v[128:131], a[8:11]
    ds_read_b64_tr_b16 v[212:213], v244 offset:24832
    v_mfma_f32_16x16x32_bf16 a[12:15], a[240:243], v[132:135], a[12:15]
    ds_read_b64_tr_b16 v[214:215], v244 offset:30976
    v_mfma_f32_16x16x32_bf16 a[16:19], a[240:243], v[136:139], a[16:19]
    v_mfma_f32_16x16x32_bf16 a[20:23], a[244:247], v[120:123], a[20:23]
    v_mfma_f32_16x16x32_bf16 a[24:27], a[244:247], v[124:127], a[24:27]
    v_mfma_f32_16x16x32_bf16 a[28:31], a[244:247], v[128:131], a[28:31]
    v_mfma_f32_16x16x32_bf16 a[32:35], a[244:247], v[132:135], a[32:35]
    v_mfma_f32_16x16x32_bf16 a[36:39], a[244:247], v[136:139], a[36:39]
    s_waitcnt vmcnt(7) lgkmcnt(0)
    s_barrier
    v_mfma_f32_16x16x32_bf16 a[40:43], a[248:251], v[120:123], a[40:43]
    ds_read_b64_tr_b16 a[240:241], v241 offset:0
    s_add_u32 m0, s70, 4096
    v_mfma_f32_16x16x32_bf16 a[44:47], a[248:251], v[124:127], a[44:47]
    ds_read_b128 v[140:143], v223 offset:20480
    v_mfma_f32_16x16x32_bf16 a[48:51], a[248:251], v[128:131], a[48:51]
    ds_read_b64_tr_b16 a[242:243], v241 offset:6144
    v_mfma_f32_16x16x32_bf16 a[52:55], a[248:251], v[132:135], a[52:55]
    ds_read_b128 v[144:147], v223 offset:22528
    v_mfma_f32_16x16x32_bf16 a[56:59], a[248:251], v[136:139], a[56:59]
    ds_read_b64_tr_b16 a[244:245], v242 offset:0
    v_mfma_f32_16x16x32_bf16 a[60:63], a[252:255], v[120:123], a[60:63]
    ds_read_b128 v[148:151], v223 offset:24576
    v_mfma_f32_16x16x32_bf16 a[64:67], a[252:255], v[124:127], a[64:67]
    ds_read_b64_tr_b16 a[246:247], v242 offset:6144
    v_mfma_f32_16x16x32_bf16 a[68:71], a[252:255], v[128:131], a[68:71]
    ds_read_b128 v[152:155], v223 offset:26624
    v_mfma_f32_16x16x32_bf16 a[72:75], a[252:255], v[132:135], a[72:75]
    ds_read_b128 v[156:159], v223 offset:28672
    v_mfma_f32_16x16x32_bf16 a[76:79], a[252:255], v[136:139], a[76:79]
    buffer_load_dwordx4 v230, s[32:35], s59 offen offset:0 lds
    v_mfma_f32_16x16x32_bf16 a[80:83], v[208:211], v[120:123], a[80:83]
    ds_read_b64_tr_b16 a[248:249], v243 offset:0
    v_mfma_f32_16x16x32_bf16 a[84:87], v[208:211], v[124:127], a[84:87]
    v_mfma_f32_16x16x32_bf16 a[88:91], v[208:211], v[128:131], a[88:91]
    ds_read_b64_tr_b16 a[250:251], v243 offset:6144
    v_mfma_f32_16x16x32_bf16 a[92:95], v[208:211], v[132:135], a[92:95]
    v_mfma_f32_16x16x32_bf16 a[96:99], v[208:211], v[136:139], a[96:99]
    ds_read_b64_tr_b16 a[252:253], v244 offset:0
    v_mfma_f32_16x16x32_bf16 a[100:103], v[212:215], v[120:123], a[100:103]
    buffer_load_dwordx4 v231, s[32:35], s59 offen offset:1024 lds
    v_mfma_f32_16x16x32_bf16 a[104:107], v[212:215], v[124:127], a[104:107]
    ds_read_b64_tr_b16 a[254:255], v244 offset:6144
    v_mfma_f32_16x16x32_bf16 a[108:111], v[212:215], v[128:131], a[108:111]
    v_mfma_f32_16x16x32_bf16 a[112:115], v[212:215], v[132:135], a[112:115]
    v_mfma_f32_16x16x32_bf16 a[116:119], v[212:215], v[136:139], a[116:119]
    s_waitcnt lgkmcnt(6)
    v_mfma_f32_16x16x32_bf16 v[0:3], a[240:243], v[140:143], v[0:3]
    ds_read_b64_tr_b16 v[208:209], v241 offset:128
    v_mfma_f32_16x16x32_bf16 v[8:11], a[240:243], v[144:147], v[8:11]
    buffer_load_dwordx4 v232, s[32:35], s59 offen offset:2048 lds
    v_mfma_f32_16x16x32_bf16 v[16:19], a[240:243], v[148:151], v[16:19]
    ds_read_b64_tr_b16 v[210:211], v241 offset:6272
    s_waitcnt lgkmcnt(7)
    v_mfma_f32_16x16x32_bf16 v[24:27], a[240:243], v[152:155], v[24:27]
    s_waitcnt lgkmcnt(6)
    v_mfma_f32_16x16x32_bf16 v[32:35], a[240:243], v[156:159], v[32:35]
    ds_read_b64_tr_b16 v[212:213], v242 offset:128
    v_mfma_f32_16x16x32_bf16 v[4:7], a[244:247], v[140:143], v[4:7]
    v_mfma_f32_16x16x32_bf16 v[12:15], a[244:247], v[144:147], v[12:15]
    ds_read_b64_tr_b16 v[214:215], v242 offset:6272
    v_mfma_f32_16x16x32_bf16 v[20:23], a[244:247], v[148:151], v[20:23]
    buffer_load_dwordx4 v233, s[32:35], s59 offen offset:3072 lds
    s_add_u32 s59, s59, 40960
    v_mfma_f32_16x16x32_bf16 v[28:31], a[244:247], v[152:155], v[28:31]
    s_add_u32 m0, s70, 8192
    v_mfma_f32_16x16x32_bf16 v[36:39], a[244:247], v[156:159], v[36:39]
    s_waitcnt lgkmcnt(4)
    v_mfma_f32_16x16x32_bf16 v[40:43], a[248:251], v[140:143], v[40:43]
    ds_read_b64_tr_b16 a[240:241], v243 offset:128
    v_mfma_f32_16x16x32_bf16 v[48:51], a[248:251], v[144:147], v[48:51]
    v_mfma_f32_16x16x32_bf16 v[56:59], a[248:251], v[148:151], v[56:59]
    ds_read_b64_tr_b16 a[242:243], v243 offset:6272
    v_mfma_f32_16x16x32_bf16 v[64:67], a[248:251], v[152:155], v[64:67]
    buffer_load_dwordx4 v230, s[32:35], s59 offen offset:0 lds
    v_mfma_f32_16x16x32_bf16 v[72:75], a[248:251], v[156:159], v[72:75]
    ds_read_b64_tr_b16 a[244:245], v244 offset:128
    v_mfma_f32_16x16x32_bf16 v[44:47], a[252:255], v[140:143], v[44:47]
    v_mfma_f32_16x16x32_bf16 v[52:55], a[252:255], v[144:147], v[52:55]
    ds_read_b64_tr_b16 a[246:247], v244 offset:6272
    v_mfma_f32_16x16x32_bf16 v[60:63], a[252:255], v[148:151], v[60:63]
    v_mfma_f32_16x16x32_bf16 v[68:71], a[252:255], v[152:155], v[68:71]
    buffer_load_dwordx4 v231, s[32:35], s59 offen offset:1024 lds
    v_mfma_f32_16x16x32_bf16 v[76:79], a[252:255], v[156:159], v[76:79]
    s_waitcnt lgkmcnt(4)
    v_mfma_f32_16x16x32_bf16 v[80:83], v[208:211], v[140:143], v[80:83]
    ds_read_b64_tr_b16 a[248:249], v241 offset:256
    v_mfma_f32_16x16x32_bf16 v[88:91], v[208:211], v[144:147], v[88:91]
    s_add_u32 s68, s68, 128
    s_cmp_ge_u32 s68, 1280
    s_cselect_b32 s68, 0, s68
    v_mfma_f32_16x16x32_bf16 v[96:99], v[208:211], v[148:151], v[96:99]
    ds_read_b64_tr_b16 a[250:251], v241 offset:6400
    s_add_u32 s58, s71, s67
    v_mfma_f32_16x16x32_bf16 v[104:107], v[208:211], v[152:155], v[104:107]
    s_add_u32 m0, s8, 65536
    v_mfma_f32_16x16x32_bf16 v[112:115], v[208:211], v[156:159], v[112:115]
    ds_read_b64_tr_b16 a[252:253], v242 offset:256
    v_mfma_f32_16x16x32_bf16 v[84:87], v[212:215], v[140:143], v[84:87]
    buffer_load_dwordx4 v227, s[36:39], s58 offen offset:0 lds
    v_mfma_f32_16x16x32_bf16 v[92:95], v[212:215], v[144:147], v[92:95]
    ds_read_b64_tr_b16 a[254:255], v242 offset:6400
    v_mfma_f32_16x16x32_bf16 v[100:103], v[212:215], v[148:151], v[100:103]
    v_mfma_f32_16x16x32_bf16 v[108:111], v[212:215], v[152:155], v[108:111]
    v_mfma_f32_16x16x32_bf16 v[116:119], v[212:215], v[156:159], v[116:119]
    s_waitcnt lgkmcnt(4)
    v_mfma_f32_16x16x32_bf16 a[0:3], a[240:243], v[140:143], a[0:3]
    ds_read_b64_tr_b16 v[208:209], v243 offset:256
    v_mfma_f32_16x16x32_bf16 a[4:7], a[240:243], v[144:147], a[4:7]
    ds_read_b64_tr_b16 v[210:211], v243 offset:6400
    v_mfma_f32_16x16x32_bf16 a[8:11], a[240:243], v[148:151], a[8:11]
    ds_read_b64_tr_b16 v[212:213], v244 offset:256
    v_mfma_f32_16x16x32_bf16 a[12:15], a[240:243], v[152:155], a[12:15]
    ds_read_b64_tr_b16 v[214:215], v244 offset:6400
    v_mfma_f32_16x16x32_bf16 a[16:19], a[240:243], v[156:159], a[16:19]
    buffer_load_dwordx4 v228, s[36:39], s58 offen offset:1024 lds
    v_mfma_f32_16x16x32_bf16 a[20:23], a[244:247], v[140:143], a[20:23]
    v_mfma_f32_16x16x32_bf16 a[24:27], a[244:247], v[144:147], a[24:27]
    v_mfma_f32_16x16x32_bf16 a[28:31], a[244:247], v[148:151], a[28:31]
    v_mfma_f32_16x16x32_bf16 a[32:35], a[244:247], v[152:155], a[32:35]
    v_mfma_f32_16x16x32_bf16 a[36:39], a[244:247], v[156:159], a[36:39]
    buffer_load_dwordx4 v229, s[36:39], s58 offen offset:2048 lds
    s_add_u32 s67, s67, 393216
    s_cmp_ge_u32 s67, 7864320
    s_cselect_b32 s67, 0, s67
    s_waitcnt vmcnt(3) lgkmcnt(0)
    s_barrier
    v_mfma_f32_16x16x32_bf16 a[40:43], a[248:251], v[140:143], a[40:43]
    ds_read_b64_tr_b16 a[240:241], v241 offset:12288
    s_add_u32 s58, s71, s67
    v_mfma_f32_16x16x32_bf16 a[44:47], a[248:251], v[144:147], a[44:47]
    ds_read_b128 v[120:123], v222 offset:0
    s_add_u32 m0, s8, 40960
    v_mfma_f32_16x16x32_bf16 a[48:51], a[248:251], v[148:151], a[48:51]
    ds_read_b64_tr_b16 a[242:243], v241 offset:18432
    v_mfma_f32_16x16x32_bf16 a[52:55], a[248:251], v[152:155], a[52:55]
    ds_read_b128 v[124:127], v222 offset:2048
    v_mfma_f32_16x16x32_bf16 a[56:59], a[248:251], v[156:159], a[56:59]
    ds_read_b64_tr_b16 a[244:245], v242 offset:12288
    v_mfma_f32_16x16x32_bf16 a[60:63], a[252:255], v[140:143], a[60:63]
    ds_read_b128 v[128:131], v222 offset:4096
    v_mfma_f32_16x16x32_bf16 a[64:67], a[252:255], v[144:147], a[64:67]
    ds_read_b64_tr_b16 a[246:247], v242 offset:18432
    v_mfma_f32_16x16x32_bf16 a[68:71], a[252:255], v[148:151], a[68:71]
    ds_read_b128 v[132:135], v222 offset:6144
    v_mfma_f32_16x16x32_bf16 a[72:75], a[252:255], v[152:155], a[72:75]
    ds_read_b128 v[136:139], v222 offset:8192
    v_mfma_f32_16x16x32_bf16 a[76:79], a[252:255], v[156:159], a[76:79]
    buffer_load_dwordx4 v227, s[36:39], s58 offen offset:0 lds
    v_mfma_f32_16x16x32_bf16 a[80:83], v[208:211], v[140:143], a[80:83]
    ds_read_b64_tr_b16 a[248:249], v243 offset:12288
    v_mfma_f32_16x16x32_bf16 a[84:87], v[208:211], v[144:147], a[84:87]
    v_mfma_f32_16x16x32_bf16 a[88:91], v[208:211], v[148:151], a[88:91]
    ds_read_b64_tr_b16 a[250:251], v243 offset:18432
    v_mfma_f32_16x16x32_bf16 a[92:95], v[208:211], v[152:155], a[92:95]
    v_mfma_f32_16x16x32_bf16 a[96:99], v[208:211], v[156:159], a[96:99]
    ds_read_b64_tr_b16 a[252:253], v244 offset:12288
    v_mfma_f32_16x16x32_bf16 a[100:103], v[212:215], v[140:143], a[100:103]
    buffer_load_dwordx4 v228, s[36:39], s58 offen offset:1024 lds
    v_mfma_f32_16x16x32_bf16 a[104:107], v[212:215], v[144:147], a[104:107]
    ds_read_b64_tr_b16 a[254:255], v244 offset:18432
    v_mfma_f32_16x16x32_bf16 a[108:111], v[212:215], v[148:151], a[108:111]
    v_mfma_f32_16x16x32_bf16 a[112:115], v[212:215], v[152:155], a[112:115]
    v_mfma_f32_16x16x32_bf16 a[116:119], v[212:215], v[156:159], a[116:119]
    s_waitcnt lgkmcnt(6)
    v_mfma_f32_16x16x32_bf16 v[0:3], a[240:243], v[120:123], v[0:3]
    ds_read_b64_tr_b16 v[208:209], v241 offset:12416
    v_mfma_f32_16x16x32_bf16 v[8:11], a[240:243], v[124:127], v[8:11]
    buffer_load_dwordx4 v229, s[36:39], s58 offen offset:2048 lds
    v_mfma_f32_16x16x32_bf16 v[16:19], a[240:243], v[128:131], v[16:19]
    ds_read_b64_tr_b16 v[210:211], v241 offset:18560
    s_waitcnt lgkmcnt(7)
    v_mfma_f32_16x16x32_bf16 v[24:27], a[240:243], v[132:135], v[24:27]
    s_add_u32 s67, s67, 393216
    s_cmp_ge_u32 s67, 7864320
    s_cselect_b32 s67, 0, s67
    s_waitcnt lgkmcnt(6)
    v_mfma_f32_16x16x32_bf16 v[32:35], a[240:243], v[136:139], v[32:35]
    ds_read_b64_tr_b16 v[212:213], v242 offset:12416
    s_add_u32 s59, s74, s68
    v_mfma_f32_16x16x32_bf16 v[4:7], a[244:247], v[120:123], v[4:7]
    s_add_u32 m0, s70, 20480
    v_mfma_f32_16x16x32_bf16 v[12:15], a[244:247], v[124:127], v[12:15]
    ds_read_b64_tr_b16 v[214:215], v242 offset:18560
    v_mfma_f32_16x16x32_bf16 v[20:23], a[244:247], v[128:131], v[20:23]
    buffer_load_dwordx4 v230, s[32:35], s59 offen offset:0 lds
    v_mfma_f32_16x16x32_bf16 v[28:31], a[244:247], v[132:135], v[28:31]
    v_mfma_f32_16x16x32_bf16 v[36:39], a[244:247], v[136:139], v[36:39]
    s_waitcnt lgkmcnt(4)
    v_mfma_f32_16x16x32_bf16 v[40:43], a[248:251], v[120:123], v[40:43]
    ds_read_b64_tr_b16 a[240:241], v243 offset:12416
    v_mfma_f32_16x16x32_bf16 v[48:51], a[248:251], v[124:127], v[48:51]
    v_mfma_f32_16x16x32_bf16 v[56:59], a[248:251], v[128:131], v[56:59]
    ds_read_b64_tr_b16 a[242:243], v243 offset:18560
    v_mfma_f32_16x16x32_bf16 v[64:67], a[248:251], v[132:135], v[64:67]
    buffer_load_dwordx4 v231, s[32:35], s59 offen offset:1024 lds
    v_mfma_f32_16x16x32_bf16 v[72:75], a[248:251], v[136:139], v[72:75]
    ds_read_b64_tr_b16 a[244:245], v244 offset:12416
    v_mfma_f32_16x16x32_bf16 v[44:47], a[252:255], v[120:123], v[44:47]
    v_mfma_f32_16x16x32_bf16 v[52:55], a[252:255], v[124:127], v[52:55]
    ds_read_b64_tr_b16 a[246:247], v244 offset:18560
    v_mfma_f32_16x16x32_bf16 v[60:63], a[252:255], v[128:131], v[60:63]
    v_mfma_f32_16x16x32_bf16 v[68:71], a[252:255], v[132:135], v[68:71]
    buffer_load_dwordx4 v232, s[32:35], s59 offen offset:2048 lds
    v_mfma_f32_16x16x32_bf16 v[76:79], a[252:255], v[136:139], v[76:79]
    s_waitcnt lgkmcnt(4)
    v_mfma_f32_16x16x32_bf16 v[80:83], v[208:211], v[120:123], v[80:83]
    ds_read_b64_tr_b16 a[248:249], v241 offset:12544
    v_mfma_f32_16x16x32_bf16 v[88:91], v[208:211], v[124:127], v[88:91]
    v_mfma_f32_16x16x32_bf16 v[96:99], v[208:211], v[128:131], v[96:99]
    ds_read_b64_tr_b16 a[250:251], v241 offset:18688
    v_mfma_f32_16x16x32_bf16 v[104:107], v[208:211], v[132:135], v[104:107]
    buffer_load_dwordx4 v233, s[32:35], s59 offen offset:3072 lds
    s_add_u32 s59, s59, 40960
    v_mfma_f32_16x16x32_bf16 v[112:115], v[208:211], v[136:139], v[112:115]
    ds_read_b64_tr_b16 a[252:253], v242 offset:12544
    v_mfma_f32_16x16x32_bf16 v[84:87], v[212:215], v[120:123], v[84:87]
    v_mfma_f32_16x16x32_bf16 v[92:95], v[212:215], v[124:127], v[92:95]
    ds_read_b64_tr_b16 a[254:255], v242 offset:18688
    v_mfma_f32_16x16x32_bf16 v[100:103], v[212:215], v[128:131], v[100:103]
    v_mfma_f32_16x16x32_bf16 v[108:111], v[212:215], v[132:135], v[108:111]
    v_mfma_f32_16x16x32_bf16 v[116:119], v[212:215], v[136:139], v[116:119]
    s_waitcnt lgkmcnt(4)
    v_mfma_f32_16x16x32_bf16 a[0:3], a[240:243], v[120:123], a[0:3]
    ds_read_b64_tr_b16 v[208:209], v243 offset:12544
    v_mfma_f32_16x16x32_bf16 a[4:7], a[240:243], v[124:127], a[4:7]
    ds_read_b64_tr_b16 v[210:211], v243 offset:18688
    v_mfma_f32_16x16x32_bf16 a[8:11], a[240:243], v[128:131], a[8:11]
    ds_read_b64_tr_b16 v[212:213], v244 offset:12544
    v_mfma_f32_16x16x32_bf16 a[12:15], a[240:243], v[132:135], a[12:15]
    ds_read_b64_tr_b16 v[214:215], v244 offset:18688
    v_mfma_f32_16x16x32_bf16 a[16:19], a[240:243], v[136:139], a[16:19]
    v_mfma_f32_16x16x32_bf16 a[20:23], a[244:247], v[120:123], a[20:23]
    v_mfma_f32_16x16x32_bf16 a[24:27], a[244:247], v[124:127], a[24:27]
    v_mfma_f32_16x16x32_bf16 a[28:31], a[244:247], v[128:131], a[28:31]
    v_mfma_f32_16x16x32_bf16 a[32:35], a[244:247], v[132:135], a[32:35]
    v_mfma_f32_16x16x32_bf16 a[36:39], a[244:247], v[136:139], a[36:39]
    s_waitcnt vmcnt(7) lgkmcnt(0)
    s_barrier
    v_mfma_f32_16x16x32_bf16 a[40:43], a[248:251], v[120:123], a[40:43]
    ds_read_b64_tr_b16 a[240:241], v241 offset:24576
    s_add_u32 m0, s70, 24576
    v_mfma_f32_16x16x32_bf16 a[44:47], a[248:251], v[124:127], a[44:47]
    ds_read_b128 v[140:143], v223 offset:0
    v_mfma_f32_16x16x32_bf16 a[48:51], a[248:251], v[128:131], a[48:51]
    ds_read_b64_tr_b16 a[242:243], v241 offset:30720
    v_mfma_f32_16x16x32_bf16 a[52:55], a[248:251], v[132:135], a[52:55]
    ds_read_b128 v[144:147], v223 offset:2048
    v_mfma_f32_16x16x32_bf16 a[56:59], a[248:251], v[136:139], a[56:59]
    ds_read_b64_tr_b16 a[244:245], v242 offset:24576
    v_mfma_f32_16x16x32_bf16 a[60:63], a[252:255], v[120:123], a[60:63]
    ds_read_b128 v[148:151], v223 offset:4096
    v_mfma_f32_16x16x32_bf16 a[64:67], a[252:255], v[124:127], a[64:67]
    ds_read_b64_tr_b16 a[246:247], v242 offset:30720
    v_mfma_f32_16x16x32_bf16 a[68:71], a[252:255], v[128:131], a[68:71]
    ds_read_b128 v[152:155], v223 offset:6144
    v_mfma_f32_16x16x32_bf16 a[72:75], a[252:255], v[132:135], a[72:75]
    ds_read_b128 v[156:159], v223 offset:8192
    v_mfma_f32_16x16x32_bf16 a[76:79], a[252:255], v[136:139], a[76:79]
    buffer_load_dwordx4 v230, s[32:35], s59 offen offset:0 lds
    v_mfma_f32_16x16x32_bf16 a[80:83], v[208:211], v[120:123], a[80:83]
    ds_read_b64_tr_b16 a[248:249], v243 offset:24576
    v_mfma_f32_16x16x32_bf16 a[84:87], v[208:211], v[124:127], a[84:87]
    v_mfma_f32_16x16x32_bf16 a[88:91], v[208:211], v[128:131], a[88:91]
    ds_read_b64_tr_b16 a[250:251], v243 offset:30720
    v_mfma_f32_16x16x32_bf16 a[92:95], v[208:211], v[132:135], a[92:95]
    v_mfma_f32_16x16x32_bf16 a[96:99], v[208:211], v[136:139], a[96:99]
    ds_read_b64_tr_b16 a[252:253], v244 offset:24576
    v_mfma_f32_16x16x32_bf16 a[100:103], v[212:215], v[120:123], a[100:103]
    buffer_load_dwordx4 v231, s[32:35], s59 offen offset:1024 lds
    v_mfma_f32_16x16x32_bf16 a[104:107], v[212:215], v[124:127], a[104:107]
    ds_read_b64_tr_b16 a[254:255], v244 offset:30720
    v_mfma_f32_16x16x32_bf16 a[108:111], v[212:215], v[128:131], a[108:111]
    v_mfma_f32_16x16x32_bf16 a[112:115], v[212:215], v[132:135], a[112:115]
    v_mfma_f32_16x16x32_bf16 a[116:119], v[212:215], v[136:139], a[116:119]
    s_waitcnt lgkmcnt(6)
    v_mfma_f32_16x16x32_bf16 v[0:3], a[240:243], v[140:143], v[0:3]
    ds_read_b64_tr_b16 v[208:209], v241 offset:24704
    v_mfma_f32_16x16x32_bf16 v[8:11], a[240:243], v[144:147], v[8:11]
    buffer_load_dwordx4 v232, s[32:35], s59 offen offset:2048 lds
    v_mfma_f32_16x16x32_bf16 v[16:19], a[240:243], v[148:151], v[16:19]
    ds_read_b64_tr_b16 v[210:211], v241 offset:30848
    s_waitcnt lgkmcnt(7)
    v_mfma_f32_16x16x32_bf16 v[24:27], a[240:243], v[152:155], v[24:27]
    s_waitcnt lgkmcnt(6)
    v_mfma_f32_16x16x32_bf16 v[32:35], a[240:243], v[156:159], v[32:35]
    ds_read_b64_tr_b16 v[212:213], v242 offset:24704
    v_mfma_f32_16x16x32_bf16 v[4:7], a[244:247], v[140:143], v[4:7]
    v_mfma_f32_16x16x32_bf16 v[12:15], a[244:247], v[144:147], v[12:15]
    ds_read_b64_tr_b16 v[214:215], v242 offset:30848
    v_mfma_f32_16x16x32_bf16 v[20:23], a[244:247], v[148:151], v[20:23]
    buffer_load_dwordx4 v233, s[32:35], s59 offen offset:3072 lds
    s_add_u32 s59, s59, 40960
    v_mfma_f32_16x16x32_bf16 v[28:31], a[244:247], v[152:155], v[28:31]
    s_add_u32 m0, s70, 28672
    v_mfma_f32_16x16x32_bf16 v[36:39], a[244:247], v[156:159], v[36:39]
    s_waitcnt lgkmcnt(4)
    v_mfma_f32_16x16x32_bf16 v[40:43], a[248:251], v[140:143], v[40:43]
    ds_read_b64_tr_b16 a[240:241], v243 offset:24704
    v_mfma_f32_16x16x32_bf16 v[48:51], a[248:251], v[144:147], v[48:51]
    v_mfma_f32_16x16x32_bf16 v[56:59], a[248:251], v[148:151], v[56:59]
    ds_read_b64_tr_b16 a[242:243], v243 offset:30848
    v_mfma_f32_16x16x32_bf16 v[64:67], a[248:251], v[152:155], v[64:67]
    buffer_load_dwordx4 v230, s[32:35], s59 offen offset:0 lds
    v_mfma_f32_16x16x32_bf16 v[72:75], a[248:251], v[156:159], v[72:75]
    ds_read_b64_tr_b16 a[244:245], v244 offset:24704
    v_mfma_f32_16x16x32_bf16 v[44:47], a[252:255], v[140:143], v[44:47]
    v_mfma_f32_16x16x32_bf16 v[52:55], a[252:255], v[144:147], v[52:55]
    ds_read_b64_tr_b16 a[246:247], v244 offset:30848
    v_mfma_f32_16x16x32_bf16 v[60:63], a[252:255], v[148:151], v[60:63]
    v_mfma_f32_16x16x32_bf16 v[68:71], a[252:255], v[152:155], v[68:71]
    buffer_load_dwordx4 v231, s[32:35], s59 offen offset:1024 lds
    v_mfma_f32_16x16x32_bf16 v[76:79], a[252:255], v[156:159], v[76:79]
    s_waitcnt lgkmcnt(4)
    v_mfma_f32_16x16x32_bf16 v[80:83], v[208:211], v[140:143], v[80:83]
    ds_read_b64_tr_b16 a[248:249], v241 offset:24832
    v_mfma_f32_16x16x32_bf16 v[88:91], v[208:211], v[144:147], v[88:91]
    s_add_u32 s68, s68, 128
    s_cmp_ge_u32 s68, 1280
    s_cselect_b32 s68, 0, s68
    v_mfma_f32_16x16x32_bf16 v[96:99], v[208:211], v[148:151], v[96:99]
    ds_read_b64_tr_b16 a[250:251], v241 offset:30976
    s_add_u32 s58, s71, s67
    v_mfma_f32_16x16x32_bf16 v[104:107], v[208:211], v[152:155], v[104:107]
    s_add_u32 m0, s8, 53248
    v_mfma_f32_16x16x32_bf16 v[112:115], v[208:211], v[156:159], v[112:115]
    ds_read_b64_tr_b16 a[252:253], v242 offset:24832
    v_mfma_f32_16x16x32_bf16 v[84:87], v[212:215], v[140:143], v[84:87]
    buffer_load_dwordx4 v227, s[36:39], s58 offen offset:0 lds
    v_mfma_f32_16x16x32_bf16 v[92:95], v[212:215], v[144:147], v[92:95]
    ds_read_b64_tr_b16 a[254:255], v242 offset:30976
    v_mfma_f32_16x16x32_bf16 v[100:103], v[212:215], v[148:151], v[100:103]
    v_mfma_f32_16x16x32_bf16 v[108:111], v[212:215], v[152:155], v[108:111]
    v_mfma_f32_16x16x32_bf16 v[116:119], v[212:215], v[156:159], v[116:119]
    s_waitcnt lgkmcnt(4)
    v_mfma_f32_16x16x32_bf16 a[0:3], a[240:243], v[140:143], a[0:3]
    ds_read_b64_tr_b16 v[208:209], v243 offset:24832
    v_mfma_f32_16x16x32_bf16 a[4:7], a[240:243], v[144:147], a[4:7]
    ds_read_b64_tr_b16 v[210:211], v243 offset:30976
    v_mfma_f32_16x16x32_bf16 a[8:11], a[240:243], v[148:151], a[8:11]
    ds_read_b64_tr_b16 v[212:213], v244 offset:24832
    v_mfma_f32_16x16x32_bf16 a[12:15], a[240:243], v[152:155], a[12:15]
    ds_read_b64_tr_b16 v[214:215], v244 offset:30976
    v_mfma_f32_16x16x32_bf16 a[16:19], a[240:243], v[156:159], a[16:19]
    buffer_load_dwordx4 v228, s[36:39], s58 offen offset:1024 lds
    v_mfma_f32_16x16x32_bf16 a[20:23], a[244:247], v[140:143], a[20:23]
    v_mfma_f32_16x16x32_bf16 a[24:27], a[244:247], v[144:147], a[24:27]
    v_mfma_f32_16x16x32_bf16 a[28:31], a[244:247], v[148:151], a[28:31]
    v_mfma_f32_16x16x32_bf16 a[32:35], a[244:247], v[152:155], a[32:35]
    v_mfma_f32_16x16x32_bf16 a[36:39], a[244:247], v[156:159], a[36:39]
    buffer_load_dwordx4 v229, s[36:39], s58 offen offset:2048 lds
    s_add_u32 s67, s67, 393216
    s_cmp_ge_u32 s67, 7864320
    s_cselect_b32 s67, 0, s67
    s_waitcnt vmcnt(3) lgkmcnt(0)
    s_barrier
    v_mfma_f32_16x16x32_bf16 a[40:43], a[248:251], v[140:143], a[40:43]
    ds_read_b64_tr_b16 a[240:241], v241 offset:0
    s_add_u32 s58, s71, s67
    v_mfma_f32_16x16x32_bf16 a[44:47], a[248:251], v[144:147], a[44:47]
    ds_read_b128 v[120:123], v222 offset:20480
    s_add_u32 m0, s8, 65536
    v_mfma_f32_16x16x32_bf16 a[48:51], a[248:251], v[148:151], a[48:51]
    ds_read_b64_tr_b16 a[242:243], v241 offset:6144
    v_mfma_f32_16x16x32_bf16 a[52:55], a[248:251], v[152:155], a[52:55]
    ds_read_b128 v[124:127], v222 offset:22528
    v_mfma_f32_16x16x32_bf16 a[56:59], a[248:251], v[156:159], a[56:59]
    ds_read_b64_tr_b16 a[244:245], v242 offset:0
    v_mfma_f32_16x16x32_bf16 a[60:63], a[252:255], v[140:143], a[60:63]
    ds_read_b128 v[128:131], v222 offset:24576
    v_mfma_f32_16x16x32_bf16 a[64:67], a[252:255], v[144:147], a[64:67]
    ds_read_b64_tr_b16 a[246:247], v242 offset:6144
    v_mfma_f32_16x16x32_bf16 a[68:71], a[252:255], v[148:151], a[68:71]
    ds_read_b128 v[132:135], v222 offset:26624
    v_mfma_f32_16x16x32_bf16 a[72:75], a[252:255], v[152:155], a[72:75]
    ds_read_b128 v[136:139], v222 offset:28672
    v_mfma_f32_16x16x32_bf16 a[76:79], a[252:255], v[156:159], a[76:79]
    buffer_load_dwordx4 v227, s[36:39], s58 offen offset:0 lds
    v_mfma_f32_16x16x32_bf16 a[80:83], v[208:211], v[140:143], a[80:83]
    ds_read_b64_tr_b16 a[248:249], v243 offset:0
    v_mfma_f32_16x16x32_bf16 a[84:87], v[208:211], v[144:147], a[84:87]
    v_mfma_f32_16x16x32_bf16 a[88:91], v[208:211], v[148:151], a[88:91]
    ds_read_b64_tr_b16 a[250:251], v243 offset:6144
    v_mfma_f32_16x16x32_bf16 a[92:95], v[208:211], v[152:155], a[92:95]
    v_mfma_f32_16x16x32_bf16 a[96:99], v[208:211], v[156:159], a[96:99]
    ds_read_b64_tr_b16 a[252:253], v244 offset:0
    v_mfma_f32_16x16x32_bf16 a[100:103], v[212:215], v[140:143], a[100:103]
    buffer_load_dwordx4 v228, s[36:39], s58 offen offset:1024 lds
    v_mfma_f32_16x16x32_bf16 a[104:107], v[212:215], v[144:147], a[104:107]
    ds_read_b64_tr_b16 a[254:255], v244 offset:6144
    v_mfma_f32_16x16x32_bf16 a[108:111], v[212:215], v[148:151], a[108:111]
    v_mfma_f32_16x16x32_bf16 a[112:115], v[212:215], v[152:155], a[112:115]
    v_mfma_f32_16x16x32_bf16 a[116:119], v[212:215], v[156:159], a[116:119]
    s_waitcnt lgkmcnt(6)
    v_mfma_f32_16x16x32_bf16 v[0:3], a[240:243], v[120:123], v[0:3]
    ds_read_b64_tr_b16 v[208:209], v241 offset:128
    v_mfma_f32_16x16x32_bf16 v[8:11], a[240:243], v[124:127], v[8:11]
    buffer_load_dwordx4 v229, s[36:39], s58 offen offset:2048 lds
    v_mfma_f32_16x16x32_bf16 v[16:19], a[240:243], v[128:131], v[16:19]
    ds_read_b64_tr_b16 v[210:211], v241 offset:6272
    s_waitcnt lgkmcnt(7)
    v_mfma_f32_16x16x32_bf16 v[24:27], a[240:243], v[132:135], v[24:27]
    s_add_u32 s67, s67, 393216
    s_cmp_ge_u32 s67, 7864320
    s_cselect_b32 s67, 0, s67
    s_waitcnt lgkmcnt(6)
    v_mfma_f32_16x16x32_bf16 v[32:35], a[240:243], v[136:139], v[32:35]
    ds_read_b64_tr_b16 v[212:213], v242 offset:128
    s_add_u32 s59, s74, s68
    v_mfma_f32_16x16x32_bf16 v[4:7], a[244:247], v[120:123], v[4:7]
    s_add_u32 m0, s70, 0
    v_mfma_f32_16x16x32_bf16 v[12:15], a[244:247], v[124:127], v[12:15]
    ds_read_b64_tr_b16 v[214:215], v242 offset:6272
    v_mfma_f32_16x16x32_bf16 v[20:23], a[244:247], v[128:131], v[20:23]
    buffer_load_dwordx4 v230, s[32:35], s59 offen offset:0 lds
    v_mfma_f32_16x16x32_bf16 v[28:31], a[244:247], v[132:135], v[28:31]
    v_mfma_f32_16x16x32_bf16 v[36:39], a[244:247], v[136:139], v[36:39]
    s_waitcnt lgkmcnt(4)
    v_mfma_f32_16x16x32_bf16 v[40:43], a[248:251], v[120:123], v[40:43]
    ds_read_b64_tr_b16 a[240:241], v243 offset:128
    v_mfma_f32_16x16x32_bf16 v[48:51], a[248:251], v[124:127], v[48:51]
    v_mfma_f32_16x16x32_bf16 v[56:59], a[248:251], v[128:131], v[56:59]
    ds_read_b64_tr_b16 a[242:243], v243 offset:6272
    v_mfma_f32_16x16x32_bf16 v[64:67], a[248:251], v[132:135], v[64:67]
    buffer_load_dwordx4 v231, s[32:35], s59 offen offset:1024 lds
    v_mfma_f32_16x16x32_bf16 v[72:75], a[248:251], v[136:139], v[72:75]
    ds_read_b64_tr_b16 a[244:245], v244 offset:128
    v_mfma_f32_16x16x32_bf16 v[44:47], a[252:255], v[120:123], v[44:47]
    v_mfma_f32_16x16x32_bf16 v[52:55], a[252:255], v[124:127], v[52:55]
    ds_read_b64_tr_b16 a[246:247], v244 offset:6272
    v_mfma_f32_16x16x32_bf16 v[60:63], a[252:255], v[128:131], v[60:63]
    v_mfma_f32_16x16x32_bf16 v[68:71], a[252:255], v[132:135], v[68:71]
    buffer_load_dwordx4 v232, s[32:35], s59 offen offset:2048 lds
    v_mfma_f32_16x16x32_bf16 v[76:79], a[252:255], v[136:139], v[76:79]
    s_waitcnt lgkmcnt(4)
    v_mfma_f32_16x16x32_bf16 v[80:83], v[208:211], v[120:123], v[80:83]
    ds_read_b64_tr_b16 a[248:249], v241 offset:256
    v_mfma_f32_16x16x32_bf16 v[88:91], v[208:211], v[124:127], v[88:91]
    v_mfma_f32_16x16x32_bf16 v[96:99], v[208:211], v[128:131], v[96:99]
    ds_read_b64_tr_b16 a[250:251], v241 offset:6400
    v_mfma_f32_16x16x32_bf16 v[104:107], v[208:211], v[132:135], v[104:107]
    buffer_load_dwordx4 v233, s[32:35], s59 offen offset:3072 lds
    s_add_u32 s59, s59, 40960
    v_mfma_f32_16x16x32_bf16 v[112:115], v[208:211], v[136:139], v[112:115]
    ds_read_b64_tr_b16 a[252:253], v242 offset:256
    v_mfma_f32_16x16x32_bf16 v[84:87], v[212:215], v[120:123], v[84:87]
    v_mfma_f32_16x16x32_bf16 v[92:95], v[212:215], v[124:127], v[92:95]
    ds_read_b64_tr_b16 a[254:255], v242 offset:6400
    v_mfma_f32_16x16x32_bf16 v[100:103], v[212:215], v[128:131], v[100:103]
    v_mfma_f32_16x16x32_bf16 v[108:111], v[212:215], v[132:135], v[108:111]
    v_mfma_f32_16x16x32_bf16 v[116:119], v[212:215], v[136:139], v[116:119]
    s_waitcnt lgkmcnt(4)
    v_mfma_f32_16x16x32_bf16 a[0:3], a[240:243], v[120:123], a[0:3]
    ds_read_b64_tr_b16 v[208:209], v243 offset:256
    v_mfma_f32_16x16x32_bf16 a[4:7], a[240:243], v[124:127], a[4:7]
    ds_read_b64_tr_b16 v[210:211], v243 offset:6400
    v_mfma_f32_16x16x32_bf16 a[8:11], a[240:243], v[128:131], a[8:11]
    ds_read_b64_tr_b16 v[212:213], v244 offset:256
    v_mfma_f32_16x16x32_bf16 a[12:15], a[240:243], v[132:135], a[12:15]
    ds_read_b64_tr_b16 v[214:215], v244 offset:6400
    v_mfma_f32_16x16x32_bf16 a[16:19], a[240:243], v[136:139], a[16:19]
    v_mfma_f32_16x16x32_bf16 a[20:23], a[244:247], v[120:123], a[20:23]
    v_mfma_f32_16x16x32_bf16 a[24:27], a[244:247], v[124:127], a[24:27]
    v_mfma_f32_16x16x32_bf16 a[28:31], a[244:247], v[128:131], a[28:31]
    v_mfma_f32_16x16x32_bf16 a[32:35], a[244:247], v[132:135], a[32:35]
    v_mfma_f32_16x16x32_bf16 a[36:39], a[244:247], v[136:139], a[36:39]
    s_waitcnt vmcnt(7) lgkmcnt(0)
    s_barrier
    v_mfma_f32_16x16x32_bf16 a[40:43], a[248:251], v[120:123], a[40:43]
    ds_read_b64_tr_b16 a[240:241], v241 offset:12288
    s_add_u32 m0, s70, 4096
    v_mfma_f32_16x16x32_bf16 a[44:47], a[248:251], v[124:127], a[44:47]
    ds_read_b128 v[140:143], v223 offset:20480
    v_mfma_f32_16x16x32_bf16 a[48:51], a[248:251], v[128:131], a[48:51]
    ds_read_b64_tr_b16 a[242:243], v241 offset:18432
    v_mfma_f32_16x16x32_bf16 a[52:55], a[248:251], v[132:135], a[52:55]
    ds_read_b128 v[144:147], v223 offset:22528
    v_mfma_f32_16x16x32_bf16 a[56:59], a[248:251], v[136:139], a[56:59]
    ds_read_b64_tr_b16 a[244:245], v242 offset:12288
    v_mfma_f32_16x16x32_bf16 a[60:63], a[252:255], v[120:123], a[60:63]
    ds_read_b128 v[148:151], v223 offset:24576
    v_mfma_f32_16x16x32_bf16 a[64:67], a[252:255], v[124:127], a[64:67]
    ds_read_b64_tr_b16 a[246:247], v242 offset:18432
    v_mfma_f32_16x16x32_bf16 a[68:71], a[252:255], v[128:131], a[68:71]
    ds_read_b128 v[152:155], v223 offset:26624
    v_mfma_f32_16x16x32_bf16 a[72:75], a[252:255], v[132:135], a[72:75]
    ds_read_b128 v[156:159], v223 offset:28672
    v_mfma_f32_16x16x32_bf16 a[76:79], a[252:255], v[136:139], a[76:79]
    buffer_load_dwordx4 v230, s[32:35], s59 offen offset:0 lds
    v_mfma_f32_16x16x32_bf16 a[80:83], v[208:211], v[120:123], a[80:83]
    ds_read_b64_tr_b16 a[248:249], v243 offset:12288
    v_mfma_f32_16x16x32_bf16 a[84:87], v[208:211], v[124:127], a[84:87]
    v_mfma_f32_16x16x32_bf16 a[88:91], v[208:211], v[128:131], a[88:91]
    ds_read_b64_tr_b16 a[250:251], v243 offset:18432
    v_mfma_f32_16x16x32_bf16 a[92:95], v[208:211], v[132:135], a[92:95]
    v_mfma_f32_16x16x32_bf16 a[96:99], v[208:211], v[136:139], a[96:99]
    ds_read_b64_tr_b16 a[252:253], v244 offset:12288
    v_mfma_f32_16x16x32_bf16 a[100:103], v[212:215], v[120:123], a[100:103]
    buffer_load_dwordx4 v231, s[32:35], s59 offen offset:1024 lds
    v_mfma_f32_16x16x32_bf16 a[104:107], v[212:215], v[124:127], a[104:107]
    ds_read_b64_tr_b16 a[254:255], v244 offset:18432
    v_mfma_f32_16x16x32_bf16 a[108:111], v[212:215], v[128:131], a[108:111]
    v_mfma_f32_16x16x32_bf16 a[112:115], v[212:215], v[132:135], a[112:115]
    v_mfma_f32_16x16x32_bf16 a[116:119], v[212:215], v[136:139], a[116:119]
    s_waitcnt lgkmcnt(6)
    v_mfma_f32_16x16x32_bf16 v[0:3], a[240:243], v[140:143], v[0:3]
    ds_read_b64_tr_b16 v[208:209], v241 offset:12416
    v_mfma_f32_16x16x32_bf16 v[8:11], a[240:243], v[144:147], v[8:11]
    buffer_load_dwordx4 v232, s[32:35], s59 offen offset:2048 lds
    v_mfma_f32_16x16x32_bf16 v[16:19], a[240:243], v[148:151], v[16:19]
    ds_read_b64_tr_b16 v[210:211], v241 offset:18560
    s_waitcnt lgkmcnt(7)
    v_mfma_f32_16x16x32_bf16 v[24:27], a[240:243], v[152:155], v[24:27]
    s_waitcnt lgkmcnt(6)
    v_mfma_f32_16x16x32_bf16 v[32:35], a[240:243], v[156:159], v[32:35]
    ds_read_b64_tr_b16 v[212:213], v242 offset:12416
    v_mfma_f32_16x16x32_bf16 v[4:7], a[244:247], v[140:143], v[4:7]
    v_mfma_f32_16x16x32_bf16 v[12:15], a[244:247], v[144:147], v[12:15]
    ds_read_b64_tr_b16 v[214:215], v242 offset:18560
    v_mfma_f32_16x16x32_bf16 v[20:23], a[244:247], v[148:151], v[20:23]
    buffer_load_dwordx4 v233, s[32:35], s59 offen offset:3072 lds
    s_add_u32 s59, s59, 40960
    v_mfma_f32_16x16x32_bf16 v[28:31], a[244:247], v[152:155], v[28:31]
    s_add_u32 m0, s70, 8192
    v_mfma_f32_16x16x32_bf16 v[36:39], a[244:247], v[156:159], v[36:39]
    s_waitcnt lgkmcnt(4)
    v_mfma_f32_16x16x32_bf16 v[40:43], a[248:251], v[140:143], v[40:43]
    ds_read_b64_tr_b16 a[240:241], v243 offset:12416
    v_mfma_f32_16x16x32_bf16 v[48:51], a[248:251], v[144:147], v[48:51]
    v_mfma_f32_16x16x32_bf16 v[56:59], a[248:251], v[148:151], v[56:59]
    ds_read_b64_tr_b16 a[242:243], v243 offset:18560
    v_mfma_f32_16x16x32_bf16 v[64:67], a[248:251], v[152:155], v[64:67]
    buffer_load_dwordx4 v230, s[32:35], s59 offen offset:0 lds
    v_mfma_f32_16x16x32_bf16 v[72:75], a[248:251], v[156:159], v[72:75]
    ds_read_b64_tr_b16 a[244:245], v244 offset:12416
    v_mfma_f32_16x16x32_bf16 v[44:47], a[252:255], v[140:143], v[44:47]
    v_mfma_f32_16x16x32_bf16 v[52:55], a[252:255], v[144:147], v[52:55]
    ds_read_b64_tr_b16 a[246:247], v244 offset:18560
    v_mfma_f32_16x16x32_bf16 v[60:63], a[252:255], v[148:151], v[60:63]
    v_mfma_f32_16x16x32_bf16 v[68:71], a[252:255], v[152:155], v[68:71]
    buffer_load_dwordx4 v231, s[32:35], s59 offen offset:1024 lds
    v_mfma_f32_16x16x32_bf16 v[76:79], a[252:255], v[156:159], v[76:79]
    s_waitcnt lgkmcnt(4)
    v_mfma_f32_16x16x32_bf16 v[80:83], v[208:211], v[140:143], v[80:83]
    ds_read_b64_tr_b16 a[248:249], v241 offset:12544
    v_mfma_f32_16x16x32_bf16 v[88:91], v[208:211], v[144:147], v[88:91]
    s_add_u32 s68, s68, 128
    s_cmp_ge_u32 s68, 1280
    s_cselect_b32 s68, 0, s68
    v_mfma_f32_16x16x32_bf16 v[96:99], v[208:211], v[148:151], v[96:99]
    ds_read_b64_tr_b16 a[250:251], v241 offset:18688
    s_add_u32 s58, s71, s67
    v_mfma_f32_16x16x32_bf16 v[104:107], v[208:211], v[152:155], v[104:107]
    s_add_u32 m0, s8, 40960
    v_mfma_f32_16x16x32_bf16 v[112:115], v[208:211], v[156:159], v[112:115]
    ds_read_b64_tr_b16 a[252:253], v242 offset:12544
    v_mfma_f32_16x16x32_bf16 v[84:87], v[212:215], v[140:143], v[84:87]
    buffer_load_dwordx4 v227, s[36:39], s58 offen offset:0 lds
    v_mfma_f32_16x16x32_bf16 v[92:95], v[212:215], v[144:147], v[92:95]
    ds_read_b64_tr_b16 a[254:255], v242 offset:18688
    v_mfma_f32_16x16x32_bf16 v[100:103], v[212:215], v[148:151], v[100:103]
    v_mfma_f32_16x16x32_bf16 v[108:111], v[212:215], v[152:155], v[108:111]
    v_mfma_f32_16x16x32_bf16 v[116:119], v[212:215], v[156:159], v[116:119]
    s_waitcnt lgkmcnt(4)
    v_mfma_f32_16x16x32_bf16 a[0:3], a[240:243], v[140:143], a[0:3]
    ds_read_b64_tr_b16 v[208:209], v243 offset:12544
    v_mfma_f32_16x16x32_bf16 a[4:7], a[240:243], v[144:147], a[4:7]
    ds_read_b64_tr_b16 v[210:211], v243 offset:18688
    v_mfma_f32_16x16x32_bf16 a[8:11], a[240:243], v[148:151], a[8:11]
    ds_read_b64_tr_b16 v[212:213], v244 offset:12544
    v_mfma_f32_16x16x32_bf16 a[12:15], a[240:243], v[152:155], a[12:15]
    ds_read_b64_tr_b16 v[214:215], v244 offset:18688
    v_mfma_f32_16x16x32_bf16 a[16:19], a[240:243], v[156:159], a[16:19]
    buffer_load_dwordx4 v228, s[36:39], s58 offen offset:1024 lds
    v_mfma_f32_16x16x32_bf16 a[20:23], a[244:247], v[140:143], a[20:23]
    v_mfma_f32_16x16x32_bf16 a[24:27], a[244:247], v[144:147], a[24:27]
    v_mfma_f32_16x16x32_bf16 a[28:31], a[244:247], v[148:151], a[28:31]
    v_mfma_f32_16x16x32_bf16 a[32:35], a[244:247], v[152:155], a[32:35]
    v_mfma_f32_16x16x32_bf16 a[36:39], a[244:247], v[156:159], a[36:39]
    buffer_load_dwordx4 v229, s[36:39], s58 offen offset:2048 lds
    s_add_u32 s67, s67, 393216
    s_cmp_ge_u32 s67, 7864320
    s_cselect_b32 s67, 0, s67
    s_waitcnt vmcnt(3) lgkmcnt(0)
    s_barrier
    v_mfma_f32_16x16x32_bf16 a[40:43], a[248:251], v[140:143], a[40:43]
    ds_read_b64_tr_b16 a[240:241], v241 offset:24576
    s_add_u32 s58, s71, s67
    v_mfma_f32_16x16x32_bf16 a[44:47], a[248:251], v[144:147], a[44:47]
    ds_read_b128 v[120:123], v222 offset:0
    s_add_u32 m0, s8, 53248
    v_mfma_f32_16x16x32_bf16 a[48:51], a[248:251], v[148:151], a[48:51]
    ds_read_b64_tr_b16 a[242:243], v241 offset:30720
    v_mfma_f32_16x16x32_bf16 a[52:55], a[248:251], v[152:155], a[52:55]
    ds_read_b128 v[124:127], v222 offset:2048
    v_mfma_f32_16x16x32_bf16 a[56:59], a[248:251], v[156:159], a[56:59]
    ds_read_b64_tr_b16 a[244:245], v242 offset:24576
    v_mfma_f32_16x16x32_bf16 a[60:63], a[252:255], v[140:143], a[60:63]
    ds_read_b128 v[128:131], v222 offset:4096
    v_mfma_f32_16x16x32_bf16 a[64:67], a[252:255], v[144:147], a[64:67]
    ds_read_b64_tr_b16 a[246:247], v242 offset:30720
    v_mfma_f32_16x16x32_bf16 a[68:71], a[252:255], v[148:151], a[68:71]
    ds_read_b128 v[132:135], v222 offset:6144
    v_mfma_f32_16x16x32_bf16 a[72:75], a[252:255], v[152:155], a[72:75]
    ds_read_b128 v[136:139], v222 offset:8192
    v_mfma_f32_16x16x32_bf16 a[76:79], a[252:255], v[156:159], a[76:79]
    buffer_load_dwordx4 v227, s[36:39], s58 offen offset:0 lds
    v_mfma_f32_16x16x32_bf16 a[80:83], v[208:211], v[140:143], a[80:83]
    ds_read_b64_tr_b16 a[248:249], v243 offset:24576
    v_mfma_f32_16x16x32_bf16 a[84:87], v[208:211], v[144:147], a[84:87]
    v_mfma_f32_16x16x32_bf16 a[88:91], v[208:211], v[148:151], a[88:91]
    ds_read_b64_tr_b16 a[250:251], v243 offset:30720
    v_mfma_f32_16x16x32_bf16 a[92:95], v[208:211], v[152:155], a[92:95]
    v_mfma_f32_16x16x32_bf16 a[96:99], v[208:211], v[156:159], a[96:99]
    ds_read_b64_tr_b16 a[252:253], v244 offset:24576
    v_mfma_f32_16x16x32_bf16 a[100:103], v[212:215], v[140:143], a[100:103]
    buffer_load_dwordx4 v228, s[36:39], s58 offen offset:1024 lds
    v_mfma_f32_16x16x32_bf16 a[104:107], v[212:215], v[144:147], a[104:107]
    ds_read_b64_tr_b16 a[254:255], v244 offset:30720
    v_mfma_f32_16x16x32_bf16 a[108:111], v[212:215], v[148:151], a[108:111]
    v_mfma_f32_16x16x32_bf16 a[112:115], v[212:215], v[152:155], a[112:115]
    v_mfma_f32_16x16x32_bf16 a[116:119], v[212:215], v[156:159], a[116:119]
    s_waitcnt lgkmcnt(6)
    v_mfma_f32_16x16x32_bf16 v[0:3], a[240:243], v[120:123], v[0:3]
    ds_read_b64_tr_b16 v[208:209], v241 offset:24704
    v_mfma_f32_16x16x32_bf16 v[8:11], a[240:243], v[124:127], v[8:11]
    buffer_load_dwordx4 v229, s[36:39], s58 offen offset:2048 lds
    v_mfma_f32_16x16x32_bf16 v[16:19], a[240:243], v[128:131], v[16:19]
    ds_read_b64_tr_b16 v[210:211], v241 offset:30848
    s_waitcnt lgkmcnt(7)
    v_mfma_f32_16x16x32_bf16 v[24:27], a[240:243], v[132:135], v[24:27]
    s_add_u32 s67, s67, 393216
    s_cmp_ge_u32 s67, 7864320
    s_cselect_b32 s67, 0, s67
    s_waitcnt lgkmcnt(6)
    v_mfma_f32_16x16x32_bf16 v[32:35], a[240:243], v[136:139], v[32:35]
    ds_read_b64_tr_b16 v[212:213], v242 offset:24704
    s_add_u32 s59, s74, s68
    v_mfma_f32_16x16x32_bf16 v[4:7], a[244:247], v[120:123], v[4:7]
    s_add_u32 m0, s70, 20480
    v_mfma_f32_16x16x32_bf16 v[12:15], a[244:247], v[124:127], v[12:15]
    ds_read_b64_tr_b16 v[214:215], v242 offset:30848
    v_mfma_f32_16x16x32_bf16 v[20:23], a[244:247], v[128:131], v[20:23]
    buffer_load_dwordx4 v230, s[32:35], s59 offen offset:0 lds
    v_mfma_f32_16x16x32_bf16 v[28:31], a[244:247], v[132:135], v[28:31]
    v_mfma_f32_16x16x32_bf16 v[36:39], a[244:247], v[136:139], v[36:39]
    s_waitcnt lgkmcnt(4)
    v_mfma_f32_16x16x32_bf16 v[40:43], a[248:251], v[120:123], v[40:43]
    ds_read_b64_tr_b16 a[240:241], v243 offset:24704
    v_mfma_f32_16x16x32_bf16 v[48:51], a[248:251], v[124:127], v[48:51]
    v_mfma_f32_16x16x32_bf16 v[56:59], a[248:251], v[128:131], v[56:59]
    ds_read_b64_tr_b16 a[242:243], v243 offset:30848
    v_mfma_f32_16x16x32_bf16 v[64:67], a[248:251], v[132:135], v[64:67]
    buffer_load_dwordx4 v231, s[32:35], s59 offen offset:1024 lds
    v_mfma_f32_16x16x32_bf16 v[72:75], a[248:251], v[136:139], v[72:75]
    ds_read_b64_tr_b16 a[244:245], v244 offset:24704
    v_mfma_f32_16x16x32_bf16 v[44:47], a[252:255], v[120:123], v[44:47]
    v_mfma_f32_16x16x32_bf16 v[52:55], a[252:255], v[124:127], v[52:55]
    ds_read_b64_tr_b16 a[246:247], v244 offset:30848
    v_mfma_f32_16x16x32_bf16 v[60:63], a[252:255], v[128:131], v[60:63]
    v_mfma_f32_16x16x32_bf16 v[68:71], a[252:255], v[132:135], v[68:71]
    buffer_load_dwordx4 v232, s[32:35], s59 offen offset:2048 lds
    v_mfma_f32_16x16x32_bf16 v[76:79], a[252:255], v[136:139], v[76:79]
    s_waitcnt lgkmcnt(4)
    v_mfma_f32_16x16x32_bf16 v[80:83], v[208:211], v[120:123], v[80:83]
    ds_read_b64_tr_b16 a[248:249], v241 offset:24832
    v_mfma_f32_16x16x32_bf16 v[88:91], v[208:211], v[124:127], v[88:91]
    v_mfma_f32_16x16x32_bf16 v[96:99], v[208:211], v[128:131], v[96:99]
    ds_read_b64_tr_b16 a[250:251], v241 offset:30976
    v_mfma_f32_16x16x32_bf16 v[104:107], v[208:211], v[132:135], v[104:107]
    buffer_load_dwordx4 v233, s[32:35], s59 offen offset:3072 lds
    s_add_u32 s59, s59, 40960
    v_mfma_f32_16x16x32_bf16 v[112:115], v[208:211], v[136:139], v[112:115]
    ds_read_b64_tr_b16 a[252:253], v242 offset:24832
    v_mfma_f32_16x16x32_bf16 v[84:87], v[212:215], v[120:123], v[84:87]
    v_mfma_f32_16x16x32_bf16 v[92:95], v[212:215], v[124:127], v[92:95]
    ds_read_b64_tr_b16 a[254:255], v242 offset:30976
    v_mfma_f32_16x16x32_bf16 v[100:103], v[212:215], v[128:131], v[100:103]
    v_mfma_f32_16x16x32_bf16 v[108:111], v[212:215], v[132:135], v[108:111]
    v_mfma_f32_16x16x32_bf16 v[116:119], v[212:215], v[136:139], v[116:119]
    s_waitcnt lgkmcnt(4)
    v_mfma_f32_16x16x32_bf16 a[0:3], a[240:243], v[120:123], a[0:3]
    ds_read_b64_tr_b16 v[208:209], v243 offset:24832
    v_mfma_f32_16x16x32_bf16 a[4:7], a[240:243], v[124:127], a[4:7]
    ds_read_b64_tr_b16 v[210:211], v243 offset:30976
    v_mfma_f32_16x16x32_bf16 a[8:11], a[240:243], v[128:131], a[8:11]
    ds_read_b64_tr_b16 v[212:213], v244 offset:24832
    v_mfma_f32_16x16x32_bf16 a[12:15], a[240:243], v[132:135], a[12:15]
    ds_read_b64_tr_b16 v[214:215], v244 offset:30976
    v_mfma_f32_16x16x32_bf16 a[16:19], a[240:243], v[136:139], a[16:19]
    v_mfma_f32_16x16x32_bf16 a[20:23], a[244:247], v[120:123], a[20:23]
    v_mfma_f32_16x16x32_bf16 a[24:27], a[244:247], v[124:127], a[24:27]
    v_mfma_f32_16x16x32_bf16 a[28:31], a[244:247], v[128:131], a[28:31]
    v_mfma_f32_16x16x32_bf16 a[32:35], a[244:247], v[132:135], a[32:35]
    v_mfma_f32_16x16x32_bf16 a[36:39], a[244:247], v[136:139], a[36:39]
    s_waitcnt vmcnt(7) lgkmcnt(0)
    s_barrier
    v_mfma_f32_16x16x32_bf16 a[40:43], a[248:251], v[120:123], a[40:43]
    ds_read_b64_tr_b16 a[240:241], v241 offset:0
    s_add_u32 m0, s70, 24576
    v_mfma_f32_16x16x32_bf16 a[44:47], a[248:251], v[124:127], a[44:47]
    ds_read_b128 v[140:143], v223 offset:0
    v_mfma_f32_16x16x32_bf16 a[48:51], a[248:251], v[128:131], a[48:51]
    ds_read_b64_tr_b16 a[242:243], v241 offset:6144
    v_mfma_f32_16x16x32_bf16 a[52:55], a[248:251], v[132:135], a[52:55]
    ds_read_b128 v[144:147], v223 offset:2048
    v_mfma_f32_16x16x32_bf16 a[56:59], a[248:251], v[136:139], a[56:59]
    ds_read_b64_tr_b16 a[244:245], v242 offset:0
    v_mfma_f32_16x16x32_bf16 a[60:63], a[252:255], v[120:123], a[60:63]
    ds_read_b128 v[148:151], v223 offset:4096
    v_mfma_f32_16x16x32_bf16 a[64:67], a[252:255], v[124:127], a[64:67]
    ds_read_b64_tr_b16 a[246:247], v242 offset:6144
    v_mfma_f32_16x16x32_bf16 a[68:71], a[252:255], v[128:131], a[68:71]
    ds_read_b128 v[152:155], v223 offset:6144
    v_mfma_f32_16x16x32_bf16 a[72:75], a[252:255], v[132:135], a[72:75]
    ds_read_b128 v[156:159], v223 offset:8192
    v_mfma_f32_16x16x32_bf16 a[76:79], a[252:255], v[136:139], a[76:79]
    buffer_load_dwordx4 v230, s[32:35], s59 offen offset:0 lds
    v_mfma_f32_16x16x32_bf16 a[80:83], v[208:211], v[120:123], a[80:83]
    ds_read_b64_tr_b16 a[248:249], v243 offset:0
    v_mfma_f32_16x16x32_bf16 a[84:87], v[208:211], v[124:127], a[84:87]
    v_mfma_f32_16x16x32_bf16 a[88:91], v[208:211], v[128:131], a[88:91]
    ds_read_b64_tr_b16 a[250:251], v243 offset:6144
    v_mfma_f32_16x16x32_bf16 a[92:95], v[208:211], v[132:135], a[92:95]
    v_mfma_f32_16x16x32_bf16 a[96:99], v[208:211], v[136:139], a[96:99]
    ds_read_b64_tr_b16 a[252:253], v244 offset:0
    v_mfma_f32_16x16x32_bf16 a[100:103], v[212:215], v[120:123], a[100:103]
    buffer_load_dwordx4 v231, s[32:35], s59 offen offset:1024 lds
    v_mfma_f32_16x16x32_bf16 a[104:107], v[212:215], v[124:127], a[104:107]
    ds_read_b64_tr_b16 a[254:255], v244 offset:6144
    v_mfma_f32_16x16x32_bf16 a[108:111], v[212:215], v[128:131], a[108:111]
    v_mfma_f32_16x16x32_bf16 a[112:115], v[212:215], v[132:135], a[112:115]
    v_mfma_f32_16x16x32_bf16 a[116:119], v[212:215], v[136:139], a[116:119]
    s_waitcnt lgkmcnt(6)
    v_mfma_f32_16x16x32_bf16 v[0:3], a[240:243], v[140:143], v[0:3]
    ds_read_b64_tr_b16 v[208:209], v241 offset:128
    v_mfma_f32_16x16x32_bf16 v[8:11], a[240:243], v[144:147], v[8:11]
    buffer_load_dwordx4 v232, s[32:35], s59 offen offset:2048 lds
    v_mfma_f32_16x16x32_bf16 v[16:19], a[240:243], v[148:151], v[16:19]
    ds_read_b64_tr_b16 v[210:211], v241 offset:6272
    s_waitcnt lgkmcnt(7)
    v_mfma_f32_16x16x32_bf16 v[24:27], a[240:243], v[152:155], v[24:27]
    s_waitcnt lgkmcnt(6)
    v_mfma_f32_16x16x32_bf16 v[32:35], a[240:243], v[156:159], v[32:35]
    ds_read_b64_tr_b16 v[212:213], v242 offset:128
    v_mfma_f32_16x16x32_bf16 v[4:7], a[244:247], v[140:143], v[4:7]
    buffer_load_dwordx4 v233, s[32:35], s59 offen offset:3072 lds
    s_add_u32 s59, s59, 40960
    v_mfma_f32_16x16x32_bf16 v[12:15], a[244:247], v[144:147], v[12:15]
    ds_read_b64_tr_b16 v[214:215], v242 offset:6272
    s_add_u32 m0, s70, 28672
    v_mfma_f32_16x16x32_bf16 v[20:23], a[244:247], v[148:151], v[20:23]
    v_mfma_f32_16x16x32_bf16 v[28:31], a[244:247], v[152:155], v[28:31]
    buffer_load_dwordx4 v230, s[32:35], s59 offen offset:0 lds
    v_mfma_f32_16x16x32_bf16 v[36:39], a[244:247], v[156:159], v[36:39]
    s_waitcnt lgkmcnt(4)
    v_mfma_f32_16x16x32_bf16 v[40:43], a[248:251], v[140:143], v[40:43]
    ds_read_b64_tr_b16 a[240:241], v243 offset:128
    v_mfma_f32_16x16x32_bf16 v[48:51], a[248:251], v[144:147], v[48:51]
    buffer_load_dwordx4 v231, s[32:35], s59 offen offset:1024 lds
    v_mfma_f32_16x16x32_bf16 v[56:59], a[248:251], v[148:151], v[56:59]
    ds_read_b64_tr_b16 a[242:243], v243 offset:6272
    v_mfma_f32_16x16x32_bf16 v[64:67], a[248:251], v[152:155], v[64:67]
    s_add_u32 s68, s68, 128
    s_cmp_ge_u32 s68, 1280
    s_cselect_b32 s68, 0, s68
    v_mfma_f32_16x16x32_bf16 v[72:75], a[248:251], v[156:159], v[72:75]
    ds_read_b64_tr_b16 a[244:245], v244 offset:128
    s_add_u32 s58, s71, s67
    v_mfma_f32_16x16x32_bf16 v[44:47], a[252:255], v[140:143], v[44:47]
    s_add_u32 m0, s8, 65536
    v_mfma_f32_16x16x32_bf16 v[52:55], a[252:255], v[144:147], v[52:55]
    ds_read_b64_tr_b16 a[246:247], v244 offset:6272
    v_mfma_f32_16x16x32_bf16 v[60:63], a[252:255], v[148:151], v[60:63]
    buffer_load_dwordx4 v227, s[36:39], s58 offen offset:0 lds
    v_mfma_f32_16x16x32_bf16 v[68:71], a[252:255], v[152:155], v[68:71]
    v_mfma_f32_16x16x32_bf16 v[76:79], a[252:255], v[156:159], v[76:79]
    s_waitcnt lgkmcnt(4)
    v_mfma_f32_16x16x32_bf16 v[80:83], v[208:211], v[140:143], v[80:83]
    ds_read_b64_tr_b16 a[248:249], v241 offset:256
    v_mfma_f32_16x16x32_bf16 v[88:91], v[208:211], v[144:147], v[88:91]
    buffer_load_dwordx4 v228, s[36:39], s58 offen offset:1024 lds
    v_mfma_f32_16x16x32_bf16 v[96:99], v[208:211], v[148:151], v[96:99]
    ds_read_b64_tr_b16 a[250:251], v241 offset:6400
    v_mfma_f32_16x16x32_bf16 v[104:107], v[208:211], v[152:155], v[104:107]
    v_mfma_f32_16x16x32_bf16 v[112:115], v[208:211], v[156:159], v[112:115]
    ds_read_b64_tr_b16 a[252:253], v242 offset:256
    v_mfma_f32_16x16x32_bf16 v[84:87], v[212:215], v[140:143], v[84:87]
    buffer_load_dwordx4 v229, s[36:39], s58 offen offset:2048 lds
    v_mfma_f32_16x16x32_bf16 v[92:95], v[212:215], v[144:147], v[92:95]
    ds_read_b64_tr_b16 a[254:255], v242 offset:6400
    v_mfma_f32_16x16x32_bf16 v[100:103], v[212:215], v[148:151], v[100:103]
    s_add_u32 s67, s67, 393216
    s_cmp_ge_u32 s67, 7864320
    s_cselect_b32 s67, 0, s67
    v_mfma_f32_16x16x32_bf16 v[108:111], v[212:215], v[152:155], v[108:111]
    v_mfma_f32_16x16x32_bf16 v[116:119], v[212:215], v[156:159], v[116:119]
    s_waitcnt lgkmcnt(4)
    v_mfma_f32_16x16x32_bf16 a[0:3], a[240:243], v[140:143], a[0:3]
    ds_read_b64_tr_b16 v[208:209], v243 offset:256
    v_mfma_f32_16x16x32_bf16 a[4:7], a[240:243], v[144:147], a[4:7]
    ds_read_b64_tr_b16 v[210:211], v243 offset:6400
    v_mfma_f32_16x16x32_bf16 a[8:11], a[240:243], v[148:151], a[8:11]
    ds_read_b64_tr_b16 v[212:213], v244 offset:256
    v_mfma_f32_16x16x32_bf16 a[12:15], a[240:243], v[152:155], a[12:15]
    ds_read_b64_tr_b16 v[214:215], v244 offset:6400
    v_mfma_f32_16x16x32_bf16 a[16:19], a[240:243], v[156:159], a[16:19]
    v_mfma_f32_16x16x32_bf16 a[20:23], a[244:247], v[140:143], a[20:23]
    v_mfma_f32_16x16x32_bf16 a[24:27], a[244:247], v[144:147], a[24:27]
    v_mfma_f32_16x16x32_bf16 a[28:31], a[244:247], v[148:151], a[28:31]
    v_mfma_f32_16x16x32_bf16 a[32:35], a[244:247], v[152:155], a[32:35]
    v_mfma_f32_16x16x32_bf16 a[36:39], a[244:247], v[156:159], a[36:39]
    s_waitcnt vmcnt(3) lgkmcnt(0)
    s_barrier
    v_mfma_f32_16x16x32_bf16 a[40:43], a[248:251], v[140:143], a[40:43]
    ds_read_b64_tr_b16 a[240:241], v241 offset:12288
    s_add_u32 m0, s8, 0
    v_mfma_f32_16x16x32_bf16 a[44:47], a[248:251], v[144:147], a[44:47]
    ds_read_b128 v[120:123], v222 offset:20480
    v_mfma_f32_16x16x32_bf16 a[48:51], a[248:251], v[148:151], a[48:51]
    ds_read_b64_tr_b16 a[242:243], v241 offset:18432
    v_mfma_f32_16x16x32_bf16 a[52:55], a[248:251], v[152:155], a[52:55]
    ds_read_b128 v[124:127], v222 offset:22528
    v_mfma_f32_16x16x32_bf16 a[56:59], a[248:251], v[156:159], a[56:59]
    ds_read_b64_tr_b16 a[244:245], v242 offset:12288
    v_mfma_f32_16x16x32_bf16 a[60:63], a[252:255], v[140:143], a[60:63]
    ds_read_b128 v[128:131], v222 offset:24576
    v_mfma_f32_16x16x32_bf16 a[64:67], a[252:255], v[144:147], a[64:67]
    ds_read_b64_tr_b16 a[246:247], v242 offset:18432
    v_mfma_f32_16x16x32_bf16 a[68:71], a[252:255], v[148:151], a[68:71]
    ds_read_b128 v[132:135], v222 offset:26624
    v_mfma_f32_16x16x32_bf16 a[72:75], a[252:255], v[152:155], a[72:75]
    ds_read_b128 v[136:139], v222 offset:28672
    v_mfma_f32_16x16x32_bf16 a[76:79], a[252:255], v[156:159], a[76:79]
    buffer_load_dwordx4 v224, s[40:43], s65 offen offset:0 nt lds
    v_mfma_f32_16x16x32_bf16 a[80:83], v[208:211], v[140:143], a[80:83]
    ds_read_b64_tr_b16 a[248:249], v243 offset:12288
    buffer_load_dwordx4 v225, s[40:43], s65 offen offset:1024 nt lds
    v_mfma_f32_16x16x32_bf16 a[84:87], v[208:211], v[144:147], a[84:87]
    buffer_load_dwordx4 v226, s[40:43], s65 offen offset:2048 nt lds
    s_add_u32 s65, s65, 6291456
    v_mfma_f32_16x16x32_bf16 a[88:91], v[208:211], v[148:151], a[88:91]
    ds_read_b64_tr_b16 a[250:251], v243 offset:18432
    s_add_u32 m0, s8, 81920
    v_mfma_f32_16x16x32_bf16 a[92:95], v[208:211], v[152:155], a[92:95]
    buffer_load_dwordx4 v224, s[40:43], s65 offen offset:0 nt lds
    v_mfma_f32_16x16x32_bf16 a[96:99], v[208:211], v[156:159], a[96:99]
    ds_read_b64_tr_b16 a[252:253], v244 offset:12288
    buffer_load_dwordx4 v225, s[40:43], s65 offen offset:1024 nt lds
    v_mfma_f32_16x16x32_bf16 a[100:103], v[212:215], v[140:143], a[100:103]
    buffer_load_dwordx4 v226, s[40:43], s65 offen offset:2048 nt lds
    s_add_u32 s65, s65, 4288688128
    v_mfma_f32_16x16x32_bf16 a[104:107], v[212:215], v[144:147], a[104:107]
    ds_read_b64_tr_b16 a[254:255], v244 offset:18432
    s_add_u32 m0, s8, 40960
    v_mfma_f32_16x16x32_bf16 a[108:111], v[212:215], v[148:151], a[108:111]
    buffer_load_dwordx4 v224, s[44:47], s66 offen offset:0 nt lds
    v_mfma_f32_16x16x32_bf16 a[112:115], v[212:215], v[152:155], a[112:115]
    buffer_load_dwordx4 v225, s[44:47], s66 offen offset:1024 nt lds
    v_mfma_f32_16x16x32_bf16 a[116:119], v[212:215], v[156:159], a[116:119]
    buffer_load_dwordx4 v226, s[44:47], s66 offen offset:2048 nt lds
    s_waitcnt lgkmcnt(6)
    v_mfma_f32_16x16x32_bf16 v[0:3], a[240:243], v[120:123], v[0:3]
    ds_read_b64_tr_b16 v[208:209], v241 offset:12416
    s_add_u32 s66, s66, 6291456
    v_mfma_f32_16x16x32_bf16 v[8:11], a[240:243], v[124:127], v[8:11]
    s_add_u32 m0, s8, 122880
    v_mfma_f32_16x16x32_bf16 v[16:19], a[240:243], v[128:131], v[16:19]
    ds_read_b64_tr_b16 v[210:211], v241 offset:18560
    s_waitcnt lgkmcnt(7)
    v_mfma_f32_16x16x32_bf16 v[24:27], a[240:243], v[132:135], v[24:27]
    buffer_load_dwordx4 v224, s[44:47], s66 offen offset:0 nt lds
    s_waitcnt lgkmcnt(6)
    v_mfma_f32_16x16x32_bf16 v[32:35], a[240:243], v[136:139], v[32:35]
    ds_read_b64_tr_b16 v[212:213], v242 offset:12416
    buffer_load_dwordx4 v225, s[44:47], s66 offen offset:1024 nt lds
    v_mfma_f32_16x16x32_bf16 v[4:7], a[244:247], v[120:123], v[4:7]
    buffer_load_dwordx4 v226, s[44:47], s66 offen offset:2048 nt lds
    s_add_u32 s66, s66, 4288688128
    v_mfma_f32_16x16x32_bf16 v[12:15], a[244:247], v[124:127], v[12:15]
    ds_read_b64_tr_b16 v[214:215], v242 offset:18560
    v_mfma_f32_16x16x32_bf16 v[20:23], a[244:247], v[128:131], v[20:23]
    v_mfma_f32_16x16x32_bf16 v[28:31], a[244:247], v[132:135], v[28:31]
    v_mfma_f32_16x16x32_bf16 v[36:39], a[244:247], v[136:139], v[36:39]
    s_waitcnt lgkmcnt(4)
    v_mfma_f32_16x16x32_bf16 v[40:43], a[248:251], v[120:123], v[40:43]
    ds_read_b64_tr_b16 a[240:241], v243 offset:12416
    v_mfma_f32_16x16x32_bf16 v[48:51], a[248:251], v[124:127], v[48:51]
    v_mfma_f32_16x16x32_bf16 v[56:59], a[248:251], v[128:131], v[56:59]
    ds_read_b64_tr_b16 a[242:243], v243 offset:18560
    v_mfma_f32_16x16x32_bf16 v[64:67], a[248:251], v[132:135], v[64:67]
    v_mfma_f32_16x16x32_bf16 v[72:75], a[248:251], v[136:139], v[72:75]
    ds_read_b64_tr_b16 a[244:245], v244 offset:12416
    v_mfma_f32_16x16x32_bf16 v[44:47], a[252:255], v[120:123], v[44:47]
    v_mfma_f32_16x16x32_bf16 v[52:55], a[252:255], v[124:127], v[52:55]
    ds_read_b64_tr_b16 a[246:247], v244 offset:18560
    v_mfma_f32_16x16x32_bf16 v[60:63], a[252:255], v[128:131], v[60:63]
    v_mfma_f32_16x16x32_bf16 v[68:71], a[252:255], v[132:135], v[68:71]
    v_mfma_f32_16x16x32_bf16 v[76:79], a[252:255], v[136:139], v[76:79]
    s_waitcnt lgkmcnt(4)
    v_mfma_f32_16x16x32_bf16 v[80:83], v[208:211], v[120:123], v[80:83]
    ds_read_b64_tr_b16 a[248:249], v241 offset:12544
    v_mfma_f32_16x16x32_bf16 v[88:91], v[208:211], v[124:127], v[88:91]
    v_mfma_f32_16x16x32_bf16 v[96:99], v[208:211], v[128:131], v[96:99]
    ds_read_b64_tr_b16 a[250:251], v241 offset:18688
    v_mfma_f32_16x16x32_bf16 v[104:107], v[208:211], v[132:135], v[104:107]
    v_mfma_f32_16x16x32_bf16 v[112:115], v[208:211], v[136:139], v[112:115]
    ds_read_b64_tr_b16 a[252:253], v242 offset:12544
    v_mfma_f32_16x16x32_bf16 v[84:87], v[212:215], v[120:123], v[84:87]
    v_mfma_f32_16x16x32_bf16 v[92:95], v[212:215], v[124:127], v[92:95]
    ds_read_b64_tr_b16 a[254:255], v242 offset:18688
    v_mfma_f32_16x16x32_bf16 v[100:103], v[212:215], v[128:131], v[100:103]
    v_mfma_f32_16x16x32_bf16 v[108:111], v[212:215], v[132:135], v[108:111]
    v_mfma_f32_16x16x32_bf16 v[116:119], v[212:215], v[136:139], v[116:119]
    s_waitcnt lgkmcnt(4)
    v_mfma_f32_16x16x32_bf16 a[0:3], a[240:243], v[120:123], a[0:3]
    ds_read_b64_tr_b16 v[208:209], v243 offset:12544
    v_mfma_f32_16x16x32_bf16 a[4:7], a[240:243], v[124:127], a[4:7]
    ds_read_b64_tr_b16 v[210:211], v243 offset:18688
    v_mfma_f32_16x16x32_bf16 a[8:11], a[240:243], v[128:131], a[8:11]
    ds_read_b64_tr_b16 v[212:213], v244 offset:12544
    v_mfma_f32_16x16x32_bf16 a[12:15], a[240:243], v[132:135], a[12:15]
    ds_read_b64_tr_b16 v[214:215], v244 offset:18688
    v_mfma_f32_16x16x32_bf16 a[16:19], a[240:243], v[136:139], a[16:19]
    v_mfma_f32_16x16x32_bf16 a[20:23], a[244:247], v[120:123], a[20:23]
    v_mfma_f32_16x16x32_bf16 a[24:27], a[244:247], v[124:127], a[24:27]
    v_mfma_f32_16x16x32_bf16 a[28:31], a[244:247], v[128:131], a[28:31]
    v_mfma_f32_16x16x32_bf16 a[32:35], a[244:247], v[132:135], a[32:35]
    v_mfma_f32_16x16x32_bf16 a[36:39], a[244:247], v[136:139], a[36:39]
    s_waitcnt vmcnt(12) lgkmcnt(0)
    s_barrier
    v_mfma_f32_16x16x32_bf16 a[40:43], a[248:251], v[120:123], a[40:43]
    ds_read_b64_tr_b16 a[240:241], v241 offset:24576
    s_add_u32 m0, s8, 53248
    v_mfma_f32_16x16x32_bf16 a[44:47], a[248:251], v[124:127], a[44:47]
    ds_read_b128 v[140:143], v223 offset:20480
    v_mfma_f32_16x16x32_bf16 a[48:51], a[248:251], v[128:131], a[48:51]
    ds_read_b64_tr_b16 a[242:243], v241 offset:30720
    v_mfma_f32_16x16x32_bf16 a[52:55], a[248:251], v[132:135], a[52:55]
    ds_read_b128 v[144:147], v223 offset:22528
    v_mfma_f32_16x16x32_bf16 a[56:59], a[248:251], v[136:139], a[56:59]
    ds_read_b64_tr_b16 a[244:245], v242 offset:24576
    v_mfma_f32_16x16x32_bf16 a[60:63], a[252:255], v[120:123], a[60:63]
    ds_read_b128 v[148:151], v223 offset:24576
    v_mfma_f32_16x16x32_bf16 a[64:67], a[252:255], v[124:127], a[64:67]
    ds_read_b64_tr_b16 a[246:247], v242 offset:30720
    v_mfma_f32_16x16x32_bf16 a[68:71], a[252:255], v[128:131], a[68:71]
    ds_read_b128 v[152:155], v223 offset:26624
    v_mfma_f32_16x16x32_bf16 a[72:75], a[252:255], v[132:135], a[72:75]
    ds_read_b128 v[156:159], v223 offset:28672
    v_mfma_f32_16x16x32_bf16 a[76:79], a[252:255], v[136:139], a[76:79]
    buffer_load_dwordx4 v224, s[44:47], s66 offen offset:0 nt lds
    v_mfma_f32_16x16x32_bf16 a[80:83], v[208:211], v[120:123], a[80:83]
    ds_read_b64_tr_b16 a[248:249], v243 offset:24576
    buffer_load_dwordx4 v225, s[44:47], s66 offen offset:1024 nt lds
    v_mfma_f32_16x16x32_bf16 a[84:87], v[208:211], v[124:127], a[84:87]
    buffer_load_dwordx4 v226, s[44:47], s66 offen offset:2048 nt lds
    s_add_u32 s66, s66, 6291456
    v_mfma_f32_16x16x32_bf16 a[88:91], v[208:211], v[128:131], a[88:91]
    ds_read_b64_tr_b16 a[250:251], v243 offset:30720
    s_add_u32 m0, s8, 135168
    v_mfma_f32_16x16x32_bf16 a[92:95], v[208:211], v[132:135], a[92:95]
    buffer_load_dwordx4 v224, s[44:47], s66 offen offset:0 nt lds
    v_mfma_f32_16x16x32_bf16 a[96:99], v[208:211], v[136:139], a[96:99]
    ds_read_b64_tr_b16 a[252:253], v244 offset:24576
    buffer_load_dwordx4 v225, s[44:47], s66 offen offset:1024 nt lds
    v_mfma_f32_16x16x32_bf16 a[100:103], v[212:215], v[120:123], a[100:103]
    buffer_load_dwordx4 v226, s[44:47], s66 offen offset:2048 nt lds
    s_add_u32 s66, s66, 4288688128
    v_mfma_f32_16x16x32_bf16 a[104:107], v[212:215], v[124:127], a[104:107]
    ds_read_b64_tr_b16 a[254:255], v244 offset:30720
    v_mfma_f32_16x16x32_bf16 a[108:111], v[212:215], v[128:131], a[108:111]
    v_mfma_f32_16x16x32_bf16 a[112:115], v[212:215], v[132:135], a[112:115]
    v_mfma_f32_16x16x32_bf16 a[116:119], v[212:215], v[136:139], a[116:119]
    s_waitcnt lgkmcnt(6)
    v_mfma_f32_16x16x32_bf16 v[0:3], a[240:243], v[140:143], v[0:3]
    ds_read_b64_tr_b16 v[208:209], v241 offset:24704
    v_mfma_f32_16x16x32_bf16 v[8:11], a[240:243], v[144:147], v[8:11]
    v_mfma_f32_16x16x32_bf16 v[16:19], a[240:243], v[148:151], v[16:19]
    ds_read_b64_tr_b16 v[210:211], v241 offset:30848
    s_waitcnt lgkmcnt(7)
    v_mfma_f32_16x16x32_bf16 v[24:27], a[240:243], v[152:155], v[24:27]
    s_waitcnt lgkmcnt(6)
    v_mfma_f32_16x16x32_bf16 v[32:35], a[240:243], v[156:159], v[32:35]
    ds_read_b64_tr_b16 v[212:213], v242 offset:24704
    v_mfma_f32_16x16x32_bf16 v[4:7], a[244:247], v[140:143], v[4:7]
    v_mfma_f32_16x16x32_bf16 v[12:15], a[244:247], v[144:147], v[12:15]
    ds_read_b64_tr_b16 v[214:215], v242 offset:30848
    v_mfma_f32_16x16x32_bf16 v[20:23], a[244:247], v[148:151], v[20:23]
    v_mfma_f32_16x16x32_bf16 v[28:31], a[244:247], v[152:155], v[28:31]
    v_mfma_f32_16x16x32_bf16 v[36:39], a[244:247], v[156:159], v[36:39]
    s_waitcnt lgkmcnt(4)
    v_mfma_f32_16x16x32_bf16 v[40:43], a[248:251], v[140:143], v[40:43]
    ds_read_b64_tr_b16 a[240:241], v243 offset:24704
    v_mfma_f32_16x16x32_bf16 v[48:51], a[248:251], v[144:147], v[48:51]
    v_mfma_f32_16x16x32_bf16 v[56:59], a[248:251], v[148:151], v[56:59]
    ds_read_b64_tr_b16 a[242:243], v243 offset:30848
    v_mfma_f32_16x16x32_bf16 v[64:67], a[248:251], v[152:155], v[64:67]
    v_mfma_f32_16x16x32_bf16 v[72:75], a[248:251], v[156:159], v[72:75]
    ds_read_b64_tr_b16 a[244:245], v244 offset:24704
    v_mfma_f32_16x16x32_bf16 v[44:47], a[252:255], v[140:143], v[44:47]
    v_mul_f32 v0, s72, v0
    v_mul_f32 v1, s72, v1
    v_mfma_f32_16x16x32_bf16 v[52:55], a[252:255], v[144:147], v[52:55]
    ds_read_b64_tr_b16 a[246:247], v244 offset:30848
    v_mul_f32 v2, s72, v2
    v_mfma_f32_16x16x32_bf16 v[60:63], a[252:255], v[148:151], v[60:63]
    v_mul_f32 v3, s72, v3
    v_mul_f32 v4, s72, v4
    v_mfma_f32_16x16x32_bf16 v[68:71], a[252:255], v[152:155], v[68:71]
    v_mul_f32 v5, s72, v5
    v_mul_f32 v6, s72, v6
    v_mfma_f32_16x16x32_bf16 v[76:79], a[252:255], v[156:159], v[76:79]
    v_mul_f32 v7, s72, v7
    s_waitcnt lgkmcnt(4)
    v_mfma_f32_16x16x32_bf16 v[80:83], v[208:211], v[140:143], v[80:83]
    ds_read_b64_tr_b16 a[248:249], v241 offset:24832
    v_cvt_pk_bf16_f32 v0, v0, v1
    v_mfma_f32_16x16x32_bf16 v[88:91], v[208:211], v[144:147], v[88:91]
    v_cvt_pk_bf16_f32 v1, v2, v3
    v_cvt_pk_bf16_f32 v2, v4, v5
    v_mfma_f32_16x16x32_bf16 v[96:99], v[208:211], v[148:151], v[96:99]
    ds_read_b64_tr_b16 a[250:251], v241 offset:30976
    v_cvt_pk_bf16_f32 v3, v6, v7
    v_mfma_f32_16x16x32_bf16 v[104:107], v[208:211], v[152:155], v[104:107]
    v_mul_f32 v8, s72, v8
    v_mul_f32 v9, s72, v9
    v_mfma_f32_16x16x32_bf16 v[112:115], v[208:211], v[156:159], v[112:115]
    ds_read_b64_tr_b16 a[252:253], v242 offset:24832
    v_mul_f32 v10, s72, v10
    v_mfma_f32_16x16x32_bf16 v[84:87], v[212:215], v[140:143], v[84:87]
    v_mul_f32 v11, s72, v11
    v_mul_f32 v12, s72, v12
    v_mfma_f32_16x16x32_bf16 v[92:95], v[212:215], v[144:147], v[92:95]
    ds_read_b64_tr_b16 a[254:255], v242 offset:30976
    v_mul_f32 v13, s72, v13
    v_mfma_f32_16x16x32_bf16 v[100:103], v[212:215], v[148:151], v[100:103]
    v_mul_f32 v14, s72, v14
    v_mul_f32 v15, s72, v15
    v_mfma_f32_16x16x32_bf16 v[108:111], v[212:215], v[152:155], v[108:111]
    v_cvt_pk_bf16_f32 v8, v8, v9
    v_cvt_pk_bf16_f32 v9, v10, v11
    v_mfma_f32_16x16x32_bf16 v[116:119], v[212:215], v[156:159], v[116:119]
    v_cvt_pk_bf16_f32 v10, v12, v13
    s_waitcnt lgkmcnt(4)
    v_mfma_f32_16x16x32_bf16 a[0:3], a[240:243], v[140:143], a[0:3]
    ds_read_b64_tr_b16 v[208:209], v243 offset:24832
    v_cvt_pk_bf16_f32 v11, v14, v15
    v_mfma_f32_16x16x32_bf16 a[4:7], a[240:243], v[144:147], a[4:7]
    ds_read_b64_tr_b16 v[210:211], v243 offset:30976
    v_mul_f32 v16, s72, v16
    v_mfma_f32_16x16x32_bf16 a[8:11], a[240:243], v[148:151], a[8:11]
    ds_read_b64_tr_b16 v[212:213], v244 offset:24832
    v_mul_f32 v17, s72, v17
    v_mfma_f32_16x16x32_bf16 a[12:15], a[240:243], v[152:155], a[12:15]
    ds_read_b64_tr_b16 v[214:215], v244 offset:30976
    v_mul_f32 v18, s72, v18
    v_mfma_f32_16x16x32_bf16 a[16:19], a[240:243], v[156:159], a[16:19]
    v_mul_f32 v19, s72, v19
    v_mul_f32 v20, s72, v20
    v_mfma_f32_16x16x32_bf16 a[20:23], a[244:247], v[140:143], a[20:23]
    v_mul_f32 v21, s72, v21
    v_mul_f32 v22, s72, v22
    v_mfma_f32_16x16x32_bf16 a[24:27], a[244:247], v[144:147], a[24:27]
    v_mul_f32 v23, s72, v23
    v_cvt_pk_bf16_f32 v16, v16, v17
    v_mfma_f32_16x16x32_bf16 a[28:31], a[244:247], v[148:151], a[28:31]
    v_cvt_pk_bf16_f32 v17, v18, v19
    v_cvt_pk_bf16_f32 v18, v20, v21
    v_mfma_f32_16x16x32_bf16 a[32:35], a[244:247], v[152:155], a[32:35]
    v_cvt_pk_bf16_f32 v19, v22, v23
    v_mul_f32 v24, s72, v24
    v_mfma_f32_16x16x32_bf16 a[36:39], a[244:247], v[156:159], a[36:39]
    s_waitcnt lgkmcnt(0)
    s_barrier
    v_mfma_f32_16x16x32_bf16 a[40:43], a[248:251], v[140:143], a[40:43]
    s_add_u32 m0, s8, 12288
    v_mul_f32 v25, s72, v25
    v_mfma_f32_16x16x32_bf16 a[44:47], a[248:251], v[144:147], a[44:47]
    buffer_load_dwordx4 v224, s[40:43], s65 offen offset:0 nt lds
    v_mfma_f32_16x16x32_bf16 a[48:51], a[248:251], v[148:151], a[48:51]
    buffer_load_dwordx4 v225, s[40:43], s65 offen offset:1024 nt lds
    v_mfma_f32_16x16x32_bf16 a[52:55], a[248:251], v[152:155], a[52:55]
    buffer_load_dwordx4 v226, s[40:43], s65 offen offset:2048 nt lds
    s_add_u32 s65, s65, 6291456
    v_mfma_f32_16x16x32_bf16 a[56:59], a[248:251], v[156:159], a[56:59]
    s_add_u32 m0, s8, 94208
    v_mul_f32 v26, s72, v26
    v_mfma_f32_16x16x32_bf16 a[60:63], a[252:255], v[140:143], a[60:63]
    buffer_load_dwordx4 v224, s[40:43], s65 offen offset:0 nt lds
    v_mfma_f32_16x16x32_bf16 a[64:67], a[252:255], v[144:147], a[64:67]
    buffer_load_dwordx4 v225, s[40:43], s65 offen offset:1024 nt lds
    v_mfma_f32_16x16x32_bf16 a[68:71], a[252:255], v[148:151], a[68:71]
    buffer_load_dwordx4 v226, s[40:43], s65 offen offset:2048 nt lds
    s_add_u32 s65, s65, 4288688128
    v_mfma_f32_16x16x32_bf16 a[72:75], a[252:255], v[152:155], a[72:75]
    s_add_u32 m0, s8, 24576
    v_mul_f32 v27, s72, v27
    v_mfma_f32_16x16x32_bf16 a[76:79], a[252:255], v[156:159], a[76:79]
    buffer_load_dwordx4 v224, s[40:43], s65 offen offset:0 nt lds
    v_mfma_f32_16x16x32_bf16 a[80:83], v[208:211], v[140:143], a[80:83]
    buffer_load_dwordx4 v225, s[40:43], s65 offen offset:1024 nt lds
    v_mfma_f32_16x16x32_bf16 a[84:87], v[208:211], v[144:147], a[84:87]
    buffer_load_dwordx4 v226, s[40:43], s65 offen offset:2048 nt lds
    s_add_u32 s65, s65, 6291456
    v_mfma_f32_16x16x32_bf16 a[88:91], v[208:211], v[148:151], a[88:91]
    s_add_u32 m0, s8, 106496
    v_mul_f32 v28, s72, v28
    v_mfma_f32_16x16x32_bf16 a[92:95], v[208:211], v[152:155], a[92:95]
    buffer_load_dwordx4 v224, s[40:43], s65 offen offset:0 nt lds
    v_mfma_f32_16x16x32_bf16 a[96:99], v[208:211], v[156:159], a[96:99]
    buffer_load_dwordx4 v225, s[40:43], s65 offen offset:1024 nt lds
    v_mfma_f32_16x16x32_bf16 a[100:103], v[212:215], v[140:143], a[100:103]
    buffer_load_dwordx4 v226, s[40:43], s65 offen offset:2048 nt lds
    s_add_u32 s65, s65, 4288688128
    v_mfma_f32_16x16x32_bf16 a[104:107], v[212:215], v[144:147], a[104:107]
    v_mul_f32 v29, s72, v29
    v_mul_f32 v30, s72, v30
    v_mfma_f32_16x16x32_bf16 a[108:111], v[212:215], v[148:151], a[108:111]
    v_mul_f32 v31, s72, v31
    v_cvt_pk_bf16_f32 v24, v24, v25
    v_mfma_f32_16x16x32_bf16 a[112:115], v[212:215], v[152:155], a[112:115]
    v_cvt_pk_bf16_f32 v25, v26, v27
    v_cvt_pk_bf16_f32 v26, v28, v29
    v_mfma_f32_16x16x32_bf16 a[116:119], v[212:215], v[156:159], a[116:119]
    v_cvt_pk_bf16_f32 v27, v30, v31
    s_add_u32 s63, s63, 1
    s_mov_b32 s55, s54
    s_mov_b32 s61, s52
    s_mov_b32 s64, 0
    v_mov_b32 v236, 0xff800000
    v_mov_b32 v237, 0xff800000
    v_mov_b32 v238, 0xff800000
    v_mov_b32 v239, 0xff800000
    v_mov_b32 v240, 0xff800000
    s_add_u32 s3, s98, 24
    s_mul_i32 s71, s3, 384
    s_lshl_b32 s3, s9, 4
    s_lshl_b32 s4, s10, 2
    s_add_u32 s3, s3, s4
    s_mul_i32 s3, s3, 12288
    s_add_u32 s71, s71, s3
    s_cmp_eq_u32 s63, 9
    s_cselect_b32 s3, 6144, 0
    s_sub_u32 s71, s71, s3
    s_and_b32 s3, s63, 7
    s_cmp_eq_u32 s3, 1
    s_cselect_b32 s71, s71, 0x7f000000
    s_cselect_b32 s74, s53, 0x7f000000
    v_mul_f32 v32, s72, v32
    v_mul_f32 v33, s72, v33
    v_mul_f32 v34, s72, v34
    v_mul_f32 v35, s72, v35
    v_mul_f32 v36, s72, v36
    v_mul_f32 v37, s72, v37
    v_mul_f32 v38, s72, v38
    v_mul_f32 v39, s72, v39
    v_cvt_pk_bf16_f32 v32, v32, v33
    v_cvt_pk_bf16_f32 v33, v34, v35
    v_cvt_pk_bf16_f32 v34, v36, v37
    v_cvt_pk_bf16_f32 v35, v38, v39
    v_permlane32_swap_b32 v0, v2
    v_permlane32_swap_b32 v1, v3
    v_permlane32_swap_b32 v8, v10
    v_permlane32_swap_b32 v9, v11
    v_permlane32_swap_b32 v16, v18
    v_permlane32_swap_b32 v17, v19
    v_permlane32_swap_b32 v24, v26
    v_permlane32_swap_b32 v25, v27
    v_permlane32_swap_b32 v32, v34
    v_permlane32_swap_b32 v33, v35
    v_permlane16_swap_b32 v0, v2
    v_permlane16_swap_b32 v1, v3
    v_permlane16_swap_b32 v8, v10
    v_permlane16_swap_b32 v9, v11
    v_permlane16_swap_b32 v16, v18
    v_permlane16_swap_b32 v17, v19
    v_permlane16_swap_b32 v24, v26
    v_permlane16_swap_b32 v25, v27
    v_permlane16_swap_b32 v32, v34
    v_permlane16_swap_b32 v33, v35
    v_mul_f32 v40, s72, v40
    v_mul_f32 v41, s72, v41
    v_mul_f32 v42, s72, v42
    v_mul_f32 v43, s72, v43
    v_mul_f32 v44, s72, v44
    v_mul_f32 v45, s72, v45
    v_mul_f32 v46, s72, v46
    v_mul_f32 v47, s72, v47
    v_cvt_pk_bf16_f32 v40, v40, v41
    v_cvt_pk_bf16_f32 v41, v42, v43
    v_cvt_pk_bf16_f32 v42, v44, v45
    v_cvt_pk_bf16_f32 v43, v46, v47
    v_mul_f32 v48, s72, v48
    v_mul_f32 v49, s72, v49
    v_mul_f32 v50, s72, v50
    v_mul_f32 v51, s72, v51
    v_mul_f32 v52, s72, v52
    v_mul_f32 v53, s72, v53
    v_mul_f32 v54, s72, v54
    v_mul_f32 v55, s72, v55
    v_cvt_pk_bf16_f32 v48, v48, v49
    v_cvt_pk_bf16_f32 v49, v50, v51
    v_cvt_pk_bf16_f32 v50, v52, v53
    v_cvt_pk_bf16_f32 v51, v54, v55
    v_mul_f32 v56, s72, v56
    v_mul_f32 v57, s72, v57
    v_mul_f32 v58, s72, v58
    v_mul_f32 v59, s72, v59
    v_mul_f32 v60, s72, v60
    v_mul_f32 v61, s72, v61
    v_mul_f32 v62, s72, v62
    v_mul_f32 v63, s72, v63
    v_cvt_pk_bf16_f32 v56, v56, v57
    v_cvt_pk_bf16_f32 v57, v58, v59
    v_cvt_pk_bf16_f32 v58, v60, v61
    v_cvt_pk_bf16_f32 v59, v62, v63
    v_mul_f32 v64, s72, v64
    v_mul_f32 v65, s72, v65
    v_mul_f32 v66, s72, v66
    v_mul_f32 v67, s72, v67
    v_mul_f32 v68, s72, v68
    v_mul_f32 v69, s72, v69
    v_mul_f32 v70, s72, v70
    v_mul_f32 v71, s72, v71
    v_cvt_pk_bf16_f32 v64, v64, v65
    v_cvt_pk_bf16_f32 v65, v66, v67
    v_cvt_pk_bf16_f32 v66, v68, v69
    v_cvt_pk_bf16_f32 v67, v70, v71
    v_mul_f32 v72, s72, v72
    v_mul_f32 v73, s72, v73
    v_mul_f32 v74, s72, v74
    v_mul_f32 v75, s72, v75
    v_mul_f32 v76, s72, v76
    v_mul_f32 v77, s72, v77
    v_mul_f32 v78, s72, v78
    v_mul_f32 v79, s72, v79
    v_cvt_pk_bf16_f32 v72, v72, v73
    v_cvt_pk_bf16_f32 v73, v74, v75
    v_cvt_pk_bf16_f32 v74, v76, v77
    v_cvt_pk_bf16_f32 v75, v78, v79
    v_permlane32_swap_b32 v40, v42
    v_permlane32_swap_b32 v41, v43
    v_permlane32_swap_b32 v48, v50
    v_permlane32_swap_b32 v49, v51
    v_permlane32_swap_b32 v56, v58
    v_permlane32_swap_b32 v57, v59
    v_permlane32_swap_b32 v64, v66
    v_permlane32_swap_b32 v65, v67
    v_permlane32_swap_b32 v72, v74
    v_permlane32_swap_b32 v73, v75
    v_permlane16_swap_b32 v40, v42
    v_permlane16_swap_b32 v41, v43
    v_permlane16_swap_b32 v48, v50
    v_permlane16_swap_b32 v49, v51
    v_permlane16_swap_b32 v56, v58
    v_permlane16_swap_b32 v57, v59
    v_permlane16_swap_b32 v64, v66
    v_permlane16_swap_b32 v65, v67
    v_permlane16_swap_b32 v72, v74
    v_permlane16_swap_b32 v73, v75
    v_pk_mul_f32 v[80:81], v[80:81], s[72:73]
    v_pk_mul_f32 v[82:83], v[82:83], s[72:73]
    v_pk_mul_f32 v[84:85], v[84:85], s[72:73]
    v_pk_mul_f32 v[86:87], v[86:87], s[72:73]
    v_cvt_pk_bf16_f32 v80, v80, v81
    v_cvt_pk_bf16_f32 v81, v82, v83
    v_cvt_pk_bf16_f32 v82, v84, v85
    v_cvt_pk_bf16_f32 v83, v86, v87
    v_pk_mul_f32 v[88:89], v[88:89], s[72:73]
    v_pk_mul_f32 v[90:91], v[90:91], s[72:73]
    v_pk_mul_f32 v[92:93], v[92:93], s[72:73]
    v_pk_mul_f32 v[94:95], v[94:95], s[72:73]
    v_cvt_pk_bf16_f32 v88, v88, v89
    v_cvt_pk_bf16_f32 v89, v90, v91
    v_cvt_pk_bf16_f32 v90, v92, v93
    v_cvt_pk_bf16_f32 v91, v94, v95
    v_pk_mul_f32 v[96:97], v[96:97], s[72:73]
    v_pk_mul_f32 v[98:99], v[98:99], s[72:73]
    v_pk_mul_f32 v[100:101], v[100:101], s[72:73]
    v_pk_mul_f32 v[102:103], v[102:103], s[72:73]
    v_cvt_pk_bf16_f32 v96, v96, v97
    v_cvt_pk_bf16_f32 v97, v98, v99
    v_cvt_pk_bf16_f32 v98, v100, v101
    v_cvt_pk_bf16_f32 v99, v102, v103
    v_pk_mul_f32 v[104:105], v[104:105], s[72:73]
    v_pk_mul_f32 v[106:107], v[106:107], s[72:73]
    v_pk_mul_f32 v[108:109], v[108:109], s[72:73]
    v_pk_mul_f32 v[110:111], v[110:111], s[72:73]
    v_cvt_pk_bf16_f32 v104, v104, v105
    v_cvt_pk_bf16_f32 v105, v106, v107
    v_cvt_pk_bf16_f32 v106, v108, v109
    v_cvt_pk_bf16_f32 v107, v110, v111
    v_pk_mul_f32 v[112:113], v[112:113], s[72:73]
    v_pk_mul_f32 v[114:115], v[114:115], s[72:73]
    v_pk_mul_f32 v[116:117], v[116:117], s[72:73]
    v_pk_mul_f32 v[118:119], v[118:119], s[72:73]
    v_cvt_pk_bf16_f32 v112, v112, v113
    v_cvt_pk_bf16_f32 v113, v114, v115
    v_cvt_pk_bf16_f32 v114, v116, v117
    v_cvt_pk_bf16_f32 v115, v118, v119
    v_permlane32_swap_b32 v80, v82
    v_permlane32_swap_b32 v81, v83
    v_permlane32_swap_b32 v88, v90
    v_permlane32_swap_b32 v89, v91
    v_permlane32_swap_b32 v96, v98
    v_permlane32_swap_b32 v97, v99
    v_permlane32_swap_b32 v104, v106
    v_permlane32_swap_b32 v105, v107
    v_permlane32_swap_b32 v112, v114
    v_permlane32_swap_b32 v113, v115
    v_permlane16_swap_b32 v80, v82
    v_permlane16_swap_b32 v81, v83
    v_permlane16_swap_b32 v88, v90
    v_permlane16_swap_b32 v89, v91
    v_permlane16_swap_b32 v96, v98
    v_permlane16_swap_b32 v97, v99
    v_permlane16_swap_b32 v104, v106
    v_permlane16_swap_b32 v105, v107
    v_permlane16_swap_b32 v112, v114
    v_permlane16_swap_b32 v113, v115
    v_accvgpr_read_b32 v180, a0
    v_accvgpr_read_b32 v184, a20
    v_accvgpr_read_b32 v181, a1
    v_accvgpr_read_b32 v185, a21
    v_accvgpr_read_b32 v182, a2
    v_accvgpr_read_b32 v186, a22
    v_accvgpr_read_b32 v183, a3
    v_accvgpr_read_b32 v187, a23
    v_pk_mul_f32 v[180:181], v[180:181], s[72:73]
    v_pk_mul_f32 v[182:183], v[182:183], s[72:73]
    v_pk_mul_f32 v[184:185], v[184:185], s[72:73]
    v_pk_mul_f32 v[186:187], v[186:187], s[72:73]
    v_cvt_pk_bf16_f32 v4, v180, v181
    v_cvt_pk_bf16_f32 v5, v182, v183
    v_cvt_pk_bf16_f32 v6, v184, v185
    v_cvt_pk_bf16_f32 v7, v186, v187
    v_accvgpr_read_b32 v188, a4
    v_accvgpr_read_b32 v192, a24
    v_accvgpr_read_b32 v189, a5
    v_accvgpr_read_b32 v193, a25
    v_accvgpr_read_b32 v190, a6
    v_accvgpr_read_b32 v194, a26
    v_accvgpr_read_b32 v191, a7
    v_accvgpr_read_b32 v195, a27
    v_pk_mul_f32 v[188:189], v[188:189], s[72:73]
    v_pk_mul_f32 v[190:191], v[190:191], s[72:73]
    v_pk_mul_f32 v[192:193], v[192:193], s[72:73]
    v_pk_mul_f32 v[194:195], v[194:195], s[72:73]
    v_cvt_pk_bf16_f32 v12, v188, v189
    v_cvt_pk_bf16_f32 v13, v190, v191
    v_cvt_pk_bf16_f32 v14, v192, v193
    v_cvt_pk_bf16_f32 v15, v194, v195
    v_accvgpr_read_b32 v180, a8
    v_accvgpr_read_b32 v184, a28
    v_accvgpr_read_b32 v181, a9
    v_accvgpr_read_b32 v185, a29
    v_accvgpr_read_b32 v182, a10
    v_accvgpr_read_b32 v186, a30
    v_accvgpr_read_b32 v183, a11
    v_accvgpr_read_b32 v187, a31
    v_pk_mul_f32 v[180:181], v[180:181], s[72:73]
    v_pk_mul_f32 v[182:183], v[182:183], s[72:73]
    v_pk_mul_f32 v[184:185], v[184:185], s[72:73]
    v_pk_mul_f32 v[186:187], v[186:187], s[72:73]
    v_cvt_pk_bf16_f32 v20, v180, v181
    v_cvt_pk_bf16_f32 v21, v182, v183
    v_cvt_pk_bf16_f32 v22, v184, v185
    v_cvt_pk_bf16_f32 v23, v186, v187
    v_accvgpr_read_b32 v188, a12
    v_accvgpr_read_b32 v192, a32
    v_accvgpr_read_b32 v189, a13
    v_accvgpr_read_b32 v193, a33
    v_accvgpr_read_b32 v190, a14
    v_accvgpr_read_b32 v194, a34
    v_accvgpr_read_b32 v191, a15
    v_accvgpr_read_b32 v195, a35
    v_pk_mul_f32 v[188:189], v[188:189], s[72:73]
    v_pk_mul_f32 v[190:191], v[190:191], s[72:73]
    v_pk_mul_f32 v[192:193], v[192:193], s[72:73]
    v_pk_mul_f32 v[194:195], v[194:195], s[72:73]
    v_cvt_pk_bf16_f32 v28, v188, v189
    v_cvt_pk_bf16_f32 v29, v190, v191
    v_cvt_pk_bf16_f32 v30, v192, v193
    v_cvt_pk_bf16_f32 v31, v194, v195
    v_accvgpr_read_b32 v180, a16
    v_accvgpr_read_b32 v184, a36
    v_accvgpr_read_b32 v181, a17
    v_accvgpr_read_b32 v185, a37
    v_accvgpr_read_b32 v182, a18
    v_accvgpr_read_b32 v186, a38
    v_accvgpr_read_b32 v183, a19
    v_accvgpr_read_b32 v187, a39
    v_pk_mul_f32 v[180:181], v[180:181], s[72:73]
    v_pk_mul_f32 v[182:183], v[182:183], s[72:73]
    v_pk_mul_f32 v[184:185], v[184:185], s[72:73]
    v_pk_mul_f32 v[186:187], v[186:187], s[72:73]
    v_cvt_pk_bf16_f32 v36, v180, v181
    v_cvt_pk_bf16_f32 v37, v182, v183
    v_cvt_pk_bf16_f32 v38, v184, v185
    v_cvt_pk_bf16_f32 v39, v186, v187
    v_permlane32_swap_b32 v4, v6
    v_permlane32_swap_b32 v5, v7
    v_permlane32_swap_b32 v12, v14
    v_permlane32_swap_b32 v13, v15
    v_permlane32_swap_b32 v20, v22
    v_permlane32_swap_b32 v21, v23
    v_permlane32_swap_b32 v28, v30
    v_permlane32_swap_b32 v29, v31
    v_permlane32_swap_b32 v36, v38
    v_permlane32_swap_b32 v37, v39
    v_permlane16_swap_b32 v4, v6
    v_permlane16_swap_b32 v5, v7
    v_permlane16_swap_b32 v12, v14
    v_permlane16_swap_b32 v13, v15
    v_permlane16_swap_b32 v20, v22
    v_permlane16_swap_b32 v21, v23
    v_permlane16_swap_b32 v28, v30
    v_permlane16_swap_b32 v29, v31
    v_permlane16_swap_b32 v36, v38
    v_permlane16_swap_b32 v37, v39
    v_accvgpr_read_b32 v180, a40
    v_accvgpr_read_b32 v184, a60
    v_accvgpr_read_b32 v181, a41
    v_accvgpr_read_b32 v185, a61
    v_accvgpr_read_b32 v182, a42
    v_accvgpr_read_b32 v186, a62
    v_accvgpr_read_b32 v183, a43
    v_accvgpr_read_b32 v187, a63
    v_pk_mul_f32 v[180:181], v[180:181], s[72:73]
    v_pk_mul_f32 v[182:183], v[182:183], s[72:73]
    v_pk_mul_f32 v[184:185], v[184:185], s[72:73]
    v_pk_mul_f32 v[186:187], v[186:187], s[72:73]
    v_cvt_pk_bf16_f32 v44, v180, v181
    v_cvt_pk_bf16_f32 v45, v182, v183
    v_cvt_pk_bf16_f32 v46, v184, v185
    v_cvt_pk_bf16_f32 v47, v186, v187
    v_accvgpr_read_b32 v188, a44
    v_accvgpr_read_b32 v192, a64
    v_accvgpr_read_b32 v189, a45
    v_accvgpr_read_b32 v193, a65
    v_accvgpr_read_b32 v190, a46
    v_accvgpr_read_b32 v194, a66
    v_accvgpr_read_b32 v191, a47
    v_accvgpr_read_b32 v195, a67
    v_pk_mul_f32 v[188:189], v[188:189], s[72:73]
    v_pk_mul_f32 v[190:191], v[190:191], s[72:73]
    v_pk_mul_f32 v[192:193], v[192:193], s[72:73]
    v_pk_mul_f32 v[194:195], v[194:195], s[72:73]
    v_cvt_pk_bf16_f32 v52, v188, v189
    v_cvt_pk_bf16_f32 v53, v190, v191
    v_cvt_pk_bf16_f32 v54, v192, v193
    v_cvt_pk_bf16_f32 v55, v194, v195
    v_accvgpr_read_b32 v180, a48
    v_accvgpr_read_b32 v184, a68
    v_accvgpr_read_b32 v181, a49
    v_accvgpr_read_b32 v185, a69
    v_accvgpr_read_b32 v182, a50
    v_accvgpr_read_b32 v186, a70
    v_accvgpr_read_b32 v183, a51
    v_accvgpr_read_b32 v187, a71
    v_pk_mul_f32 v[180:181], v[180:181], s[72:73]
    v_pk_mul_f32 v[182:183], v[182:183], s[72:73]
    v_pk_mul_f32 v[184:185], v[184:185], s[72:73]
    v_pk_mul_f32 v[186:187], v[186:187], s[72:73]
    v_cvt_pk_bf16_f32 v60, v180, v181
    v_cvt_pk_bf16_f32 v61, v182, v183
    v_cvt_pk_bf16_f32 v62, v184, v185
    v_cvt_pk_bf16_f32 v63, v186, v187
    v_accvgpr_read_b32 v188, a52
    v_accvgpr_read_b32 v192, a72
    v_accvgpr_read_b32 v189, a53
    v_accvgpr_read_b32 v193, a73
    v_accvgpr_read_b32 v190, a54
    v_accvgpr_read_b32 v194, a74
    v_accvgpr_read_b32 v191, a55
    v_accvgpr_read_b32 v195, a75
    v_pk_mul_f32 v[188:189], v[188:189], s[72:73]
    v_pk_mul_f32 v[190:191], v[190:191], s[72:73]
    v_pk_mul_f32 v[192:193], v[192:193], s[72:73]
    v_pk_mul_f32 v[194:195], v[194:195], s[72:73]
    v_cvt_pk_bf16_f32 v68, v188, v189
    v_cvt_pk_bf16_f32 v69, v190, v191
    v_cvt_pk_bf16_f32 v70, v192, v193
    v_cvt_pk_bf16_f32 v71, v194, v195
    v_accvgpr_read_b32 v180, a56
    v_accvgpr_read_b32 v184, a76
    v_accvgpr_read_b32 v181, a57
    v_accvgpr_read_b32 v185, a77
    v_accvgpr_read_b32 v182, a58
    v_accvgpr_read_b32 v186, a78
    v_accvgpr_read_b32 v183, a59
    v_accvgpr_read_b32 v187, a79
    v_pk_mul_f32 v[180:181], v[180:181], s[72:73]
    v_pk_mul_f32 v[182:183], v[182:183], s[72:73]
    v_pk_mul_f32 v[184:185], v[184:185], s[72:73]
    v_pk_mul_f32 v[186:187], v[186:187], s[72:73]
    v_cvt_pk_bf16_f32 v76, v180, v181
    v_cvt_pk_bf16_f32 v77, v182, v183
    v_cvt_pk_bf16_f32 v78, v184, v185
    v_cvt_pk_bf16_f32 v79, v186, v187
    v_permlane32_swap_b32 v44, v46
    v_permlane32_swap_b32 v45, v47
    v_permlane32_swap_b32 v52, v54
    v_permlane32_swap_b32 v53, v55
    v_permlane32_swap_b32 v60, v62
    v_permlane32_swap_b32 v61, v63
    v_permlane32_swap_b32 v68, v70
    v_permlane32_swap_b32 v69, v71
    v_permlane32_swap_b32 v76, v78
    v_permlane32_swap_b32 v77, v79
    v_permlane16_swap_b32 v44, v46
    v_permlane16_swap_b32 v45, v47
    v_permlane16_swap_b32 v52, v54
    v_permlane16_swap_b32 v53, v55
    v_permlane16_swap_b32 v60, v62
    v_permlane16_swap_b32 v61, v63
    v_permlane16_swap_b32 v68, v70
    v_permlane16_swap_b32 v69, v71
    v_permlane16_swap_b32 v76, v78
    v_permlane16_swap_b32 v77, v79
    v_mov_b32 v200, 0
    v_mov_b32 v201, 0
    v_mov_b32 v202, 0
    v_mov_b32 v203, 0
    v_mov_b32 v204, 0
    s_waitcnt vmcnt(24)
    s_barrier
    ds_read_b128 a[240:243], v216 offset:0
    ds_read_b128 a[244:247], v216 offset:6144
    ds_read_b128 a[248:251], v217 offset:0
    ds_read_b128 a[252:255], v217 offset:6144
    s_waitcnt lgkmcnt(2)
    v_mfma_f32_16x16x32_bf16 v[120:123], a[240:243], v[0:3], 0
    ds_read_b128 v[208:211], v216 offset:128
    v_accvgpr_read_b32 v180, a80
    v_mfma_f32_16x16x32_bf16 v[124:127], a[240:243], v[8:11], 0
    v_accvgpr_read_b32 v184, a100
    v_accvgpr_read_b32 v181, a81
    v_mfma_f32_16x16x32_bf16 v[128:131], a[240:243], v[16:19], 0
    ds_read_b128 v[212:215], v216 offset:6272
    v_accvgpr_read_b32 v185, a101
    v_mfma_f32_16x16x32_bf16 v[132:135], a[240:243], v[24:27], 0
    v_accvgpr_read_b32 v182, a82
    v_accvgpr_read_b32 v186, a102
    v_mfma_f32_16x16x32_bf16 v[136:139], a[240:243], v[32:35], 0
    v_accvgpr_read_b32 v183, a83
    v_accvgpr_read_b32 v187, a103
    v_mfma_f32_16x16x32_bf16 v[160:163], a[244:247], v[0:3], 0
    v_mul_f32 v180, s72, v180
    v_mul_f32 v181, s72, v181
    v_mfma_f32_16x16x32_bf16 v[164:167], a[244:247], v[8:11], 0
    v_mul_f32 v182, s72, v182
    v_mul_f32 v183, s72, v183
    v_mfma_f32_16x16x32_bf16 v[168:171], a[244:247], v[16:19], 0
    v_mul_f32 v184, s72, v184
    v_mul_f32 v185, s72, v185
    v_mfma_f32_16x16x32_bf16 v[172:175], a[244:247], v[24:27], 0
    v_mul_f32 v186, s72, v186
    v_mul_f32 v187, s72, v187
    v_mfma_f32_16x16x32_bf16 v[176:179], a[244:247], v[32:35], 0
    v_cvt_pk_bf16_f32 v84, v180, v181
    s_waitcnt lgkmcnt(2)
    v_mfma_f32_16x16x32_bf16 v[120:123], a[248:251], v[40:43], v[120:123]
    ds_read_b128 a[240:243], v217 offset:128
    v_cvt_pk_bf16_f32 v85, v182, v183
    v_mfma_f32_16x16x32_bf16 v[124:127], a[248:251], v[48:51], v[124:127]
    v_cvt_pk_bf16_f32 v86, v184, v185
    v_cvt_pk_bf16_f32 v87, v186, v187
    v_mfma_f32_16x16x32_bf16 v[128:131], a[248:251], v[56:59], v[128:131]
    ds_read_b128 a[244:247], v217 offset:6272
    v_accvgpr_read_b32 v188, a84
    v_mfma_f32_16x16x32_bf16 v[132:135], a[248:251], v[64:67], v[132:135]
    v_accvgpr_read_b32 v192, a104
    v_accvgpr_read_b32 v189, a85
    v_mfma_f32_16x16x32_bf16 v[136:139], a[248:251], v[72:75], v[136:139]
    v_accvgpr_read_b32 v193, a105
    v_accvgpr_read_b32 v190, a86
    v_mfma_f32_16x16x32_bf16 v[160:163], a[252:255], v[40:43], v[160:163]
    v_accvgpr_read_b32 v194, a106
    v_accvgpr_read_b32 v191, a87
    v_mfma_f32_16x16x32_bf16 v[164:167], a[252:255], v[48:51], v[164:167]
    v_accvgpr_read_b32 v195, a107
    v_mul_f32 v188, s72, v188
    v_mfma_f32_16x16x32_bf16 v[168:171], a[252:255], v[56:59], v[168:171]
    v_mul_f32 v189, s72, v189
    v_mul_f32 v190, s72, v190
    v_mfma_f32_16x16x32_bf16 v[172:175], a[252:255], v[64:67], v[172:175]
    v_mul_f32 v191, s72, v191
    v_mul_f32 v192, s72, v192
    v_mfma_f32_16x16x32_bf16 v[176:179], a[252:255], v[72:75], v[176:179]
    v_mul_f32 v193, s72, v193
    s_waitcnt lgkmcnt(2)
    v_mfma_f32_16x16x32_bf16 v[120:123], v[208:211], v[80:83], v[120:123]
    ds_read_b128 a[248:251], v216 offset:256
    v_mul_f32 v194, s72, v194
    v_mfma_f32_16x16x32_bf16 v[124:127], v[208:211], v[88:91], v[124:127]
    v_mul_f32 v195, s72, v195
    v_cvt_pk_bf16_f32 v92, v188, v189
    v_mfma_f32_16x16x32_bf16 v[128:131], v[208:211], v[96:99], v[128:131]
    ds_read_b128 a[252:255], v216 offset:6400
    v_cvt_pk_bf16_f32 v93, v190, v191
    v_mfma_f32_16x16x32_bf16 v[132:135], v[208:211], v[104:107], v[132:135]
    v_cvt_pk_bf16_f32 v94, v192, v193
    v_cvt_pk_bf16_f32 v95, v194, v195
    v_mfma_f32_16x16x32_bf16 v[136:139], v[208:211], v[112:115], v[136:139]
    v_accvgpr_read_b32 v180, a88
    v_accvgpr_read_b32 v184, a108
    v_mfma_f32_16x16x32_bf16 v[160:163], v[212:215], v[80:83], v[160:163]
    v_accvgpr_read_b32 v181, a89
    v_accvgpr_read_b32 v185, a109
    v_mfma_f32_16x16x32_bf16 v[164:167], v[212:215], v[88:91], v[164:167]
    v_accvgpr_read_b32 v182, a90
    v_accvgpr_read_b32 v186, a110
    v_mfma_f32_16x16x32_bf16 v[168:171], v[212:215], v[96:99], v[168:171]
    v_accvgpr_read_b32 v183, a91
    v_accvgpr_read_b32 v187, a111
    v_mfma_f32_16x16x32_bf16 v[172:175], v[212:215], v[104:107], v[172:175]
    v_mul_f32 v180, s72, v180
    v_mul_f32 v181, s72, v181
    v_mfma_f32_16x16x32_bf16 v[176:179], v[212:215], v[112:115], v[176:179]
    v_mul_f32 v182, s72, v182
    s_waitcnt lgkmcnt(2)
    v_mfma_f32_16x16x32_bf16 v[120:123], a[240:243], v[4:7], v[120:123]
    ds_read_b128 v[208:211], v217 offset:256
    v_mul_f32 v183, s72, v183
    v_mfma_f32_16x16x32_bf16 v[124:127], a[240:243], v[12:15], v[124:127]
    ds_read_b128 v[212:215], v217 offset:6400
    v_mul_f32 v184, s72, v184
    v_mfma_f32_16x16x32_bf16 v[128:131], a[240:243], v[20:23], v[128:131]
    v_mul_f32 v185, s72, v185
    v_mul_f32 v186, s72, v186
    v_mfma_f32_16x16x32_bf16 v[132:135], a[240:243], v[28:31], v[132:135]
    v_mul_f32 v187, s72, v187
    v_cvt_pk_bf16_f32 v100, v180, v181
    v_mfma_f32_16x16x32_bf16 v[136:139], a[240:243], v[36:39], v[136:139]
    v_cvt_pk_bf16_f32 v101, v182, v183
    v_cvt_pk_bf16_f32 v102, v184, v185
    v_mfma_f32_16x16x32_bf16 v[160:163], a[244:247], v[4:7], v[160:163]
    v_cvt_pk_bf16_f32 v103, v186, v187
    v_accvgpr_read_b32 v188, a92
    v_mfma_f32_16x16x32_bf16 v[164:167], a[244:247], v[12:15], v[164:167]
    v_accvgpr_read_b32 v192, a112
    v_accvgpr_read_b32 v189, a93
    v_mfma_f32_16x16x32_bf16 v[168:171], a[244:247], v[20:23], v[168:171]
    v_accvgpr_read_b32 v193, a113
    v_accvgpr_read_b32 v190, a94
    v_mfma_f32_16x16x32_bf16 v[172:175], a[244:247], v[28:31], v[172:175]
    v_accvgpr_read_b32 v194, a114
    v_accvgpr_read_b32 v191, a95
    v_mfma_f32_16x16x32_bf16 v[176:179], a[244:247], v[36:39], v[176:179]
    s_waitcnt vmcnt(6) lgkmcnt(0)
    s_barrier
    v_mfma_f32_16x16x32_bf16 v[120:123], a[248:251], v[44:47], v[120:123]
    ds_read_b128 a[240:243], v216 offset:12288
    v_accvgpr_read_b32 v195, a115
    v_mfma_f32_16x16x32_bf16 v[124:127], a[248:251], v[52:55], v[124:127]
    v_mul_f32 v188, s72, v188
    v_mul_f32 v189, s72, v189
    v_mfma_f32_16x16x32_bf16 v[128:131], a[248:251], v[60:63], v[128:131]
    ds_read_b128 a[244:247], v217 offset:12288
    v_mul_f32 v190, s72, v190
    v_mfma_f32_16x16x32_bf16 v[132:135], a[248:251], v[68:71], v[132:135]
    v_mul_f32 v191, s72, v191
    v_mul_f32 v192, s72, v192
    v_mfma_f32_16x16x32_bf16 v[136:139], a[248:251], v[76:79], v[136:139]
    v_mul_f32 v193, s72, v193
    v_mul_f32 v194, s72, v194
    v_mfma_f32_16x16x32_bf16 v[160:163], a[252:255], v[44:47], v[160:163]
    v_mul_f32 v195, s72, v195
    v_cvt_pk_bf16_f32 v108, v188, v189
    v_mfma_f32_16x16x32_bf16 v[164:167], a[252:255], v[52:55], v[164:167]
    v_cvt_pk_bf16_f32 v109, v190, v191
    v_cvt_pk_bf16_f32 v110, v192, v193
    v_mfma_f32_16x16x32_bf16 v[168:171], a[252:255], v[60:63], v[168:171]
    v_cvt_pk_bf16_f32 v111, v194, v195
    v_accvgpr_read_b32 v180, a96
    v_mfma_f32_16x16x32_bf16 v[172:175], a[252:255], v[68:71], v[172:175]
    v_accvgpr_read_b32 v184, a116
    v_accvgpr_read_b32 v181, a97
    v_mfma_f32_16x16x32_bf16 v[176:179], a[252:255], v[76:79], v[176:179]
    v_accvgpr_read_b32 v185, a117
    v_accvgpr_read_b32 v182, a98
    v_accvgpr_read_b32 v186, a118
    v_accvgpr_read_b32 v183, a99
    v_accvgpr_read_b32 v187, a119
    v_mul_f32 v180, s72, v180
    v_mul_f32 v181, s72, v181
    v_mul_f32 v182, s72, v182
    v_mul_f32 v183, s72, v183
    v_mul_f32 v184, s72, v184
    v_mul_f32 v185, s72, v185
    v_mul_f32 v186, s72, v186
    v_mul_f32 v187, s72, v187
    v_cvt_pk_bf16_f32 v116, v180, v181
    v_cvt_pk_bf16_f32 v117, v182, v183
    v_cvt_pk_bf16_f32 v118, v184, v185
    v_cvt_pk_bf16_f32 v119, v186, v187
    v_permlane32_swap_b32 v84, v86
    v_permlane32_swap_b32 v85, v87
    v_permlane32_swap_b32 v92, v94
    v_permlane32_swap_b32 v93, v95
    v_permlane32_swap_b32 v100, v102
    v_permlane32_swap_b32 v101, v103
    v_permlane32_swap_b32 v108, v110
    v_permlane32_swap_b32 v109, v111
    v_permlane32_swap_b32 v116, v118
    v_permlane32_swap_b32 v117, v119
    v_permlane16_swap_b32 v84, v86
    v_permlane16_swap_b32 v85, v87
    v_permlane16_swap_b32 v92, v94
    v_permlane16_swap_b32 v93, v95
    v_permlane16_swap_b32 v100, v102
    v_permlane16_swap_b32 v101, v103
    v_permlane16_swap_b32 v108, v110
    v_permlane16_swap_b32 v109, v111
    v_permlane16_swap_b32 v116, v118
    v_permlane16_swap_b32 v117, v119
    v_mfma_f32_16x16x32_bf16 v[120:123], v[208:211], v[84:87], v[120:123]
    ds_read_b128 a[248:251], v216 offset:12416
    s_add_u32 m0, s8, 0
    v_mfma_f32_16x16x32_bf16 v[124:127], v[208:211], v[92:95], v[124:127]
    buffer_load_dwordx4 v224, s[40:43], s65 offen offset:0 nt lds
    v_mfma_f32_16x16x32_bf16 v[128:131], v[208:211], v[100:103], v[128:131]
    ds_read_b128 a[252:255], v217 offset:12416
    buffer_load_dwordx4 v225, s[40:43], s65 offen offset:1024 nt lds
    v_mfma_f32_16x16x32_bf16 v[132:135], v[208:211], v[108:111], v[132:135]
    buffer_load_dwordx4 v226, s[40:43], s65 offen offset:2048 nt lds
    s_add_u32 s65, s65, 6291456
    v_mfma_f32_16x16x32_bf16 v[136:139], v[208:211], v[116:119], v[136:139]
    s_add_u32 m0, s8, 81920
    v_mfma_f32_16x16x32_bf16 v[160:163], v[212:215], v[84:87], v[160:163]
    buffer_load_dwordx4 v224, s[40:43], s65 offen offset:0 nt lds
    v_mfma_f32_16x16x32_bf16 v[164:167], v[212:215], v[92:95], v[164:167]
    buffer_load_dwordx4 v225, s[40:43], s65 offen offset:1024 nt lds
    v_mfma_f32_16x16x32_bf16 v[168:171], v[212:215], v[100:103], v[168:171]
    buffer_load_dwordx4 v226, s[40:43], s65 offen offset:2048 nt lds
    s_add_u32 s65, s65, 4288688128
    v_mfma_f32_16x16x32_bf16 v[172:175], v[212:215], v[108:111], v[172:175]
    s_add_u32 m0, s8, 65536
    v_mfma_f32_16x16x32_bf16 v[176:179], v[212:215], v[116:119], v[176:179]
    buffer_load_dwordx4 v224, s[44:47], s66 offen offset:0 nt lds
    buffer_load_dwordx4 v225, s[44:47], s66 offen offset:1024 nt lds
    buffer_load_dwordx4 v226, s[44:47], s66 offen offset:2048 nt lds
    s_add_u32 s66, s66, 6291456
    s_add_u32 m0, s8, 147456
    s_nop 0
    buffer_load_dwordx4 v224, s[44:47], s66 offen offset:0 nt lds
    buffer_load_dwordx4 v225, s[44:47], s66 offen offset:1024 nt lds
    buffer_load_dwordx4 v226, s[44:47], s66 offen offset:2048 nt lds
    s_add_u32 s66, s66, 4288688128
L_att_sm0:
    v_max3_f32 v245, v120, v121, v122
    v_max3_f32 v245, v245, v123, v160
    v_max3_f32 v245, v245, v161, v162
    v_max3_f32 v245, v245, v163, v236
    v_mov_b32 v246, v245
    s_nop 1
    v_permlane32_swap_b32 v245, v246
    v_max_f32 v245, v245, v246
    v_mov_b32 v246, v245
    s_nop 1
    v_permlane16_swap_b32 v245, v246
    v_max_f32 v245, v245, v246
    v_sub_f32 v180, 0, v245
    v_sub_f32 v181, 0, v245
    v_sub_f32 v182, 0, v245
    v_sub_f32 v183, 0, v245
    v_sub_f32 v120, v120, v245
    v_sub_f32 v160, v160, v245
    v_sub_f32 v121, v121, v245
    v_sub_f32 v161, v161, v245
    v_sub_f32 v122, v122, v245
    v_sub_f32 v162, v162, v245
    v_sub_f32 v123, v123, v245
    v_sub_f32 v163, v163, v245
    v_max3_f32 v247, v124, v125, v126
    v_max3_f32 v247, v247, v127, v164
    v_max3_f32 v247, v247, v165, v166
    v_max3_f32 v247, v247, v167, v237
    v_mov_b32 v248, v247
    s_nop 1
    v_permlane32_swap_b32 v247, v248
    v_max_f32 v247, v247, v248
    v_mov_b32 v248, v247
    s_nop 1
    v_permlane16_swap_b32 v247, v248
    v_max_f32 v247, v247, v248
    v_sub_f32 v184, 0, v247
    v_sub_f32 v185, 0, v247
    v_sub_f32 v186, 0, v247
    v_sub_f32 v187, 0, v247
    v_sub_f32 v124, v124, v247
    v_sub_f32 v164, v164, v247
    v_sub_f32 v125, v125, v247
    v_sub_f32 v165, v165, v247
    v_sub_f32 v126, v126, v247
    v_sub_f32 v166, v166, v247
    v_sub_f32 v127, v127, v247
    v_sub_f32 v167, v167, v247
    v_max3_f32 v245, v128, v129, v130
    v_max3_f32 v245, v245, v131, v168
    v_max3_f32 v245, v245, v169, v170
    v_max3_f32 v245, v245, v171, v238
    v_mov_b32 v246, v245
    s_nop 1
    v_permlane32_swap_b32 v245, v246
    v_max_f32 v245, v245, v246
    v_mov_b32 v246, v245
    s_nop 1
    v_permlane16_swap_b32 v245, v246
    v_max_f32 v245, v245, v246
    v_sub_f32 v188, 0, v245
    v_sub_f32 v189, 0, v245
    v_sub_f32 v190, 0, v245
    v_sub_f32 v191, 0, v245
    v_sub_f32 v128, v128, v245
    v_sub_f32 v168, v168, v245
    v_sub_f32 v129, v129, v245
    v_sub_f32 v169, v169, v245
    v_sub_f32 v130, v130, v245
    v_sub_f32 v170, v170, v245
    v_sub_f32 v131, v131, v245
    v_sub_f32 v171, v171, v245
    v_max3_f32 v247, v132, v133, v134
    v_max3_f32 v247, v247, v135, v172
    v_max3_f32 v247, v247, v173, v174
    v_max3_f32 v247, v247, v175, v239
    v_mov_b32 v248, v247
    s_nop 1
    v_permlane32_swap_b32 v247, v248
    v_max_f32 v247, v247, v248
    v_mov_b32 v248, v247
    s_nop 1
    v_permlane16_swap_b32 v247, v248
    v_max_f32 v247, v247, v248
    v_sub_f32 v192, 0, v247
    v_sub_f32 v193, 0, v247
    v_sub_f32 v194, 0, v247
    v_sub_f32 v195, 0, v247
    v_sub_f32 v132, v132, v247
    v_sub_f32 v172, v172, v247
    v_sub_f32 v133, v133, v247
    v_sub_f32 v173, v173, v247
    v_sub_f32 v134, v134, v247
    v_sub_f32 v174, v174, v247
    v_sub_f32 v135, v135, v247
    v_sub_f32 v175, v175, v247
    v_max3_f32 v245, v136, v137, v138
    v_max3_f32 v245, v245, v139, v176
    v_max3_f32 v245, v245, v177, v178
    v_max3_f32 v245, v245, v179, v240
    v_mov_b32 v246, v245
    s_nop 1
    v_permlane32_swap_b32 v245, v246
    v_max_f32 v245, v245, v246
    v_mov_b32 v246, v245
    s_nop 1
    v_permlane16_swap_b32 v245, v246
    v_max_f32 v245, v245, v246
    v_sub_f32 v196, 0, v245
    v_sub_f32 v197, 0, v245
    v_sub_f32 v198, 0, v245
    v_sub_f32 v199, 0, v245
    v_sub_f32 v136, v136, v245
    v_sub_f32 v176, v176, v245
    v_sub_f32 v137, v137, v245
    v_sub_f32 v177, v177, v245
    v_sub_f32 v138, v138, v245
    v_sub_f32 v178, v178, v245
    v_sub_f32 v139, v139, v245
    v_sub_f32 v179, v179, v245
    v_exp_f32 v120, v120
    v_exp_f32 v121, v121
    v_exp_f32 v122, v122
    v_exp_f32 v123, v123
    v_exp_f32 v124, v124
    v_add_f32 v200, v200, v120
    v_cvt_pk_bf16_f32 v120, v120, v121
    v_exp_f32 v125, v125
    v_add_f32 v200, v200, v121
    v_cvt_pk_bf16_f32 v121, v122, v123
    v_exp_f32 v126, v126
    v_add_f32 v200, v200, v122
    v_add_f32 v200, v200, v123
    v_exp_f32 v127, v127
    v_exp_f32 v128, v128
    v_add_f32 v201, v201, v124
    v_cvt_pk_bf16_f32 v124, v124, v125
    v_exp_f32 v129, v129
    v_add_f32 v201, v201, v125
    v_cvt_pk_bf16_f32 v125, v126, v127
    v_exp_f32 v130, v130
    v_add_f32 v201, v201, v126
    v_add_f32 v201, v201, v127
    v_exp_f32 v131, v131
    v_exp_f32 v132, v132
    v_add_f32 v202, v202, v128
    v_cvt_pk_bf16_f32 v128, v128, v129
    v_exp_f32 v133, v133
    v_add_f32 v202, v202, v129
    v_cvt_pk_bf16_f32 v129, v130, v131
    v_exp_f32 v134, v134
    v_add_f32 v202, v202, v130
    v_add_f32 v202, v202, v131
    v_exp_f32 v135, v135
    v_exp_f32 v136, v136
    v_add_f32 v203, v203, v132
    v_cvt_pk_bf16_f32 v132, v132, v133
    v_exp_f32 v137, v137
    v_add_f32 v203, v203, v133
    v_cvt_pk_bf16_f32 v133, v134, v135
    v_exp_f32 v138, v138
    v_add_f32 v203, v203, v134
    v_add_f32 v203, v203, v135
    v_exp_f32 v139, v139
    v_exp_f32 v160, v160
    v_add_f32 v204, v204, v136
    v_cvt_pk_bf16_f32 v136, v136, v137
    v_exp_f32 v161, v161
    v_add_f32 v204, v204, v137
    v_cvt_pk_bf16_f32 v137, v138, v139
    v_exp_f32 v162, v162
    v_add_f32 v204, v204, v138
    v_add_f32 v204, v204, v139
    v_exp_f32 v163, v163
    v_exp_f32 v164, v164
    v_add_f32 v200, v200, v160
    v_cvt_pk_bf16_f32 v122, v160, v161
    v_exp_f32 v165, v165
    v_add_f32 v200, v200, v161
    v_cvt_pk_bf16_f32 v123, v162, v163
    v_exp_f32 v166, v166
    v_add_f32 v200, v200, v162
    v_add_f32 v200, v200, v163
    v_exp_f32 v167, v167
    v_exp_f32 v168, v168
    v_add_f32 v201, v201, v164
    v_cvt_pk_bf16_f32 v126, v164, v165
    v_exp_f32 v169, v169
    v_add_f32 v201, v201, v165
    v_cvt_pk_bf16_f32 v127, v166, v167
    v_exp_f32 v170, v170
    v_add_f32 v201, v201, v166
    v_add_f32 v201, v201, v167
    v_exp_f32 v171, v171
    v_add_f32 v202, v202, v168
    v_cvt_pk_bf16_f32 v130, v168, v169
    v_add_f32 v202, v202, v169
    v_cvt_pk_bf16_f32 v131, v170, v171
    v_add_f32 v202, v202, v170
    v_add_f32 v202, v202, v171
    s_waitcnt lgkmcnt(2)
    v_mfma_f32_16x16x32_bf16 v[140:143], a[240:243], v[0:3], v[180:183]
    ds_read_b128 v[208:211], v216 offset:12544
    v_mfma_f32_16x16x32_bf16 v[140:143], a[244:247], v[40:43], v[140:143]
    v_exp_f32 v172, v172
    v_mfma_f32_16x16x32_bf16 v[144:147], a[240:243], v[8:11], v[184:187]
    ds_read_b128 v[212:215], v217 offset:12544
    v_mfma_f32_16x16x32_bf16 v[144:147], a[244:247], v[48:51], v[144:147]
    v_exp_f32 v173, v173
    v_mfma_f32_16x16x32_bf16 v[148:151], a[240:243], v[16:19], v[188:191]
    v_exp_f32 v174, v174
    v_mfma_f32_16x16x32_bf16 v[148:151], a[244:247], v[56:59], v[148:151]
    v_exp_f32 v175, v175
    v_mfma_f32_16x16x32_bf16 v[152:155], a[240:243], v[24:27], v[192:195]
    v_exp_f32 v176, v176
    v_mfma_f32_16x16x32_bf16 v[152:155], a[244:247], v[64:67], v[152:155]
    v_exp_f32 v177, v177
    v_mfma_f32_16x16x32_bf16 v[156:159], a[240:243], v[32:35], v[196:199]
    v_exp_f32 v178, v178
    v_mfma_f32_16x16x32_bf16 v[156:159], a[244:247], v[72:75], v[156:159]
    v_add_f32 v203, v203, v172
    s_waitcnt lgkmcnt(2)
    v_mfma_f32_16x16x32_bf16 v[140:143], a[248:251], v[80:83], v[140:143]
    ds_read_b128 a[240:243], v216 offset:18432
    v_cvt_pk_bf16_f32 v134, v172, v173
    v_mfma_f32_16x16x32_bf16 v[140:143], a[252:255], v[4:7], v[140:143]
    v_exp_f32 v179, v179
    v_mfma_f32_16x16x32_bf16 v[144:147], a[248:251], v[88:91], v[144:147]
    ds_read_b128 a[244:247], v217 offset:18432
    v_add_f32 v203, v203, v173
    v_mfma_f32_16x16x32_bf16 v[144:147], a[252:255], v[12:15], v[144:147]
    v_cvt_pk_bf16_f32 v135, v174, v175
    v_add_f32 v203, v203, v174
    v_mfma_f32_16x16x32_bf16 v[148:151], a[248:251], v[96:99], v[148:151]
    v_add_f32 v203, v203, v175
    v_add_f32 v204, v204, v176
    v_mfma_f32_16x16x32_bf16 v[148:151], a[252:255], v[20:23], v[148:151]
    v_cvt_pk_bf16_f32 v138, v176, v177
    v_add_f32 v204, v204, v177
    v_mfma_f32_16x16x32_bf16 v[152:155], a[248:251], v[104:107], v[152:155]
    v_cvt_pk_bf16_f32 v139, v178, v179
    v_add_f32 v204, v204, v178
    v_mfma_f32_16x16x32_bf16 v[152:155], a[252:255], v[28:31], v[152:155]
    v_add_f32 v204, v204, v179
    v_mfma_f32_16x16x32_bf16 v[156:159], a[248:251], v[112:115], v[156:159]
    v_mfma_f32_16x16x32_bf16 v[156:159], a[252:255], v[36:39], v[156:159]
    s_waitcnt lgkmcnt(2)
    v_mfma_f32_16x16x32_bf16 v[140:143], v[208:211], v[44:47], v[140:143]
    ds_read_b128 a[248:251], v216 offset:18560
    v_mfma_f32_16x16x32_bf16 v[140:143], v[212:215], v[84:87], v[140:143]
    v_mfma_f32_16x16x32_bf16 v[144:147], v[208:211], v[52:55], v[144:147]
    ds_read_b128 a[252:255], v217 offset:18560
    v_mfma_f32_16x16x32_bf16 v[144:147], v[212:215], v[92:95], v[144:147]
    v_mfma_f32_16x16x32_bf16 v[148:151], v[208:211], v[60:63], v[148:151]
    v_mfma_f32_16x16x32_bf16 v[148:151], v[212:215], v[100:103], v[148:151]
    v_mfma_f32_16x16x32_bf16 v[152:155], v[208:211], v[68:71], v[152:155]
    v_mfma_f32_16x16x32_bf16 v[152:155], v[212:215], v[108:111], v[152:155]
    v_mfma_f32_16x16x32_bf16 v[156:159], v[208:211], v[76:79], v[156:159]
    v_mfma_f32_16x16x32_bf16 v[156:159], v[212:215], v[116:119], v[156:159]
    s_waitcnt lgkmcnt(2)
    v_mfma_f32_16x16x32_bf16 v[160:163], a[240:243], v[0:3], v[180:183]
    ds_read_b128 v[208:211], v216 offset:18688
    v_mfma_f32_16x16x32_bf16 v[160:163], a[244:247], v[40:43], v[160:163]
    ds_read_b128 v[212:215], v217 offset:18688
    v_mfma_f32_16x16x32_bf16 v[164:167], a[240:243], v[8:11], v[184:187]
    v_mfma_f32_16x16x32_bf16 v[164:167], a[244:247], v[48:51], v[164:167]
    v_mfma_f32_16x16x32_bf16 v[168:171], a[240:243], v[16:19], v[188:191]
    v_mfma_f32_16x16x32_bf16 v[168:171], a[244:247], v[56:59], v[168:171]
    v_exp_f32 v140, v140
    v_mfma_f32_16x16x32_bf16 v[172:175], a[240:243], v[24:27], v[192:195]
    v_exp_f32 v141, v141
    v_mfma_f32_16x16x32_bf16 v[172:175], a[244:247], v[64:67], v[172:175]
    v_exp_f32 v142, v142
    v_mfma_f32_16x16x32_bf16 v[176:179], a[240:243], v[32:35], v[196:199]
    v_exp_f32 v143, v143
    v_mfma_f32_16x16x32_bf16 v[176:179], a[244:247], v[72:75], v[176:179]
    s_waitcnt lgkmcnt(0)
    s_barrier
    v_mfma_f32_16x16x32_bf16 v[160:163], a[248:251], v[80:83], v[160:163]
    ds_read_b64_tr_b16 a[240:241], v218 offset:0
    s_add_u32 m0, s8, 12288
    v_mfma_f32_16x16x32_bf16 v[160:163], a[252:255], v[4:7], v[160:163]
    buffer_load_dwordx4 v224, s[40:43], s65 offen offset:0 nt lds
    v_mfma_f32_16x16x32_bf16 v[164:167], a[248:251], v[88:91], v[164:167]
    ds_read_b64_tr_b16 a[242:243], v218 offset:6144
    buffer_load_dwordx4 v225, s[40:43], s65 offen offset:1024 nt lds
    v_mfma_f32_16x16x32_bf16 v[164:167], a[252:255], v[12:15], v[164:167]
    buffer_load_dwordx4 v226, s[40:43], s65 offen offset:2048 nt lds
    s_add_u32 s65, s65, 6291456
    v_mfma_f32_16x16x32_bf16 v[168:171], a[248:251], v[96:99], v[168:171]
    ds_read_b64_tr_b16 a[244:245], v219 offset:0
    s_add_u32 m0, s8, 94208
    v_mfma_f32_16x16x32_bf16 v[168:171], a[252:255], v[20:23], v[168:171]
    v_exp_f32 v144, v144
    v_mfma_f32_16x16x32_bf16 v[172:175], a[248:251], v[104:107], v[172:175]
    ds_read_b64_tr_b16 a[246:247], v219 offset:6144
    v_add_f32 v200, v200, v140
    v_mfma_f32_16x16x32_bf16 v[172:175], a[252:255], v[28:31], v[172:175]
    v_exp_f32 v145, v145
    v_mfma_f32_16x16x32_bf16 v[176:179], a[248:251], v[112:115], v[176:179]
    v_exp_f32 v146, v146
    v_mfma_f32_16x16x32_bf16 v[176:179], a[252:255], v[36:39], v[176:179]
    v_cvt_pk_bf16_f32 v140, v140, v141
    v_mfma_f32_16x16x32_bf16 v[160:163], v[208:211], v[44:47], v[160:163]
    ds_read_b64_tr_b16 a[248:249], v220 offset:0
    v_add_f32 v200, v200, v141
    v_mfma_f32_16x16x32_bf16 v[160:163], v[212:215], v[84:87], v[160:163]
    v_exp_f32 v147, v147
    v_mfma_f32_16x16x32_bf16 v[164:167], v[208:211], v[52:55], v[164:167]
    ds_read_b64_tr_b16 a[250:251], v220 offset:6144
    v_cvt_pk_bf16_f32 v141, v142, v143
    v_mfma_f32_16x16x32_bf16 v[164:167], v[212:215], v[92:95], v[164:167]
    buffer_load_dwordx4 v224, s[40:43], s65 offen offset:0 nt lds
    v_mfma_f32_16x16x32_bf16 v[168:171], v[208:211], v[60:63], v[168:171]
    ds_read_b64_tr_b16 a[252:253], v221 offset:0
    buffer_load_dwordx4 v225, s[40:43], s65 offen offset:1024 nt lds
    v_mfma_f32_16x16x32_bf16 v[168:171], v[212:215], v[100:103], v[168:171]
    buffer_load_dwordx4 v226, s[40:43], s65 offen offset:2048 nt lds
    s_add_u32 s65, s65, 4288688128
    v_mfma_f32_16x16x32_bf16 v[172:175], v[208:211], v[68:71], v[172:175]
    ds_read_b64_tr_b16 a[254:255], v221 offset:6144
    v_add_f32 v200, v200, v142
    v_mfma_f32_16x16x32_bf16 v[172:175], v[212:215], v[108:111], v[172:175]
    v_exp_f32 v148, v148
    v_mfma_f32_16x16x32_bf16 v[176:179], v[208:211], v[76:79], v[176:179]
    v_exp_f32 v149, v149
    v_mfma_f32_16x16x32_bf16 v[176:179], v[212:215], v[116:119], v[176:179]
    v_add_f32 v200, v200, v143
    s_waitcnt lgkmcnt(4)
    v_mfma_f32_16x16x32_bf16 a[0:3], a[240:243], v[120:123], 0
    ds_read_b64_tr_b16 v[208:209], v218 offset:128
    v_add_f32 v201, v201, v144
    v_mfma_f32_16x16x32_bf16 a[4:7], a[240:243], v[124:127], 0
    v_exp_f32 v150, v150
    v_mfma_f32_16x16x32_bf16 a[8:11], a[240:243], v[128:131], 0
    ds_read_b64_tr_b16 v[210:211], v218 offset:6272
    v_cvt_pk_bf16_f32 v144, v144, v145
    v_mfma_f32_16x16x32_bf16 a[12:15], a[240:243], v[132:135], 0
    v_exp_f32 v151, v151
    v_mfma_f32_16x16x32_bf16 a[16:19], a[240:243], v[136:139], 0
    ds_read_b64_tr_b16 v[212:213], v219 offset:128
    v_add_f32 v201, v201, v145
    v_mfma_f32_16x16x32_bf16 a[20:23], a[244:247], v[120:123], 0
    v_cvt_pk_bf16_f32 v145, v146, v147
    v_add_f32 v201, v201, v146
    v_mfma_f32_16x16x32_bf16 a[24:27], a[244:247], v[124:127], 0
    ds_read_b64_tr_b16 v[214:215], v219 offset:6272
    v_add_f32 v201, v201, v147
    v_mfma_f32_16x16x32_bf16 a[28:31], a[244:247], v[128:131], 0
    v_exp_f32 v152, v152
    v_mfma_f32_16x16x32_bf16 a[32:35], a[244:247], v[132:135], 0
    v_exp_f32 v153, v153
    v_mfma_f32_16x16x32_bf16 a[36:39], a[244:247], v[136:139], 0
    v_add_f32 v202, v202, v148
    s_waitcnt lgkmcnt(4)
    v_mfma_f32_16x16x32_bf16 a[40:43], a[248:251], v[120:123], 0
    ds_read_b64_tr_b16 a[240:241], v220 offset:128
    v_cvt_pk_bf16_f32 v148, v148, v149
    v_mfma_f32_16x16x32_bf16 a[44:47], a[248:251], v[124:127], 0
    v_exp_f32 v154, v154
    v_mfma_f32_16x16x32_bf16 a[48:51], a[248:251], v[128:131], 0
    ds_read_b64_tr_b16 a[242:243], v220 offset:6272
    v_add_f32 v202, v202, v149
    v_mfma_f32_16x16x32_bf16 a[52:55], a[248:251], v[132:135], 0
    v_exp_f32 v155, v155
    v_mfma_f32_16x16x32_bf16 a[56:59], a[248:251], v[136:139], 0
    ds_read_b64_tr_b16 a[244:245], v221 offset:128
    v_cvt_pk_bf16_f32 v149, v150, v151
    v_mfma_f32_16x16x32_bf16 a[60:63], a[252:255], v[120:123], 0
    v_add_f32 v202, v202, v150
    v_add_f32 v202, v202, v151
    v_mfma_f32_16x16x32_bf16 a[64:67], a[252:255], v[124:127], 0
    ds_read_b64_tr_b16 a[246:247], v221 offset:6272
    v_add_f32 v203, v203, v152
    v_mfma_f32_16x16x32_bf16 a[68:71], a[252:255], v[128:131], 0
    v_exp_f32 v156, v156
    v_mfma_f32_16x16x32_bf16 a[72:75], a[252:255], v[132:135], 0
    v_exp_f32 v157, v157
    v_mfma_f32_16x16x32_bf16 a[76:79], a[252:255], v[136:139], 0
    v_cvt_pk_bf16_f32 v152, v152, v153
    s_waitcnt lgkmcnt(4)
    v_mfma_f32_16x16x32_bf16 a[80:83], v[208:211], v[120:123], 0
    ds_read_b64_tr_b16 a[248:249], v218 offset:256
    v_add_f32 v203, v203, v153
    v_mfma_f32_16x16x32_bf16 a[84:87], v[208:211], v[124:127], 0
    v_exp_f32 v158, v158
    v_mfma_f32_16x16x32_bf16 a[88:91], v[208:211], v[128:131], 0
    ds_read_b64_tr_b16 a[250:251], v218 offset:6400
    v_cvt_pk_bf16_f32 v153, v154, v155
    v_mfma_f32_16x16x32_bf16 a[92:95], v[208:211], v[132:135], 0
    v_exp_f32 v159, v159
    v_mfma_f32_16x16x32_bf16 a[96:99], v[208:211], v[136:139], 0
    ds_read_b64_tr_b16 a[252:253], v219 offset:256
    v_add_f32 v203, v203, v154
    v_mfma_f32_16x16x32_bf16 a[100:103], v[212:215], v[120:123], 0
    v_exp_f32 v160, v160
    v_mfma_f32_16x16x32_bf16 a[104:107], v[212:215], v[124:127], 0
    ds_read_b64_tr_b16 a[254:255], v219 offset:6400
    v_add_f32 v203, v203, v155
    v_mfma_f32_16x16x32_bf16 a[108:111], v[212:215], v[128:131], 0
    v_exp_f32 v161, v161
    v_mfma_f32_16x16x32_bf16 a[112:115], v[212:215], v[132:135], 0
    v_exp_f32 v162, v162
    v_mfma_f32_16x16x32_bf16 a[116:119], v[212:215], v[136:139], 0
    v_add_f32 v204, v204, v156
    s_waitcnt lgkmcnt(4)
    v_mfma_f32_16x16x32_bf16 a[120:123], a[240:243], v[120:123], 0
    ds_read_b64_tr_b16 v[208:209], v220 offset:256
    v_cvt_pk_bf16_f32 v156, v156, v157
    v_mfma_f32_16x16x32_bf16 a[124:127], a[240:243], v[124:127], 0
    ds_read_b64_tr_b16 v[210:211], v220 offset:6400
    v_add_f32 v204, v204, v157
    v_mfma_f32_16x16x32_bf16 a[128:131], a[240:243], v[128:131], 0
    ds_read_b64_tr_b16 v[212:213], v221 offset:256
    v_cvt_pk_bf16_f32 v157, v158, v159
    v_mfma_f32_16x16x32_bf16 a[132:135], a[240:243], v[132:135], 0
    ds_read_b64_tr_b16 v[214:215], v221 offset:6400
    v_add_f32 v204, v204, v158
    v_mfma_f32_16x16x32_bf16 a[136:139], a[240:243], v[136:139], 0
    v_exp_f32 v163, v163
    v_mfma_f32_16x16x32_bf16 a[140:143], a[244:247], v[120:123], 0
    v_exp_f32 v164, v164
    v_mfma_f32_16x16x32_bf16 a[144:147], a[244:247], v[124:127], 0
    v_exp_f32 v165, v165
    v_mfma_f32_16x16x32_bf16 a[148:151], a[244:247], v[128:131], 0
    v_exp_f32 v166, v166
    v_mfma_f32_16x16x32_bf16 a[152:155], a[244:247], v[132:135], 0
    v_exp_f32 v167, v167
    v_mfma_f32_16x16x32_bf16 a[156:159], a[244:247], v[136:139], 0
    s_waitcnt vmcnt(18) lgkmcnt(0)
    s_barrier
    v_mfma_f32_16x16x32_bf16 a[160:163], a[248:251], v[120:123], 0
    ds_read_b128 a[240:243], v216 offset:24576
    s_add_u32 m0, s8, 40960
    v_mfma_f32_16x16x32_bf16 a[164:167], a[248:251], v[124:127], 0
    buffer_load_dwordx4 v224, s[44:47], s66 offen offset:0 nt lds
    v_mfma_f32_16x16x32_bf16 a[168:171], a[248:251], v[128:131], 0
    ds_read_b128 a[244:247], v217 offset:24576
    buffer_load_dwordx4 v225, s[44:47], s66 offen offset:1024 nt lds
    v_mfma_f32_16x16x32_bf16 a[172:175], a[248:251], v[132:135], 0
    buffer_load_dwordx4 v226, s[44:47], s66 offen offset:2048 nt lds
    s_add_u32 s66, s66, 6291456
    v_mfma_f32_16x16x32_bf16 a[176:179], a[248:251], v[136:139], 0
    s_add_u32 m0, s8, 122880
    v_add_f32 v204, v204, v159
    v_mfma_f32_16x16x32_bf16 a[180:183], a[252:255], v[120:123], 0
    v_add_f32 v200, v200, v160
    v_cvt_pk_bf16_f32 v142, v160, v161
    v_mfma_f32_16x16x32_bf16 a[184:187], a[252:255], v[124:127], 0
    v_add_f32 v200, v200, v161
    v_cvt_pk_bf16_f32 v143, v162, v163
    v_mfma_f32_16x16x32_bf16 a[188:191], a[252:255], v[128:131], 0
    v_add_f32 v200, v200, v162
    v_add_f32 v200, v200, v163
    v_mfma_f32_16x16x32_bf16 a[192:195], a[252:255], v[132:135], 0
    v_exp_f32 v168, v168
    v_mfma_f32_16x16x32_bf16 a[196:199], a[252:255], v[136:139], 0
    v_add_f32 v201, v201, v164
    v_mfma_f32_16x16x32_bf16 a[200:203], v[208:211], v[120:123], 0
    ds_read_b128 a[248:251], v216 offset:24704
    v_cvt_pk_bf16_f32 v146, v164, v165
    v_mfma_f32_16x16x32_bf16 a[204:207], v[208:211], v[124:127], 0
    v_exp_f32 v169, v169
    v_mfma_f32_16x16x32_bf16 a[208:211], v[208:211], v[128:131], 0
    ds_read_b128 a[252:255], v217 offset:24704
    v_add_f32 v201, v201, v165
    v_mfma_f32_16x16x32_bf16 a[212:215], v[208:211], v[132:135], 0
    buffer_load_dwordx4 v224, s[44:47], s66 offen offset:0 nt lds
    v_mfma_f32_16x16x32_bf16 a[216:219], v[208:211], v[136:139], 0
    buffer_load_dwordx4 v225, s[44:47], s66 offen offset:1024 nt lds
    v_mfma_f32_16x16x32_bf16 a[220:223], v[212:215], v[120:123], 0
    buffer_load_dwordx4 v226, s[44:47], s66 offen offset:2048 nt lds
    s_add_u32 s66, s66, 4288688128
    v_mfma_f32_16x16x32_bf16 a[224:227], v[212:215], v[124:127], 0
    v_exp_f32 v170, v170
    v_mfma_f32_16x16x32_bf16 a[228:231], v[212:215], v[128:131], 0
    v_exp_f32 v171, v171
    v_mfma_f32_16x16x32_bf16 a[232:235], v[212:215], v[132:135], 0
    v_cvt_pk_bf16_f32 v147, v166, v167
    v_add_f32 v201, v201, v166
    v_mfma_f32_16x16x32_bf16 a[236:239], v[212:215], v[136:139], 0
    v_add_f32 v201, v201, v167
    v_add_f32 v202, v202, v168
    v_cvt_pk_bf16_f32 v150, v168, v169
    v_add_f32 v202, v202, v169
    v_cvt_pk_bf16_f32 v151, v170, v171
    v_add_f32 v202, v202, v170
    v_add_f32 v202, v202, v171
    s_mov_b32 s62, 0
    s_nop 0
L_att_loop:
    s_waitcnt lgkmcnt(2)
    v_mfma_f32_16x16x32_bf16 v[120:123], a[240:243], v[0:3], v[180:183]
    ds_read_b128 v[208:211], v216 offset:24832
    v_mfma_f32_16x16x32_bf16 v[120:123], a[244:247], v[40:43], v[120:123]
    v_exp_f32 v172, v172
    v_mfma_f32_16x16x32_bf16 v[124:127], a[240:243], v[8:11], v[184:187]
    ds_read_b128 v[212:215], v217 offset:24832
    v_mfma_f32_16x16x32_bf16 v[124:127], a[244:247], v[48:51], v[124:127]
    v_exp_f32 v173, v173
    v_mfma_f32_16x16x32_bf16 v[128:131], a[240:243], v[16:19], v[188:191]
    v_exp_f32 v174, v174
    v_mfma_f32_16x16x32_bf16 v[128:131], a[244:247], v[56:59], v[128:131]
    v_exp_f32 v175, v175
    v_mfma_f32_16x16x32_bf16 v[132:135], a[240:243], v[24:27], v[192:195]
    v_exp_f32 v176, v176
    v_mfma_f32_16x16x32_bf16 v[132:135], a[244:247], v[64:67], v[132:135]
    v_exp_f32 v177, v177
    v_mfma_f32_16x16x32_bf16 v[136:139], a[240:243], v[32:35], v[196:199]
    v_exp_f32 v178, v178
    v_mfma_f32_16x16x32_bf16 v[136:139], a[244:247], v[72:75], v[136:139]
    v_add_f32 v203, v203, v172
    s_waitcnt lgkmcnt(2)
    v_mfma_f32_16x16x32_bf16 v[120:123], a[248:251], v[80:83], v[120:123]
    ds_read_b128 a[240:243], v216 offset:30720
    v_cvt_pk_bf16_f32 v154, v172, v173
    v_mfma_f32_16x16x32_bf16 v[120:123], a[252:255], v[4:7], v[120:123]
    v_exp_f32 v179, v179
    v_mfma_f32_16x16x32_bf16 v[124:127], a[248:251], v[88:91], v[124:127]
    ds_read_b128 a[244:247], v217 offset:30720
    v_add_f32 v203, v203, v173
    v_mfma_f32_16x16x32_bf16 v[124:127], a[252:255], v[12:15], v[124:127]
    v_cvt_pk_bf16_f32 v155, v174, v175
    v_add_f32 v203, v203, v174
    v_mfma_f32_16x16x32_bf16 v[128:131], a[248:251], v[96:99], v[128:131]
    v_add_f32 v203, v203, v175
    v_add_f32 v204, v204, v176
    v_mfma_f32_16x16x32_bf16 v[128:131], a[252:255], v[20:23], v[128:131]
    v_cvt_pk_bf16_f32 v158, v176, v177
    v_add_f32 v204, v204, v177
    v_mfma_f32_16x16x32_bf16 v[132:135], a[248:251], v[104:107], v[132:135]
    v_cvt_pk_bf16_f32 v159, v178, v179
    v_add_f32 v204, v204, v178
    v_mfma_f32_16x16x32_bf16 v[132:135], a[252:255], v[28:31], v[132:135]
    v_add_f32 v204, v204, v179
    v_mfma_f32_16x16x32_bf16 v[136:139], a[248:251], v[112:115], v[136:139]
    v_mfma_f32_16x16x32_bf16 v[136:139], a[252:255], v[36:39], v[136:139]
    s_waitcnt lgkmcnt(2)
    v_mfma_f32_16x16x32_bf16 v[120:123], v[208:211], v[44:47], v[120:123]
    ds_read_b128 a[248:251], v216 offset:30848
    v_mfma_f32_16x16x32_bf16 v[120:123], v[212:215], v[84:87], v[120:123]
    v_mfma_f32_16x16x32_bf16 v[124:127], v[208:211], v[52:55], v[124:127]
    ds_read_b128 a[252:255], v217 offset:30848
    v_mfma_f32_16x16x32_bf16 v[124:127], v[212:215], v[92:95], v[124:127]
    v_mfma_f32_16x16x32_bf16 v[128:131], v[208:211], v[60:63], v[128:131]
    v_mfma_f32_16x16x32_bf16 v[128:131], v[212:215], v[100:103], v[128:131]
    v_mfma_f32_16x16x32_bf16 v[132:135], v[208:211], v[68:71], v[132:135]
    v_mfma_f32_16x16x32_bf16 v[132:135], v[212:215], v[108:111], v[132:135]
    v_mfma_f32_16x16x32_bf16 v[136:139], v[208:211], v[76:79], v[136:139]
    v_mfma_f32_16x16x32_bf16 v[136:139], v[212:215], v[116:119], v[136:139]
    s_waitcnt lgkmcnt(2)
    v_mfma_f32_16x16x32_bf16 v[160:163], a[240:243], v[0:3], v[180:183]
    ds_read_b128 v[208:211], v216 offset:30976
    v_mfma_f32_16x16x32_bf16 v[160:163], a[244:247], v[40:43], v[160:163]
    ds_read_b128 v[212:215], v217 offset:30976
    v_mfma_f32_16x16x32_bf16 v[164:167], a[240:243], v[8:11], v[184:187]
    v_mfma_f32_16x16x32_bf16 v[164:167], a[244:247], v[48:51], v[164:167]
    v_mfma_f32_16x16x32_bf16 v[168:171], a[240:243], v[16:19], v[188:191]
    v_mfma_f32_16x16x32_bf16 v[168:171], a[244:247], v[56:59], v[168:171]
    v_exp_f32 v120, v120
    v_mfma_f32_16x16x32_bf16 v[172:175], a[240:243], v[24:27], v[192:195]
    v_exp_f32 v121, v121
    v_mfma_f32_16x16x32_bf16 v[172:175], a[244:247], v[64:67], v[172:175]
    v_exp_f32 v122, v122
    v_mfma_f32_16x16x32_bf16 v[176:179], a[240:243], v[32:35], v[196:199]
    v_exp_f32 v123, v123
    v_mfma_f32_16x16x32_bf16 v[176:179], a[244:247], v[72:75], v[176:179]
    s_waitcnt vmcnt(24) lgkmcnt(0)
    s_barrier
    v_mfma_f32_16x16x32_bf16 v[160:163], a[248:251], v[80:83], v[160:163]
    ds_read_b64_tr_b16 a[240:241], v218 offset:12288
    s_add_u32 m0, s8, 24576
    v_mfma_f32_16x16x32_bf16 v[160:163], a[252:255], v[4:7], v[160:163]
    buffer_load_dwordx4 v224, s[40:43], s65 offen offset:0 nt lds
    v_mfma_f32_16x16x32_bf16 v[164:167], a[248:251], v[88:91], v[164:167]
    ds_read_b64_tr_b16 a[242:243], v218 offset:18432
    buffer_load_dwordx4 v225, s[40:43], s65 offen offset:1024 nt lds
    v_mfma_f32_16x16x32_bf16 v[164:167], a[252:255], v[12:15], v[164:167]
    buffer_load_dwordx4 v226, s[40:43], s65 offen offset:2048 nt lds
    s_add_u32 s65, s65, 6291456
    v_mfma_f32_16x16x32_bf16 v[168:171], a[248:251], v[96:99], v[168:171]
    ds_read_b64_tr_b16 a[244:245], v219 offset:12288
    s_add_u32 m0, s8, 106496
    v_mfma_f32_16x16x32_bf16 v[168:171], a[252:255], v[20:23], v[168:171]
    v_exp_f32 v124, v124
    v_mfma_f32_16x16x32_bf16 v[172:175], a[248:251], v[104:107], v[172:175]
    ds_read_b64_tr_b16 a[246:247], v219 offset:18432
    v_add_f32 v200, v200, v120
    v_mfma_f32_16x16x32_bf16 v[172:175], a[252:255], v[28:31], v[172:175]
    v_exp_f32 v125, v125
    v_mfma_f32_16x16x32_bf16 v[176:179], a[248:251], v[112:115], v[176:179]
    v_exp_f32 v126, v126
    v_mfma_f32_16x16x32_bf16 v[176:179], a[252:255], v[36:39], v[176:179]
    v_cvt_pk_bf16_f32 v120, v120, v121
    v_mfma_f32_16x16x32_bf16 v[160:163], v[208:211], v[44:47], v[160:163]
    ds_read_b64_tr_b16 a[248:249], v220 offset:12288
    v_add_f32 v200, v200, v121
    v_mfma_f32_16x16x32_bf16 v[160:163], v[212:215], v[84:87], v[160:163]
    v_exp_f32 v127, v127
    v_mfma_f32_16x16x32_bf16 v[164:167], v[208:211], v[52:55], v[164:167]
    ds_read_b64_tr_b16 a[250:251], v220 offset:18432
    v_cvt_pk_bf16_f32 v121, v122, v123
    v_mfma_f32_16x16x32_bf16 v[164:167], v[212:215], v[92:95], v[164:167]
    buffer_load_dwordx4 v224, s[40:43], s65 offen offset:0 nt lds
    v_mfma_f32_16x16x32_bf16 v[168:171], v[208:211], v[60:63], v[168:171]
    ds_read_b64_tr_b16 a[252:253], v221 offset:12288
    buffer_load_dwordx4 v225, s[40:43], s65 offen offset:1024 nt lds
    v_mfma_f32_16x16x32_bf16 v[168:171], v[212:215], v[100:103], v[168:171]
    buffer_load_dwordx4 v226, s[40:43], s65 offen offset:2048 nt lds
    s_add_u32 s65, s65, 4288688128
    v_mfma_f32_16x16x32_bf16 v[172:175], v[208:211], v[68:71], v[172:175]
    ds_read_b64_tr_b16 a[254:255], v221 offset:18432
    v_add_f32 v200, v200, v122
    v_mfma_f32_16x16x32_bf16 v[172:175], v[212:215], v[108:111], v[172:175]
    v_exp_f32 v128, v128
    v_mfma_f32_16x16x32_bf16 v[176:179], v[208:211], v[76:79], v[176:179]
    v_exp_f32 v129, v129
    v_mfma_f32_16x16x32_bf16 v[176:179], v[212:215], v[116:119], v[176:179]
    v_add_f32 v200, v200, v123
    s_waitcnt lgkmcnt(4)
    v_mfma_f32_16x16x32_bf16 a[0:3], a[240:243], v[140:143], a[0:3]
    ds_read_b64_tr_b16 v[208:209], v218 offset:12416
    v_add_f32 v201, v201, v124
    v_mfma_f32_16x16x32_bf16 a[4:7], a[240:243], v[144:147], a[4:7]
    v_exp_f32 v130, v130
    v_mfma_f32_16x16x32_bf16 a[8:11], a[240:243], v[148:151], a[8:11]
    ds_read_b64_tr_b16 v[210:211], v218 offset:18560
    v_cvt_pk_bf16_f32 v124, v124, v125
    v_mfma_f32_16x16x32_bf16 a[12:15], a[240:243], v[152:155], a[12:15]
    v_exp_f32 v131, v131
    v_mfma_f32_16x16x32_bf16 a[16:19], a[240:243], v[156:159], a[16:19]
    ds_read_b64_tr_b16 v[212:213], v219 offset:12416
    v_add_f32 v201, v201, v125
    v_mfma_f32_16x16x32_bf16 a[20:23], a[244:247], v[140:143], a[20:23]
    v_cvt_pk_bf16_f32 v125, v126, v127
    v_add_f32 v201, v201, v126
    v_mfma_f32_16x16x32_bf16 a[24:27], a[244:247], v[144:147], a[24:27]
    ds_read_b64_tr_b16 v[214:215], v219 offset:18560
    v_add_f32 v201, v201, v127
    v_mfma_f32_16x16x32_bf16 a[28:31], a[244:247], v[148:151], a[28:31]
    v_exp_f32 v132, v132
    v_mfma_f32_16x16x32_bf16 a[32:35], a[244:247], v[152:155], a[32:35]
    v_exp_f32 v133, v133
    v_mfma_f32_16x16x32_bf16 a[36:39], a[244:247], v[156:159], a[36:39]
    v_add_f32 v202, v202, v128
    s_waitcnt lgkmcnt(4)
    v_mfma_f32_16x16x32_bf16 a[40:43], a[248:251], v[140:143], a[40:43]
    ds_read_b64_tr_b16 a[240:241], v220 offset:12416
    v_cvt_pk_bf16_f32 v128, v128, v129
    v_mfma_f32_16x16x32_bf16 a[44:47], a[248:251], v[144:147], a[44:47]
    v_exp_f32 v134, v134
    v_mfma_f32_16x16x32_bf16 a[48:51], a[248:251], v[148:151], a[48:51]
    ds_read_b64_tr_b16 a[242:243], v220 offset:18560
    v_add_f32 v202, v202, v129
    v_mfma_f32_16x16x32_bf16 a[52:55], a[248:251], v[152:155], a[52:55]
    v_exp_f32 v135, v135
    v_mfma_f32_16x16x32_bf16 a[56:59], a[248:251], v[156:159], a[56:59]
    ds_read_b64_tr_b16 a[244:245], v221 offset:12416
    v_cvt_pk_bf16_f32 v129, v130, v131
    v_mfma_f32_16x16x32_bf16 a[60:63], a[252:255], v[140:143], a[60:63]
    v_add_f32 v202, v202, v130
    v_add_f32 v202, v202, v131
    v_mfma_f32_16x16x32_bf16 a[64:67], a[252:255], v[144:147], a[64:67]
    ds_read_b64_tr_b16 a[246:247], v221 offset:18560
    v_add_f32 v203, v203, v132
    v_mfma_f32_16x16x32_bf16 a[68:71], a[252:255], v[148:151], a[68:71]
    v_exp_f32 v136, v136
    v_mfma_f32_16x16x32_bf16 a[72:75], a[252:255], v[152:155], a[72:75]
    v_exp_f32 v137, v137
    v_mfma_f32_16x16x32_bf16 a[76:79], a[252:255], v[156:159], a[76:79]
    v_cvt_pk_bf16_f32 v132, v132, v133
    s_waitcnt lgkmcnt(4)
    v_mfma_f32_16x16x32_bf16 a[80:83], v[208:211], v[140:143], a[80:83]
    ds_read_b64_tr_b16 a[248:249], v218 offset:12544
    v_add_f32 v203, v203, v133
    v_mfma_f32_16x16x32_bf16 a[84:87], v[208:211], v[144:147], a[84:87]
    v_exp_f32 v138, v138
    v_mfma_f32_16x16x32_bf16 a[88:91], v[208:211], v[148:151], a[88:91]
    ds_read_b64_tr_b16 a[250:251], v218 offset:18688
    v_cvt_pk_bf16_f32 v133, v134, v135
    v_mfma_f32_16x16x32_bf16 a[92:95], v[208:211], v[152:155], a[92:95]
    v_exp_f32 v139, v139
    v_mfma_f32_16x16x32_bf16 a[96:99], v[208:211], v[156:159], a[96:99]
    ds_read_b64_tr_b16 a[252:253], v219 offset:12544
    v_add_f32 v203, v203, v134
    v_mfma_f32_16x16x32_bf16 a[100:103], v[212:215], v[140:143], a[100:103]
    v_exp_f32 v160, v160
    v_mfma_f32_16x16x32_bf16 a[104:107], v[212:215], v[144:147], a[104:107]
    ds_read_b64_tr_b16 a[254:255], v219 offset:18688
    v_add_f32 v203, v203, v135
    v_mfma_f32_16x16x32_bf16 a[108:111], v[212:215], v[148:151], a[108:111]
    v_exp_f32 v161, v161
    v_mfma_f32_16x16x32_bf16 a[112:115], v[212:215], v[152:155], a[112:115]
    v_exp_f32 v162, v162
    v_mfma_f32_16x16x32_bf16 a[116:119], v[212:215], v[156:159], a[116:119]
    v_add_f32 v204, v204, v136
    s_waitcnt lgkmcnt(4)
    v_mfma_f32_16x16x32_bf16 a[120:123], a[240:243], v[140:143], a[120:123]
    ds_read_b64_tr_b16 v[208:209], v220 offset:12544
    v_cvt_pk_bf16_f32 v136, v136, v137
    v_mfma_f32_16x16x32_bf16 a[124:127], a[240:243], v[144:147], a[124:127]
    ds_read_b64_tr_b16 v[210:211], v220 offset:18688
    v_add_f32 v204, v204, v137
    v_mfma_f32_16x16x32_bf16 a[128:131], a[240:243], v[148:151], a[128:131]
    ds_read_b64_tr_b16 v[212:213], v221 offset:12544
    v_cvt_pk_bf16_f32 v137, v138, v139
    v_mfma_f32_16x16x32_bf16 a[132:135], a[240:243], v[152:155], a[132:135]
    ds_read_b64_tr_b16 v[214:215], v221 offset:18688
    v_add_f32 v204, v204, v138
    v_mfma_f32_16x16x32_bf16 a[136:139], a[240:243], v[156:159], a[136:139]
    v_exp_f32 v163, v163
    v_mfma_f32_16x16x32_bf16 a[140:143], a[244:247], v[140:143], a[140:143]
    v_exp_f32 v164, v164
    v_mfma_f32_16x16x32_bf16 a[144:147], a[244:247], v[144:147], a[144:147]
    v_exp_f32 v165, v165
    v_mfma_f32_16x16x32_bf16 a[148:151], a[244:247], v[148:151], a[148:151]
    v_exp_f32 v166, v166
    v_mfma_f32_16x16x32_bf16 a[152:155], a[244:247], v[152:155], a[152:155]
    v_exp_f32 v167, v167
    v_mfma_f32_16x16x32_bf16 a[156:159], a[244:247], v[156:159], a[156:159]
    s_waitcnt vmcnt(24) lgkmcnt(0)
    s_barrier
    v_mfma_f32_16x16x32_bf16 a[160:163], a[248:251], v[140:143], a[160:163]
    ds_read_b128 a[240:243], v216 offset:0
    s_add_u32 m0, s8, 53248
    v_mfma_f32_16x16x32_bf16 a[164:167], a[248:251], v[144:147], a[164:167]
    buffer_load_dwordx4 v224, s[44:47], s66 offen offset:0 nt lds
    v_mfma_f32_16x16x32_bf16 a[168:171], a[248:251], v[148:151], a[168:171]
    ds_read_b128 a[244:247], v217 offset:0
    buffer_load_dwordx4 v225, s[44:47], s66 offen offset:1024 nt lds
    v_mfma_f32_16x16x32_bf16 a[172:175], a[248:251], v[152:155], a[172:175]
    buffer_load_dwordx4 v226, s[44:47], s66 offen offset:2048 nt lds
    s_add_u32 s66, s66, 6291456
    v_mfma_f32_16x16x32_bf16 a[176:179], a[248:251], v[156:159], a[176:179]
    s_add_u32 m0, s8, 135168
    v_add_f32 v204, v204, v139
    v_mfma_f32_16x16x32_bf16 a[180:183], a[252:255], v[140:143], a[180:183]
    v_add_f32 v200, v200, v160
    v_cvt_pk_bf16_f32 v122, v160, v161
    v_mfma_f32_16x16x32_bf16 a[184:187], a[252:255], v[144:147], a[184:187]
    v_add_f32 v200, v200, v161
    v_cvt_pk_bf16_f32 v123, v162, v163
    v_mfma_f32_16x16x32_bf16 a[188:191], a[252:255], v[148:151], a[188:191]
    v_add_f32 v200, v200, v162
    v_add_f32 v200, v200, v163
    v_mfma_f32_16x16x32_bf16 a[192:195], a[252:255], v[152:155], a[192:195]
    v_exp_f32 v168, v168
    v_mfma_f32_16x16x32_bf16 a[196:199], a[252:255], v[156:159], a[196:199]
    v_add_f32 v201, v201, v164
    v_mfma_f32_16x16x32_bf16 a[200:203], v[208:211], v[140:143], a[200:203]
    ds_read_b128 a[248:251], v216 offset:128
    v_cvt_pk_bf16_f32 v126, v164, v165
    v_mfma_f32_16x16x32_bf16 a[204:207], v[208:211], v[144:147], a[204:207]
    v_exp_f32 v169, v169
    v_mfma_f32_16x16x32_bf16 a[208:211], v[208:211], v[148:151], a[208:211]
    ds_read_b128 a[252:255], v217 offset:128
    v_add_f32 v201, v201, v165
    v_mfma_f32_16x16x32_bf16 a[212:215], v[208:211], v[152:155], a[212:215]
    buffer_load_dwordx4 v224, s[44:47], s66 offen offset:0 nt lds
    v_mfma_f32_16x16x32_bf16 a[216:219], v[208:211], v[156:159], a[216:219]
    buffer_load_dwordx4 v225, s[44:47], s66 offen offset:1024 nt lds
    v_mfma_f32_16x16x32_bf16 a[220:223], v[212:215], v[140:143], a[220:223]
    buffer_load_dwordx4 v226, s[44:47], s66 offen offset:2048 nt lds
    s_add_u32 s66, s66, 4288688128
    v_mfma_f32_16x16x32_bf16 a[224:227], v[212:215], v[144:147], a[224:227]
    v_exp_f32 v170, v170
    v_mfma_f32_16x16x32_bf16 a[228:231], v[212:215], v[148:151], a[228:231]
    v_exp_f32 v171, v171
    v_mfma_f32_16x16x32_bf16 a[232:235], v[212:215], v[152:155], a[232:235]
    v_cvt_pk_bf16_f32 v127, v166, v167
    v_add_f32 v201, v201, v166
    v_mfma_f32_16x16x32_bf16 a[236:239], v[212:215], v[156:159], a[236:239]
    v_add_f32 v201, v201, v167
    v_add_f32 v202, v202, v168
    v_cvt_pk_bf16_f32 v130, v168, v169
    v_add_f32 v202, v202, v169
    v_cvt_pk_bf16_f32 v131, v170, v171
    v_add_f32 v202, v202, v170
    v_add_f32 v202, v202, v171
    s_waitcnt lgkmcnt(2)
    v_mfma_f32_16x16x32_bf16 v[140:143], a[240:243], v[0:3], v[180:183]
    ds_read_b128 v[208:211], v216 offset:256
    v_mfma_f32_16x16x32_bf16 v[140:143], a[244:247], v[40:43], v[140:143]
    v_exp_f32 v172, v172
    v_mfma_f32_16x16x32_bf16 v[144:147], a[240:243], v[8:11], v[184:187]
    ds_read_b128 v[212:215], v217 offset:256
    v_mfma_f32_16x16x32_bf16 v[144:147], a[244:247], v[48:51], v[144:147]
    v_exp_f32 v173, v173
    v_mfma_f32_16x16x32_bf16 v[148:151], a[240:243], v[16:19], v[188:191]
    v_exp_f32 v174, v174
    v_mfma_f32_16x16x32_bf16 v[148:151], a[244:247], v[56:59], v[148:151]
    v_exp_f32 v175, v175
    v_mfma_f32_16x16x32_bf16 v[152:155], a[240:243], v[24:27], v[192:195]
    v_exp_f32 v176, v176
    v_mfma_f32_16x16x32_bf16 v[152:155], a[244:247], v[64:67], v[152:155]
    v_exp_f32 v177, v177
    v_mfma_f32_16x16x32_bf16 v[156:159], a[240:243], v[32:35], v[196:199]
    v_exp_f32 v178, v178
    v_mfma_f32_16x16x32_bf16 v[156:159], a[244:247], v[72:75], v[156:159]
    v_add_f32 v203, v203, v172
    s_waitcnt lgkmcnt(2)
    v_mfma_f32_16x16x32_bf16 v[140:143], a[248:251], v[80:83], v[140:143]
    ds_read_b128 a[240:243], v216 offset:6144
    v_cvt_pk_bf16_f32 v134, v172, v173
    v_mfma_f32_16x16x32_bf16 v[140:143], a[252:255], v[4:7], v[140:143]
    v_exp_f32 v179, v179
    v_mfma_f32_16x16x32_bf16 v[144:147], a[248:251], v[88:91], v[144:147]
    ds_read_b128 a[244:247], v217 offset:6144
    v_add_f32 v203, v203, v173
    v_mfma_f32_16x16x32_bf16 v[144:147], a[252:255], v[12:15], v[144:147]
    v_cvt_pk_bf16_f32 v135, v174, v175
    v_add_f32 v203, v203, v174
    v_mfma_f32_16x16x32_bf16 v[148:151], a[248:251], v[96:99], v[148:151]
    v_add_f32 v203, v203, v175
    v_add_f32 v204, v204, v176
    v_mfma_f32_16x16x32_bf16 v[148:151], a[252:255], v[20:23], v[148:151]
    v_cvt_pk_bf16_f32 v138, v176, v177
    v_add_f32 v204, v204, v177
    v_mfma_f32_16x16x32_bf16 v[152:155], a[248:251], v[104:107], v[152:155]
    v_cvt_pk_bf16_f32 v139, v178, v179
    v_add_f32 v204, v204, v178
    v_mfma_f32_16x16x32_bf16 v[152:155], a[252:255], v[28:31], v[152:155]
    v_add_f32 v204, v204, v179
    v_mfma_f32_16x16x32_bf16 v[156:159], a[248:251], v[112:115], v[156:159]
    v_mfma_f32_16x16x32_bf16 v[156:159], a[252:255], v[36:39], v[156:159]
    s_waitcnt lgkmcnt(2)
    v_mfma_f32_16x16x32_bf16 v[140:143], v[208:211], v[44:47], v[140:143]
    ds_read_b128 a[248:251], v216 offset:6272
    v_mfma_f32_16x16x32_bf16 v[140:143], v[212:215], v[84:87], v[140:143]
    v_mfma_f32_16x16x32_bf16 v[144:147], v[208:211], v[52:55], v[144:147]
    ds_read_b128 a[252:255], v217 offset:6272
    v_mfma_f32_16x16x32_bf16 v[144:147], v[212:215], v[92:95], v[144:147]
    v_mfma_f32_16x16x32_bf16 v[148:151], v[208:211], v[60:63], v[148:151]
    v_mfma_f32_16x16x32_bf16 v[148:151], v[212:215], v[100:103], v[148:151]
    v_mfma_f32_16x16x32_bf16 v[152:155], v[208:211], v[68:71], v[152:155]
    v_mfma_f32_16x16x32_bf16 v[152:155], v[212:215], v[108:111], v[152:155]
    v_mfma_f32_16x16x32_bf16 v[156:159], v[208:211], v[76:79], v[156:159]
    v_mfma_f32_16x16x32_bf16 v[156:159], v[212:215], v[116:119], v[156:159]
    s_waitcnt lgkmcnt(2)
    v_mfma_f32_16x16x32_bf16 v[160:163], a[240:243], v[0:3], v[180:183]
    ds_read_b128 v[208:211], v216 offset:6400
    v_mfma_f32_16x16x32_bf16 v[160:163], a[244:247], v[40:43], v[160:163]
    ds_read_b128 v[212:215], v217 offset:6400
    v_mfma_f32_16x16x32_bf16 v[164:167], a[240:243], v[8:11], v[184:187]
    v_mfma_f32_16x16x32_bf16 v[164:167], a[244:247], v[48:51], v[164:167]
    v_mfma_f32_16x16x32_bf16 v[168:171], a[240:243], v[16:19], v[188:191]
    v_mfma_f32_16x16x32_bf16 v[168:171], a[244:247], v[56:59], v[168:171]
    v_exp_f32 v140, v140
    v_mfma_f32_16x16x32_bf16 v[172:175], a[240:243], v[24:27], v[192:195]
    v_exp_f32 v141, v141
    v_mfma_f32_16x16x32_bf16 v[172:175], a[244:247], v[64:67], v[172:175]
    v_exp_f32 v142, v142
    v_mfma_f32_16x16x32_bf16 v[176:179], a[240:243], v[32:35], v[196:199]
    v_exp_f32 v143, v143
    v_mfma_f32_16x16x32_bf16 v[176:179], a[244:247], v[72:75], v[176:179]
    s_waitcnt vmcnt(24) lgkmcnt(0)
    s_barrier
    v_mfma_f32_16x16x32_bf16 v[160:163], a[248:251], v[80:83], v[160:163]
    ds_read_b64_tr_b16 a[240:241], v218 offset:24576
    v_mov_b32 v206, s97
    v_mfma_f32_16x16x32_bf16 v[160:163], a[252:255], v[4:7], v[160:163]
    buffer_atomic_add v206, v205, s[48:51], s96 offen sc1
    s_mov_b32 s96, 0x7f000000
    v_mfma_f32_16x16x32_bf16 v[164:167], a[248:251], v[88:91], v[164:167]
    ds_read_b64_tr_b16 a[242:243], v218 offset:30720
    s_add_u32 m0, s8, 0
    v_mfma_f32_16x16x32_bf16 v[164:167], a[252:255], v[12:15], v[164:167]
    v_exp_f32 v144, v144
    v_mfma_f32_16x16x32_bf16 v[168:171], a[248:251], v[96:99], v[168:171]
    ds_read_b64_tr_b16 a[244:245], v219 offset:24576
    v_add_f32 v200, v200, v140
    v_mfma_f32_16x16x32_bf16 v[168:171], a[252:255], v[20:23], v[168:171]
    v_exp_f32 v145, v145
    v_mfma_f32_16x16x32_bf16 v[172:175], a[248:251], v[104:107], v[172:175]
    ds_read_b64_tr_b16 a[246:247], v219 offset:30720
    v_cvt_pk_bf16_f32 v140, v140, v141
    v_mfma_f32_16x16x32_bf16 v[172:175], a[252:255], v[28:31], v[172:175]
    v_exp_f32 v146, v146
    v_mfma_f32_16x16x32_bf16 v[176:179], a[248:251], v[112:115], v[176:179]
    v_exp_f32 v147, v147
    v_mfma_f32_16x16x32_bf16 v[176:179], a[252:255], v[36:39], v[176:179]
    v_add_f32 v200, v200, v141
    v_mfma_f32_16x16x32_bf16 v[160:163], v[208:211], v[44:47], v[160:163]
    ds_read_b64_tr_b16 a[248:249], v220 offset:24576
    v_cvt_pk_bf16_f32 v141, v142, v143
    v_mfma_f32_16x16x32_bf16 v[160:163], v[212:215], v[84:87], v[160:163]
    v_add_f32 v200, v200, v142
    v_add_f32 v200, v200, v143
    v_mfma_f32_16x16x32_bf16 v[164:167], v[208:211], v[52:55], v[164:167]
    ds_read_b64_tr_b16 a[250:251], v220 offset:30720
    v_add_f32 v201, v201, v144
    v_mfma_f32_16x16x32_bf16 v[164:167], v[212:215], v[92:95], v[164:167]
    buffer_load_dwordx4 v224, s[40:43], s65 offen offset:0 nt lds
    v_mfma_f32_16x16x32_bf16 v[168:171], v[208:211], v[60:63], v[168:171]
    ds_read_b64_tr_b16 a[252:253], v221 offset:24576
    buffer_load_dwordx4 v225, s[40:43], s65 offen offset:1024 nt lds
    v_mfma_f32_16x16x32_bf16 v[168:171], v[212:215], v[100:103], v[168:171]
    buffer_load_dwordx4 v226, s[40:43], s65 offen offset:2048 nt lds
    s_add_u32 s65, s65, 6291456
    v_mfma_f32_16x16x32_bf16 v[172:175], v[208:211], v[68:71], v[172:175]
    ds_read_b64_tr_b16 a[254:255], v221 offset:30720
    s_add_u32 m0, s8, 81920
    v_mfma_f32_16x16x32_bf16 v[172:175], v[212:215], v[108:111], v[172:175]
    v_exp_f32 v148, v148
    v_mfma_f32_16x16x32_bf16 v[176:179], v[208:211], v[76:79], v[176:179]
    v_exp_f32 v149, v149
    v_mfma_f32_16x16x32_bf16 v[176:179], v[212:215], v[116:119], v[176:179]
    v_cvt_pk_bf16_f32 v144, v144, v145
    s_waitcnt lgkmcnt(4)
    v_mfma_f32_16x16x32_bf16 a[0:3], a[240:243], v[120:123], a[0:3]
    ds_read_b64_tr_b16 v[208:209], v218 offset:24704
    v_add_f32 v201, v201, v145
    v_mfma_f32_16x16x32_bf16 a[4:7], a[240:243], v[124:127], a[4:7]
    v_exp_f32 v150, v150
    v_mfma_f32_16x16x32_bf16 a[8:11], a[240:243], v[128:131], a[8:11]
    ds_read_b64_tr_b16 v[210:211], v218 offset:30848
    v_cvt_pk_bf16_f32 v145, v146, v147
    v_mfma_f32_16x16x32_bf16 a[12:15], a[240:243], v[132:135], a[12:15]
    v_exp_f32 v151, v151
    v_mfma_f32_16x16x32_bf16 a[16:19], a[240:243], v[136:139], a[16:19]
    ds_read_b64_tr_b16 v[212:213], v219 offset:24704
    v_add_f32 v201, v201, v146
    v_mfma_f32_16x16x32_bf16 a[20:23], a[244:247], v[120:123], a[20:23]
    buffer_load_dwordx4 v224, s[40:43], s65 offen offset:0 nt lds
    v_mfma_f32_16x16x32_bf16 a[24:27], a[244:247], v[124:127], a[24:27]
    ds_read_b64_tr_b16 v[214:215], v219 offset:30848
    buffer_load_dwordx4 v225, s[40:43], s65 offen offset:1024 nt lds
    v_mfma_f32_16x16x32_bf16 a[28:31], a[244:247], v[128:131], a[28:31]
    buffer_load_dwordx4 v226, s[40:43], s65 offen offset:2048 nt lds
    s_add_u32 s65, s65, 4288688128
    v_mfma_f32_16x16x32_bf16 a[32:35], a[244:247], v[132:135], a[32:35]
    v_exp_f32 v152, v152
    v_mfma_f32_16x16x32_bf16 a[36:39], a[244:247], v[136:139], a[36:39]
    v_add_f32 v201, v201, v147
    s_waitcnt lgkmcnt(4)
    v_mfma_f32_16x16x32_bf16 a[40:43], a[248:251], v[120:123], a[40:43]
    ds_read_b64_tr_b16 a[240:241], v220 offset:24704
    v_add_f32 v202, v202, v148
    v_mfma_f32_16x16x32_bf16 a[44:47], a[248:251], v[124:127], a[44:47]
    v_exp_f32 v153, v153
    v_mfma_f32_16x16x32_bf16 a[48:51], a[248:251], v[128:131], a[48:51]
    ds_read_b64_tr_b16 a[242:243], v220 offset:30848
    v_cvt_pk_bf16_f32 v148, v148, v149
    v_mfma_f32_16x16x32_bf16 a[52:55], a[248:251], v[132:135], a[52:55]
    v_exp_f32 v154, v154
    v_mfma_f32_16x16x32_bf16 a[56:59], a[248:251], v[136:139], a[56:59]
    ds_read_b64_tr_b16 a[244:245], v221 offset:24704
    v_add_f32 v202, v202, v149
    v_mfma_f32_16x16x32_bf16 a[60:63], a[252:255], v[120:123], a[60:63]
    v_exp_f32 v155, v155
    v_mfma_f32_16x16x32_bf16 a[64:67], a[252:255], v[124:127], a[64:67]
    ds_read_b64_tr_b16 a[246:247], v221 offset:30848
    v_cvt_pk_bf16_f32 v149, v150, v151
    v_mfma_f32_16x16x32_bf16 a[68:71], a[252:255], v[128:131], a[68:71]
    v_add_f32 v202, v202, v150
    v_add_f32 v202, v202, v151
    v_mfma_f32_16x16x32_bf16 a[72:75], a[252:255], v[132:135], a[72:75]
    v_exp_f32 v156, v156
    v_mfma_f32_16x16x32_bf16 a[76:79], a[252:255], v[136:139], a[76:79]
    v_add_f32 v203, v203, v152
    s_waitcnt lgkmcnt(4)
    v_mfma_f32_16x16x32_bf16 a[80:83], v[208:211], v[120:123], a[80:83]
    ds_read_b64_tr_b16 a[248:249], v218 offset:24832
    v_cvt_pk_bf16_f32 v152, v152, v153
    v_mfma_f32_16x16x32_bf16 a[84:87], v[208:211], v[124:127], a[84:87]
    v_exp_f32 v157, v157
    v_mfma_f32_16x16x32_bf16 a[88:91], v[208:211], v[128:131], a[88:91]
    ds_read_b64_tr_b16 a[250:251], v218 offset:30976
    v_add_f32 v203, v203, v153
    v_mfma_f32_16x16x32_bf16 a[92:95], v[208:211], v[132:135], a[92:95]
    v_exp_f32 v158, v158
    v_mfma_f32_16x16x32_bf16 a[96:99], v[208:211], v[136:139], a[96:99]
    ds_read_b64_tr_b16 a[252:253], v219 offset:24832
    v_cvt_pk_bf16_f32 v153, v154, v155
    v_mfma_f32_16x16x32_bf16 a[100:103], v[212:215], v[120:123], a[100:103]
    v_exp_f32 v159, v159
    v_mfma_f32_16x16x32_bf16 a[104:107], v[212:215], v[124:127], a[104:107]
    ds_read_b64_tr_b16 a[254:255], v219 offset:30976
    v_add_f32 v203, v203, v154
    v_mfma_f32_16x16x32_bf16 a[108:111], v[212:215], v[128:131], a[108:111]
    v_exp_f32 v160, v160
    v_mfma_f32_16x16x32_bf16 a[112:115], v[212:215], v[132:135], a[112:115]
    v_exp_f32 v161, v161
    v_mfma_f32_16x16x32_bf16 a[116:119], v[212:215], v[136:139], a[116:119]
    v_add_f32 v203, v203, v155
    s_waitcnt lgkmcnt(4)
    v_mfma_f32_16x16x32_bf16 a[120:123], a[240:243], v[120:123], a[120:123]
    ds_read_b64_tr_b16 v[208:209], v220 offset:24832
    v_add_f32 v204, v204, v156
    v_mfma_f32_16x16x32_bf16 a[124:127], a[240:243], v[124:127], a[124:127]
    ds_read_b64_tr_b16 v[210:211], v220 offset:30976
    v_cvt_pk_bf16_f32 v156, v156, v157
    v_mfma_f32_16x16x32_bf16 a[128:131], a[240:243], v[128:131], a[128:131]
    ds_read_b64_tr_b16 v[212:213], v221 offset:24832
    v_add_f32 v204, v204, v157
    v_mfma_f32_16x16x32_bf16 a[132:135], a[240:243], v[132:135], a[132:135]
    ds_read_b64_tr_b16 v[214:215], v221 offset:30976
    v_cvt_pk_bf16_f32 v157, v158, v159
    v_mfma_f32_16x16x32_bf16 a[136:139], a[240:243], v[136:139], a[136:139]
    v_exp_f32 v162, v162
    v_mfma_f32_16x16x32_bf16 a[140:143], a[244:247], v[120:123], a[140:143]
    v_exp_f32 v163, v163
    v_mfma_f32_16x16x32_bf16 a[144:147], a[244:247], v[124:127], a[144:147]
    v_add_f32 v204, v204, v158
    v_add_f32 v204, v204, v159
    v_mfma_f32_16x16x32_bf16 a[148:151], a[244:247], v[128:131], a[148:151]
    v_exp_f32 v164, v164
    v_mfma_f32_16x16x32_bf16 a[152:155], a[244:247], v[132:135], a[152:155]
    v_exp_f32 v165, v165
    v_mfma_f32_16x16x32_bf16 a[156:159], a[244:247], v[136:139], a[156:159]
    s_waitcnt vmcnt(25) lgkmcnt(0)
    s_barrier
    v_mfma_f32_16x16x32_bf16 a[160:163], a[248:251], v[120:123], a[160:163]
    ds_read_b128 a[240:243], v216 offset:12288
    s_add_u32 m0, s8, 65536
    v_mfma_f32_16x16x32_bf16 a[164:167], a[248:251], v[124:127], a[164:167]
    buffer_load_dwordx4 v224, s[44:47], s66 offen offset:0 nt lds
    v_mfma_f32_16x16x32_bf16 a[168:171], a[248:251], v[128:131], a[168:171]
    ds_read_b128 a[244:247], v217 offset:12288
    buffer_load_dwordx4 v225, s[44:47], s66 offen offset:1024 nt lds
    v_mfma_f32_16x16x32_bf16 a[172:175], a[248:251], v[132:135], a[172:175]
    buffer_load_dwordx4 v226, s[44:47], s66 offen offset:2048 nt lds
    s_add_u32 s66, s66, 6291456
    v_mfma_f32_16x16x32_bf16 a[176:179], a[248:251], v[136:139], a[176:179]
    s_add_u32 m0, s8, 147456
    v_add_f32 v200, v200, v160
    v_mfma_f32_16x16x32_bf16 a[180:183], a[252:255], v[120:123], a[180:183]
    v_exp_f32 v166, v166
    v_mfma_f32_16x16x32_bf16 a[184:187], a[252:255], v[124:127], a[184:187]
    v_exp_f32 v167, v167
    v_mfma_f32_16x16x32_bf16 a[188:191], a[252:255], v[128:131], a[188:191]
    v_cvt_pk_bf16_f32 v142, v160, v161
    v_add_f32 v200, v200, v161
    v_mfma_f32_16x16x32_bf16 a[192:195], a[252:255], v[132:135], a[192:195]
    v_cvt_pk_bf16_f32 v143, v162, v163
    v_add_f32 v200, v200, v162
    v_mfma_f32_16x16x32_bf16 a[196:199], a[252:255], v[136:139], a[196:199]
    v_add_f32 v200, v200, v163
    v_mfma_f32_16x16x32_bf16 a[200:203], v[208:211], v[120:123], a[200:203]
    ds_read_b128 a[248:251], v216 offset:12416
    v_add_f32 v201, v201, v164
    v_mfma_f32_16x16x32_bf16 a[204:207], v[208:211], v[124:127], a[204:207]
    v_exp_f32 v168, v168
    v_mfma_f32_16x16x32_bf16 a[208:211], v[208:211], v[128:131], a[208:211]
    ds_read_b128 a[252:255], v217 offset:12416
    v_cvt_pk_bf16_f32 v146, v164, v165
    v_mfma_f32_16x16x32_bf16 a[212:215], v[208:211], v[132:135], a[212:215]
    buffer_load_dwordx4 v224, s[44:47], s66 offen offset:0 nt lds
    v_mfma_f32_16x16x32_bf16 a[216:219], v[208:211], v[136:139], a[216:219]
    buffer_load_dwordx4 v225, s[44:47], s66 offen offset:1024 nt lds
    v_mfma_f32_16x16x32_bf16 a[220:223], v[212:215], v[120:123], a[220:223]
    buffer_load_dwordx4 v226, s[44:47], s66 offen offset:2048 nt lds
    s_add_u32 s66, s66, 4288688128
    v_mfma_f32_16x16x32_bf16 a[224:227], v[212:215], v[124:127], a[224:227]
    v_exp_f32 v169, v169
    v_mfma_f32_16x16x32_bf16 a[228:231], v[212:215], v[128:131], a[228:231]
    v_exp_f32 v170, v170
    v_mfma_f32_16x16x32_bf16 a[232:235], v[212:215], v[132:135], a[232:235]
    v_exp_f32 v171, v171
    v_mfma_f32_16x16x32_bf16 a[236:239], v[212:215], v[136:139], a[236:239]
    v_add_f32 v201, v201, v165
    v_cvt_pk_bf16_f32 v147, v166, v167
    v_add_f32 v201, v201, v166
    v_add_f32 v201, v201, v167
    v_add_f32 v202, v202, v168
    v_cvt_pk_bf16_f32 v150, v168, v169
    v_add_f32 v202, v202, v169
    v_cvt_pk_bf16_f32 v151, v170, v171
    v_add_f32 v202, v202, v170
    v_add_f32 v202, v202, v171
    s_waitcnt lgkmcnt(2)
    v_mfma_f32_16x16x32_bf16 v[120:123], a[240:243], v[0:3], v[180:183]
    ds_read_b128 v[208:211], v216 offset:12544
    v_mfma_f32_16x16x32_bf16 v[120:123], a[244:247], v[40:43], v[120:123]
    v_exp_f32 v172, v172
    v_mfma_f32_16x16x32_bf16 v[124:127], a[240:243], v[8:11], v[184:187]
    ds_read_b128 v[212:215], v217 offset:12544
    v_mfma_f32_16x16x32_bf16 v[124:127], a[244:247], v[48:51], v[124:127]
    v_exp_f32 v173, v173
    v_mfma_f32_16x16x32_bf16 v[128:131], a[240:243], v[16:19], v[188:191]
    v_exp_f32 v174, v174
    v_mfma_f32_16x16x32_bf16 v[128:131], a[244:247], v[56:59], v[128:131]
    v_exp_f32 v175, v175
    v_mfma_f32_16x16x32_bf16 v[132:135], a[240:243], v[24:27], v[192:195]
    v_exp_f32 v176, v176
    v_mfma_f32_16x16x32_bf16 v[132:135], a[244:247], v[64:67], v[132:135]
    v_exp_f32 v177, v177
    v_mfma_f32_16x16x32_bf16 v[136:139], a[240:243], v[32:35], v[196:199]
    v_exp_f32 v178, v178
    v_mfma_f32_16x16x32_bf16 v[136:139], a[244:247], v[72:75], v[136:139]
    v_add_f32 v203, v203, v172
    s_waitcnt lgkmcnt(2)
    v_mfma_f32_16x16x32_bf16 v[120:123], a[248:251], v[80:83], v[120:123]
    ds_read_b128 a[240:243], v216 offset:18432
    v_cvt_pk_bf16_f32 v154, v172, v173
    v_mfma_f32_16x16x32_bf16 v[120:123], a[252:255], v[4:7], v[120:123]
    v_exp_f32 v179, v179
    v_mfma_f32_16x16x32_bf16 v[124:127], a[248:251], v[88:91], v[124:127]
    ds_read_b128 a[244:247], v217 offset:18432
    v_add_f32 v203, v203, v173
    v_mfma_f32_16x16x32_bf16 v[124:127], a[252:255], v[12:15], v[124:127]
    v_cvt_pk_bf16_f32 v155, v174, v175
    v_add_f32 v203, v203, v174
    v_mfma_f32_16x16x32_bf16 v[128:131], a[248:251], v[96:99], v[128:131]
    v_add_f32 v203, v203, v175
    v_add_f32 v204, v204, v176
    v_mfma_f32_16x16x32_bf16 v[128:131], a[252:255], v[20:23], v[128:131]
    v_cvt_pk_bf16_f32 v158, v176, v177
    v_add_f32 v204, v204, v177
    v_mfma_f32_16x16x32_bf16 v[132:135], a[248:251], v[104:107], v[132:135]
    v_cvt_pk_bf16_f32 v159, v178, v179
    v_add_f32 v204, v204, v178
    v_mfma_f32_16x16x32_bf16 v[132:135], a[252:255], v[28:31], v[132:135]
    v_add_f32 v204, v204, v179
    v_mfma_f32_16x16x32_bf16 v[136:139], a[248:251], v[112:115], v[136:139]
    v_mfma_f32_16x16x32_bf16 v[136:139], a[252:255], v[36:39], v[136:139]
    s_waitcnt lgkmcnt(2)
    v_mfma_f32_16x16x32_bf16 v[120:123], v[208:211], v[44:47], v[120:123]
    ds_read_b128 a[248:251], v216 offset:18560
    v_mfma_f32_16x16x32_bf16 v[120:123], v[212:215], v[84:87], v[120:123]
    v_mfma_f32_16x16x32_bf16 v[124:127], v[208:211], v[52:55], v[124:127]
    ds_read_b128 a[252:255], v217 offset:18560
    v_mfma_f32_16x16x32_bf16 v[124:127], v[212:215], v[92:95], v[124:127]
    v_mfma_f32_16x16x32_bf16 v[128:131], v[208:211], v[60:63], v[128:131]
    v_mfma_f32_16x16x32_bf16 v[128:131], v[212:215], v[100:103], v[128:131]
    v_mfma_f32_16x16x32_bf16 v[132:135], v[208:211], v[68:71], v[132:135]
    v_mfma_f32_16x16x32_bf16 v[132:135], v[212:215], v[108:111], v[132:135]
    v_mfma_f32_16x16x32_bf16 v[136:139], v[208:211], v[76:79], v[136:139]
    v_mfma_f32_16x16x32_bf16 v[136:139], v[212:215], v[116:119], v[136:139]
    s_waitcnt lgkmcnt(2)
    v_mfma_f32_16x16x32_bf16 v[160:163], a[240:243], v[0:3], v[180:183]
    ds_read_b128 v[208:211], v216 offset:18688
    v_mfma_f32_16x16x32_bf16 v[160:163], a[244:247], v[40:43], v[160:163]
    ds_read_b128 v[212:215], v217 offset:18688
    v_mfma_f32_16x16x32_bf16 v[164:167], a[240:243], v[8:11], v[184:187]
    v_mfma_f32_16x16x32_bf16 v[164:167], a[244:247], v[48:51], v[164:167]
    v_mfma_f32_16x16x32_bf16 v[168:171], a[240:243], v[16:19], v[188:191]
    v_mfma_f32_16x16x32_bf16 v[168:171], a[244:247], v[56:59], v[168:171]
    v_exp_f32 v120, v120
    v_mfma_f32_16x16x32_bf16 v[172:175], a[240:243], v[24:27], v[192:195]
    v_exp_f32 v121, v121
    v_mfma_f32_16x16x32_bf16 v[172:175], a[244:247], v[64:67], v[172:175]
    v_exp_f32 v122, v122
    v_mfma_f32_16x16x32_bf16 v[176:179], a[240:243], v[32:35], v[196:199]
    v_exp_f32 v123, v123
    v_mfma_f32_16x16x32_bf16 v[176:179], a[244:247], v[72:75], v[176:179]
    s_waitcnt vmcnt(25) lgkmcnt(0)
    s_barrier
    v_mfma_f32_16x16x32_bf16 v[160:163], a[248:251], v[80:83], v[160:163]
    ds_read_b64_tr_b16 a[240:241], v218 offset:0
    s_add_u32 m0, s8, 12288
    v_mfma_f32_16x16x32_bf16 v[160:163], a[252:255], v[4:7], v[160:163]
    buffer_load_dwordx4 v224, s[40:43], s65 offen offset:0 nt lds
    v_mfma_f32_16x16x32_bf16 v[164:167], a[248:251], v[88:91], v[164:167]
    ds_read_b64_tr_b16 a[242:243], v218 offset:6144
    buffer_load_dwordx4 v225, s[40:43], s65 offen offset:1024 nt lds
    v_mfma_f32_16x16x32_bf16 v[164:167], a[252:255], v[12:15], v[164:167]
    buffer_load_dwordx4 v226, s[40:43], s65 offen offset:2048 nt lds
    s_add_u32 s65, s65, 6291456
    v_mfma_f32_16x16x32_bf16 v[168:171], a[248:251], v[96:99], v[168:171]
    ds_read_b64_tr_b16 a[244:245], v219 offset:0
    s_add_u32 m0, s8, 94208
    v_mfma_f32_16x16x32_bf16 v[168:171], a[252:255], v[20:23], v[168:171]
    v_exp_f32 v124, v124
    v_mfma_f32_16x16x32_bf16 v[172:175], a[248:251], v[104:107], v[172:175]
    ds_read_b64_tr_b16 a[246:247], v219 offset:6144
    v_add_f32 v200, v200, v120
    v_mfma_f32_16x16x32_bf16 v[172:175], a[252:255], v[28:31], v[172:175]
    v_exp_f32 v125, v125
    v_mfma_f32_16x16x32_bf16 v[176:179], a[248:251], v[112:115], v[176:179]
    v_exp_f32 v126, v126
    v_mfma_f32_16x16x32_bf16 v[176:179], a[252:255], v[36:39], v[176:179]
    v_cvt_pk_bf16_f32 v120, v120, v121
    v_mfma_f32_16x16x32_bf16 v[160:163], v[208:211], v[44:47], v[160:163]
    ds_read_b64_tr_b16 a[248:249], v220 offset:0
    v_add_f32 v200, v200, v121
    v_mfma_f32_16x16x32_bf16 v[160:163], v[212:215], v[84:87], v[160:163]
    v_exp_f32 v127, v127
    v_mfma_f32_16x16x32_bf16 v[164:167], v[208:211], v[52:55], v[164:167]
    ds_read_b64_tr_b16 a[250:251], v220 offset:6144
    v_cvt_pk_bf16_f32 v121, v122, v123
    v_mfma_f32_16x16x32_bf16 v[164:167], v[212:215], v[92:95], v[164:167]
    buffer_load_dwordx4 v224, s[40:43], s65 offen offset:0 nt lds
    v_mfma_f32_16x16x32_bf16 v[168:171], v[208:211], v[60:63], v[168:171]
    ds_read_b64_tr_b16 a[252:253], v221 offset:0
    buffer_load_dwordx4 v225, s[40:43], s65 offen offset:1024 nt lds
    v_mfma_f32_16x16x32_bf16 v[168:171], v[212:215], v[100:103], v[168:171]
    buffer_load_dwordx4 v226, s[40:43], s65 offen offset:2048 nt lds
    s_add_u32 s65, s65, 4288688128
    v_mfma_f32_16x16x32_bf16 v[172:175], v[208:211], v[68:71], v[172:175]
    ds_read_b64_tr_b16 a[254:255], v221 offset:6144
    v_add_f32 v200, v200, v122
    v_mfma_f32_16x16x32_bf16 v[172:175], v[212:215], v[108:111], v[172:175]
    v_exp_f32 v128, v128
    v_mfma_f32_16x16x32_bf16 v[176:179], v[208:211], v[76:79], v[176:179]
    v_exp_f32 v129, v129
    v_mfma_f32_16x16x32_bf16 v[176:179], v[212:215], v[116:119], v[176:179]
    v_add_f32 v200, v200, v123
    s_waitcnt lgkmcnt(4)
    v_mfma_f32_16x16x32_bf16 a[0:3], a[240:243], v[140:143], a[0:3]
    ds_read_b64_tr_b16 v[208:209], v218 offset:128
    v_add_f32 v201, v201, v124
    v_mfma_f32_16x16x32_bf16 a[4:7], a[240:243], v[144:147], a[4:7]
    v_exp_f32 v130, v130
    v_mfma_f32_16x16x32_bf16 a[8:11], a[240:243], v[148:151], a[8:11]
    ds_read_b64_tr_b16 v[210:211], v218 offset:6272
    v_cvt_pk_bf16_f32 v124, v124, v125
    v_mfma_f32_16x16x32_bf16 a[12:15], a[240:243], v[152:155], a[12:15]
    v_exp_f32 v131, v131
    v_mfma_f32_16x16x32_bf16 a[16:19], a[240:243], v[156:159], a[16:19]
    ds_read_b64_tr_b16 v[212:213], v219 offset:128
    v_add_f32 v201, v201, v125
    v_mfma_f32_16x16x32_bf16 a[20:23], a[244:247], v[140:143], a[20:23]
    v_cvt_pk_bf16_f32 v125, v126, v127
    v_add_f32 v201, v201, v126
    v_mfma_f32_16x16x32_bf16 a[24:27], a[244:247], v[144:147], a[24:27]
    ds_read_b64_tr_b16 v[214:215], v219 offset:6272
    v_add_f32 v201, v201, v127
    v_mfma_f32_16x16x32_bf16 a[28:31], a[244:247], v[148:151], a[28:31]
    v_exp_f32 v132, v132
    v_mfma_f32_16x16x32_bf16 a[32:35], a[244:247], v[152:155], a[32:35]
    v_exp_f32 v133, v133
    v_mfma_f32_16x16x32_bf16 a[36:39], a[244:247], v[156:159], a[36:39]
    v_add_f32 v202, v202, v128
    s_waitcnt lgkmcnt(4)
    v_mfma_f32_16x16x32_bf16 a[40:43], a[248:251], v[140:143], a[40:43]
    ds_read_b64_tr_b16 a[240:241], v220 offset:128
    v_cvt_pk_bf16_f32 v128, v128, v129
    v_mfma_f32_16x16x32_bf16 a[44:47], a[248:251], v[144:147], a[44:47]
    v_exp_f32 v134, v134
    v_mfma_f32_16x16x32_bf16 a[48:51], a[248:251], v[148:151], a[48:51]
    ds_read_b64_tr_b16 a[242:243], v220 offset:6272
    v_add_f32 v202, v202, v129
    v_mfma_f32_16x16x32_bf16 a[52:55], a[248:251], v[152:155], a[52:55]
    v_exp_f32 v135, v135
    v_mfma_f32_16x16x32_bf16 a[56:59], a[248:251], v[156:159], a[56:59]
    ds_read_b64_tr_b16 a[244:245], v221 offset:128
    v_cvt_pk_bf16_f32 v129, v130, v131
    v_mfma_f32_16x16x32_bf16 a[60:63], a[252:255], v[140:143], a[60:63]
    v_add_f32 v202, v202, v130
    v_add_f32 v202, v202, v131
    v_mfma_f32_16x16x32_bf16 a[64:67], a[252:255], v[144:147], a[64:67]
    ds_read_b64_tr_b16 a[246:247], v221 offset:6272
    v_add_f32 v203, v203, v132
    v_mfma_f32_16x16x32_bf16 a[68:71], a[252:255], v[148:151], a[68:71]
    v_exp_f32 v136, v136
    v_mfma_f32_16x16x32_bf16 a[72:75], a[252:255], v[152:155], a[72:75]
    v_exp_f32 v137, v137
    v_mfma_f32_16x16x32_bf16 a[76:79], a[252:255], v[156:159], a[76:79]
    v_cvt_pk_bf16_f32 v132, v132, v133
    s_waitcnt lgkmcnt(4)
    v_mfma_f32_16x16x32_bf16 a[80:83], v[208:211], v[140:143], a[80:83]
    ds_read_b64_tr_b16 a[248:249], v218 offset:256
    v_add_f32 v203, v203, v133
    v_mfma_f32_16x16x32_bf16 a[84:87], v[208:211], v[144:147], a[84:87]
    v_exp_f32 v138, v138
    v_mfma_f32_16x16x32_bf16 a[88:91], v[208:211], v[148:151], a[88:91]
    ds_read_b64_tr_b16 a[250:251], v218 offset:6400
    v_cvt_pk_bf16_f32 v133, v134, v135
    v_mfma_f32_16x16x32_bf16 a[92:95], v[208:211], v[152:155], a[92:95]
    v_exp_f32 v139, v139
    v_mfma_f32_16x16x32_bf16 a[96:99], v[208:211], v[156:159], a[96:99]
    ds_read_b64_tr_b16 a[252:253], v219 offset:256
    v_add_f32 v203, v203, v134
    v_mfma_f32_16x16x32_bf16 a[100:103], v[212:215], v[140:143], a[100:103]
    v_exp_f32 v160, v160
    v_mfma_f32_16x16x32_bf16 a[104:107], v[212:215], v[144:147], a[104:107]
    ds_read_b64_tr_b16 a[254:255], v219 offset:6400
    v_add_f32 v203, v203, v135
    v_mfma_f32_16x16x32_bf16 a[108:111], v[212:215], v[148:151], a[108:111]
    v_exp_f32 v161, v161
    v_mfma_f32_16x16x32_bf16 a[112:115], v[212:215], v[152:155], a[112:115]
    v_exp_f32 v162, v162
    v_mfma_f32_16x16x32_bf16 a[116:119], v[212:215], v[156:159], a[116:119]
    v_add_f32 v204, v204, v136
    s_waitcnt lgkmcnt(4)
    v_mfma_f32_16x16x32_bf16 a[120:123], a[240:243], v[140:143], a[120:123]
    ds_read_b64_tr_b16 v[208:209], v220 offset:256
    v_cvt_pk_bf16_f32 v136, v136, v137
    v_mfma_f32_16x16x32_bf16 a[124:127], a[240:243], v[144:147], a[124:127]
    ds_read_b64_tr_b16 v[210:211], v220 offset:6400
    v_add_f32 v204, v204, v137
    v_mfma_f32_16x16x32_bf16 a[128:131], a[240:243], v[148:151], a[128:131]
    ds_read_b64_tr_b16 v[212:213], v221 offset:256
    v_cvt_pk_bf16_f32 v137, v138, v139
    v_mfma_f32_16x16x32_bf16 a[132:135], a[240:243], v[152:155], a[132:135]
    ds_read_b64_tr_b16 v[214:215], v221 offset:6400
    v_add_f32 v204, v204, v138
    v_mfma_f32_16x16x32_bf16 a[136:139], a[240:243], v[156:159], a[136:139]
    v_exp_f32 v163, v163
    v_mfma_f32_16x16x32_bf16 a[140:143], a[244:247], v[140:143], a[140:143]
    v_exp_f32 v164, v164
    v_mfma_f32_16x16x32_bf16 a[144:147], a[244:247], v[144:147], a[144:147]
    v_exp_f32 v165, v165
    v_mfma_f32_16x16x32_bf16 a[148:151], a[244:247], v[148:151], a[148:151]
    v_exp_f32 v166, v166
    v_mfma_f32_16x16x32_bf16 a[152:155], a[244:247], v[152:155], a[152:155]
    v_exp_f32 v167, v167
    v_mfma_f32_16x16x32_bf16 a[156:159], a[244:247], v[156:159], a[156:159]
    s_waitcnt vmcnt(25) lgkmcnt(0)
    s_barrier
    v_mfma_f32_16x16x32_bf16 a[160:163], a[248:251], v[140:143], a[160:163]
    ds_read_b128 a[240:243], v216 offset:24576
    s_add_u32 m0, s8, 40960
    v_mfma_f32_16x16x32_bf16 a[164:167], a[248:251], v[144:147], a[164:167]
    buffer_load_dwordx4 v224, s[44:47], s66 offen offset:0 nt lds
    v_mfma_f32_16x16x32_bf16 a[168:171], a[248:251], v[148:151], a[168:171]
    ds_read_b128 a[244:247], v217 offset:24576
    buffer_load_dwordx4 v225, s[44:47], s66 offen offset:1024 nt lds
    v_mfma_f32_16x16x32_bf16 a[172:175], a[248:251], v[152:155], a[172:175]
    buffer_load_dwordx4 v226, s[44:47], s66 offen offset:2048 nt lds
    s_add_u32 s66, s66, 6291456
    v_mfma_f32_16x16x32_bf16 a[176:179], a[248:251], v[156:159], a[176:179]
    s_add_u32 m0, s8, 122880
    v_add_f32 v204, v204, v139
    v_mfma_f32_16x16x32_bf16 a[180:183], a[252:255], v[140:143], a[180:183]
    v_add_f32 v200, v200, v160
    v_cvt_pk_bf16_f32 v122, v160, v161
    v_mfma_f32_16x16x32_bf16 a[184:187], a[252:255], v[144:147], a[184:187]
    v_add_f32 v200, v200, v161
    v_cvt_pk_bf16_f32 v123, v162, v163
    v_mfma_f32_16x16x32_bf16 a[188:191], a[252:255], v[148:151], a[188:191]
    v_add_f32 v200, v200, v162
    v_add_f32 v200, v200, v163
    v_mfma_f32_16x16x32_bf16 a[192:195], a[252:255], v[152:155], a[192:195]
    v_exp_f32 v168, v168
    v_mfma_f32_16x16x32_bf16 a[196:199], a[252:255], v[156:159], a[196:199]
    v_add_f32 v201, v201, v164
    v_mfma_f32_16x16x32_bf16 a[200:203], v[208:211], v[140:143], a[200:203]
    ds_read_b128 a[248:251], v216 offset:24704
    v_cvt_pk_bf16_f32 v126, v164, v165
    v_mfma_f32_16x16x32_bf16 a[204:207], v[208:211], v[144:147], a[204:207]
    v_exp_f32 v169, v169
    v_mfma_f32_16x16x32_bf16 a[208:211], v[208:211], v[148:151], a[208:211]
    ds_read_b128 a[252:255], v217 offset:24704
    v_add_f32 v201, v201, v165
    v_mfma_f32_16x16x32_bf16 a[212:215], v[208:211], v[152:155], a[212:215]
    buffer_load_dwordx4 v224, s[44:47], s66 offen offset:0 nt lds
    v_mfma_f32_16x16x32_bf16 a[216:219], v[208:211], v[156:159], a[216:219]
    buffer_load_dwordx4 v225, s[44:47], s66 offen offset:1024 nt lds
    v_mfma_f32_16x16x32_bf16 a[220:223], v[212:215], v[140:143], a[220:223]
    buffer_load_dwordx4 v226, s[44:47], s66 offen offset:2048 nt lds
    s_add_u32 s66, s66, 4288688128
    v_mfma_f32_16x16x32_bf16 a[224:227], v[212:215], v[144:147], a[224:227]
    v_exp_f32 v170, v170
    v_mfma_f32_16x16x32_bf16 a[228:231], v[212:215], v[148:151], a[228:231]
    v_exp_f32 v171, v171
    v_mfma_f32_16x16x32_bf16 a[232:235], v[212:215], v[152:155], a[232:235]
    v_cvt_pk_bf16_f32 v127, v166, v167
    v_add_f32 v201, v201, v166
    v_mfma_f32_16x16x32_bf16 a[236:239], v[212:215], v[156:159], a[236:239]
    v_add_f32 v201, v201, v167
    v_add_f32 v202, v202, v168
    v_cvt_pk_bf16_f32 v130, v168, v169
    v_add_f32 v202, v202, v169
    v_cvt_pk_bf16_f32 v131, v170, v171
    v_add_f32 v202, v202, v170
    v_add_f32 v202, v202, v171
    s_waitcnt lgkmcnt(2)
    v_mfma_f32_16x16x32_bf16 v[140:143], a[240:243], v[0:3], v[180:183]
    ds_read_b128 v[208:211], v216 offset:24832
    v_mfma_f32_16x16x32_bf16 v[140:143], a[244:247], v[40:43], v[140:143]
    v_exp_f32 v172, v172
    v_mfma_f32_16x16x32_bf16 v[144:147], a[240:243], v[8:11], v[184:187]
    ds_read_b128 v[212:215], v217 offset:24832
    v_mfma_f32_16x16x32_bf16 v[144:147], a[244:247], v[48:51], v[144:147]
    v_exp_f32 v173, v173
    v_mfma_f32_16x16x32_bf16 v[148:151], a[240:243], v[16:19], v[188:191]
    v_exp_f32 v174, v174
    v_mfma_f32_16x16x32_bf16 v[148:151], a[244:247], v[56:59], v[148:151]
    v_exp_f32 v175, v175
    v_mfma_f32_16x16x32_bf16 v[152:155], a[240:243], v[24:27], v[192:195]
    v_exp_f32 v176, v176
    v_mfma_f32_16x16x32_bf16 v[152:155], a[244:247], v[64:67], v[152:155]
    v_exp_f32 v177, v177
    v_mfma_f32_16x16x32_bf16 v[156:159], a[240:243], v[32:35], v[196:199]
    v_exp_f32 v178, v178
    v_mfma_f32_16x16x32_bf16 v[156:159], a[244:247], v[72:75], v[156:159]
    v_add_f32 v203, v203, v172
    s_waitcnt lgkmcnt(2)
    v_mfma_f32_16x16x32_bf16 v[140:143], a[248:251], v[80:83], v[140:143]
    ds_read_b128 a[240:243], v216 offset:30720
    v_cvt_pk_bf16_f32 v134, v172, v173
    v_mfma_f32_16x16x32_bf16 v[140:143], a[252:255], v[4:7], v[140:143]
    v_exp_f32 v179, v179
    v_mfma_f32_16x16x32_bf16 v[144:147], a[248:251], v[88:91], v[144:147]
    ds_read_b128 a[244:247], v217 offset:30720
    v_add_f32 v203, v203, v173
    v_mfma_f32_16x16x32_bf16 v[144:147], a[252:255], v[12:15], v[144:147]
    v_cvt_pk_bf16_f32 v135, v174, v175
    v_add_f32 v203, v203, v174
    v_mfma_f32_16x16x32_bf16 v[148:151], a[248:251], v[96:99], v[148:151]
    v_add_f32 v203, v203, v175
    v_add_f32 v204, v204, v176
    v_mfma_f32_16x16x32_bf16 v[148:151], a[252:255], v[20:23], v[148:151]
    v_cvt_pk_bf16_f32 v138, v176, v177
    v_add_f32 v204, v204, v177
    v_mfma_f32_16x16x32_bf16 v[152:155], a[248:251], v[104:107], v[152:155]
    v_cvt_pk_bf16_f32 v139, v178, v179
    v_add_f32 v204, v204, v178
    v_mfma_f32_16x16x32_bf16 v[152:155], a[252:255], v[28:31], v[152:155]
    v_add_f32 v204, v204, v179
    v_mfma_f32_16x16x32_bf16 v[156:159], a[248:251], v[112:115], v[156:159]
    v_mfma_f32_16x16x32_bf16 v[156:159], a[252:255], v[36:39], v[156:159]
    s_waitcnt lgkmcnt(2)
    v_mfma_f32_16x16x32_bf16 v[140:143], v[208:211], v[44:47], v[140:143]
    ds_read_b128 a[248:251], v216 offset:30848
    v_mfma_f32_16x16x32_bf16 v[140:143], v[212:215], v[84:87], v[140:143]
    v_mfma_f32_16x16x32_bf16 v[144:147], v[208:211], v[52:55], v[144:147]
    ds_read_b128 a[252:255], v217 offset:30848
    v_mfma_f32_16x16x32_bf16 v[144:147], v[212:215], v[92:95], v[144:147]
    v_mfma_f32_16x16x32_bf16 v[148:151], v[208:211], v[60:63], v[148:151]
    v_mfma_f32_16x16x32_bf16 v[148:151], v[212:215], v[100:103], v[148:151]
    v_mfma_f32_16x16x32_bf16 v[152:155], v[208:211], v[68:71], v[152:155]
    v_mfma_f32_16x16x32_bf16 v[152:155], v[212:215], v[108:111], v[152:155]
    v_mfma_f32_16x16x32_bf16 v[156:159], v[208:211], v[76:79], v[156:159]
    v_mfma_f32_16x16x32_bf16 v[156:159], v[212:215], v[116:119], v[156:159]
    s_waitcnt lgkmcnt(2)
    v_mfma_f32_16x16x32_bf16 v[160:163], a[240:243], v[0:3], v[180:183]
    ds_read_b128 v[208:211], v216 offset:30976
    v_mfma_f32_16x16x32_bf16 v[160:163], a[244:247], v[40:43], v[160:163]
    ds_read_b128 v[212:215], v217 offset:30976
    v_mfma_f32_16x16x32_bf16 v[164:167], a[240:243], v[8:11], v[184:187]
    v_mfma_f32_16x16x32_bf16 v[164:167], a[244:247], v[48:51], v[164:167]
    v_mfma_f32_16x16x32_bf16 v[168:171], a[240:243], v[16:19], v[188:191]
    v_mfma_f32_16x16x32_bf16 v[168:171], a[244:247], v[56:59], v[168:171]
    v_exp_f32 v140, v140
    v_mfma_f32_16x16x32_bf16 v[172:175], a[240:243], v[24:27], v[192:195]
    v_exp_f32 v141, v141
    v_mfma_f32_16x16x32_bf16 v[172:175], a[244:247], v[64:67], v[172:175]
    v_exp_f32 v142, v142
    v_mfma_f32_16x16x32_bf16 v[176:179], a[240:243], v[32:35], v[196:199]
    v_exp_f32 v143, v143
    v_mfma_f32_16x16x32_bf16 v[176:179], a[244:247], v[72:75], v[176:179]
    s_waitcnt vmcnt(25) lgkmcnt(0)
    s_barrier
    v_mfma_f32_16x16x32_bf16 v[160:163], a[248:251], v[80:83], v[160:163]
    ds_read_b64_tr_b16 a[240:241], v218 offset:12288
    s_add_u32 m0, s8, 24576
    v_mfma_f32_16x16x32_bf16 v[160:163], a[252:255], v[4:7], v[160:163]
    buffer_load_dwordx4 v224, s[40:43], s65 offen offset:0 nt lds
    v_mfma_f32_16x16x32_bf16 v[164:167], a[248:251], v[88:91], v[164:167]
    ds_read_b64_tr_b16 a[242:243], v218 offset:18432
    buffer_load_dwordx4 v225, s[40:43], s65 offen offset:1024 nt lds
    v_mfma_f32_16x16x32_bf16 v[164:167], a[252:255], v[12:15], v[164:167]
    buffer_load_dwordx4 v226, s[40:43], s65 offen offset:2048 nt lds
    s_add_u32 s65, s65, 6291456
    v_mfma_f32_16x16x32_bf16 v[168:171], a[248:251], v[96:99], v[168:171]
    ds_read_b64_tr_b16 a[244:245], v219 offset:12288
    s_add_u32 m0, s8, 106496
    v_mfma_f32_16x16x32_bf16 v[168:171], a[252:255], v[20:23], v[168:171]
    v_exp_f32 v144, v144
    v_mfma_f32_16x16x32_bf16 v[172:175], a[248:251], v[104:107], v[172:175]
    ds_read_b64_tr_b16 a[246:247], v219 offset:18432
    v_add_f32 v200, v200, v140
    v_mfma_f32_16x16x32_bf16 v[172:175], a[252:255], v[28:31], v[172:175]
    v_exp_f32 v145, v145
    v_mfma_f32_16x16x32_bf16 v[176:179], a[248:251], v[112:115], v[176:179]
    v_exp_f32 v146, v146
    v_mfma_f32_16x16x32_bf16 v[176:179], a[252:255], v[36:39], v[176:179]
    v_cvt_pk_bf16_f32 v140, v140, v141
    v_mfma_f32_16x16x32_bf16 v[160:163], v[208:211], v[44:47], v[160:163]
    ds_read_b64_tr_b16 a[248:249], v220 offset:12288
    v_add_f32 v200, v200, v141
    v_mfma_f32_16x16x32_bf16 v[160:163], v[212:215], v[84:87], v[160:163]
    v_exp_f32 v147, v147
    v_mfma_f32_16x16x32_bf16 v[164:167], v[208:211], v[52:55], v[164:167]
    ds_read_b64_tr_b16 a[250:251], v220 offset:18432
    v_cvt_pk_bf16_f32 v141, v142, v143
    v_mfma_f32_16x16x32_bf16 v[164:167], v[212:215], v[92:95], v[164:167]
    buffer_load_dwordx4 v224, s[40:43], s65 offen offset:0 nt lds
    v_mfma_f32_16x16x32_bf16 v[168:171], v[208:211], v[60:63], v[168:171]
    ds_read_b64_tr_b16 a[252:253], v221 offset:12288
    buffer_load_dwordx4 v225, s[40:43], s65 offen offset:1024 nt lds
    v_mfma_f32_16x16x32_bf16 v[168:171], v[212:215], v[100:103], v[168:171]
    buffer_load_dwordx4 v226, s[40:43], s65 offen offset:2048 nt lds
    s_add_u32 s65, s65, 4288688128
    v_mfma_f32_16x16x32_bf16 v[172:175], v[208:211], v[68:71], v[172:175]
    ds_read_b64_tr_b16 a[254:255], v221 offset:18432
    v_add_f32 v200, v200, v142
    v_mfma_f32_16x16x32_bf16 v[172:175], v[212:215], v[108:111], v[172:175]
    v_exp_f32 v148, v148
    v_mfma_f32_16x16x32_bf16 v[176:179], v[208:211], v[76:79], v[176:179]
    v_exp_f32 v149, v149
    v_mfma_f32_16x16x32_bf16 v[176:179], v[212:215], v[116:119], v[176:179]
    v_add_f32 v200, v200, v143
    s_waitcnt lgkmcnt(4)
    v_mfma_f32_16x16x32_bf16 a[0:3], a[240:243], v[120:123], a[0:3]
    ds_read_b64_tr_b16 v[208:209], v218 offset:12416
    v_add_f32 v201, v201, v144
    v_mfma_f32_16x16x32_bf16 a[4:7], a[240:243], v[124:127], a[4:7]
    v_exp_f32 v150, v150
    v_mfma_f32_16x16x32_bf16 a[8:11], a[240:243], v[128:131], a[8:11]
    ds_read_b64_tr_b16 v[210:211], v218 offset:18560
    v_cvt_pk_bf16_f32 v144, v144, v145
    v_mfma_f32_16x16x32_bf16 a[12:15], a[240:243], v[132:135], a[12:15]
    v_exp_f32 v151, v151
    v_mfma_f32_16x16x32_bf16 a[16:19], a[240:243], v[136:139], a[16:19]
    ds_read_b64_tr_b16 v[212:213], v219 offset:12416
    v_add_f32 v201, v201, v145
    v_mfma_f32_16x16x32_bf16 a[20:23], a[244:247], v[120:123], a[20:23]
    v_cvt_pk_bf16_f32 v145, v146, v147
    v_add_f32 v201, v201, v146
    v_mfma_f32_16x16x32_bf16 a[24:27], a[244:247], v[124:127], a[24:27]
    ds_read_b64_tr_b16 v[214:215], v219 offset:18560
    v_add_f32 v201, v201, v147
    v_mfma_f32_16x16x32_bf16 a[28:31], a[244:247], v[128:131], a[28:31]
    v_exp_f32 v152, v152
    v_mfma_f32_16x16x32_bf16 a[32:35], a[244:247], v[132:135], a[32:35]
    v_exp_f32 v153, v153
    v_mfma_f32_16x16x32_bf16 a[36:39], a[244:247], v[136:139], a[36:39]
    v_add_f32 v202, v202, v148
    s_waitcnt lgkmcnt(4)
    v_mfma_f32_16x16x32_bf16 a[40:43], a[248:251], v[120:123], a[40:43]
    ds_read_b64_tr_b16 a[240:241], v220 offset:12416
    v_cvt_pk_bf16_f32 v148, v148, v149
    v_mfma_f32_16x16x32_bf16 a[44:47], a[248:251], v[124:127], a[44:47]
    v_exp_f32 v154, v154
    v_mfma_f32_16x16x32_bf16 a[48:51], a[248:251], v[128:131], a[48:51]
    ds_read_b64_tr_b16 a[242:243], v220 offset:18560
    v_add_f32 v202, v202, v149
    v_mfma_f32_16x16x32_bf16 a[52:55], a[248:251], v[132:135], a[52:55]
    v_exp_f32 v155, v155
    v_mfma_f32_16x16x32_bf16 a[56:59], a[248:251], v[136:139], a[56:59]
    ds_read_b64_tr_b16 a[244:245], v221 offset:12416
    v_cvt_pk_bf16_f32 v149, v150, v151
    v_mfma_f32_16x16x32_bf16 a[60:63], a[252:255], v[120:123], a[60:63]
    v_add_f32 v202, v202, v150
    v_add_f32 v202, v202, v151
    v_mfma_f32_16x16x32_bf16 a[64:67], a[252:255], v[124:127], a[64:67]
    ds_read_b64_tr_b16 a[246:247], v221 offset:18560
    v_add_f32 v203, v203, v152
    v_mfma_f32_16x16x32_bf16 a[68:71], a[252:255], v[128:131], a[68:71]
    v_exp_f32 v156, v156
    v_mfma_f32_16x16x32_bf16 a[72:75], a[252:255], v[132:135], a[72:75]
    v_exp_f32 v157, v157
    v_mfma_f32_16x16x32_bf16 a[76:79], a[252:255], v[136:139], a[76:79]
    v_cvt_pk_bf16_f32 v152, v152, v153
    s_waitcnt lgkmcnt(4)
    v_mfma_f32_16x16x32_bf16 a[80:83], v[208:211], v[120:123], a[80:83]
    ds_read_b64_tr_b16 a[248:249], v218 offset:12544
    v_add_f32 v203, v203, v153
    v_mfma_f32_16x16x32_bf16 a[84:87], v[208:211], v[124:127], a[84:87]
    v_exp_f32 v158, v158
    v_mfma_f32_16x16x32_bf16 a[88:91], v[208:211], v[128:131], a[88:91]
    ds_read_b64_tr_b16 a[250:251], v218 offset:18688
    v_cvt_pk_bf16_f32 v153, v154, v155
    v_mfma_f32_16x16x32_bf16 a[92:95], v[208:211], v[132:135], a[92:95]
    v_exp_f32 v159, v159
    v_mfma_f32_16x16x32_bf16 a[96:99], v[208:211], v[136:139], a[96:99]
    ds_read_b64_tr_b16 a[252:253], v219 offset:12544
    v_add_f32 v203, v203, v154
    v_mfma_f32_16x16x32_bf16 a[100:103], v[212:215], v[120:123], a[100:103]
    v_exp_f32 v160, v160
    v_mfma_f32_16x16x32_bf16 a[104:107], v[212:215], v[124:127], a[104:107]
    ds_read_b64_tr_b16 a[254:255], v219 offset:18688
    v_add_f32 v203, v203, v155
    v_mfma_f32_16x16x32_bf16 a[108:111], v[212:215], v[128:131], a[108:111]
    v_exp_f32 v161, v161
    v_mfma_f32_16x16x32_bf16 a[112:115], v[212:215], v[132:135], a[112:115]
    v_exp_f32 v162, v162
    v_mfma_f32_16x16x32_bf16 a[116:119], v[212:215], v[136:139], a[116:119]
    v_add_f32 v204, v204, v156
    s_waitcnt lgkmcnt(4)
    v_mfma_f32_16x16x32_bf16 a[120:123], a[240:243], v[120:123], a[120:123]
    ds_read_b64_tr_b16 v[208:209], v220 offset:12544
    v_cvt_pk_bf16_f32 v156, v156, v157
    v_mfma_f32_16x16x32_bf16 a[124:127], a[240:243], v[124:127], a[124:127]
    ds_read_b64_tr_b16 v[210:211], v220 offset:18688
    v_add_f32 v204, v204, v157
    v_mfma_f32_16x16x32_bf16 a[128:131], a[240:243], v[128:131], a[128:131]
    ds_read_b64_tr_b16 v[212:213], v221 offset:12544
    v_cvt_pk_bf16_f32 v157, v158, v159
    v_mfma_f32_16x16x32_bf16 a[132:135], a[240:243], v[132:135], a[132:135]
    ds_read_b64_tr_b16 v[214:215], v221 offset:18688
    v_add_f32 v204, v204, v158
    v_mfma_f32_16x16x32_bf16 a[136:139], a[240:243], v[136:139], a[136:139]
    v_exp_f32 v163, v163
    v_mfma_f32_16x16x32_bf16 a[140:143], a[244:247], v[120:123], a[140:143]
    v_exp_f32 v164, v164
    v_mfma_f32_16x16x32_bf16 a[144:147], a[244:247], v[124:127], a[144:147]
    v_exp_f32 v165, v165
    v_mfma_f32_16x16x32_bf16 a[148:151], a[244:247], v[128:131], a[148:151]
    v_exp_f32 v166, v166
    v_mfma_f32_16x16x32_bf16 a[152:155], a[244:247], v[132:135], a[152:155]
    v_exp_f32 v167, v167
    v_mfma_f32_16x16x32_bf16 a[156:159], a[244:247], v[136:139], a[156:159]
    s_waitcnt vmcnt(24) lgkmcnt(0)
    s_barrier
    v_mfma_f32_16x16x32_bf16 a[160:163], a[248:251], v[120:123], a[160:163]
    ds_read_b128 a[240:243], v216 offset:0
    s_add_u32 m0, s8, 53248
    v_mfma_f32_16x16x32_bf16 a[164:167], a[248:251], v[124:127], a[164:167]
    buffer_load_dwordx4 v224, s[44:47], s66 offen offset:0 nt lds
    v_mfma_f32_16x16x32_bf16 a[168:171], a[248:251], v[128:131], a[168:171]
    ds_read_b128 a[244:247], v217 offset:0
    buffer_load_dwordx4 v225, s[44:47], s66 offen offset:1024 nt lds
    v_mfma_f32_16x16x32_bf16 a[172:175], a[248:251], v[132:135], a[172:175]
    buffer_load_dwordx4 v226, s[44:47], s66 offen offset:2048 nt lds
    s_add_u32 s66, s66, 6291456
    v_mfma_f32_16x16x32_bf16 a[176:179], a[248:251], v[136:139], a[176:179]
    s_add_u32 m0, s8, 135168
    v_add_f32 v204, v204, v159
    v_mfma_f32_16x16x32_bf16 a[180:183], a[252:255], v[120:123], a[180:183]
    v_add_f32 v200, v200, v160
    v_cvt_pk_bf16_f32 v142, v160, v161
    v_mfma_f32_16x16x32_bf16 a[184:187], a[252:255], v[124:127], a[184:187]
    v_add_f32 v200, v200, v161
    v_cvt_pk_bf16_f32 v143, v162, v163
    v_mfma_f32_16x16x32_bf16 a[188:191], a[252:255], v[128:131], a[188:191]
    v_add_f32 v200, v200, v162
    v_add_f32 v200, v200, v163
    v_mfma_f32_16x16x32_bf16 a[192:195], a[252:255], v[132:135], a[192:195]
    v_exp_f32 v168, v168
    v_mfma_f32_16x16x32_bf16 a[196:199], a[252:255], v[136:139], a[196:199]
    v_add_f32 v201, v201, v164
    v_mfma_f32_16x16x32_bf16 a[200:203], v[208:211], v[120:123], a[200:203]
    ds_read_b128 a[248:251], v216 offset:128
    v_cvt_pk_bf16_f32 v146, v164, v165
    v_mfma_f32_16x16x32_bf16 a[204:207], v[208:211], v[124:127], a[204:207]
    v_exp_f32 v169, v169
    v_mfma_f32_16x16x32_bf16 a[208:211], v[208:211], v[128:131], a[208:211]
    ds_read_b128 a[252:255], v217 offset:128
    v_add_f32 v201, v201, v165
    v_mfma_f32_16x16x32_bf16 a[212:215], v[208:211], v[132:135], a[212:215]
    buffer_load_dwordx4 v224, s[44:47], s66 offen offset:0 nt lds
    v_mfma_f32_16x16x32_bf16 a[216:219], v[208:211], v[136:139], a[216:219]
    buffer_load_dwordx4 v225, s[44:47], s66 offen offset:1024 nt lds
    v_mfma_f32_16x16x32_bf16 a[220:223], v[212:215], v[120:123], a[220:223]
    buffer_load_dwordx4 v226, s[44:47], s66 offen offset:2048 nt lds
    s_add_u32 s66, s66, 4288688128
    v_mfma_f32_16x16x32_bf16 a[224:227], v[212:215], v[124:127], a[224:227]
    v_exp_f32 v170, v170
    v_mfma_f32_16x16x32_bf16 a[228:231], v[212:215], v[128:131], a[228:231]
    v_exp_f32 v171, v171
    v_mfma_f32_16x16x32_bf16 a[232:235], v[212:215], v[132:135], a[232:235]
    v_cvt_pk_bf16_f32 v147, v166, v167
    v_add_f32 v201, v201, v166
    v_mfma_f32_16x16x32_bf16 a[236:239], v[212:215], v[136:139], a[236:239]
    v_add_f32 v201, v201, v167
    v_add_f32 v202, v202, v168
    v_cvt_pk_bf16_f32 v150, v168, v169
    v_add_f32 v202, v202, v169
    v_cvt_pk_bf16_f32 v151, v170, v171
    v_add_f32 v202, v202, v170
    v_add_f32 v202, v202, v171
    s_waitcnt lgkmcnt(2)
    v_mfma_f32_16x16x32_bf16 v[120:123], a[240:243], v[0:3], v[180:183]
    ds_read_b128 v[208:211], v216 offset:256
    v_mfma_f32_16x16x32_bf16 v[120:123], a[244:247], v[40:43], v[120:123]
    v_exp_f32 v172, v172
    v_mfma_f32_16x16x32_bf16 v[124:127], a[240:243], v[8:11], v[184:187]
    ds_read_b128 v[212:215], v217 offset:256
    v_mfma_f32_16x16x32_bf16 v[124:127], a[244:247], v[48:51], v[124:127]
    v_exp_f32 v173, v173
    v_mfma_f32_16x16x32_bf16 v[128:131], a[240:243], v[16:19], v[188:191]
    v_exp_f32 v174, v174
    v_mfma_f32_16x16x32_bf16 v[128:131], a[244:247], v[56:59], v[128:131]
    v_exp_f32 v175, v175
    v_mfma_f32_16x16x32_bf16 v[132:135], a[240:243], v[24:27], v[192:195]
    v_exp_f32 v176, v176
    v_mfma_f32_16x16x32_bf16 v[132:135], a[244:247], v[64:67], v[132:135]
    v_exp_f32 v177, v177
    v_mfma_f32_16x16x32_bf16 v[136:139], a[240:243], v[32:35], v[196:199]
    v_exp_f32 v178, v178
    v_mfma_f32_16x16x32_bf16 v[136:139], a[244:247], v[72:75], v[136:139]
    v_add_f32 v203, v203, v172
    s_waitcnt lgkmcnt(2)
    v_mfma_f32_16x16x32_bf16 v[120:123], a[248:251], v[80:83], v[120:123]
    ds_read_b128 a[240:243], v216 offset:6144
    v_cvt_pk_bf16_f32 v154, v172, v173
    v_mfma_f32_16x16x32_bf16 v[120:123], a[252:255], v[4:7], v[120:123]
    v_exp_f32 v179, v179
    v_mfma_f32_16x16x32_bf16 v[124:127], a[248:251], v[88:91], v[124:127]
    ds_read_b128 a[244:247], v217 offset:6144
    v_add_f32 v203, v203, v173
    v_mfma_f32_16x16x32_bf16 v[124:127], a[252:255], v[12:15], v[124:127]
    v_cvt_pk_bf16_f32 v155, v174, v175
    v_add_f32 v203, v203, v174
    v_mfma_f32_16x16x32_bf16 v[128:131], a[248:251], v[96:99], v[128:131]
    v_add_f32 v203, v203, v175
    v_add_f32 v204, v204, v176
    v_mfma_f32_16x16x32_bf16 v[128:131], a[252:255], v[20:23], v[128:131]
    v_cvt_pk_bf16_f32 v158, v176, v177
    v_add_f32 v204, v204, v177
    v_mfma_f32_16x16x32_bf16 v[132:135], a[248:251], v[104:107], v[132:135]
    v_cvt_pk_bf16_f32 v159, v178, v179
    v_add_f32 v204, v204, v178
    v_mfma_f32_16x16x32_bf16 v[132:135], a[252:255], v[28:31], v[132:135]
    v_add_f32 v204, v204, v179
    v_mfma_f32_16x16x32_bf16 v[136:139], a[248:251], v[112:115], v[136:139]
    v_mfma_f32_16x16x32_bf16 v[136:139], a[252:255], v[36:39], v[136:139]
    s_waitcnt lgkmcnt(2)
    v_mfma_f32_16x16x32_bf16 v[120:123], v[208:211], v[44:47], v[120:123]
    ds_read_b128 a[248:251], v216 offset:6272
    v_mfma_f32_16x16x32_bf16 v[120:123], v[212:215], v[84:87], v[120:123]
    v_mfma_f32_16x16x32_bf16 v[124:127], v[208:211], v[52:55], v[124:127]
    ds_read_b128 a[252:255], v217 offset:6272
    v_mfma_f32_16x16x32_bf16 v[124:127], v[212:215], v[92:95], v[124:127]
    v_mfma_f32_16x16x32_bf16 v[128:131], v[208:211], v[60:63], v[128:131]
    v_mfma_f32_16x16x32_bf16 v[128:131], v[212:215], v[100:103], v[128:131]
    v_mfma_f32_16x16x32_bf16 v[132:135], v[208:211], v[68:71], v[132:135]
    v_mfma_f32_16x16x32_bf16 v[132:135], v[212:215], v[108:111], v[132:135]
    v_mfma_f32_16x16x32_bf16 v[136:139], v[208:211], v[76:79], v[136:139]
    v_mfma_f32_16x16x32_bf16 v[136:139], v[212:215], v[116:119], v[136:139]
    s_waitcnt lgkmcnt(2)
    v_mfma_f32_16x16x32_bf16 v[160:163], a[240:243], v[0:3], v[180:183]
    ds_read_b128 v[208:211], v216 offset:6400
    v_mfma_f32_16x16x32_bf16 v[160:163], a[244:247], v[40:43], v[160:163]
    ds_read_b128 v[212:215], v217 offset:6400
    v_mfma_f32_16x16x32_bf16 v[164:167], a[240:243], v[8:11], v[184:187]
    v_mfma_f32_16x16x32_bf16 v[164:167], a[244:247], v[48:51], v[164:167]
    v_mfma_f32_16x16x32_bf16 v[168:171], a[240:243], v[16:19], v[188:191]
    v_mfma_f32_16x16x32_bf16 v[168:171], a[244:247], v[56:59], v[168:171]
    v_exp_f32 v120, v120
    v_mfma_f32_16x16x32_bf16 v[172:175], a[240:243], v[24:27], v[192:195]
    v_exp_f32 v121, v121
    v_mfma_f32_16x16x32_bf16 v[172:175], a[244:247], v[64:67], v[172:175]
    v_exp_f32 v122, v122
    v_mfma_f32_16x16x32_bf16 v[176:179], a[240:243], v[32:35], v[196:199]
    v_exp_f32 v123, v123
    v_mfma_f32_16x16x32_bf16 v[176:179], a[244:247], v[72:75], v[176:179]
    s_waitcnt vmcnt(24) lgkmcnt(0)
    s_barrier
    v_mfma_f32_16x16x32_bf16 v[160:163], a[248:251], v[80:83], v[160:163]
    ds_read_b64_tr_b16 a[240:241], v218 offset:24576
    s_add_u32 m0, s8, 0
    v_mfma_f32_16x16x32_bf16 v[160:163], a[252:255], v[4:7], v[160:163]
    buffer_load_dwordx4 v224, s[40:43], s65 offen offset:0 nt lds
    v_mfma_f32_16x16x32_bf16 v[164:167], a[248:251], v[88:91], v[164:167]
    ds_read_b64_tr_b16 a[242:243], v218 offset:30720
    buffer_load_dwordx4 v225, s[40:43], s65 offen offset:1024 nt lds
    v_mfma_f32_16x16x32_bf16 v[164:167], a[252:255], v[12:15], v[164:167]
    buffer_load_dwordx4 v226, s[40:43], s65 offen offset:2048 nt lds
    s_add_u32 s65, s65, 6291456
    v_mfma_f32_16x16x32_bf16 v[168:171], a[248:251], v[96:99], v[168:171]
    ds_read_b64_tr_b16 a[244:245], v219 offset:24576
    s_add_u32 m0, s8, 81920
    v_mfma_f32_16x16x32_bf16 v[168:171], a[252:255], v[20:23], v[168:171]
    v_exp_f32 v124, v124
    v_mfma_f32_16x16x32_bf16 v[172:175], a[248:251], v[104:107], v[172:175]
    ds_read_b64_tr_b16 a[246:247], v219 offset:30720
    v_add_f32 v200, v200, v120
    v_mfma_f32_16x16x32_bf16 v[172:175], a[252:255], v[28:31], v[172:175]
    v_exp_f32 v125, v125
    v_mfma_f32_16x16x32_bf16 v[176:179], a[248:251], v[112:115], v[176:179]
    v_exp_f32 v126, v126
    v_mfma_f32_16x16x32_bf16 v[176:179], a[252:255], v[36:39], v[176:179]
    v_cvt_pk_bf16_f32 v120, v120, v121
    v_mfma_f32_16x16x32_bf16 v[160:163], v[208:211], v[44:47], v[160:163]
    ds_read_b64_tr_b16 a[248:249], v220 offset:24576
    v_add_f32 v200, v200, v121
    v_mfma_f32_16x16x32_bf16 v[160:163], v[212:215], v[84:87], v[160:163]
    v_exp_f32 v127, v127
    v_mfma_f32_16x16x32_bf16 v[164:167], v[208:211], v[52:55], v[164:167]
    ds_read_b64_tr_b16 a[250:251], v220 offset:30720
    v_cvt_pk_bf16_f32 v121, v122, v123
    v_mfma_f32_16x16x32_bf16 v[164:167], v[212:215], v[92:95], v[164:167]
    buffer_load_dwordx4 v224, s[40:43], s65 offen offset:0 nt lds
    v_mfma_f32_16x16x32_bf16 v[168:171], v[208:211], v[60:63], v[168:171]
    ds_read_b64_tr_b16 a[252:253], v221 offset:24576
    buffer_load_dwordx4 v225, s[40:43], s65 offen offset:1024 nt lds
    v_mfma_f32_16x16x32_bf16 v[168:171], v[212:215], v[100:103], v[168:171]
    buffer_load_dwordx4 v226, s[40:43], s65 offen offset:2048 nt lds
    s_add_u32 s65, s65, 4288688128
    v_mfma_f32_16x16x32_bf16 v[172:175], v[208:211], v[68:71], v[172:175]
    ds_read_b64_tr_b16 a[254:255], v221 offset:30720
    v_add_f32 v200, v200, v122
    v_mfma_f32_16x16x32_bf16 v[172:175], v[212:215], v[108:111], v[172:175]
    v_exp_f32 v128, v128
    v_mfma_f32_16x16x32_bf16 v[176:179], v[208:211], v[76:79], v[176:179]
    v_exp_f32 v129, v129
    v_mfma_f32_16x16x32_bf16 v[176:179], v[212:215], v[116:119], v[176:179]
    v_add_f32 v200, v200, v123
    s_waitcnt lgkmcnt(4)
    v_mfma_f32_16x16x32_bf16 a[0:3], a[240:243], v[140:143], a[0:3]
    ds_read_b64_tr_b16 v[208:209], v218 offset:24704
    v_add_f32 v201, v201, v124
    v_mfma_f32_16x16x32_bf16 a[4:7], a[240:243], v[144:147], a[4:7]
    v_exp_f32 v130, v130
    v_mfma_f32_16x16x32_bf16 a[8:11], a[240:243], v[148:151], a[8:11]
    ds_read_b64_tr_b16 v[210:211], v218 offset:30848
    v_cvt_pk_bf16_f32 v124, v124, v125
    v_mfma_f32_16x16x32_bf16 a[12:15], a[240:243], v[152:155], a[12:15]
    v_exp_f32 v131, v131
    v_mfma_f32_16x16x32_bf16 a[16:19], a[240:243], v[156:159], a[16:19]
    ds_read_b64_tr_b16 v[212:213], v219 offset:24704
    v_add_f32 v201, v201, v125
    v_mfma_f32_16x16x32_bf16 a[20:23], a[244:247], v[140:143], a[20:23]
    v_cvt_pk_bf16_f32 v125, v126, v127
    v_add_f32 v201, v201, v126
    v_mfma_f32_16x16x32_bf16 a[24:27], a[244:247], v[144:147], a[24:27]
    ds_read_b64_tr_b16 v[214:215], v219 offset:30848
    v_add_f32 v201, v201, v127
    v_mfma_f32_16x16x32_bf16 a[28:31], a[244:247], v[148:151], a[28:31]
    v_exp_f32 v132, v132
    v_mfma_f32_16x16x32_bf16 a[32:35], a[244:247], v[152:155], a[32:35]
    v_exp_f32 v133, v133
    v_mfma_f32_16x16x32_bf16 a[36:39], a[244:247], v[156:159], a[36:39]
    v_add_f32 v202, v202, v128
    s_waitcnt lgkmcnt(4)
    v_mfma_f32_16x16x32_bf16 a[40:43], a[248:251], v[140:143], a[40:43]
    ds_read_b64_tr_b16 a[240:241], v220 offset:24704
    v_cvt_pk_bf16_f32 v128, v128, v129
    v_mfma_f32_16x16x32_bf16 a[44:47], a[248:251], v[144:147], a[44:47]
    v_exp_f32 v134, v134
    v_mfma_f32_16x16x32_bf16 a[48:51], a[248:251], v[148:151], a[48:51]
    ds_read_b64_tr_b16 a[242:243], v220 offset:30848
    v_add_f32 v202, v202, v129
    v_mfma_f32_16x16x32_bf16 a[52:55], a[248:251], v[152:155], a[52:55]
    v_exp_f32 v135, v135
    v_mfma_f32_16x16x32_bf16 a[56:59], a[248:251], v[156:159], a[56:59]
    ds_read_b64_tr_b16 a[244:245], v221 offset:24704
    v_cvt_pk_bf16_f32 v129, v130, v131
    v_mfma_f32_16x16x32_bf16 a[60:63], a[252:255], v[140:143], a[60:63]
    v_add_f32 v202, v202, v130
    v_add_f32 v202, v202, v131
    v_mfma_f32_16x16x32_bf16 a[64:67], a[252:255], v[144:147], a[64:67]
    ds_read_b64_tr_b16 a[246:247], v221 offset:30848
    v_add_f32 v203, v203, v132
    v_mfma_f32_16x16x32_bf16 a[68:71], a[252:255], v[148:151], a[68:71]
    v_exp_f32 v136, v136
    v_mfma_f32_16x16x32_bf16 a[72:75], a[252:255], v[152:155], a[72:75]
    v_exp_f32 v137, v137
    v_mfma_f32_16x16x32_bf16 a[76:79], a[252:255], v[156:159], a[76:79]
    v_cvt_pk_bf16_f32 v132, v132, v133
    s_waitcnt lgkmcnt(4)
    v_mfma_f32_16x16x32_bf16 a[80:83], v[208:211], v[140:143], a[80:83]
    ds_read_b64_tr_b16 a[248:249], v218 offset:24832
    v_add_f32 v203, v203, v133
    v_mfma_f32_16x16x32_bf16 a[84:87], v[208:211], v[144:147], a[84:87]
    v_exp_f32 v138, v138
    v_mfma_f32_16x16x32_bf16 a[88:91], v[208:211], v[148:151], a[88:91]
    ds_read_b64_tr_b16 a[250:251], v218 offset:30976
    v_cvt_pk_bf16_f32 v133, v134, v135
    v_mfma_f32_16x16x32_bf16 a[92:95], v[208:211], v[152:155], a[92:95]
    v_exp_f32 v139, v139
    v_mfma_f32_16x16x32_bf16 a[96:99], v[208:211], v[156:159], a[96:99]
    ds_read_b64_tr_b16 a[252:253], v219 offset:24832
    v_add_f32 v203, v203, v134
    v_mfma_f32_16x16x32_bf16 a[100:103], v[212:215], v[140:143], a[100:103]
    v_exp_f32 v160, v160
    v_mfma_f32_16x16x32_bf16 a[104:107], v[212:215], v[144:147], a[104:107]
    ds_read_b64_tr_b16 a[254:255], v219 offset:30976
    v_add_f32 v203, v203, v135
    v_mfma_f32_16x16x32_bf16 a[108:111], v[212:215], v[148:151], a[108:111]
    v_exp_f32 v161, v161
    v_mfma_f32_16x16x32_bf16 a[112:115], v[212:215], v[152:155], a[112:115]
    v_exp_f32 v162, v162
    v_mfma_f32_16x16x32_bf16 a[116:119], v[212:215], v[156:159], a[116:119]
    v_add_f32 v204, v204, v136
    s_waitcnt lgkmcnt(4)
    v_mfma_f32_16x16x32_bf16 a[120:123], a[240:243], v[140:143], a[120:123]
    ds_read_b64_tr_b16 v[208:209], v220 offset:24832
    v_cvt_pk_bf16_f32 v136, v136, v137
    v_mfma_f32_16x16x32_bf16 a[124:127], a[240:243], v[144:147], a[124:127]
    ds_read_b64_tr_b16 v[210:211], v220 offset:30976
    v_add_f32 v204, v204, v137
    v_mfma_f32_16x16x32_bf16 a[128:131], a[240:243], v[148:151], a[128:131]
    ds_read_b64_tr_b16 v[212:213], v221 offset:24832
    v_cvt_pk_bf16_f32 v137, v138, v139
    v_mfma_f32_16x16x32_bf16 a[132:135], a[240:243], v[152:155], a[132:135]
    ds_read_b64_tr_b16 v[214:215], v221 offset:30976
    v_add_f32 v204, v204, v138
    v_mfma_f32_16x16x32_bf16 a[136:139], a[240:243], v[156:159], a[136:139]
    v_exp_f32 v163, v163
    v_mfma_f32_16x16x32_bf16 a[140:143], a[244:247], v[140:143], a[140:143]
    v_exp_f32 v164, v164
    v_mfma_f32_16x16x32_bf16 a[144:147], a[244:247], v[144:147], a[144:147]
    v_exp_f32 v165, v165
    v_mfma_f32_16x16x32_bf16 a[148:151], a[244:247], v[148:151], a[148:151]
    v_exp_f32 v166, v166
    v_mfma_f32_16x16x32_bf16 a[152:155], a[244:247], v[152:155], a[152:155]
    v_exp_f32 v167, v167
    v_mfma_f32_16x16x32_bf16 a[156:159], a[244:247], v[156:159], a[156:159]
    s_waitcnt vmcnt(24) lgkmcnt(0)
    s_barrier
    v_mfma_f32_16x16x32_bf16 a[160:163], a[248:251], v[140:143], a[160:163]
    ds_read_b128 a[240:243], v216 offset:12288
    s_add_u32 m0, s8, 65536
    v_mfma_f32_16x16x32_bf16 a[164:167], a[248:251], v[144:147], a[164:167]
    buffer_load_dwordx4 v224, s[44:47], s66 offen offset:0 nt lds
    v_mfma_f32_16x16x32_bf16 a[168:171], a[248:251], v[148:151], a[168:171]
    ds_read_b128 a[244:247], v217 offset:12288
    buffer_load_dwordx4 v225, s[44:47], s66 offen offset:1024 nt lds
    v_mfma_f32_16x16x32_bf16 a[172:175], a[248:251], v[152:155], a[172:175]
    buffer_load_dwordx4 v226, s[44:47], s66 offen offset:2048 nt lds
    s_add_u32 s66, s66, 6291456
    v_mfma_f32_16x16x32_bf16 a[176:179], a[248:251], v[156:159], a[176:179]
    s_add_u32 m0, s8, 147456
    v_add_f32 v204, v204, v139
    v_mfma_f32_16x16x32_bf16 a[180:183], a[252:255], v[140:143], a[180:183]
    v_add_f32 v200, v200, v160
    v_cvt_pk_bf16_f32 v122, v160, v161
    v_mfma_f32_16x16x32_bf16 a[184:187], a[252:255], v[144:147], a[184:187]
    v_add_f32 v200, v200, v161
    v_cvt_pk_bf16_f32 v123, v162, v163
    v_mfma_f32_16x16x32_bf16 a[188:191], a[252:255], v[148:151], a[188:191]
    v_add_f32 v200, v200, v162
    v_add_f32 v200, v200, v163
    v_mfma_f32_16x16x32_bf16 a[192:195], a[252:255], v[152:155], a[192:195]
    v_exp_f32 v168, v168
    v_mfma_f32_16x16x32_bf16 a[196:199], a[252:255], v[156:159], a[196:199]
    v_add_f32 v201, v201, v164
    v_mfma_f32_16x16x32_bf16 a[200:203], v[208:211], v[140:143], a[200:203]
    ds_read_b128 a[248:251], v216 offset:12416
    v_cvt_pk_bf16_f32 v126, v164, v165
    v_mfma_f32_16x16x32_bf16 a[204:207], v[208:211], v[144:147], a[204:207]
    v_exp_f32 v169, v169
    v_mfma_f32_16x16x32_bf16 a[208:211], v[208:211], v[148:151], a[208:211]
    ds_read_b128 a[252:255], v217 offset:12416
    v_add_f32 v201, v201, v165
    v_mfma_f32_16x16x32_bf16 a[212:215], v[208:211], v[152:155], a[212:215]
    buffer_load_dwordx4 v224, s[44:47], s66 offen offset:0 nt lds
    v_mfma_f32_16x16x32_bf16 a[216:219], v[208:211], v[156:159], a[216:219]
    buffer_load_dwordx4 v225, s[44:47], s66 offen offset:1024 nt lds
    v_mfma_f32_16x16x32_bf16 a[220:223], v[212:215], v[140:143], a[220:223]
    buffer_load_dwordx4 v226, s[44:47], s66 offen offset:2048 nt lds
    s_add_u32 s66, s66, 4288688128
    v_mfma_f32_16x16x32_bf16 a[224:227], v[212:215], v[144:147], a[224:227]
    v_exp_f32 v170, v170
    v_mfma_f32_16x16x32_bf16 a[228:231], v[212:215], v[148:151], a[228:231]
    v_exp_f32 v171, v171
    v_mfma_f32_16x16x32_bf16 a[232:235], v[212:215], v[152:155], a[232:235]
    v_cvt_pk_bf16_f32 v127, v166, v167
    v_add_f32 v201, v201, v166
    v_mfma_f32_16x16x32_bf16 a[236:239], v[212:215], v[156:159], a[236:239]
    v_add_f32 v201, v201, v167
    v_add_f32 v202, v202, v168
    v_cvt_pk_bf16_f32 v130, v168, v169
    v_add_f32 v202, v202, v169
    v_cvt_pk_bf16_f32 v131, v170, v171
    v_add_f32 v202, v202, v170
    v_add_f32 v202, v202, v171
    s_waitcnt lgkmcnt(2)
    v_mfma_f32_16x16x32_bf16 v[140:143], a[240:243], v[0:3], v[180:183]
    ds_read_b128 v[208:211], v216 offset:12544
    v_mfma_f32_16x16x32_bf16 v[140:143], a[244:247], v[40:43], v[140:143]
    v_exp_f32 v172, v172
    v_mfma_f32_16x16x32_bf16 v[144:147], a[240:243], v[8:11], v[184:187]
    ds_read_b128 v[212:215], v217 offset:12544
    v_mfma_f32_16x16x32_bf16 v[144:147], a[244:247], v[48:51], v[144:147]
    v_exp_f32 v173, v173
    v_mfma_f32_16x16x32_bf16 v[148:151], a[240:243], v[16:19], v[188:191]
    v_exp_f32 v174, v174
    v_mfma_f32_16x16x32_bf16 v[148:151], a[244:247], v[56:59], v[148:151]
    v_exp_f32 v175, v175
    v_mfma_f32_16x16x32_bf16 v[152:155], a[240:243], v[24:27], v[192:195]
    v_exp_f32 v176, v176
    v_mfma_f32_16x16x32_bf16 v[152:155], a[244:247], v[64:67], v[152:155]
    v_exp_f32 v177, v177
    v_mfma_f32_16x16x32_bf16 v[156:159], a[240:243], v[32:35], v[196:199]
    v_exp_f32 v178, v178
    v_mfma_f32_16x16x32_bf16 v[156:159], a[244:247], v[72:75], v[156:159]
    v_add_f32 v203, v203, v172
    s_waitcnt lgkmcnt(2)
    v_mfma_f32_16x16x32_bf16 v[140:143], a[248:251], v[80:83], v[140:143]
    ds_read_b128 a[240:243], v216 offset:18432
    v_cvt_pk_bf16_f32 v134, v172, v173
    v_mfma_f32_16x16x32_bf16 v[140:143], a[252:255], v[4:7], v[140:143]
    v_exp_f32 v179, v179
    v_mfma_f32_16x16x32_bf16 v[144:147], a[248:251], v[88:91], v[144:147]
    ds_read_b128 a[244:247], v217 offset:18432
    v_add_f32 v203, v203, v173
    v_mfma_f32_16x16x32_bf16 v[144:147], a[252:255], v[12:15], v[144:147]
    v_cvt_pk_bf16_f32 v135, v174, v175
    v_add_f32 v203, v203, v174
    v_mfma_f32_16x16x32_bf16 v[148:151], a[248:251], v[96:99], v[148:151]
    v_add_f32 v203, v203, v175
    v_add_f32 v204, v204, v176
    v_mfma_f32_16x16x32_bf16 v[148:151], a[252:255], v[20:23], v[148:151]
    v_cvt_pk_bf16_f32 v138, v176, v177
    v_add_f32 v204, v204, v177
    v_mfma_f32_16x16x32_bf16 v[152:155], a[248:251], v[104:107], v[152:155]
    v_cvt_pk_bf16_f32 v139, v178, v179
    v_add_f32 v204, v204, v178
    v_mfma_f32_16x16x32_bf16 v[152:155], a[252:255], v[28:31], v[152:155]
    v_add_f32 v204, v204, v179
    v_mfma_f32_16x16x32_bf16 v[156:159], a[248:251], v[112:115], v[156:159]
    v_mfma_f32_16x16x32_bf16 v[156:159], a[252:255], v[36:39], v[156:159]
    s_waitcnt lgkmcnt(2)
    v_mfma_f32_16x16x32_bf16 v[140:143], v[208:211], v[44:47], v[140:143]
    ds_read_b128 a[248:251], v216 offset:18560
    v_mfma_f32_16x16x32_bf16 v[140:143], v[212:215], v[84:87], v[140:143]
    v_mfma_f32_16x16x32_bf16 v[144:147], v[208:211], v[52:55], v[144:147]
    ds_read_b128 a[252:255], v217 offset:18560
    v_mfma_f32_16x16x32_bf16 v[144:147], v[212:215], v[92:95], v[144:147]
    v_mfma_f32_16x16x32_bf16 v[148:151], v[208:211], v[60:63], v[148:151]
    v_mfma_f32_16x16x32_bf16 v[148:151], v[212:215], v[100:103], v[148:151]
    v_mfma_f32_16x16x32_bf16 v[152:155], v[208:211], v[68:71], v[152:155]
    v_mfma_f32_16x16x32_bf16 v[152:155], v[212:215], v[108:111], v[152:155]
    v_mfma_f32_16x16x32_bf16 v[156:159], v[208:211], v[76:79], v[156:159]
    v_mfma_f32_16x16x32_bf16 v[156:159], v[212:215], v[116:119], v[156:159]
    s_waitcnt lgkmcnt(2)
    v_mfma_f32_16x16x32_bf16 v[160:163], a[240:243], v[0:3], v[180:183]
    ds_read_b128 v[208:211], v216 offset:18688
    v_mfma_f32_16x16x32_bf16 v[160:163], a[244:247], v[40:43], v[160:163]
    ds_read_b128 v[212:215], v217 offset:18688
    v_mfma_f32_16x16x32_bf16 v[164:167], a[240:243], v[8:11], v[184:187]
    v_mfma_f32_16x16x32_bf16 v[164:167], a[244:247], v[48:51], v[164:167]
    v_mfma_f32_16x16x32_bf16 v[168:171], a[240:243], v[16:19], v[188:191]
    v_mfma_f32_16x16x32_bf16 v[168:171], a[244:247], v[56:59], v[168:171]
    v_exp_f32 v140, v140
    v_mfma_f32_16x16x32_bf16 v[172:175], a[240:243], v[24:27], v[192:195]
    v_exp_f32 v141, v141
    v_mfma_f32_16x16x32_bf16 v[172:175], a[244:247], v[64:67], v[172:175]
    v_exp_f32 v142, v142
    v_mfma_f32_16x16x32_bf16 v[176:179], a[240:243], v[32:35], v[196:199]
    v_exp_f32 v143, v143
    v_mfma_f32_16x16x32_bf16 v[176:179], a[244:247], v[72:75], v[176:179]
    s_waitcnt vmcnt(24) lgkmcnt(0)
    s_barrier
    v_mfma_f32_16x16x32_bf16 v[160:163], a[248:251], v[80:83], v[160:163]
    ds_read_b64_tr_b16 a[240:241], v218 offset:0
    v_add_f32 v200, v200, v140
    v_mfma_f32_16x16x32_bf16 v[160:163], a[252:255], v[4:7], v[160:163]
    s_cmp_eq_u32 s62, 1
    s_cselect_b32 s65, 0x7f000000, s65
    v_mfma_f32_16x16x32_bf16 v[164:167], a[248:251], v[88:91], v[164:167]
    ds_read_b64_tr_b16 a[242:243], v218 offset:6144
    s_add_u32 m0, s8, 12288
    v_mfma_f32_16x16x32_bf16 v[164:167], a[252:255], v[12:15], v[164:167]
    buffer_load_dwordx4 v224, s[40:43], s65 offen offset:0 nt lds
    v_mfma_f32_16x16x32_bf16 v[168:171], a[248:251], v[96:99], v[168:171]
    ds_read_b64_tr_b16 a[244:245], v219 offset:0
    buffer_load_dwordx4 v225, s[40:43], s65 offen offset:1024 nt lds
    v_mfma_f32_16x16x32_bf16 v[168:171], a[252:255], v[20:23], v[168:171]
    buffer_load_dwordx4 v226, s[40:43], s65 offen offset:2048 nt lds
    s_add_u32 s65, s65, 6291456
    v_mfma_f32_16x16x32_bf16 v[172:175], a[248:251], v[104:107], v[172:175]
    ds_read_b64_tr_b16 a[246:247], v219 offset:6144
    s_add_u32 m0, s8, 94208
    v_mfma_f32_16x16x32_bf16 v[172:175], a[252:255], v[28:31], v[172:175]
    v_exp_f32 v144, v144
    v_mfma_f32_16x16x32_bf16 v[176:179], a[248:251], v[112:115], v[176:179]
    v_exp_f32 v145, v145
    v_mfma_f32_16x16x32_bf16 v[176:179], a[252:255], v[36:39], v[176:179]
    v_cvt_pk_bf16_f32 v140, v140, v141
    v_mfma_f32_16x16x32_bf16 v[160:163], v[208:211], v[44:47], v[160:163]
    ds_read_b64_tr_b16 a[248:249], v220 offset:0
    v_add_f32 v200, v200, v141
    v_mfma_f32_16x16x32_bf16 v[160:163], v[212:215], v[84:87], v[160:163]
    v_exp_f32 v146, v146
    v_mfma_f32_16x16x32_bf16 v[164:167], v[208:211], v[52:55], v[164:167]
    ds_read_b64_tr_b16 a[250:251], v220 offset:6144
    v_cvt_pk_bf16_f32 v141, v142, v143
    v_mfma_f32_16x16x32_bf16 v[164:167], v[212:215], v[92:95], v[164:167]
    v_exp_f32 v147, v147
    v_mfma_f32_16x16x32_bf16 v[168:171], v[208:211], v[60:63], v[168:171]
    ds_read_b64_tr_b16 a[252:253], v221 offset:0
    v_add_f32 v200, v200, v142
    v_mfma_f32_16x16x32_bf16 v[168:171], v[212:215], v[100:103], v[168:171]
    buffer_load_dwordx4 v224, s[40:43], s65 offen offset:0 nt lds
    v_mfma_f32_16x16x32_bf16 v[172:175], v[208:211], v[68:71], v[172:175]
    ds_read_b64_tr_b16 a[254:255], v221 offset:6144
    buffer_load_dwordx4 v225, s[40:43], s65 offen offset:1024 nt lds
    v_mfma_f32_16x16x32_bf16 v[172:175], v[212:215], v[108:111], v[172:175]
    buffer_load_dwordx4 v226, s[40:43], s65 offen offset:2048 nt lds
    s_add_u32 s65, s65, 4288688128
    v_mfma_f32_16x16x32_bf16 v[176:179], v[208:211], v[76:79], v[176:179]
    v_exp_f32 v148, v148
    v_mfma_f32_16x16x32_bf16 v[176:179], v[212:215], v[116:119], v[176:179]
    v_add_f32 v200, v200, v143
    s_waitcnt lgkmcnt(4)
    v_mfma_f32_16x16x32_bf16 a[0:3], a[240:243], v[120:123], a[0:3]
    ds_read_b64_tr_b16 v[208:209], v218 offset:128
    v_add_f32 v201, v201, v144
    v_mfma_f32_16x16x32_bf16 a[4:7], a[240:243], v[124:127], a[4:7]
    v_exp_f32 v149, v149
    v_mfma_f32_16x16x32_bf16 a[8:11], a[240:243], v[128:131], a[8:11]
    ds_read_b64_tr_b16 v[210:211], v218 offset:6272
    v_cvt_pk_bf16_f32 v144, v144, v145
    v_mfma_f32_16x16x32_bf16 a[12:15], a[240:243], v[132:135], a[12:15]
    v_exp_f32 v150, v150
    v_mfma_f32_16x16x32_bf16 a[16:19], a[240:243], v[136:139], a[16:19]
    ds_read_b64_tr_b16 v[212:213], v219 offset:128
    v_add_f32 v201, v201, v145
    v_mfma_f32_16x16x32_bf16 a[20:23], a[244:247], v[120:123], a[20:23]
    v_exp_f32 v151, v151
    v_mfma_f32_16x16x32_bf16 a[24:27], a[244:247], v[124:127], a[24:27]
    ds_read_b64_tr_b16 v[214:215], v219 offset:6272
    v_cvt_pk_bf16_f32 v145, v146, v147
    v_mfma_f32_16x16x32_bf16 a[28:31], a[244:247], v[128:131], a[28:31]
    v_add_f32 v201, v201, v146
    v_add_f32 v201, v201, v147
    v_mfma_f32_16x16x32_bf16 a[32:35], a[244:247], v[132:135], a[32:35]
    v_exp_f32 v152, v152
    v_mfma_f32_16x16x32_bf16 a[36:39], a[244:247], v[136:139], a[36:39]
    v_add_f32 v202, v202, v148
    s_waitcnt lgkmcnt(4)
    v_mfma_f32_16x16x32_bf16 a[40:43], a[248:251], v[120:123], a[40:43]
    ds_read_b64_tr_b16 a[240:241], v220 offset:128
    v_cvt_pk_bf16_f32 v148, v148, v149
    v_mfma_f32_16x16x32_bf16 a[44:47], a[248:251], v[124:127], a[44:47]
    v_exp_f32 v153, v153
    v_mfma_f32_16x16x32_bf16 a[48:51], a[248:251], v[128:131], a[48:51]
    ds_read_b64_tr_b16 a[242:243], v220 offset:6272
    v_add_f32 v202, v202, v149
    v_mfma_f32_16x16x32_bf16 a[52:55], a[248:251], v[132:135], a[52:55]
    v_exp_f32 v154, v154
    v_mfma_f32_16x16x32_bf16 a[56:59], a[248:251], v[136:139], a[56:59]
    ds_read_b64_tr_b16 a[244:245], v221 offset:128
    v_cvt_pk_bf16_f32 v149, v150, v151
    v_mfma_f32_16x16x32_bf16 a[60:63], a[252:255], v[120:123], a[60:63]
    v_exp_f32 v155, v155
    v_mfma_f32_16x16x32_bf16 a[64:67], a[252:255], v[124:127], a[64:67]
    ds_read_b64_tr_b16 a[246:247], v221 offset:6272
    v_add_f32 v202, v202, v150
    v_mfma_f32_16x16x32_bf16 a[68:71], a[252:255], v[128:131], a[68:71]
    v_exp_f32 v156, v156
    v_mfma_f32_16x16x32_bf16 a[72:75], a[252:255], v[132:135], a[72:75]
    v_exp_f32 v157, v157
    v_mfma_f32_16x16x32_bf16 a[76:79], a[252:255], v[136:139], a[76:79]
    v_add_f32 v202, v202, v151
    s_waitcnt lgkmcnt(4)
    v_mfma_f32_16x16x32_bf16 a[80:83], v[208:211], v[120:123], a[80:83]
    ds_read_b64_tr_b16 a[248:249], v218 offset:256
    v_add_f32 v203, v203, v152
    v_mfma_f32_16x16x32_bf16 a[84:87], v[208:211], v[124:127], a[84:87]
    v_exp_f32 v158, v158
    v_mfma_f32_16x16x32_bf16 a[88:91], v[208:211], v[128:131], a[88:91]
    ds_read_b64_tr_b16 a[250:251], v218 offset:6400
    v_cvt_pk_bf16_f32 v152, v152, v153
    v_mfma_f32_16x16x32_bf16 a[92:95], v[208:211], v[132:135], a[92:95]
    v_exp_f32 v159, v159
    v_mfma_f32_16x16x32_bf16 a[96:99], v[208:211], v[136:139], a[96:99]
    ds_read_b64_tr_b16 a[252:253], v219 offset:256
    v_add_f32 v203, v203, v153
    v_mfma_f32_16x16x32_bf16 a[100:103], v[212:215], v[120:123], a[100:103]
    v_cvt_pk_bf16_f32 v153, v154, v155
    v_add_f32 v203, v203, v154
    v_mfma_f32_16x16x32_bf16 a[104:107], v[212:215], v[124:127], a[104:107]
    ds_read_b64_tr_b16 a[254:255], v219 offset:6400
    v_add_f32 v203, v203, v155
    v_mfma_f32_16x16x32_bf16 a[108:111], v[212:215], v[128:131], a[108:111]
    v_exp_f32 v160, v160
    v_mfma_f32_16x16x32_bf16 a[112:115], v[212:215], v[132:135], a[112:115]
    v_exp_f32 v161, v161
    v_mfma_f32_16x16x32_bf16 a[116:119], v[212:215], v[136:139], a[116:119]
    v_add_f32 v204, v204, v156
    s_waitcnt lgkmcnt(4)
    v_mfma_f32_16x16x32_bf16 a[120:123], a[240:243], v[120:123], a[120:123]
    ds_read_b64_tr_b16 v[208:209], v220 offset:256
    v_cvt_pk_bf16_f32 v156, v156, v157
    v_mfma_f32_16x16x32_bf16 a[124:127], a[240:243], v[124:127], a[124:127]
    ds_read_b64_tr_b16 v[210:211], v220 offset:6400
    v_add_f32 v204, v204, v157
    v_mfma_f32_16x16x32_bf16 a[128:131], a[240:243], v[128:131], a[128:131]
    ds_read_b64_tr_b16 v[212:213], v221 offset:256
    v_cvt_pk_bf16_f32 v157, v158, v159
    v_mfma_f32_16x16x32_bf16 a[132:135], a[240:243], v[132:135], a[132:135]
    ds_read_b64_tr_b16 v[214:215], v221 offset:6400
    v_add_f32 v204, v204, v158
    v_mfma_f32_16x16x32_bf16 a[136:139], a[240:243], v[136:139], a[136:139]
    v_exp_f32 v162, v162
    v_mfma_f32_16x16x32_bf16 a[140:143], a[244:247], v[120:123], a[140:143]
    v_exp_f32 v163, v163
    v_mfma_f32_16x16x32_bf16 a[144:147], a[244:247], v[124:127], a[144:147]
    v_exp_f32 v164, v164
    v_mfma_f32_16x16x32_bf16 a[148:151], a[244:247], v[128:131], a[148:151]
    v_exp_f32 v165, v165
    v_mfma_f32_16x16x32_bf16 a[152:155], a[244:247], v[132:135], a[152:155]
    v_exp_f32 v166, v166
    v_mfma_f32_16x16x32_bf16 a[156:159], a[244:247], v[136:139], a[156:159]
    s_waitcnt vmcnt(24) lgkmcnt(0)
    s_barrier
    v_mfma_f32_16x16x32_bf16 a[160:163], a[248:251], v[120:123], a[160:163]
    ds_read_b128 a[240:243], v216 offset:24576
    s_add_u32 m0, s8, 40960
    v_mfma_f32_16x16x32_bf16 a[164:167], a[248:251], v[124:127], a[164:167]
    buffer_load_dwordx4 v224, s[44:47], s66 offen offset:0 nt lds
    v_mfma_f32_16x16x32_bf16 a[168:171], a[248:251], v[128:131], a[168:171]
    ds_read_b128 a[244:247], v217 offset:24576
    buffer_load_dwordx4 v225, s[44:47], s66 offen offset:1024 nt lds
    v_mfma_f32_16x16x32_bf16 a[172:175], a[248:251], v[132:135], a[172:175]
    buffer_load_dwordx4 v226, s[44:47], s66 offen offset:2048 nt lds
    s_add_u32 s66, s66, 6291456
    v_mfma_f32_16x16x32_bf16 a[176:179], a[248:251], v[136:139], a[176:179]
    s_add_u32 m0, s8, 122880
    v_add_f32 v204, v204, v159
    v_mfma_f32_16x16x32_bf16 a[180:183], a[252:255], v[120:123], a[180:183]
    v_exp_f32 v167, v167
    v_mfma_f32_16x16x32_bf16 a[184:187], a[252:255], v[124:127], a[184:187]
    v_add_f32 v200, v200, v160
    v_cvt_pk_bf16_f32 v142, v160, v161
    v_mfma_f32_16x16x32_bf16 a[188:191], a[252:255], v[128:131], a[188:191]
    v_add_f32 v200, v200, v161
    v_cvt_pk_bf16_f32 v143, v162, v163
    v_mfma_f32_16x16x32_bf16 a[192:195], a[252:255], v[132:135], a[192:195]
    v_add_f32 v200, v200, v162
    v_add_f32 v200, v200, v163
    v_mfma_f32_16x16x32_bf16 a[196:199], a[252:255], v[136:139], a[196:199]
    v_add_f32 v201, v201, v164
    v_mfma_f32_16x16x32_bf16 a[200:203], v[208:211], v[120:123], a[200:203]
    ds_read_b128 a[248:251], v216 offset:24704
    v_cvt_pk_bf16_f32 v146, v164, v165
    v_mfma_f32_16x16x32_bf16 a[204:207], v[208:211], v[124:127], a[204:207]
    v_exp_f32 v168, v168
    v_mfma_f32_16x16x32_bf16 a[208:211], v[208:211], v[128:131], a[208:211]
    ds_read_b128 a[252:255], v217 offset:24704
    v_add_f32 v201, v201, v165
    v_mfma_f32_16x16x32_bf16 a[212:215], v[208:211], v[132:135], a[212:215]
    buffer_load_dwordx4 v224, s[44:47], s66 offen offset:0 nt lds
    v_mfma_f32_16x16x32_bf16 a[216:219], v[208:211], v[136:139], a[216:219]
    buffer_load_dwordx4 v225, s[44:47], s66 offen offset:1024 nt lds
    v_mfma_f32_16x16x32_bf16 a[220:223], v[212:215], v[120:123], a[220:223]
    buffer_load_dwordx4 v226, s[44:47], s66 offen offset:2048 nt lds
    s_add_u32 s66, s66, 4288688128
    v_mfma_f32_16x16x32_bf16 a[224:227], v[212:215], v[124:127], a[224:227]
    v_exp_f32 v169, v169
    v_mfma_f32_16x16x32_bf16 a[228:231], v[212:215], v[128:131], a[228:231]
    v_exp_f32 v170, v170
    v_mfma_f32_16x16x32_bf16 a[232:235], v[212:215], v[132:135], a[232:235]
    v_exp_f32 v171, v171
    v_mfma_f32_16x16x32_bf16 a[236:239], v[212:215], v[136:139], a[236:239]
    v_cvt_pk_bf16_f32 v147, v166, v167
    v_add_f32 v201, v201, v166
    v_add_f32 v201, v201, v167
    v_add_f32 v202, v202, v168
    v_cvt_pk_bf16_f32 v150, v168, v169
    v_add_f32 v202, v202, v169
    v_cvt_pk_bf16_f32 v151, v170, v171
    v_add_f32 v202, v202, v170
    v_add_f32 v202, v202, v171
    s_add_u32 s62, s62, 1
    s_cmp_lt_u32 s62, 2
    s_cbranch_scc1 L_att_loop
    s_waitcnt lgkmcnt(2)
    v_mfma_f32_16x16x32_bf16 v[120:123], a[240:243], v[0:3], v[180:183]
    ds_read_b128 v[208:211], v216 offset:24832
    v_mfma_f32_16x16x32_bf16 v[120:123], a[244:247], v[40:43], v[120:123]
    v_exp_f32 v172, v172
    v_mfma_f32_16x16x32_bf16 v[124:127], a[240:243], v[8:11], v[184:187]
    ds_read_b128 v[212:215], v217 offset:24832
    v_mfma_f32_16x16x32_bf16 v[124:127], a[244:247], v[48:51], v[124:127]
    v_exp_f32 v173, v173
    v_mfma_f32_16x16x32_bf16 v[128:131], a[240:243], v[16:19], v[188:191]
    v_exp_f32 v174, v174
    v_mfma_f32_16x16x32_bf16 v[128:131], a[244:247], v[56:59], v[128:131]
    v_exp_f32 v175, v175
    v_mfma_f32_16x16x32_bf16 v[132:135], a[240:243], v[24:27], v[192:195]
    v_exp_f32 v176, v176
    v_mfma_f32_16x16x32_bf16 v[132:135], a[244:247], v[64:67], v[132:135]
    v_exp_f32 v177, v177
    v_mfma_f32_16x16x32_bf16 v[136:139], a[240:243], v[32:35], v[196:199]
    v_exp_f32 v178, v178
    v_mfma_f32_16x16x32_bf16 v[136:139], a[244:247], v[72:75], v[136:139]
    v_add_f32 v203, v203, v172
    s_waitcnt lgkmcnt(2)
    v_mfma_f32_16x16x32_bf16 v[120:123], a[248:251], v[80:83], v[120:123]
    ds_read_b128 a[240:243], v216 offset:30720
    v_cvt_pk_bf16_f32 v154, v172, v173
    v_mfma_f32_16x16x32_bf16 v[120:123], a[252:255], v[4:7], v[120:123]
    v_exp_f32 v179, v179
    v_mfma_f32_16x16x32_bf16 v[124:127], a[248:251], v[88:91], v[124:127]
    ds_read_b128 a[244:247], v217 offset:30720
    v_add_f32 v203, v203, v173
    v_mfma_f32_16x16x32_bf16 v[124:127], a[252:255], v[12:15], v[124:127]
    v_cvt_pk_bf16_f32 v155, v174, v175
    v_add_f32 v203, v203, v174
    v_mfma_f32_16x16x32_bf16 v[128:131], a[248:251], v[96:99], v[128:131]
    v_add_f32 v203, v203, v175
    v_add_f32 v204, v204, v176
    v_mfma_f32_16x16x32_bf16 v[128:131], a[252:255], v[20:23], v[128:131]
    v_cvt_pk_bf16_f32 v158, v176, v177
    v_add_f32 v204, v204, v177
    v_mfma_f32_16x16x32_bf16 v[132:135], a[248:251], v[104:107], v[132:135]
    v_cvt_pk_bf16_f32 v159, v178, v179
    v_add_f32 v204, v204, v178
    v_mfma_f32_16x16x32_bf16 v[132:135], a[252:255], v[28:31], v[132:135]
    v_add_f32 v204, v204, v179
    v_mfma_f32_16x16x32_bf16 v[136:139], a[248:251], v[112:115], v[136:139]
    v_mfma_f32_16x16x32_bf16 v[136:139], a[252:255], v[36:39], v[136:139]
    s_waitcnt lgkmcnt(2)
    v_mfma_f32_16x16x32_bf16 v[120:123], v[208:211], v[44:47], v[120:123]
    ds_read_b128 a[248:251], v216 offset:30848
    v_mfma_f32_16x16x32_bf16 v[120:123], v[212:215], v[84:87], v[120:123]
    v_mfma_f32_16x16x32_bf16 v[124:127], v[208:211], v[52:55], v[124:127]
    ds_read_b128 a[252:255], v217 offset:30848
    v_mfma_f32_16x16x32_bf16 v[124:127], v[212:215], v[92:95], v[124:127]
    v_mfma_f32_16x16x32_bf16 v[128:131], v[208:211], v[60:63], v[128:131]
    v_mfma_f32_16x16x32_bf16 v[128:131], v[212:215], v[100:103], v[128:131]
    v_mfma_f32_16x16x32_bf16 v[132:135], v[208:211], v[68:71], v[132:135]
    v_mfma_f32_16x16x32_bf16 v[132:135], v[212:215], v[108:111], v[132:135]
    v_mfma_f32_16x16x32_bf16 v[136:139], v[208:211], v[76:79], v[136:139]
    v_mfma_f32_16x16x32_bf16 v[136:139], v[212:215], v[116:119], v[136:139]
    s_waitcnt lgkmcnt(2)
    v_mfma_f32_16x16x32_bf16 v[160:163], a[240:243], v[0:3], v[180:183]
    ds_read_b128 v[208:211], v216 offset:30976
    v_mfma_f32_16x16x32_bf16 v[160:163], a[244:247], v[40:43], v[160:163]
    ds_read_b128 v[212:215], v217 offset:30976
    v_mfma_f32_16x16x32_bf16 v[164:167], a[240:243], v[8:11], v[184:187]
    v_mfma_f32_16x16x32_bf16 v[164:167], a[244:247], v[48:51], v[164:167]
    v_mfma_f32_16x16x32_bf16 v[168:171], a[240:243], v[16:19], v[188:191]
    v_mfma_f32_16x16x32_bf16 v[168:171], a[244:247], v[56:59], v[168:171]
    v_exp_f32 v120, v120
    v_mfma_f32_16x16x32_bf16 v[172:175], a[240:243], v[24:27], v[192:195]
    v_exp_f32 v121, v121
    v_mfma_f32_16x16x32_bf16 v[172:175], a[244:247], v[64:67], v[172:175]
    v_exp_f32 v122, v122
    v_mfma_f32_16x16x32_bf16 v[176:179], a[240:243], v[32:35], v[196:199]
    v_exp_f32 v123, v123
    v_mfma_f32_16x16x32_bf16 v[176:179], a[244:247], v[72:75], v[176:179]
    s_waitcnt vmcnt(24) lgkmcnt(0)
    s_barrier
    v_mfma_f32_16x16x32_bf16 v[160:163], a[248:251], v[80:83], v[160:163]
    ds_read_b64_tr_b16 a[240:241], v218 offset:12288
    v_add_f32 v200, v200, v120
    v_mfma_f32_16x16x32_bf16 v[160:163], a[252:255], v[4:7], v[160:163]
    s_getpc_b64 s[78:79]
L_ct_here:
    s_lshl_b32 s3, s56, 13
    s_add_u32 s3, s3, L_zf_ok-L_ct_here
    s_min_u32 s3, s3, L_exit-L_ct_here-8192
    s_add_u32 s78, s78, s3
    s_addc_u32 s79, s79, 0
    v_lshlrev_b32 v250, 7, v235
    v_mov_b32 v251, s79
    v_add_co_u32 v250, vcc, s78, v250
    s_nop 1
    v_addc_co_u32 v251, vcc, 0, v251, vcc
    v_mfma_f32_16x16x32_bf16 v[164:167], a[248:251], v[88:91], v[164:167]
    ds_read_b64_tr_b16 a[242:243], v218 offset:18432
    v_cvt_pk_bf16_f32 v120, v120, v121
    v_mfma_f32_16x16x32_bf16 v[164:167], a[252:255], v[12:15], v[164:167]
    global_load_dword v252, v[250:251], off
    v_add_f32 v200, v200, v121
    v_mfma_f32_16x16x32_bf16 v[168:171], a[248:251], v[96:99], v[168:171]
    ds_read_b64_tr_b16 a[244:245], v219 offset:12288
    v_cvt_pk_bf16_f32 v121, v122, v123
    v_mfma_f32_16x16x32_bf16 v[168:171], a[252:255], v[20:23], v[168:171]
    v_exp_f32 v124, v124
    v_mfma_f32_16x16x32_bf16 v[172:175], a[248:251], v[104:107], v[172:175]
    ds_read_b64_tr_b16 a[246:247], v219 offset:18432
    v_add_f32 v200, v200, v122
    v_mfma_f32_16x16x32_bf16 v[172:175], a[252:255], v[28:31], v[172:175]
    v_exp_f32 v125, v125
    v_mfma_f32_16x16x32_bf16 v[176:179], a[248:251], v[112:115], v[176:179]
    v_exp_f32 v126, v126
    v_mfma_f32_16x16x32_bf16 v[176:179], a[252:255], v[36:39], v[176:179]
    v_add_f32 v200, v200, v123
    v_mfma_f32_16x16x32_bf16 v[160:163], v[208:211], v[44:47], v[160:163]
    ds_read_b64_tr_b16 a[248:249], v220 offset:12288
    v_mfma_f32_16x16x32_bf16 v[160:163], v[212:215], v[84:87], v[160:163]
    v_exp_f32 v127, v127
    v_mfma_f32_16x16x32_bf16 v[164:167], v[208:211], v[52:55], v[164:167]
    ds_read_b64_tr_b16 a[250:251], v220 offset:18432
    v_add_f32 v201, v201, v124
    v_mfma_f32_16x16x32_bf16 v[164:167], v[212:215], v[92:95], v[164:167]
    v_exp_f32 v128, v128
    v_mfma_f32_16x16x32_bf16 v[168:171], v[208:211], v[60:63], v[168:171]
    ds_read_b64_tr_b16 a[252:253], v221 offset:12288
    v_cvt_pk_bf16_f32 v124, v124, v125
    v_mfma_f32_16x16x32_bf16 v[168:171], v[212:215], v[100:103], v[168:171]
    v_exp_f32 v129, v129
    v_mfma_f32_16x16x32_bf16 v[172:175], v[208:211], v[68:71], v[172:175]
    ds_read_b64_tr_b16 a[254:255], v221 offset:18432
    v_add_f32 v201, v201, v125
    v_mfma_f32_16x16x32_bf16 v[172:175], v[212:215], v[108:111], v[172:175]
    v_exp_f32 v130, v130
    v_mfma_f32_16x16x32_bf16 v[176:179], v[208:211], v[76:79], v[176:179]
    v_exp_f32 v131, v131
    v_mfma_f32_16x16x32_bf16 v[176:179], v[212:215], v[116:119], v[176:179]
    v_cvt_pk_bf16_f32 v125, v126, v127
    s_waitcnt lgkmcnt(4)
    v_mfma_f32_16x16x32_bf16 a[0:3], a[240:243], v[140:143], a[0:3]
    ds_read_b64_tr_b16 v[208:209], v218 offset:12416
    v_add_f32 v201, v201, v126
    v_mfma_f32_16x16x32_bf16 a[4:7], a[240:243], v[144:147], a[4:7]
    v_exp_f32 v132, v132
    v_mfma_f32_16x16x32_bf16 a[8:11], a[240:243], v[148:151], a[8:11]
    ds_read_b64_tr_b16 v[210:211], v218 offset:18560
    v_add_f32 v201, v201, v127
    v_mfma_f32_16x16x32_bf16 a[12:15], a[240:243], v[152:155], a[12:15]
    v_exp_f32 v133, v133
    v_mfma_f32_16x16x32_bf16 a[16:19], a[240:243], v[156:159], a[16:19]
    ds_read_b64_tr_b16 v[212:213], v219 offset:12416
    v_add_f32 v202, v202, v128
    v_mfma_f32_16x16x32_bf16 a[20:23], a[244:247], v[140:143], a[20:23]
    v_exp_f32 v134, v134
    v_mfma_f32_16x16x32_bf16 a[24:27], a[244:247], v[144:147], a[24:27]
    ds_read_b64_tr_b16 v[214:215], v219 offset:18560
    v_cvt_pk_bf16_f32 v128, v128, v129
    v_mfma_f32_16x16x32_bf16 a[28:31], a[244:247], v[148:151], a[28:31]
    v_exp_f32 v135, v135
    v_mfma_f32_16x16x32_bf16 a[32:35], a[244:247], v[152:155], a[32:35]
    v_add_f32 v202, v202, v129
    v_cvt_pk_bf16_f32 v129, v130, v131
    v_mfma_f32_16x16x32_bf16 a[36:39], a[244:247], v[156:159], a[36:39]
    v_add_f32 v202, v202, v130
    s_waitcnt lgkmcnt(4)
    v_mfma_f32_16x16x32_bf16 a[40:43], a[248:251], v[140:143], a[40:43]
    ds_read_b64_tr_b16 a[240:241], v220 offset:12416
    v_add_f32 v202, v202, v131
    v_mfma_f32_16x16x32_bf16 a[44:47], a[248:251], v[144:147], a[44:47]
    v_exp_f32 v136, v136
    v_mfma_f32_16x16x32_bf16 a[48:51], a[248:251], v[148:151], a[48:51]
    ds_read_b64_tr_b16 a[242:243], v220 offset:18560
    v_add_f32 v203, v203, v132
    v_mfma_f32_16x16x32_bf16 a[52:55], a[248:251], v[152:155], a[52:55]
    v_exp_f32 v137, v137
    v_mfma_f32_16x16x32_bf16 a[56:59], a[248:251], v[156:159], a[56:59]
    ds_read_b64_tr_b16 a[244:245], v221 offset:12416
    v_cvt_pk_bf16_f32 v132, v132, v133
    v_mfma_f32_16x16x32_bf16 a[60:63], a[252:255], v[140:143], a[60:63]
    v_exp_f32 v138, v138
    v_mfma_f32_16x16x32_bf16 a[64:67], a[252:255], v[144:147], a[64:67]
    ds_read_b64_tr_b16 a[246:247], v221 offset:18560
    v_add_f32 v203, v203, v133
    v_mfma_f32_16x16x32_bf16 a[68:71], a[252:255], v[148:151], a[68:71]
    v_exp_f32 v139, v139
    v_mfma_f32_16x16x32_bf16 a[72:75], a[252:255], v[152:155], a[72:75]
    v_cvt_pk_bf16_f32 v133, v134, v135
    v_add_f32 v203, v203, v134
    v_mfma_f32_16x16x32_bf16 a[76:79], a[252:255], v[156:159], a[76:79]
    v_add_f32 v203, v203, v135
    s_waitcnt lgkmcnt(4)
    v_mfma_f32_16x16x32_bf16 a[80:83], v[208:211], v[140:143], a[80:83]
    ds_read_b64_tr_b16 a[248:249], v218 offset:12544
    v_add_f32 v204, v204, v136
    v_mfma_f32_16x16x32_bf16 a[84:87], v[208:211], v[144:147], a[84:87]
    v_exp_f32 v160, v160
    v_mfma_f32_16x16x32_bf16 a[88:91], v[208:211], v[148:151], a[88:91]
    ds_read_b64_tr_b16 a[250:251], v218 offset:18688
    v_cvt_pk_bf16_f32 v136, v136, v137
    v_mfma_f32_16x16x32_bf16 a[92:95], v[208:211], v[152:155], a[92:95]
    v_exp_f32 v161, v161
    v_mfma_f32_16x16x32_bf16 a[96:99], v[208:211], v[156:159], a[96:99]
    ds_read_b64_tr_b16 a[252:253], v219 offset:12544
    v_add_f32 v204, v204, v137
    v_mfma_f32_16x16x32_bf16 a[100:103], v[212:215], v[140:143], a[100:103]
    v_exp_f32 v162, v162
    v_mfma_f32_16x16x32_bf16 a[104:107], v[212:215], v[144:147], a[104:107]
    ds_read_b64_tr_b16 a[254:255], v219 offset:18688
    v_cvt_pk_bf16_f32 v137, v138, v139
    v_mfma_f32_16x16x32_bf16 a[108:111], v[212:215], v[148:151], a[108:111]
    v_exp_f32 v163, v163
    v_mfma_f32_16x16x32_bf16 a[112:115], v[212:215], v[152:155], a[112:115]
    v_add_f32 v204, v204, v138
    v_add_f32 v204, v204, v139
    v_mfma_f32_16x16x32_bf16 a[116:119], v[212:215], v[156:159], a[116:119]
    v_add_f32 v200, v200, v160
    s_waitcnt lgkmcnt(4)
    v_mfma_f32_16x16x32_bf16 a[120:123], a[240:243], v[140:143], a[120:123]
    ds_read_b64_tr_b16 v[208:209], v220 offset:12544
    v_cvt_pk_bf16_f32 v122, v160, v161
    v_mfma_f32_16x16x32_bf16 a[124:127], a[240:243], v[144:147], a[124:127]
    ds_read_b64_tr_b16 v[210:211], v220 offset:18688
    v_add_f32 v200, v200, v161
    v_mfma_f32_16x16x32_bf16 a[128:131], a[240:243], v[148:151], a[128:131]
    ds_read_b64_tr_b16 v[212:213], v221 offset:12544
    v_cvt_pk_bf16_f32 v123, v162, v163
    v_mfma_f32_16x16x32_bf16 a[132:135], a[240:243], v[152:155], a[132:135]
    ds_read_b64_tr_b16 v[214:215], v221 offset:18688
    v_add_f32 v200, v200, v162
    v_mfma_f32_16x16x32_bf16 a[136:139], a[240:243], v[156:159], a[136:139]
    v_exp_f32 v164, v164
    v_mfma_f32_16x16x32_bf16 a[140:143], a[244:247], v[140:143], a[140:143]
    v_exp_f32 v165, v165
    v_mfma_f32_16x16x32_bf16 a[144:147], a[244:247], v[144:147], a[144:147]
    v_exp_f32 v166, v166
    v_mfma_f32_16x16x32_bf16 a[148:151], a[244:247], v[148:151], a[148:151]
    v_exp_f32 v167, v167
    v_mfma_f32_16x16x32_bf16 a[152:155], a[244:247], v[152:155], a[152:155]
    v_exp_f32 v168, v168
    v_mfma_f32_16x16x32_bf16 a[156:159], a[244:247], v[156:159], a[156:159]
    s_waitcnt vmcnt(19) lgkmcnt(0)
    s_barrier
    v_mfma_f32_16x16x32_bf16 a[160:163], a[248:251], v[140:143], a[160:163]
    ds_read_b128 a[240:243], v216 offset:0
    s_add_u32 s58, s71, s67
    v_mfma_f32_16x16x32_bf16 a[164:167], a[248:251], v[144:147], a[164:167]
    s_add_u32 m0, s8, 53248
    v_add_f32 v200, v200, v163
    v_mfma_f32_16x16x32_bf16 a[168:171], a[248:251], v[148:151], a[168:171]
    ds_read_b128 a[244:247], v217 offset:0
    v_add_f32 v201, v201, v164
    v_mfma_f32_16x16x32_bf16 a[172:175], a[248:251], v[152:155], a[172:175]
    buffer_load_dwordx4 v227, s[36:39], s58 offen offset:0 lds
    v_cvt_pk_bf16_f32 v126, v164, v165
    v_mfma_f32_16x16x32_bf16 a[176:179], a[248:251], v[156:159], a[176:179]
    v_exp_f32 v169, v169
    v_mfma_f32_16x16x32_bf16 a[180:183], a[252:255], v[140:143], a[180:183]
    v_exp_f32 v170, v170
    v_mfma_f32_16x16x32_bf16 a[184:187], a[252:255], v[144:147], a[184:187]
    v_exp_f32 v171, v171
    v_mfma_f32_16x16x32_bf16 a[188:191], a[252:255], v[148:151], a[188:191]
    v_add_f32 v201, v201, v165
    v_cvt_pk_bf16_f32 v127, v166, v167
    v_mfma_f32_16x16x32_bf16 a[192:195], a[252:255], v[152:155], a[192:195]
    v_add_f32 v201, v201, v166
    v_add_f32 v201, v201, v167
    v_mfma_f32_16x16x32_bf16 a[196:199], a[252:255], v[156:159], a[196:199]
    v_add_f32 v202, v202, v168
    v_mfma_f32_16x16x32_bf16 a[200:203], v[208:211], v[140:143], a[200:203]
    ds_read_b128 a[248:251], v216 offset:128
    v_cvt_pk_bf16_f32 v130, v168, v169
    v_mfma_f32_16x16x32_bf16 a[204:207], v[208:211], v[144:147], a[204:207]
    v_add_f32 v202, v202, v169
    v_cvt_pk_bf16_f32 v131, v170, v171
    v_mfma_f32_16x16x32_bf16 a[208:211], v[208:211], v[148:151], a[208:211]
    ds_read_b128 a[252:255], v217 offset:128
    v_add_f32 v202, v202, v170
    v_mfma_f32_16x16x32_bf16 a[212:215], v[208:211], v[152:155], a[212:215]
    v_add_f32 v202, v202, v171
    v_mfma_f32_16x16x32_bf16 a[216:219], v[208:211], v[156:159], a[216:219]
    v_mfma_f32_16x16x32_bf16 a[220:223], v[212:215], v[140:143], a[220:223]
    buffer_load_dwordx4 v228, s[36:39], s58 offen offset:1024 lds
    v_mfma_f32_16x16x32_bf16 a[224:227], v[212:215], v[144:147], a[224:227]
    v_mfma_f32_16x16x32_bf16 a[228:231], v[212:215], v[148:151], a[228:231]
    v_mfma_f32_16x16x32_bf16 a[232:235], v[212:215], v[152:155], a[232:235]
    v_mfma_f32_16x16x32_bf16 a[236:239], v[212:215], v[156:159], a[236:239]
    s_waitcnt lgkmcnt(2)
    v_mfma_f32_16x16x32_bf16 v[140:143], a[240:243], v[0:3], v[180:183]
    ds_read_b128 v[208:211], v216 offset:256
    v_mfma_f32_16x16x32_bf16 v[140:143], a[244:247], v[40:43], v[140:143]
    v_exp_f32 v172, v172
    v_mfma_f32_16x16x32_bf16 v[144:147], a[240:243], v[8:11], v[184:187]
    ds_read_b128 v[212:215], v217 offset:256
    v_mfma_f32_16x16x32_bf16 v[144:147], a[244:247], v[48:51], v[144:147]
    v_exp_f32 v173, v173
    v_mfma_f32_16x16x32_bf16 v[148:151], a[240:243], v[16:19], v[188:191]
    v_exp_f32 v174, v174
    v_mfma_f32_16x16x32_bf16 v[148:151], a[244:247], v[56:59], v[148:151]
    v_exp_f32 v175, v175
    v_mfma_f32_16x16x32_bf16 v[152:155], a[240:243], v[24:27], v[192:195]
    v_exp_f32 v176, v176
    v_mfma_f32_16x16x32_bf16 v[152:155], a[244:247], v[64:67], v[152:155]
    buffer_load_dwordx4 v229, s[36:39], s58 offen offset:2048 lds
    v_add_f32 v203, v203, v172
    v_mfma_f32_16x16x32_bf16 v[156:159], a[240:243], v[32:35], v[196:199]
    s_add_u32 s67, s67, 393216
    s_cmp_ge_u32 s67, 7864320
    s_cselect_b32 s67, 0, s67
    v_mfma_f32_16x16x32_bf16 v[156:159], a[244:247], v[72:75], v[156:159]
    v_cvt_pk_bf16_f32 v134, v172, v173
    s_waitcnt lgkmcnt(2)
    v_mfma_f32_16x16x32_bf16 v[140:143], a[248:251], v[80:83], v[140:143]
    ds_read_b128 a[240:243], v216 offset:6144
    v_add_f32 v203, v203, v173
    v_mfma_f32_16x16x32_bf16 v[140:143], a[252:255], v[4:7], v[140:143]
    v_exp_f32 v177, v177
    v_mfma_f32_16x16x32_bf16 v[144:147], a[248:251], v[88:91], v[144:147]
    ds_read_b128 a[244:247], v217 offset:6144
    v_cvt_pk_bf16_f32 v135, v174, v175
    v_mfma_f32_16x16x32_bf16 v[144:147], a[252:255], v[12:15], v[144:147]
    v_exp_f32 v178, v178
    v_mfma_f32_16x16x32_bf16 v[148:151], a[248:251], v[96:99], v[148:151]
    v_exp_f32 v179, v179
    v_mfma_f32_16x16x32_bf16 v[148:151], a[252:255], v[20:23], v[148:151]
    v_add_f32 v203, v203, v174
    v_add_f32 v203, v203, v175
    v_mfma_f32_16x16x32_bf16 v[152:155], a[248:251], v[104:107], v[152:155]
    v_add_f32 v204, v204, v176
    v_cvt_pk_bf16_f32 v138, v176, v177
    v_mfma_f32_16x16x32_bf16 v[152:155], a[252:255], v[28:31], v[152:155]
    v_add_f32 v204, v204, v177
    v_cvt_pk_bf16_f32 v139, v178, v179
    v_mfma_f32_16x16x32_bf16 v[156:159], a[248:251], v[112:115], v[156:159]
    v_add_f32 v204, v204, v178
    v_add_f32 v204, v204, v179
    v_mfma_f32_16x16x32_bf16 v[156:159], a[252:255], v[36:39], v[156:159]
    s_waitcnt lgkmcnt(2)
    v_mfma_f32_16x16x32_bf16 v[140:143], v[208:211], v[44:47], v[140:143]
    ds_read_b128 a[248:251], v216 offset:6272
    v_mfma_f32_16x16x32_bf16 v[140:143], v[212:215], v[84:87], v[140:143]
    v_mfma_f32_16x16x32_bf16 v[144:147], v[208:211], v[52:55], v[144:147]
    ds_read_b128 a[252:255], v217 offset:6272
    v_mfma_f32_16x16x32_bf16 v[144:147], v[212:215], v[92:95], v[144:147]
    v_mfma_f32_16x16x32_bf16 v[148:151], v[208:211], v[60:63], v[148:151]
    v_mfma_f32_16x16x32_bf16 v[148:151], v[212:215], v[100:103], v[148:151]
    v_mfma_f32_16x16x32_bf16 v[152:155], v[208:211], v[68:71], v[152:155]
    v_mfma_f32_16x16x32_bf16 v[152:155], v[212:215], v[108:111], v[152:155]
    v_mfma_f32_16x16x32_bf16 v[156:159], v[208:211], v[76:79], v[156:159]
    v_mfma_f32_16x16x32_bf16 v[156:159], v[212:215], v[116:119], v[156:159]
    s_waitcnt lgkmcnt(2)
    v_mfma_f32_16x16x32_bf16 v[160:163], a[240:243], v[0:3], v[180:183]
    ds_read_b128 v[208:211], v216 offset:6400
    v_mfma_f32_16x16x32_bf16 v[160:163], a[244:247], v[40:43], v[160:163]
    ds_read_b128 v[212:215], v217 offset:6400
    v_mfma_f32_16x16x32_bf16 v[164:167], a[240:243], v[8:11], v[184:187]
    v_mfma_f32_16x16x32_bf16 v[164:167], a[244:247], v[48:51], v[164:167]
    v_mfma_f32_16x16x32_bf16 v[168:171], a[240:243], v[16:19], v[188:191]
    v_mfma_f32_16x16x32_bf16 v[168:171], a[244:247], v[56:59], v[168:171]
    v_exp_f32 v140, v140
    v_mfma_f32_16x16x32_bf16 v[172:175], a[240:243], v[24:27], v[192:195]
    v_exp_f32 v141, v141
    v_mfma_f32_16x16x32_bf16 v[172:175], a[244:247], v[64:67], v[172:175]
    v_exp_f32 v142, v142
    v_mfma_f32_16x16x32_bf16 v[176:179], a[240:243], v[32:35], v[196:199]
    v_exp_f32 v143, v143
    v_mfma_f32_16x16x32_bf16 v[176:179], a[244:247], v[72:75], v[176:179]
    s_waitcnt vmcnt(10) lgkmcnt(0)
    s_barrier
    v_mfma_f32_16x16x32_bf16 v[160:163], a[248:251], v[80:83], v[160:163]
    ds_read_b64_tr_b16 a[240:241], v218 offset:24576
    v_mov_b32 v254, 0
    v_mfma_f32_16x16x32_bf16 v[160:163], a[252:255], v[4:7], v[160:163]
    buffer_load_dword v253, v254, s[84:87], 0 offen sc1
    v_add_f32 v200, v200, v140
    v_mfma_f32_16x16x32_bf16 v[164:167], a[248:251], v[88:91], v[164:167]
    ds_read_b64_tr_b16 a[242:243], v218 offset:30720
    v_cvt_pk_bf16_f32 v140, v140, v141
    v_mfma_f32_16x16x32_bf16 v[164:167], a[252:255], v[12:15], v[164:167]
    v_exp_f32 v144, v144
    v_mfma_f32_16x16x32_bf16 v[168:171], a[248:251], v[96:99], v[168:171]
    ds_read_b64_tr_b16 a[244:245], v219 offset:24576
    v_add_f32 v200, v200, v141
    v_mfma_f32_16x16x32_bf16 v[168:171], a[252:255], v[20:23], v[168:171]
    v_exp_f32 v145, v145
    v_mfma_f32_16x16x32_bf16 v[172:175], a[248:251], v[104:107], v[172:175]
    ds_read_b64_tr_b16 a[246:247], v219 offset:30720
    v_cvt_pk_bf16_f32 v141, v142, v143
    v_mfma_f32_16x16x32_bf16 v[172:175], a[252:255], v[28:31], v[172:175]
    v_exp_f32 v146, v146
    v_mfma_f32_16x16x32_bf16 v[176:179], a[248:251], v[112:115], v[176:179]
    v_exp_f32 v147, v147
    v_mfma_f32_16x16x32_bf16 v[176:179], a[252:255], v[36:39], v[176:179]
    v_add_f32 v200, v200, v142
    v_mfma_f32_16x16x32_bf16 v[160:163], v[208:211], v[44:47], v[160:163]
    ds_read_b64_tr_b16 a[248:249], v220 offset:24576
    v_add_f32 v200, v200, v143
    v_mfma_f32_16x16x32_bf16 v[160:163], v[212:215], v[84:87], v[160:163]
    v_exp_f32 v148, v148
    v_mfma_f32_16x16x32_bf16 v[164:167], v[208:211], v[52:55], v[164:167]
    ds_read_b64_tr_b16 a[250:251], v220 offset:30720
    v_add_f32 v201, v201, v144
    v_mfma_f32_16x16x32_bf16 v[164:167], v[212:215], v[92:95], v[164:167]
    buffer_load_dword v255, v254, s[48:51], s25 offen sc1
    s_add_u32 s59, s74, s68
    v_mfma_f32_16x16x32_bf16 v[168:171], v[208:211], v[60:63], v[168:171]
    ds_read_b64_tr_b16 a[252:253], v221 offset:24576
    s_add_u32 m0, s70, 0
    v_mfma_f32_16x16x32_bf16 v[168:171], v[212:215], v[100:103], v[168:171]
    v_exp_f32 v149, v149
    v_mfma_f32_16x16x32_bf16 v[172:175], v[208:211], v[68:71], v[172:175]
    ds_read_b64_tr_b16 a[254:255], v221 offset:30720
    v_cvt_pk_bf16_f32 v144, v144, v145
    v_mfma_f32_16x16x32_bf16 v[172:175], v[212:215], v[108:111], v[172:175]
    v_exp_f32 v150, v150
    v_mfma_f32_16x16x32_bf16 v[176:179], v[208:211], v[76:79], v[176:179]
    v_exp_f32 v151, v151
    v_mfma_f32_16x16x32_bf16 v[176:179], v[212:215], v[116:119], v[176:179]
    v_add_f32 v201, v201, v145
    s_waitcnt lgkmcnt(4)
    v_mfma_f32_16x16x32_bf16 a[0:3], a[240:243], v[120:123], a[0:3]
    ds_read_b64_tr_b16 v[208:209], v218 offset:24704
    v_cvt_pk_bf16_f32 v145, v146, v147
    v_mfma_f32_16x16x32_bf16 a[4:7], a[240:243], v[124:127], a[4:7]
    v_add_f32 v201, v201, v146
    v_add_f32 v201, v201, v147
    v_mfma_f32_16x16x32_bf16 a[8:11], a[240:243], v[128:131], a[8:11]
    ds_read_b64_tr_b16 v[210:211], v218 offset:30848
    v_add_f32 v202, v202, v148
    v_mfma_f32_16x16x32_bf16 a[12:15], a[240:243], v[132:135], a[12:15]
    v_exp_f32 v152, v152
    v_mfma_f32_16x16x32_bf16 a[16:19], a[240:243], v[136:139], a[16:19]
    ds_read_b64_tr_b16 v[212:213], v219 offset:24704
    v_cvt_pk_bf16_f32 v148, v148, v149
    v_mfma_f32_16x16x32_bf16 a[20:23], a[244:247], v[120:123], a[20:23]
    buffer_load_dwordx4 v230, s[32:35], s59 offen offset:0 lds
    v_add_f32 v202, v202, v149
    v_mfma_f32_16x16x32_bf16 a[24:27], a[244:247], v[124:127], a[24:27]
    ds_read_b64_tr_b16 v[214:215], v219 offset:30848
    v_cvt_pk_bf16_f32 v149, v150, v151
    v_mfma_f32_16x16x32_bf16 a[28:31], a[244:247], v[128:131], a[28:31]
    v_exp_f32 v153, v153
    v_mfma_f32_16x16x32_bf16 a[32:35], a[244:247], v[132:135], a[32:35]
    v_exp_f32 v154, v154
    v_mfma_f32_16x16x32_bf16 a[36:39], a[244:247], v[136:139], a[36:39]
    v_add_f32 v202, v202, v150
    s_waitcnt lgkmcnt(4)
    v_mfma_f32_16x16x32_bf16 a[40:43], a[248:251], v[120:123], a[40:43]
    ds_read_b64_tr_b16 a[240:241], v220 offset:24704
    v_add_f32 v202, v202, v151
    v_mfma_f32_16x16x32_bf16 a[44:47], a[248:251], v[124:127], a[44:47]
    v_exp_f32 v155, v155
    v_mfma_f32_16x16x32_bf16 a[48:51], a[248:251], v[128:131], a[48:51]
    ds_read_b64_tr_b16 a[242:243], v220 offset:30848
    v_add_f32 v203, v203, v152
    v_mfma_f32_16x16x32_bf16 a[52:55], a[248:251], v[132:135], a[52:55]
    v_exp_f32 v156, v156
    v_mfma_f32_16x16x32_bf16 a[56:59], a[248:251], v[136:139], a[56:59]
    ds_read_b64_tr_b16 a[244:245], v221 offset:24704
    v_cvt_pk_bf16_f32 v152, v152, v153
    v_mfma_f32_16x16x32_bf16 a[60:63], a[252:255], v[120:123], a[60:63]
    v_exp_f32 v157, v157
    v_mfma_f32_16x16x32_bf16 a[64:67], a[252:255], v[124:127], a[64:67]
    ds_read_b64_tr_b16 a[246:247], v221 offset:30848
    v_add_f32 v203, v203, v153
    v_mfma_f32_16x16x32_bf16 a[68:71], a[252:255], v[128:131], a[68:71]
    buffer_load_dwordx4 v231, s[32:35], s59 offen offset:1024 lds
    v_cvt_pk_bf16_f32 v153, v154, v155
    v_mfma_f32_16x16x32_bf16 a[72:75], a[252:255], v[132:135], a[72:75]
    v_exp_f32 v158, v158
    v_mfma_f32_16x16x32_bf16 a[76:79], a[252:255], v[136:139], a[76:79]
    v_add_f32 v203, v203, v154
    s_waitcnt lgkmcnt(4)
    v_mfma_f32_16x16x32_bf16 a[80:83], v[208:211], v[120:123], a[80:83]
    ds_read_b64_tr_b16 a[248:249], v218 offset:24832
    v_add_f32 v203, v203, v155
    v_mfma_f32_16x16x32_bf16 a[84:87], v[208:211], v[124:127], a[84:87]
    v_exp_f32 v159, v159
    v_mfma_f32_16x16x32_bf16 a[88:91], v[208:211], v[128:131], a[88:91]
    ds_read_b64_tr_b16 a[250:251], v218 offset:30976
    v_add_f32 v204, v204, v156
    v_mfma_f32_16x16x32_bf16 a[92:95], v[208:211], v[132:135], a[92:95]
    v_exp_f32 v160, v160
    v_mfma_f32_16x16x32_bf16 a[96:99], v[208:211], v[136:139], a[96:99]
    ds_read_b64_tr_b16 a[252:253], v219 offset:24832
    v_cvt_pk_bf16_f32 v156, v156, v157
    v_mfma_f32_16x16x32_bf16 a[100:103], v[212:215], v[120:123], a[100:103]
    v_exp_f32 v161, v161
    v_mfma_f32_16x16x32_bf16 a[104:107], v[212:215], v[124:127], a[104:107]
    ds_read_b64_tr_b16 a[254:255], v219 offset:30976
    v_add_f32 v204, v204, v157
    v_mfma_f32_16x16x32_bf16 a[108:111], v[212:215], v[128:131], a[108:111]
    v_exp_f32 v162, v162
    v_mfma_f32_16x16x32_bf16 a[112:115], v[212:215], v[132:135], a[112:115]
    v_exp_f32 v163, v163
    v_mfma_f32_16x16x32_bf16 a[116:119], v[212:215], v[136:139], a[116:119]
    buffer_load_dwordx4 v232, s[32:35], s59 offen offset:2048 lds
    s_waitcnt lgkmcnt(4)
    v_mfma_f32_16x16x32_bf16 a[120:123], a[240:243], v[120:123], a[120:123]
    ds_read_b64_tr_b16 v[208:209], v220 offset:24832
    v_cvt_pk_bf16_f32 v157, v158, v159
    v_mfma_f32_16x16x32_bf16 a[124:127], a[240:243], v[124:127], a[124:127]
    ds_read_b64_tr_b16 v[210:211], v220 offset:30976
    v_add_f32 v204, v204, v158
    v_mfma_f32_16x16x32_bf16 a[128:131], a[240:243], v[128:131], a[128:131]
    ds_read_b64_tr_b16 v[212:213], v221 offset:24832
    v_add_f32 v204, v204, v159
    v_mfma_f32_16x16x32_bf16 a[132:135], a[240:243], v[132:135], a[132:135]
    ds_read_b64_tr_b16 v[214:215], v221 offset:30976
    v_add_f32 v200, v200, v160
    v_mfma_f32_16x16x32_bf16 a[136:139], a[240:243], v[136:139], a[136:139]
    v_exp_f32 v164, v164
    v_mfma_f32_16x16x32_bf16 a[140:143], a[244:247], v[120:123], a[140:143]
    v_exp_f32 v165, v165
    v_mfma_f32_16x16x32_bf16 a[144:147], a[244:247], v[124:127], a[144:147]
    v_exp_f32 v166, v166
    v_mfma_f32_16x16x32_bf16 a[148:151], a[244:247], v[128:131], a[148:151]
    v_exp_f32 v167, v167
    v_mfma_f32_16x16x32_bf16 a[152:155], a[244:247], v[132:135], a[152:155]
    v_cvt_pk_bf16_f32 v142, v160, v161
    v_add_f32 v200, v200, v161
    v_mfma_f32_16x16x32_bf16 a[156:159], a[244:247], v[136:139], a[156:159]
    buffer_load_dwordx4 v233, s[32:35], s59 offen offset:3072 lds
    s_add_u32 s59, s59, 40960
    s_waitcnt vmcnt(10) lgkmcnt(0)
    s_barrier
    v_mfma_f32_16x16x32_bf16 a[160:163], a[248:251], v[120:123], a[160:163]
    ds_read_b64_tr_b16 a[240:241], v218 offset:0
    s_add_u32 m0, s70, 4096
    v_mfma_f32_16x16x32_bf16 a[164:167], a[248:251], v[124:127], a[164:167]
    buffer_load_dwordx4 v230, s[32:35], s59 offen offset:0 lds
    v_cvt_pk_bf16_f32 v143, v162, v163
    v_mfma_f32_16x16x32_bf16 a[168:171], a[248:251], v[128:131], a[168:171]
    ds_read_b64_tr_b16 a[242:243], v218 offset:6144
    v_add_f32 v200, v200, v162
    v_mfma_f32_16x16x32_bf16 a[172:175], a[248:251], v[132:135], a[172:175]
    v_exp_f32 v168, v168
    v_mfma_f32_16x16x32_bf16 a[176:179], a[248:251], v[136:139], a[176:179]
    ds_read_b64_tr_b16 a[244:245], v219 offset:0
    v_add_f32 v200, v200, v163
    v_mfma_f32_16x16x32_bf16 a[180:183], a[252:255], v[120:123], a[180:183]
    v_exp_f32 v169, v169
    v_mfma_f32_16x16x32_bf16 a[184:187], a[252:255], v[124:127], a[184:187]
    ds_read_b64_tr_b16 a[246:247], v219 offset:6144
    v_add_f32 v201, v201, v164
    v_mfma_f32_16x16x32_bf16 a[188:191], a[252:255], v[128:131], a[188:191]
    v_exp_f32 v170, v170
    v_mfma_f32_16x16x32_bf16 a[192:195], a[252:255], v[132:135], a[192:195]
    v_exp_f32 v171, v171
    v_mfma_f32_16x16x32_bf16 a[196:199], a[252:255], v[136:139], a[196:199]
    v_cvt_pk_bf16_f32 v146, v164, v165
    v_mfma_f32_16x16x32_bf16 a[200:203], v[208:211], v[120:123], a[200:203]
    ds_read_b64_tr_b16 a[248:249], v220 offset:0
    v_add_f32 v201, v201, v165
    v_mfma_f32_16x16x32_bf16 a[204:207], v[208:211], v[124:127], a[204:207]
    v_cvt_pk_bf16_f32 v147, v166, v167
    v_add_f32 v201, v201, v166
    v_mfma_f32_16x16x32_bf16 a[208:211], v[208:211], v[128:131], a[208:211]
    ds_read_b64_tr_b16 a[250:251], v220 offset:6144
    v_add_f32 v201, v201, v167
    v_mfma_f32_16x16x32_bf16 a[212:215], v[208:211], v[132:135], a[212:215]
    buffer_load_dwordx4 v231, s[32:35], s59 offen offset:1024 lds
    v_add_f32 v202, v202, v168
    v_mfma_f32_16x16x32_bf16 a[216:219], v[208:211], v[136:139], a[216:219]
    ds_read_b64_tr_b16 a[252:253], v221 offset:0
    v_cvt_pk_bf16_f32 v150, v168, v169
    v_mfma_f32_16x16x32_bf16 a[220:223], v[212:215], v[120:123], a[220:223]
    v_exp_f32 v172, v172
    v_mfma_f32_16x16x32_bf16 a[224:227], v[212:215], v[124:127], a[224:227]
    ds_read_b64_tr_b16 a[254:255], v221 offset:6144
    v_add_f32 v202, v202, v169
    v_mfma_f32_16x16x32_bf16 a[228:231], v[212:215], v[128:131], a[228:231]
    v_exp_f32 v173, v173
    v_mfma_f32_16x16x32_bf16 a[232:235], v[212:215], v[132:135], a[232:235]
    v_exp_f32 v174, v174
    v_mfma_f32_16x16x32_bf16 a[236:239], v[212:215], v[136:139], a[236:239]
    v_cvt_pk_bf16_f32 v151, v170, v171
    v_exp_f32 v175, v175
    v_exp_f32 v176, v176
    v_exp_f32 v177, v177
    v_exp_f32 v178, v178
    v_exp_f32 v179, v179
    v_add_f32 v202, v202, v170
    v_add_f32 v202, v202, v171
    v_add_f32 v203, v203, v172
    v_cvt_pk_bf16_f32 v154, v172, v173
    v_add_f32 v203, v203, v173
    v_cvt_pk_bf16_f32 v155, v174, v175
    v_add_f32 v203, v203, v174
    v_add_f32 v203, v203, v175
    v_add_f32 v204, v204, v176
    v_cvt_pk_bf16_f32 v158, v176, v177
    v_add_f32 v204, v204, v177
    v_cvt_pk_bf16_f32 v159, v178, v179
    v_add_f32 v204, v204, v178
    v_add_f32 v204, v204, v179
    s_waitcnt lgkmcnt(4)
    v_mfma_f32_16x16x32_bf16 a[0:3], a[240:243], v[140:143], a[0:3]
    ds_read_b64_tr_b16 v[208:209], v218 offset:128
    v_mov_b32 v245, v200
    v_mfma_f32_16x16x32_bf16 a[4:7], a[240:243], v[144:147], a[4:7]
    buffer_load_dwordx4 v232, s[32:35], s59 offen offset:2048 lds
    v_mov_b32 v246, v201
    v_mfma_f32_16x16x32_bf16 a[8:11], a[240:243], v[148:151], a[8:11]
    ds_read_b64_tr_b16 v[210:211], v218 offset:6272
    v_mov_b32 v247, v202
    v_mfma_f32_16x16x32_bf16 a[12:15], a[240:243], v[152:155], a[12:15]
    v_mov_b32 v248, v203
    v_mov_b32 v249, v204
    v_mfma_f32_16x16x32_bf16 a[16:19], a[240:243], v[156:159], a[16:19]
    ds_read_b64_tr_b16 v[212:213], v219 offset:128
    v_mfma_f32_16x16x32_bf16 a[20:23], a[244:247], v[140:143], a[20:23]
    buffer_load_dwordx4 v233, s[32:35], s59 offen offset:3072 lds
    s_add_u32 s59, s59, 40960
    v_mfma_f32_16x16x32_bf16 a[24:27], a[244:247], v[144:147], a[24:27]
    ds_read_b64_tr_b16 v[214:215], v219 offset:6272
    s_add_u32 m0, s70, 8192
    v_mfma_f32_16x16x32_bf16 a[28:31], a[244:247], v[148:151], a[28:31]
    v_permlane32_swap_b32 v200, v245
    v_mfma_f32_16x16x32_bf16 a[32:35], a[244:247], v[152:155], a[32:35]
    buffer_load_dwordx4 v230, s[32:35], s59 offen offset:0 lds
    v_mfma_f32_16x16x32_bf16 a[36:39], a[244:247], v[156:159], a[36:39]
    s_waitcnt lgkmcnt(4)
    v_mfma_f32_16x16x32_bf16 a[40:43], a[248:251], v[140:143], a[40:43]
    ds_read_b64_tr_b16 a[240:241], v220 offset:128
    v_mfma_f32_16x16x32_bf16 a[44:47], a[248:251], v[144:147], a[44:47]
    buffer_load_dwordx4 v231, s[32:35], s59 offen offset:1024 lds
    v_mfma_f32_16x16x32_bf16 a[48:51], a[248:251], v[148:151], a[48:51]
    ds_read_b64_tr_b16 a[242:243], v220 offset:6272
    v_mfma_f32_16x16x32_bf16 a[52:55], a[248:251], v[152:155], a[52:55]
    s_add_u32 s68, s68, 128
    s_cmp_ge_u32 s68, 1280
    s_cselect_b32 s68, 0, s68
    v_mfma_f32_16x16x32_bf16 a[56:59], a[248:251], v[156:159], a[56:59]
    ds_read_b64_tr_b16 a[244:245], v221 offset:128
    s_add_u32 s58, s71, s67
    v_mfma_f32_16x16x32_bf16 a[60:63], a[252:255], v[140:143], a[60:63]
    s_add_u32 m0, s8, 65536
    v_mfma_f32_16x16x32_bf16 a[64:67], a[252:255], v[144:147], a[64:67]
    ds_read_b64_tr_b16 a[246:247], v221 offset:6272
    v_mfma_f32_16x16x32_bf16 a[68:71], a[252:255], v[148:151], a[68:71]
    buffer_load_dwordx4 v227, s[36:39], s58 offen offset:0 lds
    v_mfma_f32_16x16x32_bf16 a[72:75], a[252:255], v[152:155], a[72:75]
    v_permlane32_swap_b32 v201, v246
    v_mfma_f32_16x16x32_bf16 a[76:79], a[252:255], v[156:159], a[76:79]
    s_waitcnt lgkmcnt(4)
    v_mfma_f32_16x16x32_bf16 a[80:83], v[208:211], v[140:143], a[80:83]
    ds_read_b64_tr_b16 a[248:249], v218 offset:256
    v_mfma_f32_16x16x32_bf16 a[84:87], v[208:211], v[144:147], a[84:87]
    buffer_load_dwordx4 v228, s[36:39], s58 offen offset:1024 lds
    v_mfma_f32_16x16x32_bf16 a[88:91], v[208:211], v[148:151], a[88:91]
    ds_read_b64_tr_b16 a[250:251], v218 offset:6400
    v_mfma_f32_16x16x32_bf16 a[92:95], v[208:211], v[152:155], a[92:95]
    v_permlane32_swap_b32 v202, v247
    v_mfma_f32_16x16x32_bf16 a[96:99], v[208:211], v[156:159], a[96:99]
    ds_read_b64_tr_b16 a[252:253], v219 offset:256
    v_mfma_f32_16x16x32_bf16 a[100:103], v[212:215], v[140:143], a[100:103]
    buffer_load_dwordx4 v229, s[36:39], s58 offen offset:2048 lds
    v_mfma_f32_16x16x32_bf16 a[104:107], v[212:215], v[144:147], a[104:107]
    ds_read_b64_tr_b16 a[254:255], v219 offset:6400
    v_mfma_f32_16x16x32_bf16 a[108:111], v[212:215], v[148:151], a[108:111]
    s_add_u32 s67, s67, 393216
    s_cmp_ge_u32 s67, 7864320
    s_cselect_b32 s67, 0, s67
    v_mfma_f32_16x16x32_bf16 a[112:115], v[212:215], v[152:155], a[112:115]
    v_permlane32_swap_b32 v203, v248
    v_mfma_f32_16x16x32_bf16 a[116:119], v[212:215], v[156:159], a[116:119]
    s_waitcnt lgkmcnt(4)
    v_mfma_f32_16x16x32_bf16 a[120:123], a[240:243], v[140:143], a[120:123]
    ds_read_b64_tr_b16 v[208:209], v220 offset:256
    v_mfma_f32_16x16x32_bf16 a[124:127], a[240:243], v[144:147], a[124:127]
    v_permlane32_swap_b32 v204, v249
    v_mfma_f32_16x16x32_bf16 a[128:131], a[240:243], v[148:151], a[128:131]
    ds_read_b64_tr_b16 v[210:211], v220 offset:6400
    v_add_f32 v200, v200, v245
    v_mfma_f32_16x16x32_bf16 a[132:135], a[240:243], v[152:155], a[132:135]
    v_add_f32 v201, v201, v246
    v_add_f32 v202, v202, v247
    v_mfma_f32_16x16x32_bf16 a[136:139], a[240:243], v[156:159], a[136:139]
    ds_read_b64_tr_b16 v[212:213], v221 offset:256
    v_add_f32 v203, v203, v248
    v_mfma_f32_16x16x32_bf16 a[140:143], a[244:247], v[140:143], a[140:143]
    v_add_f32 v204, v204, v249
    v_mov_b32 v245, v200
    v_mfma_f32_16x16x32_bf16 a[144:147], a[244:247], v[144:147], a[144:147]
    ds_read_b64_tr_b16 v[214:215], v221 offset:6400
    v_mov_b32 v246, v201
    v_mfma_f32_16x16x32_bf16 a[148:151], a[244:247], v[148:151], a[148:151]
    v_mov_b32 v247, v202
    v_mov_b32 v248, v203
    v_mfma_f32_16x16x32_bf16 a[152:155], a[244:247], v[152:155], a[152:155]
    v_mov_b32 v249, v204
    v_mfma_f32_16x16x32_bf16 a[156:159], a[244:247], v[156:159], a[156:159]
    s_waitcnt lgkmcnt(4)
    v_mfma_f32_16x16x32_bf16 a[160:163], a[248:251], v[140:143], a[160:163]
    v_permlane16_swap_b32 v200, v245
    v_mfma_f32_16x16x32_bf16 a[164:167], a[248:251], v[144:147], a[164:167]
    v_permlane16_swap_b32 v201, v246
    v_mfma_f32_16x16x32_bf16 a[168:171], a[248:251], v[148:151], a[168:171]
    v_permlane16_swap_b32 v202, v247
    v_mfma_f32_16x16x32_bf16 a[172:175], a[248:251], v[152:155], a[172:175]
    v_permlane16_swap_b32 v203, v248
    v_mfma_f32_16x16x32_bf16 a[176:179], a[248:251], v[156:159], a[176:179]
    v_permlane16_swap_b32 v204, v249
    v_mfma_f32_16x16x32_bf16 a[180:183], a[252:255], v[140:143], a[180:183]
    v_add_f32 v200, v200, v245
    v_add_f32 v201, v201, v246
    v_mfma_f32_16x16x32_bf16 a[184:187], a[252:255], v[144:147], a[184:187]
    v_add_f32 v202, v202, v247
    v_add_f32 v203, v203, v248
    v_mfma_f32_16x16x32_bf16 a[188:191], a[252:255], v[148:151], a[188:191]
    v_add_f32 v204, v204, v249
    s_mov_b64 s[82:83], 0
    v_mfma_f32_16x16x32_bf16 a[192:195], a[252:255], v[152:155], a[192:195]
    v_cmp_nle_f32 s[78:79], v200, s76
    v_mfma_f32_16x16x32_bf16 a[196:199], a[252:255], v[156:159], a[196:199]
    s_waitcnt lgkmcnt(0)
    v_mfma_f32_16x16x32_bf16 a[200:203], v[208:211], v[140:143], a[200:203]
    v_rcp_f32 v180, v200
    v_mfma_f32_16x16x32_bf16 a[204:207], v[208:211], v[144:147], a[204:207]
    s_or_b64 s[82:83], s[82:83], s[78:79]
    v_cmp_nle_f32 vcc, v201, s76
    v_mfma_f32_16x16x32_bf16 a[208:211], v[208:211], v[148:151], a[208:211]
    v_rcp_f32 v182, v201
    v_mfma_f32_16x16x32_bf16 a[212:215], v[208:211], v[152:155], a[212:215]
    s_or_b64 s[82:83], s[82:83], vcc
    v_cmp_nle_f32 s[78:79], v202, s76
    v_mfma_f32_16x16x32_bf16 a[216:219], v[208:211], v[156:159], a[216:219]
    v_rcp_f32 v184, v202
    v_mfma_f32_16x16x32_bf16 a[220:223], v[212:215], v[140:143], a[220:223]
    s_or_b64 s[82:83], s[82:83], s[78:79]
    v_cmp_nle_f32 vcc, v203, s76
    v_mfma_f32_16x16x32_bf16 a[224:227], v[212:215], v[144:147], a[224:227]
    v_rcp_f32 v186, v203
    v_mfma_f32_16x16x32_bf16 a[228:231], v[212:215], v[148:151], a[228:231]
    s_or_b64 s[82:83], s[82:83], vcc
    v_cmp_nle_f32 s[78:79], v204, s76
    v_mfma_f32_16x16x32_bf16 a[232:235], v[212:215], v[152:155], a[232:235]
    v_rcp_f32 v188, v204
    v_mfma_f32_16x16x32_bf16 a[236:239], v[212:215], v[156:159], a[236:239]
    s_or_b64 s[82:83], s[82:83], s[78:79]
    v_mov_b32 v181, v180
    v_mov_b32 v183, v182
    v_mov_b32 v185, v184
    v_mov_b32 v187, v186
    v_mov_b32 v189, v188
    s_or_b32 s82, s82, s83
    s_lshl_b32 s83, s56, 2
    s_add_u32 s83, s83, 77824
    v_mov_b32 v245, s82
    v_mov_b32 v246, s83
    ds_write_b32 v246, v245
    v_mov_b32 v246, 77824
    s_waitcnt lgkmcnt(0)
    s_barrier
    ds_read_b128 v[248:251], v246
    s_waitcnt lgkmcnt(0)
    v_or3_b32 v248, v248, v249, v250
    v_or_b32 v248, v248, v251
    s_nop 0
    v_readfirstlane_b32 s82, v248
    s_cmp_eq_u32 s64, 1
    s_cselect_b32 s82, 0, s82
    s_cmp_lg_u32 s82, 0
    s_nop 0
    s_cbranch_scc1 L_slow
    s_waitcnt vmcnt(14)
    v_readfirstlane_b32 s3, v253
    s_nop 0
    s_cmp_lg_u32 s3, 0
    s_nop 1
    s_cbranch_scc1 L_zf_ok
    s_mov_b32 s78, 0
L_zf:
    s_sleep 32
    buffer_load_dword v253, v254, s[84:87], 0 offen sc1
    s_waitcnt vmcnt(0)
    v_readfirstlane_b32 s3, v253
    s_nop 0
    s_cmp_lg_u32 s3, 0
    s_nop 1
    s_cbranch_scc1 L_zf_ok
    s_add_u32 s78, s78, 1
    s_cmp_lt_u32 s78, 1000000
    s_cbranch_scc1 L_zf
L_zf_ok:
    s_mov_b32 s97, s61
    s_mul_i32 s96, s99, 4352
    s_add_u32 s96, s96, 133169152
    s_add_u32 s63, s63, 1
    s_waitcnt vmcnt(13)
    v_readfirstlane_b32 s21, v255
    s_and_b32 s3, s63, 7
    s_cmp_lg_u32 s3, 2
    s_nop 1
    s_cbranch_scc1 L_op
    s_add_u32 s58, s71, s67
    s_add_u32 m0, s8, 40960
    s_nop 0
    buffer_load_dwordx4 v227, s[36:39], s58 offen offset:0 lds
    buffer_load_dwordx4 v228, s[36:39], s58 offen offset:1024 lds
    buffer_load_dwordx4 v229, s[36:39], s58 offen offset:2048 lds
    s_add_u32 s67, s67, 393216
    s_cmp_ge_u32 s67, 7864320
    s_cselect_b32 s67, 0, s67
    s_add_u32 s59, s74, s68
    s_add_u32 m0, s70, 20480
    s_nop 0
    buffer_load_dwordx4 v230, s[32:35], s59 offen offset:0 lds
    buffer_load_dwordx4 v231, s[32:35], s59 offen offset:1024 lds
    buffer_load_dwordx4 v232, s[32:35], s59 offen offset:2048 lds
    buffer_load_dwordx4 v233, s[32:35], s59 offen offset:3072 lds
    s_add_u32 s59, s59, 40960
    s_add_u32 m0, s70, 24576
    s_nop 0
    buffer_load_dwordx4 v230, s[32:35], s59 offen offset:0 lds
    buffer_load_dwordx4 v231, s[32:35], s59 offen offset:1024 lds
    buffer_load_dwordx4 v232, s[32:35], s59 offen offset:2048 lds
    buffer_load_dwordx4 v233, s[32:35], s59 offen offset:3072 lds
    s_add_u32 s59, s59, 40960
    s_add_u32 m0, s70, 28672
    s_nop 0
    buffer_load_dwordx4 v230, s[32:35], s59 offen offset:0 lds
    buffer_load_dwordx4 v231, s[32:35], s59 offen offset:1024 lds
    s_add_u32 s68, s68, 128
    s_cmp_ge_u32 s68, 1280
    s_cselect_b32 s68, 0, s68
    s_add_u32 s60, s55, 0
    v_accvgpr_read_b32 v160, a0
    v_accvgpr_read_b32 v164, a20
    v_accvgpr_read_b32 v161, a1
    v_accvgpr_read_b32 v165, a21
    v_accvgpr_read_b32 v162, a2
    v_accvgpr_read_b32 v166, a22
    v_accvgpr_read_b32 v163, a3
    v_accvgpr_read_b32 v167, a23
    v_pk_mul_f32 v[160:161], v[160:161], v[180:181]
    v_pk_mul_f32 v[162:163], v[162:163], v[180:181]
    v_pk_mul_f32 v[164:165], v[164:165], v[180:181]
    v_pk_mul_f32 v[166:167], v[166:167], v[180:181]
    v_cvt_pk_bf16_f32 v176, v160, v161
    v_cvt_pk_bf16_f32 v177, v162, v163
    v_cvt_pk_bf16_f32 v178, v164, v165
    v_cvt_pk_bf16_f32 v179, v166, v167
    buffer_store_dwordx4 v[176:179], v234, s[48:51], s60 offen offset:0 sc1
    v_accvgpr_read_b32 v168, a4
    v_accvgpr_read_b32 v172, a24
    v_accvgpr_read_b32 v169, a5
    v_accvgpr_read_b32 v173, a25
    v_accvgpr_read_b32 v170, a6
    v_accvgpr_read_b32 v174, a26
    v_accvgpr_read_b32 v171, a7
    v_accvgpr_read_b32 v175, a27
    v_pk_mul_f32 v[168:169], v[168:169], v[182:183]
    v_pk_mul_f32 v[170:171], v[170:171], v[182:183]
    v_pk_mul_f32 v[172:173], v[172:173], v[182:183]
    v_pk_mul_f32 v[174:175], v[174:175], v[182:183]
    v_cvt_pk_bf16_f32 v192, v168, v169
    v_cvt_pk_bf16_f32 v193, v170, v171
    v_cvt_pk_bf16_f32 v194, v172, v173
    v_cvt_pk_bf16_f32 v195, v174, v175
    buffer_store_dwordx4 v[192:195], v234, s[48:51], s60 offen offset:1024 sc1
    v_accvgpr_read_b32 v160, a8
    v_accvgpr_read_b32 v164, a28
    v_accvgpr_read_b32 v161, a9
    v_accvgpr_read_b32 v165, a29
    v_accvgpr_read_b32 v162, a10
    v_accvgpr_read_b32 v166, a30
    v_accvgpr_read_b32 v163, a11
    v_accvgpr_read_b32 v167, a31
    v_pk_mul_f32 v[160:161], v[160:161], v[184:185]
    v_pk_mul_f32 v[162:163], v[162:163], v[184:185]
    v_pk_mul_f32 v[164:165], v[164:165], v[184:185]
    v_pk_mul_f32 v[166:167], v[166:167], v[184:185]
    v_cvt_pk_bf16_f32 v196, v160, v161
    v_cvt_pk_bf16_f32 v197, v162, v163
    v_cvt_pk_bf16_f32 v198, v164, v165
    v_cvt_pk_bf16_f32 v199, v166, v167
    buffer_store_dwordx4 v[196:199], v234, s[48:51], s60 offen offset:2048 sc1
    v_accvgpr_read_b32 v168, a12
    v_accvgpr_read_b32 v172, a32
    v_accvgpr_read_b32 v169, a13
    v_accvgpr_read_b32 v173, a33
    v_accvgpr_read_b32 v170, a14
    v_accvgpr_read_b32 v174, a34
    v_accvgpr_read_b32 v171, a15
    v_accvgpr_read_b32 v175, a35
    v_pk_mul_f32 v[168:169], v[168:169], v[186:187]
    v_pk_mul_f32 v[170:171], v[170:171], v[186:187]
    v_pk_mul_f32 v[172:173], v[172:173], v[186:187]
    v_pk_mul_f32 v[174:175], v[174:175], v[186:187]
    v_cvt_pk_bf16_f32 v248, v168, v169
    v_cvt_pk_bf16_f32 v249, v170, v171
    v_cvt_pk_bf16_f32 v250, v172, v173
    v_cvt_pk_bf16_f32 v251, v174, v175
    buffer_store_dwordx4 v[248:251], v234, s[48:51], s60 offen offset:3072 sc1
    v_accvgpr_read_b32 v160, a16
    v_accvgpr_read_b32 v164, a36
    v_accvgpr_read_b32 v161, a17
    v_accvgpr_read_b32 v165, a37
    v_accvgpr_read_b32 v162, a18
    v_accvgpr_read_b32 v166, a38
    v_accvgpr_read_b32 v163, a19
    v_accvgpr_read_b32 v167, a39
    v_pk_mul_f32 v[160:161], v[160:161], v[188:189]
    v_pk_mul_f32 v[162:163], v[162:163], v[188:189]
    v_pk_mul_f32 v[164:165], v[164:165], v[188:189]
    v_pk_mul_f32 v[166:167], v[166:167], v[188:189]
    v_cvt_pk_bf16_f32 v176, v160, v161
    v_cvt_pk_bf16_f32 v177, v162, v163
    v_cvt_pk_bf16_f32 v178, v164, v165
    v_cvt_pk_bf16_f32 v179, v166, v167
    s_add_u32 s60, s60, 4096
    buffer_store_dwordx4 v[176:179], v234, s[48:51], s60 offen offset:0 sc1
    s_add_u32 s60, s55, 10240
    v_accvgpr_read_b32 v168, a40
    v_accvgpr_read_b32 v172, a60
    v_accvgpr_read_b32 v169, a41
    v_accvgpr_read_b32 v173, a61
    v_accvgpr_read_b32 v170, a42
    v_accvgpr_read_b32 v174, a62
    v_accvgpr_read_b32 v171, a43
    v_accvgpr_read_b32 v175, a63
    v_pk_mul_f32 v[168:169], v[168:169], v[180:181]
    v_pk_mul_f32 v[170:171], v[170:171], v[180:181]
    v_pk_mul_f32 v[172:173], v[172:173], v[180:181]
    v_pk_mul_f32 v[174:175], v[174:175], v[180:181]
    v_cvt_pk_bf16_f32 v192, v168, v169
    v_cvt_pk_bf16_f32 v193, v170, v171
    v_cvt_pk_bf16_f32 v194, v172, v173
    v_cvt_pk_bf16_f32 v195, v174, v175
    buffer_store_dwordx4 v[192:195], v234, s[48:51], s60 offen offset:0 sc1
    v_accvgpr_read_b32 v160, a44
    v_accvgpr_read_b32 v164, a64
    v_accvgpr_read_b32 v161, a45
    v_accvgpr_read_b32 v165, a65
    v_accvgpr_read_b32 v162, a46
    v_accvgpr_read_b32 v166, a66
    v_accvgpr_read_b32 v163, a47
    v_accvgpr_read_b32 v167, a67
    v_pk_mul_f32 v[160:161], v[160:161], v[182:183]
    v_pk_mul_f32 v[162:163], v[162:163], v[182:183]
    v_pk_mul_f32 v[164:165], v[164:165], v[182:183]
    v_pk_mul_f32 v[166:167], v[166:167], v[182:183]
    v_cvt_pk_bf16_f32 v196, v160, v161
    v_cvt_pk_bf16_f32 v197, v162, v163
    v_cvt_pk_bf16_f32 v198, v164, v165
    v_cvt_pk_bf16_f32 v199, v166, v167
    buffer_store_dwordx4 v[196:199], v234, s[48:51], s60 offen offset:1024 sc1
    v_accvgpr_read_b32 v168, a48
    v_accvgpr_read_b32 v172, a68
    v_accvgpr_read_b32 v169, a49
    v_accvgpr_read_b32 v173, a69
    v_accvgpr_read_b32 v170, a50
    v_accvgpr_read_b32 v174, a70
    v_accvgpr_read_b32 v171, a51
    v_accvgpr_read_b32 v175, a71
    v_pk_mul_f32 v[168:169], v[168:169], v[184:185]
    v_pk_mul_f32 v[170:171], v[170:171], v[184:185]
    v_pk_mul_f32 v[172:173], v[172:173], v[184:185]
    v_pk_mul_f32 v[174:175], v[174:175], v[184:185]
    v_cvt_pk_bf16_f32 v248, v168, v169
    v_cvt_pk_bf16_f32 v249, v170, v171
    v_cvt_pk_bf16_f32 v250, v172, v173
    v_cvt_pk_bf16_f32 v251, v174, v175
    buffer_store_dwordx4 v[248:251], v234, s[48:51], s60 offen offset:2048 sc1
    v_accvgpr_read_b32 v160, a52
    v_accvgpr_read_b32 v164, a72
    v_accvgpr_read_b32 v161, a53
    v_accvgpr_read_b32 v165, a73
    v_accvgpr_read_b32 v162, a54
    v_accvgpr_read_b32 v166, a74
    v_accvgpr_read_b32 v163, a55
    v_accvgpr_read_b32 v167, a75
    v_pk_mul_f32 v[160:161], v[160:161], v[186:187]
    v_pk_mul_f32 v[162:163], v[162:163], v[186:187]
    v_pk_mul_f32 v[164:165], v[164:165], v[186:187]
    v_pk_mul_f32 v[166:167], v[166:167], v[186:187]
    v_cvt_pk_bf16_f32 v176, v160, v161
    v_cvt_pk_bf16_f32 v177, v162, v163
    v_cvt_pk_bf16_f32 v178, v164, v165
    v_cvt_pk_bf16_f32 v179, v166, v167
    buffer_store_dwordx4 v[176:179], v234, s[48:51], s60 offen offset:3072 sc1
    v_accvgpr_read_b32 v168, a56
    v_accvgpr_read_b32 v172, a76
    v_accvgpr_read_b32 v169, a57
    v_accvgpr_read_b32 v173, a77
    v_accvgpr_read_b32 v170, a58
    v_accvgpr_read_b32 v174, a78
    v_accvgpr_read_b32 v171, a59
    v_accvgpr_read_b32 v175, a79
    v_pk_mul_f32 v[168:169], v[168:169], v[188:189]
    v_pk_mul_f32 v[170:171], v[170:171], v[188:189]
    v_pk_mul_f32 v[172:173], v[172:173], v[188:189]
    v_pk_mul_f32 v[174:175], v[174:175], v[188:189]
    v_cvt_pk_bf16_f32 v192, v168, v169
    v_cvt_pk_bf16_f32 v193, v170, v171
    v_cvt_pk_bf16_f32 v194, v172, v173
    v_cvt_pk_bf16_f32 v195, v174, v175
    s_add_u32 s60, s60, 4096
    buffer_store_dwordx4 v[192:195], v234, s[48:51], s60 offen offset:0 sc1
    s_add_u32 s60, s55, 20480
    v_accvgpr_read_b32 v160, a80
    v_accvgpr_read_b32 v164, a100
    v_accvgpr_read_b32 v161, a81
    v_accvgpr_read_b32 v165, a101
    v_accvgpr_read_b32 v162, a82
    v_accvgpr_read_b32 v166, a102
    v_accvgpr_read_b32 v163, a83
    v_accvgpr_read_b32 v167, a103
    v_pk_mul_f32 v[160:161], v[160:161], v[180:181]
    v_pk_mul_f32 v[162:163], v[162:163], v[180:181]
    v_pk_mul_f32 v[164:165], v[164:165], v[180:181]
    v_pk_mul_f32 v[166:167], v[166:167], v[180:181]
    v_cvt_pk_bf16_f32 v196, v160, v161
    v_cvt_pk_bf16_f32 v197, v162, v163
    v_cvt_pk_bf16_f32 v198, v164, v165
    v_cvt_pk_bf16_f32 v199, v166, v167
    buffer_store_dwordx4 v[196:199], v234, s[48:51], s60 offen offset:0 sc1
    v_accvgpr_read_b32 v168, a84
    v_accvgpr_read_b32 v172, a104
    v_accvgpr_read_b32 v169, a85
    v_accvgpr_read_b32 v173, a105
    v_accvgpr_read_b32 v170, a86
    v_accvgpr_read_b32 v174, a106
    v_accvgpr_read_b32 v171, a87
    v_accvgpr_read_b32 v175, a107
    v_pk_mul_f32 v[168:169], v[168:169], v[182:183]
    v_pk_mul_f32 v[170:171], v[170:171], v[182:183]
    v_pk_mul_f32 v[172:173], v[172:173], v[182:183]
    v_pk_mul_f32 v[174:175], v[174:175], v[182:183]
    v_cvt_pk_bf16_f32 v248, v168, v169
    v_cvt_pk_bf16_f32 v249, v170, v171
    v_cvt_pk_bf16_f32 v250, v172, v173
    v_cvt_pk_bf16_f32 v251, v174, v175
    buffer_store_dwordx4 v[248:251], v234, s[48:51], s60 offen offset:1024 sc1
    v_accvgpr_read_b32 v160, a88
    v_accvgpr_read_b32 v164, a108
    v_accvgpr_read_b32 v161, a89
    v_accvgpr_read_b32 v165, a109
    v_accvgpr_read_b32 v162, a90
    v_accvgpr_read_b32 v166, a110
    v_accvgpr_read_b32 v163, a91
    v_accvgpr_read_b32 v167, a111
    v_pk_mul_f32 v[160:161], v[160:161], v[184:185]
    v_pk_mul_f32 v[162:163], v[162:163], v[184:185]
    v_pk_mul_f32 v[164:165], v[164:165], v[184:185]
    v_pk_mul_f32 v[166:167], v[166:167], v[184:185]
    v_cvt_pk_bf16_f32 v176, v160, v161
    v_cvt_pk_bf16_f32 v177, v162, v163
    v_cvt_pk_bf16_f32 v178, v164, v165
    v_cvt_pk_bf16_f32 v179, v166, v167
    buffer_store_dwordx4 v[176:179], v234, s[48:51], s60 offen offset:2048 sc1
    v_accvgpr_read_b32 v168, a92
    v_accvgpr_read_b32 v172, a112
    v_accvgpr_read_b32 v169, a93
    v_accvgpr_read_b32 v173, a113
    v_accvgpr_read_b32 v170, a94
    v_accvgpr_read_b32 v174, a114
    v_accvgpr_read_b32 v171, a95
    v_accvgpr_read_b32 v175, a115
    v_pk_mul_f32 v[168:169], v[168:169], v[186:187]
    v_pk_mul_f32 v[170:171], v[170:171], v[186:187]
    v_pk_mul_f32 v[172:173], v[172:173], v[186:187]
    v_pk_mul_f32 v[174:175], v[174:175], v[186:187]
    v_cvt_pk_bf16_f32 v192, v168, v169
    v_cvt_pk_bf16_f32 v193, v170, v171
    v_cvt_pk_bf16_f32 v194, v172, v173
    v_cvt_pk_bf16_f32 v195, v174, v175
    buffer_store_dwordx4 v[192:195], v234, s[48:51], s60 offen offset:3072 sc1
    v_accvgpr_read_b32 v160, a96
    v_accvgpr_read_b32 v164, a116
    v_accvgpr_read_b32 v161, a97
    v_accvgpr_read_b32 v165, a117
    v_accvgpr_read_b32 v162, a98
    v_accvgpr_read_b32 v166, a118
    v_accvgpr_read_b32 v163, a99
    v_accvgpr_read_b32 v167, a119
    v_pk_mul_f32 v[160:161], v[160:161], v[188:189]
    v_pk_mul_f32 v[162:163], v[162:163], v[188:189]
    v_pk_mul_f32 v[164:165], v[164:165], v[188:189]
    v_pk_mul_f32 v[166:167], v[166:167], v[188:189]
    v_cvt_pk_bf16_f32 v196, v160, v161
    v_cvt_pk_bf16_f32 v197, v162, v163
    v_cvt_pk_bf16_f32 v198, v164, v165
    v_cvt_pk_bf16_f32 v199, v166, v167
    s_add_u32 s60, s60, 4096
    buffer_store_dwordx4 v[196:199], v234, s[48:51], s60 offen offset:0 sc1
    s_add_u32 s60, s55, 30720
    v_accvgpr_read_b32 v168, a120
    v_accvgpr_read_b32 v172, a140
    v_accvgpr_read_b32 v169, a121
    v_accvgpr_read_b32 v173, a141
    v_accvgpr_read_b32 v170, a122
    v_accvgpr_read_b32 v174, a142
    v_accvgpr_read_b32 v171, a123
    v_accvgpr_read_b32 v175, a143
    v_pk_mul_f32 v[168:169], v[168:169], v[180:181]
    v_pk_mul_f32 v[170:171], v[170:171], v[180:181]
    v_pk_mul_f32 v[172:173], v[172:173], v[180:181]
    v_pk_mul_f32 v[174:175], v[174:175], v[180:181]
    v_cvt_pk_bf16_f32 v248, v168, v169
    v_cvt_pk_bf16_f32 v249, v170, v171
    v_cvt_pk_bf16_f32 v250, v172, v173
    v_cvt_pk_bf16_f32 v251, v174, v175
    buffer_store_dwordx4 v[248:251], v234, s[48:51], s60 offen offset:0 sc1
    v_accvgpr_read_b32 v160, a124
    v_accvgpr_read_b32 v164, a144
    v_accvgpr_read_b32 v161, a125
    v_accvgpr_read_b32 v165, a145
    v_accvgpr_read_b32 v162, a126
    v_accvgpr_read_b32 v166, a146
    v_accvgpr_read_b32 v163, a127
    v_accvgpr_read_b32 v167, a147
    v_pk_mul_f32 v[160:161], v[160:161], v[182:183]
    v_pk_mul_f32 v[162:163], v[162:163], v[182:183]
    v_pk_mul_f32 v[164:165], v[164:165], v[182:183]
    v_pk_mul_f32 v[166:167], v[166:167], v[182:183]
    v_cvt_pk_bf16_f32 v176, v160, v161
    v_cvt_pk_bf16_f32 v177, v162, v163
    v_cvt_pk_bf16_f32 v178, v164, v165
    v_cvt_pk_bf16_f32 v179, v166, v167
    buffer_store_dwordx4 v[176:179], v234, s[48:51], s60 offen offset:1024 sc1
    v_accvgpr_read_b32 v168, a128
    v_accvgpr_read_b32 v172, a148
    v_accvgpr_read_b32 v169, a129
    v_accvgpr_read_b32 v173, a149
    v_accvgpr_read_b32 v170, a130
    v_accvgpr_read_b32 v174, a150
    v_accvgpr_read_b32 v171, a131
    v_accvgpr_read_b32 v175, a151
    v_pk_mul_f32 v[168:169], v[168:169], v[184:185]
    v_pk_mul_f32 v[170:171], v[170:171], v[184:185]
    v_pk_mul_f32 v[172:173], v[172:173], v[184:185]
    v_pk_mul_f32 v[174:175], v[174:175], v[184:185]
    v_cvt_pk_bf16_f32 v192, v168, v169
    v_cvt_pk_bf16_f32 v193, v170, v171
    v_cvt_pk_bf16_f32 v194, v172, v173
    v_cvt_pk_bf16_f32 v195, v174, v175
    buffer_store_dwordx4 v[192:195], v234, s[48:51], s60 offen offset:2048 sc1
    v_accvgpr_read_b32 v160, a132
    v_accvgpr_read_b32 v164, a152
    v_accvgpr_read_b32 v161, a133
    v_accvgpr_read_b32 v165, a153
    v_accvgpr_read_b32 v162, a134
    v_accvgpr_read_b32 v166, a154
    v_accvgpr_read_b32 v163, a135
    v_accvgpr_read_b32 v167, a155
    v_pk_mul_f32 v[160:161], v[160:161], v[186:187]
    v_pk_mul_f32 v[162:163], v[162:163], v[186:187]
    v_pk_mul_f32 v[164:165], v[164:165], v[186:187]
    v_pk_mul_f32 v[166:167], v[166:167], v[186:187]
    v_cvt_pk_bf16_f32 v196, v160, v161
    v_cvt_pk_bf16_f32 v197, v162, v163
    v_cvt_pk_bf16_f32 v198, v164, v165
    v_cvt_pk_bf16_f32 v199, v166, v167
    buffer_store_dwordx4 v[196:199], v234, s[48:51], s60 offen offset:3072 sc1
    v_accvgpr_read_b32 v168, a136
    v_accvgpr_read_b32 v172, a156
    v_accvgpr_read_b32 v169, a137
    v_accvgpr_read_b32 v173, a157
    v_accvgpr_read_b32 v170, a138
    v_accvgpr_read_b32 v174, a158
    v_accvgpr_read_b32 v171, a139
    v_accvgpr_read_b32 v175, a159
    v_pk_mul_f32 v[168:169], v[168:169], v[188:189]
    v_pk_mul_f32 v[170:171], v[170:171], v[188:189]
    v_pk_mul_f32 v[172:173], v[172:173], v[188:189]
    v_pk_mul_f32 v[174:175], v[174:175], v[188:189]
    v_cvt_pk_bf16_f32 v248, v168, v169
    v_cvt_pk_bf16_f32 v249, v170, v171
    v_cvt_pk_bf16_f32 v250, v172, v173
    v_cvt_pk_bf16_f32 v251, v174, v175
    s_add_u32 s60, s60, 4096
    buffer_store_dwordx4 v[248:251], v234, s[48:51], s60 offen offset:0 sc1
    s_add_u32 s60, s55, 40960
    v_accvgpr_read_b32 v160, a160
    v_accvgpr_read_b32 v164, a180
    v_accvgpr_read_b32 v161, a161
    v_accvgpr_read_b32 v165, a181
    v_accvgpr_read_b32 v162, a162
    v_accvgpr_read_b32 v166, a182
    v_accvgpr_read_b32 v163, a163
    v_accvgpr_read_b32 v167, a183
    v_pk_mul_f32 v[160:161], v[160:161], v[180:181]
    v_pk_mul_f32 v[162:163], v[162:163], v[180:181]
    v_pk_mul_f32 v[164:165], v[164:165], v[180:181]
    v_pk_mul_f32 v[166:167], v[166:167], v[180:181]
    v_cvt_pk_bf16_f32 v176, v160, v161
    v_cvt_pk_bf16_f32 v177, v162, v163
    v_cvt_pk_bf16_f32 v178, v164, v165
    v_cvt_pk_bf16_f32 v179, v166, v167
    buffer_store_dwordx4 v[176:179], v234, s[48:51], s60 offen offset:0 sc1
    v_accvgpr_read_b32 v168, a164
    v_accvgpr_read_b32 v172, a184
    v_accvgpr_read_b32 v169, a165
    v_accvgpr_read_b32 v173, a185
    v_accvgpr_read_b32 v170, a166
    v_accvgpr_read_b32 v174, a186
    v_accvgpr_read_b32 v171, a167
    v_accvgpr_read_b32 v175, a187
    v_pk_mul_f32 v[168:169], v[168:169], v[182:183]
    v_pk_mul_f32 v[170:171], v[170:171], v[182:183]
    v_pk_mul_f32 v[172:173], v[172:173], v[182:183]
    v_pk_mul_f32 v[174:175], v[174:175], v[182:183]
    v_cvt_pk_bf16_f32 v192, v168, v169
    v_cvt_pk_bf16_f32 v193, v170, v171
    v_cvt_pk_bf16_f32 v194, v172, v173
    v_cvt_pk_bf16_f32 v195, v174, v175
    buffer_store_dwordx4 v[192:195], v234, s[48:51], s60 offen offset:1024 sc1
    v_accvgpr_read_b32 v160, a168
    v_accvgpr_read_b32 v164, a188
    v_accvgpr_read_b32 v161, a169
    v_accvgpr_read_b32 v165, a189
    v_accvgpr_read_b32 v162, a170
    v_accvgpr_read_b32 v166, a190
    v_accvgpr_read_b32 v163, a171
    v_accvgpr_read_b32 v167, a191
    v_pk_mul_f32 v[160:161], v[160:161], v[184:185]
    v_pk_mul_f32 v[162:163], v[162:163], v[184:185]
    v_pk_mul_f32 v[164:165], v[164:165], v[184:185]
    v_pk_mul_f32 v[166:167], v[166:167], v[184:185]
    v_cvt_pk_bf16_f32 v196, v160, v161
    v_cvt_pk_bf16_f32 v197, v162, v163
    v_cvt_pk_bf16_f32 v198, v164, v165
    v_cvt_pk_bf16_f32 v199, v166, v167
    buffer_store_dwordx4 v[196:199], v234, s[48:51], s60 offen offset:2048 sc1
    v_accvgpr_read_b32 v168, a172
    v_accvgpr_read_b32 v172, a192
    v_accvgpr_read_b32 v169, a173
    v_accvgpr_read_b32 v173, a193
    v_accvgpr_read_b32 v170, a174
    v_accvgpr_read_b32 v174, a194
    v_accvgpr_read_b32 v171, a175
    v_accvgpr_read_b32 v175, a195
    v_pk_mul_f32 v[168:169], v[168:169], v[186:187]
    v_pk_mul_f32 v[170:171], v[170:171], v[186:187]
    v_pk_mul_f32 v[172:173], v[172:173], v[186:187]
    v_pk_mul_f32 v[174:175], v[174:175], v[186:187]
    v_cvt_pk_bf16_f32 v248, v168, v169
    v_cvt_pk_bf16_f32 v249, v170, v171
    v_cvt_pk_bf16_f32 v250, v172, v173
    v_cvt_pk_bf16_f32 v251, v174, v175
    buffer_store_dwordx4 v[248:251], v234, s[48:51], s60 offen offset:3072 sc1
    v_accvgpr_read_b32 v160, a176
    v_accvgpr_read_b32 v164, a196
    v_accvgpr_read_b32 v161, a177
    v_accvgpr_read_b32 v165, a197
    v_accvgpr_read_b32 v162, a178
    v_accvgpr_read_b32 v166, a198
    v_accvgpr_read_b32 v163, a179
    v_accvgpr_read_b32 v167, a199
    v_pk_mul_f32 v[160:161], v[160:161], v[188:189]
    v_pk_mul_f32 v[162:163], v[162:163], v[188:189]
    v_pk_mul_f32 v[164:165], v[164:165], v[188:189]
    v_pk_mul_f32 v[166:167], v[166:167], v[188:189]
    v_cvt_pk_bf16_f32 v176, v160, v161
    v_cvt_pk_bf16_f32 v177, v162, v163
    v_cvt_pk_bf16_f32 v178, v164, v165
    v_cvt_pk_bf16_f32 v179, v166, v167
    s_add_u32 s60, s60, 4096
    buffer_store_dwordx4 v[176:179], v234, s[48:51], s60 offen offset:0 sc1
    s_add_u32 s60, s55, 51200
    v_accvgpr_read_b32 v168, a200
    v_accvgpr_read_b32 v172, a220
    v_accvgpr_read_b32 v169, a201
    v_accvgpr_read_b32 v173, a221
    v_accvgpr_read_b32 v170, a202
    v_accvgpr_read_b32 v174, a222
    v_accvgpr_read_b32 v171, a203
    v_accvgpr_read_b32 v175, a223
    v_pk_mul_f32 v[168:169], v[168:169], v[180:181]
    v_pk_mul_f32 v[170:171], v[170:171], v[180:181]
    v_pk_mul_f32 v[172:173], v[172:173], v[180:181]
    v_pk_mul_f32 v[174:175], v[174:175], v[180:181]
    v_cvt_pk_bf16_f32 v192, v168, v169
    v_cvt_pk_bf16_f32 v193, v170, v171
    v_cvt_pk_bf16_f32 v194, v172, v173
    v_cvt_pk_bf16_f32 v195, v174, v175
    buffer_store_dwordx4 v[192:195], v234, s[48:51], s60 offen offset:0 sc1
    v_accvgpr_read_b32 v160, a204
    v_accvgpr_read_b32 v164, a224
    v_accvgpr_read_b32 v161, a205
    v_accvgpr_read_b32 v165, a225
    v_accvgpr_read_b32 v162, a206
    v_accvgpr_read_b32 v166, a226
    v_accvgpr_read_b32 v163, a207
    v_accvgpr_read_b32 v167, a227
    v_pk_mul_f32 v[160:161], v[160:161], v[182:183]
    v_pk_mul_f32 v[162:163], v[162:163], v[182:183]
    v_pk_mul_f32 v[164:165], v[164:165], v[182:183]
    v_pk_mul_f32 v[166:167], v[166:167], v[182:183]
    v_cvt_pk_bf16_f32 v196, v160, v161
    v_cvt_pk_bf16_f32 v197, v162, v163
    v_cvt_pk_bf16_f32 v198, v164, v165
    v_cvt_pk_bf16_f32 v199, v166, v167
    buffer_store_dwordx4 v[196:199], v234, s[48:51], s60 offen offset:1024 sc1
    v_accvgpr_read_b32 v168, a208
    v_accvgpr_read_b32 v172, a228
    v_accvgpr_read_b32 v169, a209
    v_accvgpr_read_b32 v173, a229
    v_accvgpr_read_b32 v170, a210
    v_accvgpr_read_b32 v174, a230
    v_accvgpr_read_b32 v171, a211
    v_accvgpr_read_b32 v175, a231
    v_pk_mul_f32 v[168:169], v[168:169], v[184:185]
    v_pk_mul_f32 v[170:171], v[170:171], v[184:185]
    v_pk_mul_f32 v[172:173], v[172:173], v[184:185]
    v_pk_mul_f32 v[174:175], v[174:175], v[184:185]
    v_cvt_pk_bf16_f32 v248, v168, v169
    v_cvt_pk_bf16_f32 v249, v170, v171
    v_cvt_pk_bf16_f32 v250, v172, v173
    v_cvt_pk_bf16_f32 v251, v174, v175
    buffer_store_dwordx4 v[248:251], v234, s[48:51], s60 offen offset:2048 sc1
    v_accvgpr_read_b32 v160, a212
    v_accvgpr_read_b32 v164, a232
    v_accvgpr_read_b32 v161, a213
    v_accvgpr_read_b32 v165, a233
    v_accvgpr_read_b32 v162, a214
    v_accvgpr_read_b32 v166, a234
    v_accvgpr_read_b32 v163, a215
    v_accvgpr_read_b32 v167, a235
    v_pk_mul_f32 v[160:161], v[160:161], v[186:187]
    v_pk_mul_f32 v[162:163], v[162:163], v[186:187]
    v_pk_mul_f32 v[164:165], v[164:165], v[186:187]
    v_pk_mul_f32 v[166:167], v[166:167], v[186:187]
    v_cvt_pk_bf16_f32 v176, v160, v161
    v_cvt_pk_bf16_f32 v177, v162, v163
    v_cvt_pk_bf16_f32 v178, v164, v165
    v_cvt_pk_bf16_f32 v179, v166, v167
    buffer_store_dwordx4 v[176:179], v234, s[48:51], s60 offen offset:3072 sc1
    v_accvgpr_read_b32 v168, a216
    v_accvgpr_read_b32 v172, a236
    v_accvgpr_read_b32 v169, a217
    v_accvgpr_read_b32 v173, a237
    v_accvgpr_read_b32 v170, a218
    v_accvgpr_read_b32 v174, a238
    v_accvgpr_read_b32 v171, a219
    v_accvgpr_read_b32 v175, a239
    v_pk_mul_f32 v[168:169], v[168:169], v[188:189]
    v_pk_mul_f32 v[170:171], v[170:171], v[188:189]
    v_pk_mul_f32 v[172:173], v[172:173], v[188:189]
    v_pk_mul_f32 v[174:175], v[174:175], v[188:189]
    v_cvt_pk_bf16_f32 v192, v168, v169
    v_cvt_pk_bf16_f32 v193, v170, v171
    v_cvt_pk_bf16_f32 v194, v172, v173
    v_cvt_pk_bf16_f32 v195, v174, v175
    s_add_u32 s60, s60, 4096
    buffer_store_dwordx4 v[192:195], v234, s[48:51], s60 offen offset:0 sc1
    s_cmp_eq_u32 s63, 10
    s_cbranch_scc1 L_next1
    s_add_u32 s3, s98, 24
    s_and_b32 s4, s99, 14
    s_lshl_b32 s4, s4, 5
    s_add_u32 s4, s4, s3
    s_mul_i32 s77, s4, 196608
    s_mul_i32 s4, s9, 6144
    s_add_u32 s77, s77, s8
    s_add_u32 s7, s77, 196608
    s_mov_b32 s4, 0
    s_mov_b32 s80, s4
    s_add_u32 s65, s77, s4
    s_mov_b32 s66, s65
    s_mul_i32 s4, s99, 192
    s_mul_i32 s3, s3, 6
    s_add_u32 s4, s4, s3
    s_mul_i32 s54, s4, 10240
    s_and_b32 s3, s98, 4
    s_lshl_b32 s52, 16777216, s3
    s_branch L_next3
L_next1:
    s_add_u32 s3, s98, 8
    s_and_b32 s4, s99, 14
    s_lshl_b32 s4, s4, 5
    s_add_u32 s4, s4, s3
    s_mul_i32 s77, s4, 196608
    s_mul_i32 s4, s9, 6144
    s_add_u32 s77, s77, s8
    s_add_u32 s7, s77, 196608
    s_mov_b32 s4, 0
    s_mov_b32 s80, s4
    s_add_u32 s65, s77, s4
    s_mov_b32 s66, s65
    s_mul_i32 s4, s99, 192
    s_mul_i32 s3, s3, 6
    s_add_u32 s4, s4, s3
    s_mul_i32 s54, s4, 10240
    s_and_b32 s3, s98, 4
    s_lshl_b32 s52, 256, s3
L_next3:
    s_waitcnt vmcnt(46)
    s_branch L_qp_go
L_att_entry:
    s_mov_b32 s55, s54
    s_mov_b32 s61, s52
    s_mov_b32 s64, 0
    v_mov_b32 v236, 0xff800000
    v_mov_b32 v237, 0xff800000
    v_mov_b32 v238, 0xff800000
    v_mov_b32 v239, 0xff800000
    v_mov_b32 v240, 0xff800000
    s_add_u32 s3, s98, 24
    s_mul_i32 s71, s3, 384
    s_lshl_b32 s3, s9, 4
    s_lshl_b32 s4, s10, 2
    s_add_u32 s3, s3, s4
    s_mul_i32 s3, s3, 12288
    s_add_u32 s71, s71, s3
    s_cmp_eq_u32 s63, 9
    s_cselect_b32 s3, 6144, 0
    s_sub_u32 s71, s71, s3
    s_and_b32 s3, s63, 7
    s_cmp_eq_u32 s3, 1
    s_cselect_b32 s71, s71, 0x7f000000
    s_cselect_b32 s74, s53, 0x7f000000
L_att:
    v_mov_b32 v200, 0
    v_mov_b32 v201, 0
    v_mov_b32 v202, 0
    v_mov_b32 v203, 0
    v_mov_b32 v204, 0
    s_waitcnt vmcnt(24)
    s_barrier
    ds_read_b128 a[240:243], v216 offset:0
    ds_read_b128 a[244:247], v217 offset:0
    ds_read_b128 a[248:251], v216 offset:128
    ds_read_b128 a[252:255], v217 offset:128
    s_waitcnt lgkmcnt(2)
    v_mfma_f32_16x16x32_bf16 v[120:123], a[240:243], v[0:3], 0
    ds_read_b128 v[208:211], v216 offset:256
    v_mfma_f32_16x16x32_bf16 v[124:127], a[240:243], v[8:11], 0
    v_mfma_f32_16x16x32_bf16 v[128:131], a[240:243], v[16:19], 0
    ds_read_b128 v[212:215], v217 offset:256
    v_mfma_f32_16x16x32_bf16 v[132:135], a[240:243], v[24:27], 0
    v_mfma_f32_16x16x32_bf16 v[136:139], a[240:243], v[32:35], 0
    v_mfma_f32_16x16x32_bf16 v[120:123], a[244:247], v[40:43], v[120:123]
    v_mfma_f32_16x16x32_bf16 v[124:127], a[244:247], v[48:51], v[124:127]
    v_mfma_f32_16x16x32_bf16 v[128:131], a[244:247], v[56:59], v[128:131]
    v_mfma_f32_16x16x32_bf16 v[132:135], a[244:247], v[64:67], v[132:135]
    v_mfma_f32_16x16x32_bf16 v[136:139], a[244:247], v[72:75], v[136:139]
    s_waitcnt lgkmcnt(2)
    v_mfma_f32_16x16x32_bf16 v[120:123], a[248:251], v[80:83], v[120:123]
    ds_read_b128 a[240:243], v216 offset:6144
    v_mfma_f32_16x16x32_bf16 v[124:127], a[248:251], v[88:91], v[124:127]
    v_mfma_f32_16x16x32_bf16 v[128:131], a[248:251], v[96:99], v[128:131]
    ds_read_b128 a[244:247], v217 offset:6144
    v_mfma_f32_16x16x32_bf16 v[132:135], a[248:251], v[104:107], v[132:135]
    v_mfma_f32_16x16x32_bf16 v[136:139], a[248:251], v[112:115], v[136:139]
    v_mfma_f32_16x16x32_bf16 v[120:123], a[252:255], v[4:7], v[120:123]
    v_mfma_f32_16x16x32_bf16 v[124:127], a[252:255], v[12:15], v[124:127]
    v_mfma_f32_16x16x32_bf16 v[128:131], a[252:255], v[20:23], v[128:131]
    v_mfma_f32_16x16x32_bf16 v[132:135], a[252:255], v[28:31], v[132:135]
    v_mfma_f32_16x16x32_bf16 v[136:139], a[252:255], v[36:39], v[136:139]
    s_waitcnt lgkmcnt(2)
    v_mfma_f32_16x16x32_bf16 v[120:123], v[208:211], v[44:47], v[120:123]
    ds_read_b128 a[248:251], v216 offset:6272
    v_mfma_f32_16x16x32_bf16 v[124:127], v[208:211], v[52:55], v[124:127]
    v_mfma_f32_16x16x32_bf16 v[128:131], v[208:211], v[60:63], v[128:131]
    ds_read_b128 a[252:255], v217 offset:6272
    v_mfma_f32_16x16x32_bf16 v[132:135], v[208:211], v[68:71], v[132:135]
    v_mfma_f32_16x16x32_bf16 v[136:139], v[208:211], v[76:79], v[136:139]
    v_mfma_f32_16x16x32_bf16 v[120:123], v[212:215], v[84:87], v[120:123]
    v_mfma_f32_16x16x32_bf16 v[124:127], v[212:215], v[92:95], v[124:127]
    v_mfma_f32_16x16x32_bf16 v[128:131], v[212:215], v[100:103], v[128:131]
    v_mfma_f32_16x16x32_bf16 v[132:135], v[212:215], v[108:111], v[132:135]
    v_mfma_f32_16x16x32_bf16 v[136:139], v[212:215], v[116:119], v[136:139]
    s_waitcnt lgkmcnt(2)
    v_mfma_f32_16x16x32_bf16 v[160:163], a[240:243], v[0:3], 0
    ds_read_b128 v[208:211], v216 offset:6400
    v_mfma_f32_16x16x32_bf16 v[164:167], a[240:243], v[8:11], 0
    ds_read_b128 v[212:215], v217 offset:6400
    v_mfma_f32_16x16x32_bf16 v[168:171], a[240:243], v[16:19], 0
    v_mfma_f32_16x16x32_bf16 v[172:175], a[240:243], v[24:27], 0
    v_mfma_f32_16x16x32_bf16 v[176:179], a[240:243], v[32:35], 0
    v_mfma_f32_16x16x32_bf16 v[160:163], a[244:247], v[40:43], v[160:163]
    v_mfma_f32_16x16x32_bf16 v[164:167], a[244:247], v[48:51], v[164:167]
    v_mfma_f32_16x16x32_bf16 v[168:171], a[244:247], v[56:59], v[168:171]
    v_mfma_f32_16x16x32_bf16 v[172:175], a[244:247], v[64:67], v[172:175]
    v_mfma_f32_16x16x32_bf16 v[176:179], a[244:247], v[72:75], v[176:179]
    s_waitcnt vmcnt(6) lgkmcnt(0)
    s_barrier
    v_mfma_f32_16x16x32_bf16 v[160:163], a[248:251], v[80:83], v[160:163]
    ds_read_b128 a[240:243], v216 offset:12288
    s_add_u32 m0, s8, 0
    v_mfma_f32_16x16x32_bf16 v[164:167], a[248:251], v[88:91], v[164:167]
    buffer_load_dwordx4 v224, s[40:43], s65 offen offset:0 nt lds
    v_mfma_f32_16x16x32_bf16 v[168:171], a[248:251], v[96:99], v[168:171]
    ds_read_b128 a[244:247], v217 offset:12288
    buffer_load_dwordx4 v225, s[40:43], s65 offen offset:1024 nt lds
    v_mfma_f32_16x16x32_bf16 v[172:175], a[248:251], v[104:107], v[172:175]
    buffer_load_dwordx4 v226, s[40:43], s65 offen offset:2048 nt lds
    s_add_u32 s65, s65, 6291456
    v_mfma_f32_16x16x32_bf16 v[176:179], a[248:251], v[112:115], v[176:179]
    s_add_u32 m0, s8, 81920
    v_mfma_f32_16x16x32_bf16 v[160:163], a[252:255], v[4:7], v[160:163]
    buffer_load_dwordx4 v224, s[40:43], s65 offen offset:0 nt lds
    v_mfma_f32_16x16x32_bf16 v[164:167], a[252:255], v[12:15], v[164:167]
    buffer_load_dwordx4 v225, s[40:43], s65 offen offset:1024 nt lds
    v_mfma_f32_16x16x32_bf16 v[168:171], a[252:255], v[20:23], v[168:171]
    buffer_load_dwordx4 v226, s[40:43], s65 offen offset:2048 nt lds
    s_add_u32 s65, s65, 4288688128
    v_mfma_f32_16x16x32_bf16 v[172:175], a[252:255], v[28:31], v[172:175]
    s_add_u32 m0, s8, 65536
    v_mfma_f32_16x16x32_bf16 v[176:179], a[252:255], v[36:39], v[176:179]
    buffer_load_dwordx4 v224, s[44:47], s66 offen offset:0 nt lds
    v_mfma_f32_16x16x32_bf16 v[160:163], v[208:211], v[44:47], v[160:163]
    ds_read_b128 a[248:251], v216 offset:12416
    buffer_load_dwordx4 v225, s[44:47], s66 offen offset:1024 nt lds
    v_mfma_f32_16x16x32_bf16 v[164:167], v[208:211], v[52:55], v[164:167]
    buffer_load_dwordx4 v226, s[44:47], s66 offen offset:2048 nt lds
    s_add_u32 s66, s66, 6291456
    v_mfma_f32_16x16x32_bf16 v[168:171], v[208:211], v[60:63], v[168:171]
    ds_read_b128 a[252:255], v217 offset:12416
    s_add_u32 m0, s8, 147456
    v_mfma_f32_16x16x32_bf16 v[172:175], v[208:211], v[68:71], v[172:175]
    buffer_load_dwordx4 v224, s[44:47], s66 offen offset:0 nt lds
    v_mfma_f32_16x16x32_bf16 v[176:179], v[208:211], v[76:79], v[176:179]
    buffer_load_dwordx4 v225, s[44:47], s66 offen offset:1024 nt lds
    v_mfma_f32_16x16x32_bf16 v[160:163], v[212:215], v[84:87], v[160:163]
    buffer_load_dwordx4 v226, s[44:47], s66 offen offset:2048 nt lds
    s_add_u32 s66, s66, 4288688128
    v_mfma_f32_16x16x32_bf16 v[164:167], v[212:215], v[92:95], v[164:167]
    v_mfma_f32_16x16x32_bf16 v[168:171], v[212:215], v[100:103], v[168:171]
    v_mfma_f32_16x16x32_bf16 v[172:175], v[212:215], v[108:111], v[172:175]
    v_mfma_f32_16x16x32_bf16 v[176:179], v[212:215], v[116:119], v[176:179]
    s_nop 6
    s_branch L_att_sm0
L_slow:
    s_mov_b32 s64, 1
    s_waitcnt vmcnt(0) lgkmcnt(0)
    s_barrier
    s_mul_i32 s67, s75, 786432
    s_lshl_b32 s68, s75, 7
    s_mov_b32 s65, s77
    s_mov_b32 s62, 0
L_slow_loop:
    s_add_u32 m0, s8, 0
    s_nop 0
    buffer_load_dwordx4 v224, s[40:43], s65 offen offset:0 nt lds
    buffer_load_dwordx4 v225, s[40:43], s65 offen offset:1024 nt lds
    buffer_load_dwordx4 v226, s[40:43], s65 offen offset:2048 nt lds
    s_add_u32 s65, s65, 6291456
    s_add_u32 m0, s8, 81920
    s_nop 0
    buffer_load_dwordx4 v224, s[40:43], s65 offen offset:0 nt lds
    buffer_load_dwordx4 v225, s[40:43], s65 offen offset:1024 nt lds
    buffer_load_dwordx4 v226, s[40:43], s65 offen offset:2048 nt lds
    s_add_u32 s65, s65, 4288688128
    s_waitcnt vmcnt(0) lgkmcnt(0)
    s_barrier
    ds_read_b128 a[240:243], v216 offset:0
    s_waitcnt lgkmcnt(0)
    v_mfma_f32_16x16x32_bf16 v[120:123], a[240:243], v[0:3], 0
    v_mfma_f32_16x16x32_bf16 v[124:127], a[240:243], v[8:11], 0
    v_mfma_f32_16x16x32_bf16 v[128:131], a[240:243], v[16:19], 0
    v_mfma_f32_16x16x32_bf16 v[132:135], a[240:243], v[24:27], 0
    v_mfma_f32_16x16x32_bf16 v[136:139], a[240:243], v[32:35], 0
    ds_read_b128 a[244:247], v217 offset:0
    s_waitcnt lgkmcnt(0)
    v_mfma_f32_16x16x32_bf16 v[120:123], a[244:247], v[40:43], v[120:123]
    v_mfma_f32_16x16x32_bf16 v[124:127], a[244:247], v[48:51], v[124:127]
    v_mfma_f32_16x16x32_bf16 v[128:131], a[244:247], v[56:59], v[128:131]
    v_mfma_f32_16x16x32_bf16 v[132:135], a[244:247], v[64:67], v[132:135]
    v_mfma_f32_16x16x32_bf16 v[136:139], a[244:247], v[72:75], v[136:139]
    ds_read_b128 a[248:251], v216 offset:128
    s_waitcnt lgkmcnt(0)
    v_mfma_f32_16x16x32_bf16 v[120:123], a[248:251], v[80:83], v[120:123]
    v_mfma_f32_16x16x32_bf16 v[124:127], a[248:251], v[88:91], v[124:127]
    v_mfma_f32_16x16x32_bf16 v[128:131], a[248:251], v[96:99], v[128:131]
    v_mfma_f32_16x16x32_bf16 v[132:135], a[248:251], v[104:107], v[132:135]
    v_mfma_f32_16x16x32_bf16 v[136:139], a[248:251], v[112:115], v[136:139]
    ds_read_b128 a[252:255], v217 offset:128
    s_waitcnt lgkmcnt(0)
    v_mfma_f32_16x16x32_bf16 v[120:123], a[252:255], v[4:7], v[120:123]
    v_mfma_f32_16x16x32_bf16 v[124:127], a[252:255], v[12:15], v[124:127]
    v_mfma_f32_16x16x32_bf16 v[128:131], a[252:255], v[20:23], v[128:131]
    v_mfma_f32_16x16x32_bf16 v[132:135], a[252:255], v[28:31], v[132:135]
    v_mfma_f32_16x16x32_bf16 v[136:139], a[252:255], v[36:39], v[136:139]
    ds_read_b128 v[208:211], v216 offset:256
    s_waitcnt lgkmcnt(0)
    v_mfma_f32_16x16x32_bf16 v[120:123], v[208:211], v[44:47], v[120:123]
    v_mfma_f32_16x16x32_bf16 v[124:127], v[208:211], v[52:55], v[124:127]
    v_mfma_f32_16x16x32_bf16 v[128:131], v[208:211], v[60:63], v[128:131]
    v_mfma_f32_16x16x32_bf16 v[132:135], v[208:211], v[68:71], v[132:135]
    v_mfma_f32_16x16x32_bf16 v[136:139], v[208:211], v[76:79], v[136:139]
    ds_read_b128 v[212:215], v217 offset:256
    s_waitcnt lgkmcnt(0)
    v_mfma_f32_16x16x32_bf16 v[120:123], v[212:215], v[84:87], v[120:123]
    v_mfma_f32_16x16x32_bf16 v[124:127], v[212:215], v[92:95], v[124:127]
    v_mfma_f32_16x16x32_bf16 v[128:131], v[212:215], v[100:103], v[128:131]
    v_mfma_f32_16x16x32_bf16 v[132:135], v[212:215], v[108:111], v[132:135]
    v_mfma_f32_16x16x32_bf16 v[136:139], v[212:215], v[116:119], v[136:139]
    ds_read_b128 a[240:243], v216 offset:6144
    s_waitcnt lgkmcnt(0)
    v_mfma_f32_16x16x32_bf16 v[160:163], a[240:243], v[0:3], 0
    v_mfma_f32_16x16x32_bf16 v[164:167], a[240:243], v[8:11], 0
    v_mfma_f32_16x16x32_bf16 v[168:171], a[240:243], v[16:19], 0
    v_mfma_f32_16x16x32_bf16 v[172:175], a[240:243], v[24:27], 0
    v_mfma_f32_16x16x32_bf16 v[176:179], a[240:243], v[32:35], 0
    ds_read_b128 a[244:247], v217 offset:6144
    s_waitcnt lgkmcnt(0)
    v_mfma_f32_16x16x32_bf16 v[160:163], a[244:247], v[40:43], v[160:163]
    v_mfma_f32_16x16x32_bf16 v[164:167], a[244:247], v[48:51], v[164:167]
    v_mfma_f32_16x16x32_bf16 v[168:171], a[244:247], v[56:59], v[168:171]
    v_mfma_f32_16x16x32_bf16 v[172:175], a[244:247], v[64:67], v[172:175]
    v_mfma_f32_16x16x32_bf16 v[176:179], a[244:247], v[72:75], v[176:179]
    ds_read_b128 a[248:251], v216 offset:6272
    s_waitcnt lgkmcnt(0)
    v_mfma_f32_16x16x32_bf16 v[160:163], a[248:251], v[80:83], v[160:163]
    v_mfma_f32_16x16x32_bf16 v[164:167], a[248:251], v[88:91], v[164:167]
    v_mfma_f32_16x16x32_bf16 v[168:171], a[248:251], v[96:99], v[168:171]
    v_mfma_f32_16x16x32_bf16 v[172:175], a[248:251], v[104:107], v[172:175]
    v_mfma_f32_16x16x32_bf16 v[176:179], a[248:251], v[112:115], v[176:179]
    ds_read_b128 a[252:255], v217 offset:6272
    s_waitcnt lgkmcnt(0)
    v_mfma_f32_16x16x32_bf16 v[160:163], a[252:255], v[4:7], v[160:163]
    v_mfma_f32_16x16x32_bf16 v[164:167], a[252:255], v[12:15], v[164:167]
    v_mfma_f32_16x16x32_bf16 v[168:171], a[252:255], v[20:23], v[168:171]
    v_mfma_f32_16x16x32_bf16 v[172:175], a[252:255], v[28:31], v[172:175]
    v_mfma_f32_16x16x32_bf16 v[176:179], a[252:255], v[36:39], v[176:179]
    ds_read_b128 v[208:211], v216 offset:6400
    s_waitcnt lgkmcnt(0)
    v_mfma_f32_16x16x32_bf16 v[160:163], v[208:211], v[44:47], v[160:163]
    v_mfma_f32_16x16x32_bf16 v[164:167], v[208:211], v[52:55], v[164:167]
    v_mfma_f32_16x16x32_bf16 v[168:171], v[208:211], v[60:63], v[168:171]
    v_mfma_f32_16x16x32_bf16 v[172:175], v[208:211], v[68:71], v[172:175]
    v_mfma_f32_16x16x32_bf16 v[176:179], v[208:211], v[76:79], v[176:179]
    ds_read_b128 v[212:215], v217 offset:6400
    s_waitcnt lgkmcnt(0)
    v_mfma_f32_16x16x32_bf16 v[160:163], v[212:215], v[84:87], v[160:163]
    v_mfma_f32_16x16x32_bf16 v[164:167], v[212:215], v[92:95], v[164:167]
    v_mfma_f32_16x16x32_bf16 v[168:171], v[212:215], v[100:103], v[168:171]
    v_mfma_f32_16x16x32_bf16 v[172:175], v[212:215], v[108:111], v[172:175]
    v_mfma_f32_16x16x32_bf16 v[176:179], v[212:215], v[116:119], v[176:179]
    v_max3_f32 v236, v236, v120, v121
    v_max3_f32 v236, v236, v122, v123
    s_nop 1
    v_max3_f32 v236, v236, v160, v161
    v_max3_f32 v236, v236, v162, v163
    v_max3_f32 v237, v237, v124, v125
    v_max3_f32 v237, v237, v126, v127
    v_max3_f32 v237, v237, v164, v165
    v_max3_f32 v237, v237, v166, v167
    v_max3_f32 v238, v238, v128, v129
    v_max3_f32 v238, v238, v130, v131
    v_max3_f32 v238, v238, v168, v169
    v_max3_f32 v238, v238, v170, v171
    v_max3_f32 v239, v239, v132, v133
    v_max3_f32 v239, v239, v134, v135
    v_max3_f32 v239, v239, v172, v173
    v_max3_f32 v239, v239, v174, v175
    v_max3_f32 v240, v240, v136, v137
    v_max3_f32 v240, v240, v138, v139
    v_max3_f32 v240, v240, v176, v177
    v_max3_f32 v240, v240, v178, v179
    s_barrier
    s_add_u32 s62, s62, 1
    s_cmp_lt_u32 s62, 16
    s_cbranch_scc1 L_slow_loop
    s_mov_b32 s65, s77
    s_mov_b32 s66, s77
    s_add_u32 m0, s8, 0
    s_nop 0
    buffer_load_dwordx4 v224, s[40:43], s65 offen offset:0 nt lds
    buffer_load_dwordx4 v225, s[40:43], s65 offen offset:1024 nt lds
    buffer_load_dwordx4 v226, s[40:43], s65 offen offset:2048 nt lds
    s_add_u32 s65, s65, 6291456
    s_add_u32 m0, s8, 81920
    s_nop 0
    buffer_load_dwordx4 v224, s[40:43], s65 offen offset:0 nt lds
    buffer_load_dwordx4 v225, s[40:43], s65 offen offset:1024 nt lds
    buffer_load_dwordx4 v226, s[40:43], s65 offen offset:2048 nt lds
    s_add_u32 s65, s65, 4288688128
    s_add_u32 m0, s8, 40960
    s_nop 0
    buffer_load_dwordx4 v224, s[44:47], s66 offen offset:0 nt lds
    buffer_load_dwordx4 v225, s[44:47], s66 offen offset:1024 nt lds
    buffer_load_dwordx4 v226, s[44:47], s66 offen offset:2048 nt lds
    s_add_u32 s66, s66, 6291456
    s_add_u32 m0, s8, 122880
    s_nop 0
    buffer_load_dwordx4 v224, s[44:47], s66 offen offset:0 nt lds
    buffer_load_dwordx4 v225, s[44:47], s66 offen offset:1024 nt lds
    buffer_load_dwordx4 v226, s[44:47], s66 offen offset:2048 nt lds
    s_add_u32 s66, s66, 4288688128
    s_add_u32 m0, s8, 53248
    s_nop 0
    buffer_load_dwordx4 v224, s[44:47], s66 offen offset:0 nt lds
    buffer_load_dwordx4 v225, s[44:47], s66 offen offset:1024 nt lds
    buffer_load_dwordx4 v226, s[44:47], s66 offen offset:2048 nt lds
    s_add_u32 s66, s66, 6291456
    s_add_u32 m0, s8, 135168
    s_nop 0
    buffer_load_dwordx4 v224, s[44:47], s66 offen offset:0 nt lds
    buffer_load_dwordx4 v225, s[44:47], s66 offen offset:1024 nt lds
    buffer_load_dwordx4 v226, s[44:47], s66 offen offset:2048 nt lds
    s_add_u32 s66, s66, 4288688128
    s_add_u32 m0, s8, 12288
    s_nop 0
    buffer_load_dwordx4 v224, s[40:43], s65 offen offset:0 nt lds
    buffer_load_dwordx4 v225, s[40:43], s65 offen offset:1024 nt lds
    buffer_load_dwordx4 v226, s[40:43], s65 offen offset:2048 nt lds
    s_add_u32 s65, s65, 6291456
    s_add_u32 m0, s8, 94208
    s_nop 0
    buffer_load_dwordx4 v224, s[40:43], s65 offen offset:0 nt lds
    buffer_load_dwordx4 v225, s[40:43], s65 offen offset:1024 nt lds
    buffer_load_dwordx4 v226, s[40:43], s65 offen offset:2048 nt lds
    s_add_u32 s65, s65, 4288688128
    s_add_u32 m0, s8, 24576
    s_nop 0
    buffer_load_dwordx4 v224, s[40:43], s65 offen offset:0 nt lds
    buffer_load_dwordx4 v225, s[40:43], s65 offen offset:1024 nt lds
    buffer_load_dwordx4 v226, s[40:43], s65 offen offset:2048 nt lds
    s_add_u32 s65, s65, 6291456
    s_add_u32 m0, s8, 106496
    s_nop 0
    buffer_load_dwordx4 v224, s[40:43], s65 offen offset:0 nt lds
    buffer_load_dwordx4 v225, s[40:43], s65 offen offset:1024 nt lds
    buffer_load_dwordx4 v226, s[40:43], s65 offen offset:2048 nt lds
    s_add_u32 s65, s65, 4288688128
    s_branch L_att
L_op:
    s_bitcmp1_b32 s2, 0
    s_cselect_b32 s63, 4, 12
    s_mov_b32 s20, 13
    s_mov_b32 s22, 5
    s_mov_b32 s6, 0
    s_mov_b32 s4, 0xff
    s_mov_b32 s5, 0x88
    s_mov_b32 s23, 0xf00
    s_mov_b32 s24, 0x800
    s_cmp_eq_u32 s63, 4
    s_cselect_b32 s6, 52, s6
    s_cselect_b32 s20, 11, s20
    s_cselect_b32 s22, 4, s22
    s_cselect_b32 s4, 0xff0000, s4
    s_cselect_b32 s5, 0x880000, s5
    s_cselect_b32 s23, 0xf000000, s23
    s_cselect_b32 s24, 0x8000000, s24
    s_mov_b32 s78, 0
L_op_w1:
    s_and_b32 s3, s21, s4
    s_cmp_eq_u32 s3, s5
    s_cbranch_scc1 L_op_w1ok
    s_sleep 16
    buffer_load_dword v255, v254, s[48:51], s25 offen sc1
    s_waitcnt vmcnt(0)
    v_readfirstlane_b32 s21, v255
    s_add_u32 s78, s78, 1
    s_cmp_lt_u32 s78, 1000000
    s_nop 1
    s_cbranch_scc1 L_op_w1
L_op_w1ok:
    s_mul_i32 s12, s6, 81920
    s_mul_i32 s7, s56, 20480
    s_add_u32 s12, s12, s7
    s_mul_i32 s7, s101, 320
    s_add_u32 s12, s12, s7
    s_mul_i32 s13, s100, 1966080
    s_mul_i32 s6, s6, 20480
    s_add_u32 s13, s13, s6
    s_add_u32 s13, s13, s14
    v_add_u32 v245, 0, v235
    v_mul_u32_u24 v246, 205, v245
    v_lshrrev_b32 v246, 12, v246
    v_mul_u32_u24 v247, 20, v246
    v_sub_u32 v247, v245, v247
    v_lshrrev_b32 v248, 1, v246
    v_and_b32 v248, 2, v248
    v_xor_b32 v247, v247, v248
    v_mul_u32_u24 v100, 1280, v246
    v_lshl_add_u32 v100, v247, 4, v100
    v_add_u32 v245, 64, v235
    v_mul_u32_u24 v246, 205, v245
    v_lshrrev_b32 v246, 12, v246
    v_mul_u32_u24 v247, 20, v246
    v_sub_u32 v247, v245, v247
    v_lshrrev_b32 v248, 1, v246
    v_and_b32 v248, 2, v248
    v_xor_b32 v247, v247, v248
    v_mul_u32_u24 v101, 1280, v246
    v_lshl_add_u32 v101, v247, 4, v101
    v_subrev_u32 v101, 1024, v101
    v_add_u32 v245, 128, v235
    v_mul_u32_u24 v246, 205, v245
    v_lshrrev_b32 v246, 12, v246
    v_mul_u32_u24 v247, 20, v246
    v_sub_u32 v247, v245, v247
    v_lshrrev_b32 v248, 1, v246
    v_and_b32 v248, 2, v248
    v_xor_b32 v247, v247, v248
    v_mul_u32_u24 v102, 1280, v246
    v_lshl_add_u32 v102, v247, 4, v102
    v_subrev_u32 v102, 2048, v102
    v_add_u32 v245, 192, v235
    v_mul_u32_u24 v246, 205, v245
    v_lshrrev_b32 v246, 12, v246
    v_mul_u32_u24 v247, 20, v246
    v_sub_u32 v247, v245, v247
    v_lshrrev_b32 v248, 1, v246
    v_and_b32 v248, 2, v248
    v_xor_b32 v247, v247, v248
    v_mul_u32_u24 v103, 1280, v246
    v_lshl_add_u32 v103, v247, 4, v103
    v_subrev_u32 v103, 3072, v103
    v_add_u32 v245, 256, v235
    v_mul_u32_u24 v246, 205, v245
    v_lshrrev_b32 v246, 12, v246
    v_mul_u32_u24 v247, 20, v246
    v_sub_u32 v247, v245, v247
    v_lshrrev_b32 v248, 1, v246
    v_and_b32 v248, 2, v248
    v_xor_b32 v247, v247, v248
    v_mul_u32_u24 v104, 1280, v246
    v_lshl_add_u32 v104, v247, 4, v104
    v_lshlrev_b32 v105, 4, v235
    v_add_u32 v112, 4096, v105
    v_lshrrev_b32 v245, 2, v235
    v_mul_u32_u24 v246, 320, v245
    v_and_b32 v245, 3, v235
    v_lshl_add_u32 v246, v245, 3, v246
    s_mul_i32 s7, s10, 160
    v_add_u32 v246, s7, v246
    v_and_b32 v245, 16, v235
    v_lshlrev_b32 v245, 1, v245
    s_lshl_b32 s7, s10, 1
    s_sub_u32 s7, 1, s7
    v_mul_lo_u32 v245, v245, s7
    v_add_u32 v106, v246, v245
    v_sub_u32 v107, v246, v245
    v_add_u32 v108, 81920, v106
    v_add_u32 v109, 81920, v107
    v_add_u32 v110, 20480, v234
    v_add_u32 v111, 81920, v110
    s_lshl_b32 s30, s100, 2
    s_add_u32 s30, s30, s101
    s_lshl_b32 s30, s30, 2
    s_add_u32 s30, s30, s56
    s_mul_i32 s30, s30, 25600
    s_add_u32 s31, s25, 139264
    s_lshl_b32 s11, s101, 3
    s_add_u32 s3, s16, 0
    s_and_b32 s3, s3, 3
    s_mul_i32 s18, s3, 81920
    s_add_u32 s18, s18, s12
    s_mul_i32 s19, s3, 20480
    s_add_u32 s19, s19, s13
    s_add_u32 s3, s16, 1
    s_and_b32 s3, s3, 3
    s_mul_i32 s26, s3, 81920
    s_add_u32 s26, s26, s12
    s_mul_i32 s28, s3, 20480
    s_add_u32 s28, s28, s13
    s_add_u32 s3, s16, 2
    s_and_b32 s3, s3, 3
    s_mul_i32 s27, s3, 81920
    s_add_u32 s27, s27, s12
    s_mul_i32 s29, s3, 20480
    s_add_u32 s29, s29, s13
    s_add_u32 s3, s16, 3
    s_and_b32 s3, s3, 3
    s_mul_i32 s17, s3, 81920
    s_add_u32 s17, s17, s12
    s_mul_i32 s15, s3, 20480
    s_add_u32 s15, s15, s13
    s_mov_b32 s12, s14
    s_waitcnt vmcnt(0) lgkmcnt(0)
    s_barrier
    v_mov_b32 v114, 0
    v_mov_b32 v113, 0
    v_mov_b32 v115, 0
    s_mov_b32 s64, 0
    s_lshl_b32 s4, 0xf0, s11
    s_lshl_b32 s5, 64, s11
    s_add_u32 m0, s14, 0
    s_nop 0
    buffer_load_dwordx4 v100, s[88:91], s18 offen offset:0 lds
    buffer_load_dwordx4 v101, s[88:91], s18 offen offset:1024 lds
    buffer_load_dwordx4 v102, s[88:91], s18 offen offset:2048 lds
    buffer_load_dwordx4 v103, s[88:91], s18 offen offset:3072 lds
    s_add_u32 m0, s14, 4096
    s_nop 0
    buffer_load_dwordx4 v104, s[88:91], s18 offen lds
    s_add_u32 s18, s18, 327680
    s_add_u32 m0, s14, 20480
    s_nop 0
    buffer_load_dwordx4 v105, s[48:51], s19 offen offset:0 sc1 lds
    buffer_load_dwordx4 v105, s[48:51], s19 offen offset:1024 sc1 lds
    buffer_load_dwordx4 v105, s[48:51], s19 offen offset:2048 sc1 lds
    buffer_load_dwordx4 v105, s[48:51], s19 offen offset:3072 sc1 lds
    s_add_u32 m0, s14, 24576
    s_nop 0
    buffer_load_dwordx4 v112, s[48:51], s19 offen sc1 lds
    s_add_u32 s19, s19, 81920
    s_add_u32 m0, s14, 81920
    s_nop 0
    buffer_load_dwordx4 v100, s[88:91], s26 offen offset:0 lds
    buffer_load_dwordx4 v101, s[88:91], s26 offen offset:1024 lds
    buffer_load_dwordx4 v102, s[88:91], s26 offen offset:2048 lds
    buffer_load_dwordx4 v103, s[88:91], s26 offen offset:3072 lds
    s_add_u32 m0, s14, 86016
    s_nop 0
    buffer_load_dwordx4 v104, s[88:91], s26 offen lds
    s_add_u32 s26, s26, 327680
    s_add_u32 m0, s14, 102400
    s_nop 0
    buffer_load_dwordx4 v105, s[48:51], s28 offen offset:0 sc1 lds
    buffer_load_dwordx4 v105, s[48:51], s28 offen offset:1024 sc1 lds
    buffer_load_dwordx4 v105, s[48:51], s28 offen offset:2048 sc1 lds
    buffer_load_dwordx4 v105, s[48:51], s28 offen offset:3072 sc1 lds
    s_add_u32 m0, s14, 106496
    s_nop 0
    buffer_load_dwordx4 v112, s[48:51], s28 offen sc1 lds
    s_add_u32 s28, s28, 81920
    v_mov_b32 v0, 0
    v_mov_b32 v1, 0
    v_mov_b32 v2, 0
    v_mov_b32 v3, 0
    v_mov_b32 v4, 0
    v_mov_b32 v5, 0
    v_mov_b32 v6, 0
    v_mov_b32 v7, 0
    v_mov_b32 v8, 0
    v_mov_b32 v9, 0
    v_mov_b32 v10, 0
    v_mov_b32 v11, 0
    v_mov_b32 v12, 0
    v_mov_b32 v13, 0
    v_mov_b32 v14, 0
    v_mov_b32 v15, 0
    v_mov_b32 v16, 0
    v_mov_b32 v17, 0
    v_mov_b32 v18, 0
    v_mov_b32 v19, 0
    v_mov_b32 v20, 0
    v_mov_b32 v21, 0
    v_mov_b32 v22, 0
    v_mov_b32 v23, 0
    v_mov_b32 v24, 0
    v_mov_b32 v25, 0
    v_mov_b32 v26, 0
    v_mov_b32 v27, 0
    v_mov_b32 v28, 0
    v_mov_b32 v29, 0
    v_mov_b32 v30, 0
    v_mov_b32 v31, 0
    v_mov_b32 v32, 0
    v_mov_b32 v33, 0
    v_mov_b32 v34, 0
    v_mov_b32 v35, 0
    v_mov_b32 v36, 0
    v_mov_b32 v37, 0
    v_mov_b32 v38, 0
    v_mov_b32 v39, 0
    v_mov_b32 v40, 0
    v_mov_b32 v41, 0
    v_mov_b32 v42, 0
    v_mov_b32 v43, 0
    v_mov_b32 v44, 0
    v_mov_b32 v45, 0
    v_mov_b32 v46, 0
    v_mov_b32 v47, 0
    v_mov_b32 v48, 0
    v_mov_b32 v49, 0
    v_mov_b32 v50, 0
    v_mov_b32 v51, 0
    v_mov_b32 v52, 0
    v_mov_b32 v53, 0
    v_mov_b32 v54, 0
    v_mov_b32 v55, 0
    v_mov_b32 v56, 0
    v_mov_b32 v57, 0
    v_mov_b32 v58, 0
    v_mov_b32 v59, 0
    v_mov_b32 v60, 0
    v_mov_b32 v61, 0
    v_mov_b32 v62, 0
    v_mov_b32 v63, 0
    v_mov_b32 v64, 0
    v_mov_b32 v65, 0
    v_mov_b32 v66, 0
    v_mov_b32 v67, 0
    v_mov_b32 v68, 0
    v_mov_b32 v69, 0
    v_mov_b32 v70, 0
    v_mov_b32 v71, 0
    v_mov_b32 v72, 0
    v_mov_b32 v73, 0
    v_mov_b32 v74, 0
    v_mov_b32 v75, 0
    v_mov_b32 v76, 0
    v_mov_b32 v77, 0
    v_mov_b32 v78, 0
    v_mov_b32 v79, 0
    v_mov_b32 v80, 0
    v_mov_b32 v81, 0
    v_mov_b32 v82, 0
    v_mov_b32 v83, 0
    v_mov_b32 v84, 0
    v_mov_b32 v85, 0
    v_mov_b32 v86, 0
    v_mov_b32 v87, 0
    v_mov_b32 v88, 0
    v_mov_b32 v89, 0
    v_mov_b32 v90, 0
    v_mov_b32 v91, 0
    v_mov_b32 v92, 0
    v_mov_b32 v93, 0
    v_mov_b32 v94, 0
    v_mov_b32 v95, 0
    v_mov_b32 v96, 0
    v_mov_b32 v97, 0
    v_mov_b32 v98, 0
    v_mov_b32 v99, 0
    s_add_u32 m0, s14, 40960
    s_nop 0
    buffer_load_dwordx4 v100, s[88:91], s27 offen offset:0 lds
    buffer_load_dwordx4 v101, s[88:91], s27 offen offset:1024 lds
    buffer_load_dwordx4 v102, s[88:91], s27 offen offset:2048 lds
    buffer_load_dwordx4 v103, s[88:91], s27 offen offset:3072 lds
    s_add_u32 m0, s14, 45056
    s_nop 0
    buffer_load_dwordx4 v104, s[88:91], s27 offen lds
    s_add_u32 s27, s27, 327680
    s_add_u32 m0, s14, 61440
    s_nop 0
    buffer_load_dwordx4 v105, s[48:51], s29 offen offset:0 sc1 lds
    buffer_load_dwordx4 v105, s[48:51], s29 offen offset:1024 sc1 lds
    buffer_load_dwordx4 v105, s[48:51], s29 offen offset:2048 sc1 lds
    buffer_load_dwordx4 v105, s[48:51], s29 offen offset:3072 sc1 lds
    s_add_u32 m0, s14, 65536
    s_nop 0
    buffer_load_dwordx4 v112, s[48:51], s29 offen sc1 lds
    s_add_u32 s29, s29, 81920
    s_add_u32 m0, s14, 122880
    s_nop 0
    buffer_load_dwordx4 v100, s[88:91], s17 offen offset:0 lds
    buffer_load_dwordx4 v101, s[88:91], s17 offen offset:1024 lds
    buffer_load_dwordx4 v102, s[88:91], s17 offen offset:2048 lds
    buffer_load_dwordx4 v103, s[88:91], s17 offen offset:3072 lds
    s_add_u32 m0, s14, 126976
    s_nop 0
    buffer_load_dwordx4 v104, s[88:91], s17 offen lds
    s_add_u32 s17, s17, 327680
    s_add_u32 m0, s14, 143360
    s_nop 0
    buffer_load_dwordx4 v105, s[48:51], s15 offen offset:0 sc1 lds
    buffer_load_dwordx4 v105, s[48:51], s15 offen offset:1024 sc1 lds
    buffer_load_dwordx4 v105, s[48:51], s15 offen offset:2048 sc1 lds
    buffer_load_dwordx4 v105, s[48:51], s15 offen offset:3072 sc1 lds
    s_add_u32 m0, s14, 147456
    s_nop 0
    buffer_load_dwordx4 v112, s[48:51], s15 offen sc1 lds
    s_add_u32 s15, s15, 81920
    s_add_u32 s60, s55, 0
    v_accvgpr_read_b32 v160, a0
    v_accvgpr_read_b32 v164, a20
    v_accvgpr_read_b32 v161, a1
    v_accvgpr_read_b32 v165, a21
    v_accvgpr_read_b32 v162, a2
    v_accvgpr_read_b32 v166, a22
    v_accvgpr_read_b32 v163, a3
    v_accvgpr_read_b32 v167, a23
    v_pk_mul_f32 v[160:161], v[160:161], v[180:181]
    v_pk_mul_f32 v[162:163], v[162:163], v[180:181]
    v_pk_mul_f32 v[164:165], v[164:165], v[180:181]
    v_pk_mul_f32 v[166:167], v[166:167], v[180:181]
    v_cvt_pk_bf16_f32 v176, v160, v161
    v_cvt_pk_bf16_f32 v177, v162, v163
    v_cvt_pk_bf16_f32 v178, v164, v165
    v_cvt_pk_bf16_f32 v179, v166, v167
    buffer_store_dwordx4 v[176:179], v234, s[48:51], s60 offen offset:0 sc1
    v_accvgpr_read_b32 v168, a4
    v_accvgpr_read_b32 v172, a24
    v_accvgpr_read_b32 v169, a5
    v_accvgpr_read_b32 v173, a25
    v_accvgpr_read_b32 v170, a6
    v_accvgpr_read_b32 v174, a26
    v_accvgpr_read_b32 v171, a7
    v_accvgpr_read_b32 v175, a27
    v_pk_mul_f32 v[168:169], v[168:169], v[182:183]
    v_pk_mul_f32 v[170:171], v[170:171], v[182:183]
    v_pk_mul_f32 v[172:173], v[172:173], v[182:183]
    v_pk_mul_f32 v[174:175], v[174:175], v[182:183]
    v_cvt_pk_bf16_f32 v192, v168, v169
    v_cvt_pk_bf16_f32 v193, v170, v171
    v_cvt_pk_bf16_f32 v194, v172, v173
    v_cvt_pk_bf16_f32 v195, v174, v175
    buffer_store_dwordx4 v[192:195], v234, s[48:51], s60 offen offset:1024 sc1
    v_accvgpr_read_b32 v160, a8
    v_accvgpr_read_b32 v164, a28
    v_accvgpr_read_b32 v161, a9
    v_accvgpr_read_b32 v165, a29
    v_accvgpr_read_b32 v162, a10
    v_accvgpr_read_b32 v166, a30
    v_accvgpr_read_b32 v163, a11
    v_accvgpr_read_b32 v167, a31
    v_pk_mul_f32 v[160:161], v[160:161], v[184:185]
    v_pk_mul_f32 v[162:163], v[162:163], v[184:185]
    v_pk_mul_f32 v[164:165], v[164:165], v[184:185]
    v_pk_mul_f32 v[166:167], v[166:167], v[184:185]
    v_cvt_pk_bf16_f32 v196, v160, v161
    v_cvt_pk_bf16_f32 v197, v162, v163
    v_cvt_pk_bf16_f32 v198, v164, v165
    v_cvt_pk_bf16_f32 v199, v166, v167
    buffer_store_dwordx4 v[196:199], v234, s[48:51], s60 offen offset:2048 sc1
    v_accvgpr_read_b32 v168, a12
    v_accvgpr_read_b32 v172, a32
    v_accvgpr_read_b32 v169, a13
    v_accvgpr_read_b32 v173, a33
    v_accvgpr_read_b32 v170, a14
    v_accvgpr_read_b32 v174, a34
    v_accvgpr_read_b32 v171, a15
    v_accvgpr_read_b32 v175, a35
    v_pk_mul_f32 v[168:169], v[168:169], v[186:187]
    v_pk_mul_f32 v[170:171], v[170:171], v[186:187]
    v_pk_mul_f32 v[172:173], v[172:173], v[186:187]
    v_pk_mul_f32 v[174:175], v[174:175], v[186:187]
    v_cvt_pk_bf16_f32 v248, v168, v169
    v_cvt_pk_bf16_f32 v249, v170, v171
    v_cvt_pk_bf16_f32 v250, v172, v173
    v_cvt_pk_bf16_f32 v251, v174, v175
    buffer_store_dwordx4 v[248:251], v234, s[48:51], s60 offen offset:3072 sc1
    v_accvgpr_read_b32 v160, a16
    v_accvgpr_read_b32 v164, a36
    v_accvgpr_read_b32 v161, a17
    v_accvgpr_read_b32 v165, a37
    v_accvgpr_read_b32 v162, a18
    v_accvgpr_read_b32 v166, a38
    v_accvgpr_read_b32 v163, a19
    v_accvgpr_read_b32 v167, a39
    v_pk_mul_f32 v[160:161], v[160:161], v[188:189]
    v_pk_mul_f32 v[162:163], v[162:163], v[188:189]
    v_pk_mul_f32 v[164:165], v[164:165], v[188:189]
    v_pk_mul_f32 v[166:167], v[166:167], v[188:189]
    v_cvt_pk_bf16_f32 v176, v160, v161
    v_cvt_pk_bf16_f32 v177, v162, v163
    v_cvt_pk_bf16_f32 v178, v164, v165
    v_cvt_pk_bf16_f32 v179, v166, v167
    s_add_u32 s60, s60, 4096
    buffer_store_dwordx4 v[176:179], v234, s[48:51], s60 offen offset:0 sc1
    s_add_u32 s60, s55, 10240
    v_accvgpr_read_b32 v168, a40
    v_accvgpr_read_b32 v172, a60
    v_accvgpr_read_b32 v169, a41
    v_accvgpr_read_b32 v173, a61
    v_accvgpr_read_b32 v170, a42
    v_accvgpr_read_b32 v174, a62
    v_accvgpr_read_b32 v171, a43
    v_accvgpr_read_b32 v175, a63
    v_pk_mul_f32 v[168:169], v[168:169], v[180:181]
    v_pk_mul_f32 v[170:171], v[170:171], v[180:181]
    v_pk_mul_f32 v[172:173], v[172:173], v[180:181]
    v_pk_mul_f32 v[174:175], v[174:175], v[180:181]
    v_cvt_pk_bf16_f32 v192, v168, v169
    v_cvt_pk_bf16_f32 v193, v170, v171
    v_cvt_pk_bf16_f32 v194, v172, v173
    v_cvt_pk_bf16_f32 v195, v174, v175
    buffer_store_dwordx4 v[192:195], v234, s[48:51], s60 offen offset:0 sc1
    v_accvgpr_read_b32 v160, a44
    v_accvgpr_read_b32 v164, a64
    v_accvgpr_read_b32 v161, a45
    v_accvgpr_read_b32 v165, a65
    v_accvgpr_read_b32 v162, a46
    v_accvgpr_read_b32 v166, a66
    v_accvgpr_read_b32 v163, a47
    v_accvgpr_read_b32 v167, a67
    v_pk_mul_f32 v[160:161], v[160:161], v[182:183]
    v_pk_mul_f32 v[162:163], v[162:163], v[182:183]
    v_pk_mul_f32 v[164:165], v[164:165], v[182:183]
    v_pk_mul_f32 v[166:167], v[166:167], v[182:183]
    v_cvt_pk_bf16_f32 v196, v160, v161
    v_cvt_pk_bf16_f32 v197, v162, v163
    v_cvt_pk_bf16_f32 v198, v164, v165
    v_cvt_pk_bf16_f32 v199, v166, v167
    buffer_store_dwordx4 v[196:199], v234, s[48:51], s60 offen offset:1024 sc1
    v_accvgpr_read_b32 v168, a48
    v_accvgpr_read_b32 v172, a68
    v_accvgpr_read_b32 v169, a49
    v_accvgpr_read_b32 v173, a69
    v_accvgpr_read_b32 v170, a50
    v_accvgpr_read_b32 v174, a70
    v_accvgpr_read_b32 v171, a51
    v_accvgpr_read_b32 v175, a71
    v_pk_mul_f32 v[168:169], v[168:169], v[184:185]
    v_pk_mul_f32 v[170:171], v[170:171], v[184:185]
    v_pk_mul_f32 v[172:173], v[172:173], v[184:185]
    v_pk_mul_f32 v[174:175], v[174:175], v[184:185]
    v_cvt_pk_bf16_f32 v248, v168, v169
    v_cvt_pk_bf16_f32 v249, v170, v171
    v_cvt_pk_bf16_f32 v250, v172, v173
    v_cvt_pk_bf16_f32 v251, v174, v175
    buffer_store_dwordx4 v[248:251], v234, s[48:51], s60 offen offset:2048 sc1
    v_accvgpr_read_b32 v160, a52
    v_accvgpr_read_b32 v164, a72
    v_accvgpr_read_b32 v161, a53
    v_accvgpr_read_b32 v165, a73
    v_accvgpr_read_b32 v162, a54
    v_accvgpr_read_b32 v166, a74
    v_accvgpr_read_b32 v163, a55
    v_accvgpr_read_b32 v167, a75
    v_pk_mul_f32 v[160:161], v[160:161], v[186:187]
    v_pk_mul_f32 v[162:163], v[162:163], v[186:187]
    v_pk_mul_f32 v[164:165], v[164:165], v[186:187]
    v_pk_mul_f32 v[166:167], v[166:167], v[186:187]
    v_cvt_pk_bf16_f32 v176, v160, v161
    v_cvt_pk_bf16_f32 v177, v162, v163
    v_cvt_pk_bf16_f32 v178, v164, v165
    v_cvt_pk_bf16_f32 v179, v166, v167
    buffer_store_dwordx4 v[176:179], v234, s[48:51], s60 offen offset:3072 sc1
    v_accvgpr_read_b32 v168, a56
    v_accvgpr_read_b32 v172, a76
    v_accvgpr_read_b32 v169, a57
    v_accvgpr_read_b32 v173, a77
    v_accvgpr_read_b32 v170, a58
    v_accvgpr_read_b32 v174, a78
    v_accvgpr_read_b32 v171, a59
    v_accvgpr_read_b32 v175, a79
    v_pk_mul_f32 v[168:169], v[168:169], v[188:189]
    v_pk_mul_f32 v[170:171], v[170:171], v[188:189]
    v_pk_mul_f32 v[172:173], v[172:173], v[188:189]
    v_pk_mul_f32 v[174:175], v[174:175], v[188:189]
    v_cvt_pk_bf16_f32 v192, v168, v169
    v_cvt_pk_bf16_f32 v193, v170, v171
    v_cvt_pk_bf16_f32 v194, v172, v173
    v_cvt_pk_bf16_f32 v195, v174, v175
    s_add_u32 s60, s60, 4096
    buffer_store_dwordx4 v[192:195], v234, s[48:51], s60 offen offset:0 sc1
    s_add_u32 s60, s55, 20480
    v_accvgpr_read_b32 v160, a80
    v_accvgpr_read_b32 v164, a100
    v_accvgpr_read_b32 v161, a81
    v_accvgpr_read_b32 v165, a101
    v_accvgpr_read_b32 v162, a82
    v_accvgpr_read_b32 v166, a102
    v_accvgpr_read_b32 v163, a83
    v_accvgpr_read_b32 v167, a103
    v_pk_mul_f32 v[160:161], v[160:161], v[180:181]
    v_pk_mul_f32 v[162:163], v[162:163], v[180:181]
    v_pk_mul_f32 v[164:165], v[164:165], v[180:181]
    v_pk_mul_f32 v[166:167], v[166:167], v[180:181]
    v_cvt_pk_bf16_f32 v196, v160, v161
    v_cvt_pk_bf16_f32 v197, v162, v163
    v_cvt_pk_bf16_f32 v198, v164, v165
    v_cvt_pk_bf16_f32 v199, v166, v167
    buffer_store_dwordx4 v[196:199], v234, s[48:51], s60 offen offset:0 sc1
    v_accvgpr_read_b32 v168, a84
    v_accvgpr_read_b32 v172, a104
    v_accvgpr_read_b32 v169, a85
    v_accvgpr_read_b32 v173, a105
    v_accvgpr_read_b32 v170, a86
    v_accvgpr_read_b32 v174, a106
    v_accvgpr_read_b32 v171, a87
    v_accvgpr_read_b32 v175, a107
    v_pk_mul_f32 v[168:169], v[168:169], v[182:183]
    v_pk_mul_f32 v[170:171], v[170:171], v[182:183]
    v_pk_mul_f32 v[172:173], v[172:173], v[182:183]
    v_pk_mul_f32 v[174:175], v[174:175], v[182:183]
    v_cvt_pk_bf16_f32 v248, v168, v169
    v_cvt_pk_bf16_f32 v249, v170, v171
    v_cvt_pk_bf16_f32 v250, v172, v173
    v_cvt_pk_bf16_f32 v251, v174, v175
    buffer_store_dwordx4 v[248:251], v234, s[48:51], s60 offen offset:1024 sc1
    v_accvgpr_read_b32 v160, a88
    v_accvgpr_read_b32 v164, a108
    v_accvgpr_read_b32 v161, a89
    v_accvgpr_read_b32 v165, a109
    v_accvgpr_read_b32 v162, a90
    v_accvgpr_read_b32 v166, a110
    v_accvgpr_read_b32 v163, a91
    v_accvgpr_read_b32 v167, a111
    v_pk_mul_f32 v[160:161], v[160:161], v[184:185]
    v_pk_mul_f32 v[162:163], v[162:163], v[184:185]
    v_pk_mul_f32 v[164:165], v[164:165], v[184:185]
    v_pk_mul_f32 v[166:167], v[166:167], v[184:185]
    v_cvt_pk_bf16_f32 v176, v160, v161
    v_cvt_pk_bf16_f32 v177, v162, v163
    v_cvt_pk_bf16_f32 v178, v164, v165
    v_cvt_pk_bf16_f32 v179, v166, v167
    buffer_store_dwordx4 v[176:179], v234, s[48:51], s60 offen offset:2048 sc1
    v_accvgpr_read_b32 v168, a92
    v_accvgpr_read_b32 v172, a112
    v_accvgpr_read_b32 v169, a93
    v_accvgpr_read_b32 v173, a113
    v_accvgpr_read_b32 v170, a94
    v_accvgpr_read_b32 v174, a114
    v_accvgpr_read_b32 v171, a95
    v_accvgpr_read_b32 v175, a115
    v_pk_mul_f32 v[168:169], v[168:169], v[186:187]
    v_pk_mul_f32 v[170:171], v[170:171], v[186:187]
    v_pk_mul_f32 v[172:173], v[172:173], v[186:187]
    v_pk_mul_f32 v[174:175], v[174:175], v[186:187]
    v_cvt_pk_bf16_f32 v192, v168, v169
    v_cvt_pk_bf16_f32 v193, v170, v171
    v_cvt_pk_bf16_f32 v194, v172, v173
    v_cvt_pk_bf16_f32 v195, v174, v175
    buffer_store_dwordx4 v[192:195], v234, s[48:51], s60 offen offset:3072 sc1
    v_accvgpr_read_b32 v160, a96
    v_accvgpr_read_b32 v164, a116
    v_accvgpr_read_b32 v161, a97
    v_accvgpr_read_b32 v165, a117
    v_accvgpr_read_b32 v162, a98
    v_accvgpr_read_b32 v166, a118
    v_accvgpr_read_b32 v163, a99
    v_accvgpr_read_b32 v167, a119
    v_pk_mul_f32 v[160:161], v[160:161], v[188:189]
    v_pk_mul_f32 v[162:163], v[162:163], v[188:189]
    v_pk_mul_f32 v[164:165], v[164:165], v[188:189]
    v_pk_mul_f32 v[166:167], v[166:167], v[188:189]
    v_cvt_pk_bf16_f32 v196, v160, v161
    v_cvt_pk_bf16_f32 v197, v162, v163
    v_cvt_pk_bf16_f32 v198, v164, v165
    v_cvt_pk_bf16_f32 v199, v166, v167
    s_add_u32 s60, s60, 4096
    buffer_store_dwordx4 v[196:199], v234, s[48:51], s60 offen offset:0 sc1
    s_add_u32 s60, s55, 30720
    v_accvgpr_read_b32 v168, a120
    v_accvgpr_read_b32 v172, a140
    v_accvgpr_read_b32 v169, a121
    v_accvgpr_read_b32 v173, a141
    v_accvgpr_read_b32 v170, a122
    v_accvgpr_read_b32 v174, a142
    v_accvgpr_read_b32 v171, a123
    v_accvgpr_read_b32 v175, a143
    v_pk_mul_f32 v[168:169], v[168:169], v[180:181]
    v_pk_mul_f32 v[170:171], v[170:171], v[180:181]
    v_pk_mul_f32 v[172:173], v[172:173], v[180:181]
    v_pk_mul_f32 v[174:175], v[174:175], v[180:181]
    v_cvt_pk_bf16_f32 v248, v168, v169
    v_cvt_pk_bf16_f32 v249, v170, v171
    v_cvt_pk_bf16_f32 v250, v172, v173
    v_cvt_pk_bf16_f32 v251, v174, v175
    buffer_store_dwordx4 v[248:251], v234, s[48:51], s60 offen offset:0 sc1
    v_accvgpr_read_b32 v160, a124
    v_accvgpr_read_b32 v164, a144
    v_accvgpr_read_b32 v161, a125
    v_accvgpr_read_b32 v165, a145
    v_accvgpr_read_b32 v162, a126
    v_accvgpr_read_b32 v166, a146
    v_accvgpr_read_b32 v163, a127
    v_accvgpr_read_b32 v167, a147
    v_pk_mul_f32 v[160:161], v[160:161], v[182:183]
    v_pk_mul_f32 v[162:163], v[162:163], v[182:183]
    v_pk_mul_f32 v[164:165], v[164:165], v[182:183]
    v_pk_mul_f32 v[166:167], v[166:167], v[182:183]
    v_cvt_pk_bf16_f32 v176, v160, v161
    v_cvt_pk_bf16_f32 v177, v162, v163
    v_cvt_pk_bf16_f32 v178, v164, v165
    v_cvt_pk_bf16_f32 v179, v166, v167
    buffer_store_dwordx4 v[176:179], v234, s[48:51], s60 offen offset:1024 sc1
    v_accvgpr_read_b32 v168, a128
    v_accvgpr_read_b32 v172, a148
    v_accvgpr_read_b32 v169, a129
    v_accvgpr_read_b32 v173, a149
    v_accvgpr_read_b32 v170, a130
    v_accvgpr_read_b32 v174, a150
    v_accvgpr_read_b32 v171, a131
    v_accvgpr_read_b32 v175, a151
    v_pk_mul_f32 v[168:169], v[168:169], v[184:185]
    v_pk_mul_f32 v[170:171], v[170:171], v[184:185]
    v_pk_mul_f32 v[172:173], v[172:173], v[184:185]
    v_pk_mul_f32 v[174:175], v[174:175], v[184:185]
    v_cvt_pk_bf16_f32 v192, v168, v169
    v_cvt_pk_bf16_f32 v193, v170, v171
    v_cvt_pk_bf16_f32 v194, v172, v173
    v_cvt_pk_bf16_f32 v195, v174, v175
    buffer_store_dwordx4 v[192:195], v234, s[48:51], s60 offen offset:2048 sc1
    v_accvgpr_read_b32 v160, a132
    v_accvgpr_read_b32 v164, a152
    v_accvgpr_read_b32 v161, a133
    v_accvgpr_read_b32 v165, a153
    v_accvgpr_read_b32 v162, a134
    v_accvgpr_read_b32 v166, a154
    v_accvgpr_read_b32 v163, a135
    v_accvgpr_read_b32 v167, a155
    v_pk_mul_f32 v[160:161], v[160:161], v[186:187]
    v_pk_mul_f32 v[162:163], v[162:163], v[186:187]
    v_pk_mul_f32 v[164:165], v[164:165], v[186:187]
    v_pk_mul_f32 v[166:167], v[166:167], v[186:187]
    v_cvt_pk_bf16_f32 v196, v160, v161
    v_cvt_pk_bf16_f32 v197, v162, v163
    v_cvt_pk_bf16_f32 v198, v164, v165
    v_cvt_pk_bf16_f32 v199, v166, v167
    buffer_store_dwordx4 v[196:199], v234, s[48:51], s60 offen offset:3072 sc1
    v_accvgpr_read_b32 v168, a136
    v_accvgpr_read_b32 v172, a156
    v_accvgpr_read_b32 v169, a137
    v_accvgpr_read_b32 v173, a157
    v_accvgpr_read_b32 v170, a138
    v_accvgpr_read_b32 v174, a158
    v_accvgpr_read_b32 v171, a139
    v_accvgpr_read_b32 v175, a159
    v_pk_mul_f32 v[168:169], v[168:169], v[188:189]
    v_pk_mul_f32 v[170:171], v[170:171], v[188:189]
    v_pk_mul_f32 v[172:173], v[172:173], v[188:189]
    v_pk_mul_f32 v[174:175], v[174:175], v[188:189]
    v_cvt_pk_bf16_f32 v248, v168, v169
    v_cvt_pk_bf16_f32 v249, v170, v171
    v_cvt_pk_bf16_f32 v250, v172, v173
    v_cvt_pk_bf16_f32 v251, v174, v175
    s_add_u32 s60, s60, 4096
    buffer_store_dwordx4 v[248:251], v234, s[48:51], s60 offen offset:0 sc1
    s_waitcnt vmcnt(50)
    s_add_u32 s60, s55, 40960
    v_accvgpr_read_b32 v160, a160
    v_accvgpr_read_b32 v164, a180
    v_accvgpr_read_b32 v161, a161
    v_accvgpr_read_b32 v165, a181
    v_accvgpr_read_b32 v162, a162
    v_accvgpr_read_b32 v166, a182
    v_accvgpr_read_b32 v163, a163
    v_accvgpr_read_b32 v167, a183
    v_pk_mul_f32 v[160:161], v[160:161], v[180:181]
    v_pk_mul_f32 v[162:163], v[162:163], v[180:181]
    v_pk_mul_f32 v[164:165], v[164:165], v[180:181]
    v_pk_mul_f32 v[166:167], v[166:167], v[180:181]
    v_cvt_pk_bf16_f32 v176, v160, v161
    v_cvt_pk_bf16_f32 v177, v162, v163
    v_cvt_pk_bf16_f32 v178, v164, v165
    v_cvt_pk_bf16_f32 v179, v166, v167
    buffer_store_dwordx4 v[176:179], v234, s[48:51], s60 offen offset:0 sc1
    v_accvgpr_read_b32 v168, a164
    v_accvgpr_read_b32 v172, a184
    v_accvgpr_read_b32 v169, a165
    v_accvgpr_read_b32 v173, a185
    v_accvgpr_read_b32 v170, a166
    v_accvgpr_read_b32 v174, a186
    v_accvgpr_read_b32 v171, a167
    v_accvgpr_read_b32 v175, a187
    v_pk_mul_f32 v[168:169], v[168:169], v[182:183]
    v_pk_mul_f32 v[170:171], v[170:171], v[182:183]
    v_pk_mul_f32 v[172:173], v[172:173], v[182:183]
    v_pk_mul_f32 v[174:175], v[174:175], v[182:183]
    v_cvt_pk_bf16_f32 v192, v168, v169
    v_cvt_pk_bf16_f32 v193, v170, v171
    v_cvt_pk_bf16_f32 v194, v172, v173
    v_cvt_pk_bf16_f32 v195, v174, v175
    buffer_store_dwordx4 v[192:195], v234, s[48:51], s60 offen offset:1024 sc1
    v_accvgpr_read_b32 v160, a168
    v_accvgpr_read_b32 v164, a188
    v_accvgpr_read_b32 v161, a169
    v_accvgpr_read_b32 v165, a189
    v_accvgpr_read_b32 v162, a170
    v_accvgpr_read_b32 v166, a190
    v_accvgpr_read_b32 v163, a171
    v_accvgpr_read_b32 v167, a191
    v_pk_mul_f32 v[160:161], v[160:161], v[184:185]
    v_pk_mul_f32 v[162:163], v[162:163], v[184:185]
    v_pk_mul_f32 v[164:165], v[164:165], v[184:185]
    v_pk_mul_f32 v[166:167], v[166:167], v[184:185]
    v_cvt_pk_bf16_f32 v196, v160, v161
    v_cvt_pk_bf16_f32 v197, v162, v163
    v_cvt_pk_bf16_f32 v198, v164, v165
    v_cvt_pk_bf16_f32 v199, v166, v167
    buffer_store_dwordx4 v[196:199], v234, s[48:51], s60 offen offset:2048 sc1
    v_accvgpr_read_b32 v168, a172
    v_accvgpr_read_b32 v172, a192
    v_accvgpr_read_b32 v169, a173
    v_accvgpr_read_b32 v173, a193
    v_accvgpr_read_b32 v170, a174
    v_accvgpr_read_b32 v174, a194
    v_accvgpr_read_b32 v171, a175
    v_accvgpr_read_b32 v175, a195
    v_pk_mul_f32 v[168:169], v[168:169], v[186:187]
    v_pk_mul_f32 v[170:171], v[170:171], v[186:187]
    v_pk_mul_f32 v[172:173], v[172:173], v[186:187]
    v_pk_mul_f32 v[174:175], v[174:175], v[186:187]
    v_cvt_pk_bf16_f32 v248, v168, v169
    v_cvt_pk_bf16_f32 v249, v170, v171
    v_cvt_pk_bf16_f32 v250, v172, v173
    v_cvt_pk_bf16_f32 v251, v174, v175
    buffer_store_dwordx4 v[248:251], v234, s[48:51], s60 offen offset:3072 sc1
    v_accvgpr_read_b32 v160, a176
    v_accvgpr_read_b32 v164, a196
    v_accvgpr_read_b32 v161, a177
    v_accvgpr_read_b32 v165, a197
    v_accvgpr_read_b32 v162, a178
    v_accvgpr_read_b32 v166, a198
    v_accvgpr_read_b32 v163, a179
    v_accvgpr_read_b32 v167, a199
    v_pk_mul_f32 v[160:161], v[160:161], v[188:189]
    v_pk_mul_f32 v[162:163], v[162:163], v[188:189]
    v_pk_mul_f32 v[164:165], v[164:165], v[188:189]
    v_pk_mul_f32 v[166:167], v[166:167], v[188:189]
    v_cvt_pk_bf16_f32 v176, v160, v161
    v_cvt_pk_bf16_f32 v177, v162, v163
    v_cvt_pk_bf16_f32 v178, v164, v165
    v_cvt_pk_bf16_f32 v179, v166, v167
    s_add_u32 s60, s60, 4096
    buffer_store_dwordx4 v[176:179], v234, s[48:51], s60 offen offset:0 sc1
    s_add_u32 s60, s55, 51200
    v_accvgpr_read_b32 v168, a200
    v_accvgpr_read_b32 v172, a220
    v_accvgpr_read_b32 v169, a201
    v_accvgpr_read_b32 v173, a221
    v_accvgpr_read_b32 v170, a202
    v_accvgpr_read_b32 v174, a222
    v_accvgpr_read_b32 v171, a203
    v_accvgpr_read_b32 v175, a223
    v_pk_mul_f32 v[168:169], v[168:169], v[180:181]
    v_pk_mul_f32 v[170:171], v[170:171], v[180:181]
    v_pk_mul_f32 v[172:173], v[172:173], v[180:181]
    v_pk_mul_f32 v[174:175], v[174:175], v[180:181]
    v_cvt_pk_bf16_f32 v192, v168, v169
    v_cvt_pk_bf16_f32 v193, v170, v171
    v_cvt_pk_bf16_f32 v194, v172, v173
    v_cvt_pk_bf16_f32 v195, v174, v175
    buffer_store_dwordx4 v[192:195], v234, s[48:51], s60 offen offset:0 sc1
    v_accvgpr_read_b32 v160, a204
    v_accvgpr_read_b32 v164, a224
    v_accvgpr_read_b32 v161, a205
    v_accvgpr_read_b32 v165, a225
    v_accvgpr_read_b32 v162, a206
    v_accvgpr_read_b32 v166, a226
    v_accvgpr_read_b32 v163, a207
    v_accvgpr_read_b32 v167, a227
    v_pk_mul_f32 v[160:161], v[160:161], v[182:183]
    v_pk_mul_f32 v[162:163], v[162:163], v[182:183]
    v_pk_mul_f32 v[164:165], v[164:165], v[182:183]
    v_pk_mul_f32 v[166:167], v[166:167], v[182:183]
    v_cvt_pk_bf16_f32 v196, v160, v161
    v_cvt_pk_bf16_f32 v197, v162, v163
    v_cvt_pk_bf16_f32 v198, v164, v165
    v_cvt_pk_bf16_f32 v199, v166, v167
    buffer_store_dwordx4 v[196:199], v234, s[48:51], s60 offen offset:1024 sc1
    v_accvgpr_read_b32 v168, a208
    v_accvgpr_read_b32 v172, a228
    v_accvgpr_read_b32 v169, a209
    v_accvgpr_read_b32 v173, a229
    v_accvgpr_read_b32 v170, a210
    v_accvgpr_read_b32 v174, a230
    v_accvgpr_read_b32 v171, a211
    v_accvgpr_read_b32 v175, a231
    v_pk_mul_f32 v[168:169], v[168:169], v[184:185]
    v_pk_mul_f32 v[170:171], v[170:171], v[184:185]
    v_pk_mul_f32 v[172:173], v[172:173], v[184:185]
    v_pk_mul_f32 v[174:175], v[174:175], v[184:185]
    v_cvt_pk_bf16_f32 v248, v168, v169
    v_cvt_pk_bf16_f32 v249, v170, v171
    v_cvt_pk_bf16_f32 v250, v172, v173
    v_cvt_pk_bf16_f32 v251, v174, v175
    buffer_store_dwordx4 v[248:251], v234, s[48:51], s60 offen offset:2048 sc1
    v_accvgpr_read_b32 v160, a212
    v_accvgpr_read_b32 v164, a232
    v_accvgpr_read_b32 v161, a213
    v_accvgpr_read_b32 v165, a233
    v_accvgpr_read_b32 v162, a214
    v_accvgpr_read_b32 v166, a234
    v_accvgpr_read_b32 v163, a215
    v_accvgpr_read_b32 v167, a235
    v_pk_mul_f32 v[160:161], v[160:161], v[186:187]
    v_pk_mul_f32 v[162:163], v[162:163], v[186:187]
    v_pk_mul_f32 v[164:165], v[164:165], v[186:187]
    v_pk_mul_f32 v[166:167], v[166:167], v[186:187]
    v_cvt_pk_bf16_f32 v176, v160, v161
    v_cvt_pk_bf16_f32 v177, v162, v163
    v_cvt_pk_bf16_f32 v178, v164, v165
    v_cvt_pk_bf16_f32 v179, v166, v167
    buffer_store_dwordx4 v[176:179], v234, s[48:51], s60 offen offset:3072 sc1
    v_accvgpr_read_b32 v168, a216
    v_accvgpr_read_b32 v172, a236
    v_accvgpr_read_b32 v169, a217
    v_accvgpr_read_b32 v173, a237
    v_accvgpr_read_b32 v170, a218
    v_accvgpr_read_b32 v174, a238
    v_accvgpr_read_b32 v171, a219
    v_accvgpr_read_b32 v175, a239
    v_pk_mul_f32 v[168:169], v[168:169], v[188:189]
    v_pk_mul_f32 v[170:171], v[170:171], v[188:189]
    v_pk_mul_f32 v[172:173], v[172:173], v[188:189]
    v_pk_mul_f32 v[174:175], v[174:175], v[188:189]
    v_cvt_pk_bf16_f32 v192, v168, v169
    v_cvt_pk_bf16_f32 v193, v170, v171
    v_cvt_pk_bf16_f32 v194, v172, v173
    v_cvt_pk_bf16_f32 v195, v174, v175
    s_add_u32 s60, s60, 4096
    buffer_store_dwordx4 v[192:195], v234, s[48:51], s60 offen offset:0 sc1
    s_barrier
    ds_read_b64_tr_b16 a[240:241], v106 offset:0
    ds_read_b128 v[120:123], v110 offset:0
    ds_read_b64_tr_b16 a[242:243], v106 offset:5120
    ds_read_b128 v[140:143], v110 offset:10240
    ds_read_b64_tr_b16 a[244:245], v106 offset:10240
    ds_read_b128 v[124:127], v110 offset:1024
    ds_read_b64_tr_b16 a[246:247], v106 offset:15360
    ds_read_b128 v[144:147], v110 offset:11264
    ds_read_b128 v[128:131], v110 offset:2048
    ds_read_b64_tr_b16 a[248:249], v107 offset:32
    ds_read_b64_tr_b16 a[250:251], v107 offset:5152
    ds_read_b64_tr_b16 a[252:253], v107 offset:10272
    ds_read_b64_tr_b16 a[254:255], v107 offset:15392
    ds_read_b128 v[148:151], v110 offset:12288
    ds_read_b128 v[132:135], v110 offset:3072
    ds_read_b128 v[152:155], v110 offset:13312
    ds_read_b128 v[136:139], v110 offset:4096
    ds_read_b128 v[156:159], v110 offset:14336
    s_mov_b32 s21, 0
    s_add_u32 s3, s21, 1
    s_cmp_ge_u32 s3, s20
    s_cselect_b32 s13, s5, -1
    s_cselect_b32 s18, 0x7f000000, s18
    s_cselect_b32 s19, 0x7f000000, s19
    s_cselect_b32 s26, 0x7f000000, s26
    s_cselect_b32 s28, 0x7f000000, s28
    s_waitcnt lgkmcnt(11)
    v_mfma_f32_16x16x32_bf16 v[0:3], a[240:243], v[120:123], v[0:3]
    ds_read_b64_tr_b16 v[208:209], v106 offset:64
    v_mfma_f32_16x16x32_bf16 v[0:3], a[244:247], v[140:143], v[0:3]
    v_mfma_f32_16x16x32_bf16 v[4:7], a[240:243], v[124:127], v[4:7]
    ds_read_b64_tr_b16 v[210:211], v106 offset:5184
    s_waitcnt lgkmcnt(12)
    v_mfma_f32_16x16x32_bf16 v[4:7], a[244:247], v[144:147], v[4:7]
    s_waitcnt lgkmcnt(11)
    v_mfma_f32_16x16x32_bf16 v[8:11], a[240:243], v[128:131], v[8:11]
    ds_read_b64_tr_b16 v[212:213], v106 offset:10304
    s_waitcnt lgkmcnt(7)
    v_mfma_f32_16x16x32_bf16 v[8:11], a[244:247], v[148:151], v[8:11]
    s_waitcnt lgkmcnt(6)
    v_mfma_f32_16x16x32_bf16 v[12:15], a[240:243], v[132:135], v[12:15]
    ds_read_b64_tr_b16 v[214:215], v106 offset:15424
    s_waitcnt lgkmcnt(6)
    v_mfma_f32_16x16x32_bf16 v[12:15], a[244:247], v[152:155], v[12:15]
    s_waitcnt lgkmcnt(5)
    v_mfma_f32_16x16x32_bf16 v[16:19], a[240:243], v[136:139], v[16:19]
    s_waitcnt lgkmcnt(4)
    v_mfma_f32_16x16x32_bf16 v[16:19], a[244:247], v[156:159], v[16:19]
    v_mfma_f32_16x16x32_bf16 v[20:23], a[248:251], v[120:123], v[20:23]
    ds_read_b64_tr_b16 v[116:117], v107 offset:96
    v_mfma_f32_16x16x32_bf16 v[20:23], a[252:255], v[140:143], v[20:23]
    v_mfma_f32_16x16x32_bf16 v[24:27], a[248:251], v[124:127], v[24:27]
    ds_read_b64_tr_b16 v[118:119], v107 offset:5216
    v_mfma_f32_16x16x32_bf16 v[24:27], a[252:255], v[144:147], v[24:27]
    v_mfma_f32_16x16x32_bf16 v[28:31], a[248:251], v[128:131], v[28:31]
    ds_read_b64_tr_b16 v[200:201], v107 offset:10336
    v_mfma_f32_16x16x32_bf16 v[28:31], a[252:255], v[148:151], v[28:31]
    v_mfma_f32_16x16x32_bf16 v[32:35], a[248:251], v[132:135], v[32:35]
    ds_read_b64_tr_b16 v[202:203], v107 offset:15456
    v_mfma_f32_16x16x32_bf16 v[32:35], a[252:255], v[152:155], v[32:35]
    v_mfma_f32_16x16x32_bf16 v[36:39], a[248:251], v[136:139], v[36:39]
    v_mfma_f32_16x16x32_bf16 v[36:39], a[252:255], v[156:159], v[36:39]
    s_waitcnt lgkmcnt(4)
    v_mfma_f32_16x16x32_bf16 v[40:43], v[208:211], v[120:123], v[40:43]
    ds_read_b64_tr_b16 a[240:241], v106 offset:128
    v_mfma_f32_16x16x32_bf16 v[40:43], v[212:215], v[140:143], v[40:43]
    ds_read_b64_tr_b16 a[242:243], v106 offset:5248
    v_mfma_f32_16x16x32_bf16 v[44:47], v[208:211], v[124:127], v[44:47]
    ds_read_b64_tr_b16 a[244:245], v106 offset:10368
    v_mfma_f32_16x16x32_bf16 v[44:47], v[212:215], v[144:147], v[44:47]
    ds_read_b64_tr_b16 a[246:247], v106 offset:15488
    v_mfma_f32_16x16x32_bf16 v[48:51], v[208:211], v[128:131], v[48:51]
    v_mfma_f32_16x16x32_bf16 v[48:51], v[212:215], v[148:151], v[48:51]
    v_mfma_f32_16x16x32_bf16 v[52:55], v[208:211], v[132:135], v[52:55]
    v_mfma_f32_16x16x32_bf16 v[52:55], v[212:215], v[152:155], v[52:55]
    v_mfma_f32_16x16x32_bf16 v[56:59], v[208:211], v[136:139], v[56:59]
    v_mfma_f32_16x16x32_bf16 v[56:59], v[212:215], v[156:159], v[56:59]
    s_waitcnt vmcnt(50) lgkmcnt(0)
    s_barrier
    v_mfma_f32_16x16x32_bf16 v[60:63], v[116:119], v[120:123], v[60:63]
    ds_read_b64_tr_b16 a[248:249], v108 offset:0
    s_add_u32 m0, s12, 0
    v_mfma_f32_16x16x32_bf16 v[60:63], v[200:203], v[140:143], v[60:63]
    ds_read_b128 v[160:163], v111 offset:0
    buffer_load_dwordx4 v100, s[88:91], s18 offen offset:0 lds
    v_mfma_f32_16x16x32_bf16 v[64:67], v[116:119], v[124:127], v[64:67]
    ds_read_b64_tr_b16 a[250:251], v108 offset:5120
    v_mfma_f32_16x16x32_bf16 v[64:67], v[200:203], v[144:147], v[64:67]
    ds_read_b128 v[180:183], v111 offset:10240
    v_mfma_f32_16x16x32_bf16 v[68:71], v[116:119], v[128:131], v[68:71]
    ds_read_b64_tr_b16 a[252:253], v108 offset:10240
    buffer_load_dwordx4 v101, s[88:91], s18 offen offset:1024 lds
    v_mfma_f32_16x16x32_bf16 v[68:71], v[200:203], v[148:151], v[68:71]
    ds_read_b128 v[164:167], v111 offset:1024
    v_mfma_f32_16x16x32_bf16 v[72:75], v[116:119], v[132:135], v[72:75]
    ds_read_b64_tr_b16 a[254:255], v108 offset:15360
    v_mfma_f32_16x16x32_bf16 v[72:75], v[200:203], v[152:155], v[72:75]
    ds_read_b128 v[184:187], v111 offset:11264
    buffer_load_dwordx4 v102, s[88:91], s18 offen offset:2048 lds
    v_mfma_f32_16x16x32_bf16 v[76:79], v[116:119], v[136:139], v[76:79]
    ds_read_b128 v[168:171], v111 offset:2048
    v_mfma_f32_16x16x32_bf16 v[76:79], v[200:203], v[156:159], v[76:79]
    ds_read_b128 v[188:191], v111 offset:12288
    v_mfma_f32_16x16x32_bf16 v[80:83], a[240:243], v[120:123], v[80:83]
    ds_read_b64_tr_b16 v[208:209], v109 offset:32
    buffer_load_dwordx4 v103, s[88:91], s18 offen offset:3072 lds
    v_mfma_f32_16x16x32_bf16 v[80:83], a[244:247], v[140:143], v[80:83]
    ds_read_b128 v[172:175], v111 offset:3072
    s_add_u32 m0, s12, 4096
    v_mfma_f32_16x16x32_bf16 v[84:87], a[240:243], v[124:127], v[84:87]
    ds_read_b64_tr_b16 v[210:211], v109 offset:5152
    v_mfma_f32_16x16x32_bf16 v[84:87], a[244:247], v[144:147], v[84:87]
    ds_read_b128 v[192:195], v111 offset:13312
    buffer_load_dwordx4 v104, s[88:91], s18 offen lds
    v_mfma_f32_16x16x32_bf16 v[88:91], a[240:243], v[128:131], v[88:91]
    ds_read_b64_tr_b16 v[212:213], v109 offset:10272
    s_add_u32 s18, s18, 327680
    v_mfma_f32_16x16x32_bf16 v[88:91], a[244:247], v[148:151], v[88:91]
    ds_read_b128 v[176:179], v111 offset:4096
    v_mfma_f32_16x16x32_bf16 v[92:95], a[240:243], v[132:135], v[92:95]
    ds_read_b64_tr_b16 v[214:215], v109 offset:15392
    v_mfma_f32_16x16x32_bf16 v[92:95], a[244:247], v[152:155], v[92:95]
    ds_read_b128 v[196:199], v111 offset:14336
    v_mfma_f32_16x16x32_bf16 v[96:99], a[240:243], v[136:139], v[96:99]
    v_mfma_f32_16x16x32_bf16 v[96:99], a[244:247], v[156:159], v[96:99]
    s_waitcnt lgkmcnt(11)
    v_mfma_f32_16x16x32_bf16 v[0:3], a[248:251], v[160:163], v[0:3]
    ds_read_b64_tr_b16 v[116:117], v108 offset:64
    v_mfma_f32_16x16x32_bf16 v[0:3], a[252:255], v[180:183], v[0:3]
    v_mfma_f32_16x16x32_bf16 v[4:7], a[248:251], v[164:167], v[4:7]
    ds_read_b64_tr_b16 v[118:119], v108 offset:5184
    s_waitcnt lgkmcnt(12)
    v_mfma_f32_16x16x32_bf16 v[4:7], a[252:255], v[184:187], v[4:7]
    s_waitcnt lgkmcnt(11)
    v_mfma_f32_16x16x32_bf16 v[8:11], a[248:251], v[168:171], v[8:11]
    ds_read_b64_tr_b16 v[200:201], v108 offset:10304
    s_waitcnt lgkmcnt(11)
    v_mfma_f32_16x16x32_bf16 v[8:11], a[252:255], v[188:191], v[8:11]
    s_waitcnt lgkmcnt(9)
    v_mfma_f32_16x16x32_bf16 v[12:15], a[248:251], v[172:175], v[12:15]
    ds_read_b64_tr_b16 v[202:203], v108 offset:15424
    s_waitcnt lgkmcnt(8)
    v_mfma_f32_16x16x32_bf16 v[12:15], a[252:255], v[192:195], v[12:15]
    s_waitcnt lgkmcnt(6)
    v_mfma_f32_16x16x32_bf16 v[16:19], a[248:251], v[176:179], v[16:19]
    s_waitcnt lgkmcnt(4)
    v_mfma_f32_16x16x32_bf16 v[16:19], a[252:255], v[196:199], v[16:19]
    v_mfma_f32_16x16x32_bf16 v[20:23], v[208:211], v[160:163], v[20:23]
    ds_read_b64_tr_b16 a[240:241], v109 offset:96
    v_mfma_f32_16x16x32_bf16 v[20:23], v[212:215], v[180:183], v[20:23]
    v_mfma_f32_16x16x32_bf16 v[24:27], v[208:211], v[164:167], v[24:27]
    ds_read_b64_tr_b16 a[242:243], v109 offset:5216
    v_mfma_f32_16x16x32_bf16 v[24:27], v[212:215], v[184:187], v[24:27]
    v_mfma_f32_16x16x32_bf16 v[28:31], v[208:211], v[168:171], v[28:31]
    ds_read_b64_tr_b16 a[244:245], v109 offset:10336
    v_mfma_f32_16x16x32_bf16 v[28:31], v[212:215], v[188:191], v[28:31]
    v_mfma_f32_16x16x32_bf16 v[32:35], v[208:211], v[172:175], v[32:35]
    ds_read_b64_tr_b16 a[246:247], v109 offset:15456
    v_mfma_f32_16x16x32_bf16 v[32:35], v[212:215], v[192:195], v[32:35]
    v_mfma_f32_16x16x32_bf16 v[36:39], v[208:211], v[176:179], v[36:39]
    v_mfma_f32_16x16x32_bf16 v[36:39], v[212:215], v[196:199], v[36:39]
    s_waitcnt lgkmcnt(4)
    v_mfma_f32_16x16x32_bf16 v[40:43], v[116:119], v[160:163], v[40:43]
    ds_read_b64_tr_b16 a[248:249], v108 offset:128
    v_mfma_f32_16x16x32_bf16 v[40:43], v[200:203], v[180:183], v[40:43]
    ds_read_b64_tr_b16 a[250:251], v108 offset:5248
    v_mfma_f32_16x16x32_bf16 v[44:47], v[116:119], v[164:167], v[44:47]
    ds_read_b64_tr_b16 a[252:253], v108 offset:10368
    v_mfma_f32_16x16x32_bf16 v[44:47], v[200:203], v[184:187], v[44:47]
    ds_read_b64_tr_b16 a[254:255], v108 offset:15488
    v_mfma_f32_16x16x32_bf16 v[48:51], v[116:119], v[168:171], v[48:51]
    v_mfma_f32_16x16x32_bf16 v[48:51], v[200:203], v[188:191], v[48:51]
    v_mfma_f32_16x16x32_bf16 v[52:55], v[116:119], v[172:175], v[52:55]
    v_mfma_f32_16x16x32_bf16 v[52:55], v[200:203], v[192:195], v[52:55]
    v_mfma_f32_16x16x32_bf16 v[56:59], v[116:119], v[176:179], v[56:59]
    v_mfma_f32_16x16x32_bf16 v[56:59], v[200:203], v[196:199], v[56:59]
    s_waitcnt vmcnt(5) lgkmcnt(0)
    s_barrier
    v_mfma_f32_16x16x32_bf16 v[60:63], a[240:243], v[160:163], v[60:63]
    ds_read_b64_tr_b16 v[208:209], v106 offset:40960
    v_mov_b32 v206, s97
    v_mfma_f32_16x16x32_bf16 v[60:63], a[244:247], v[180:183], v[60:63]
    ds_read_b128 v[120:123], v110 offset:40960
    buffer_atomic_add v206, v205, s[48:51], s96 offen sc1
    v_mfma_f32_16x16x32_bf16 v[64:67], a[240:243], v[164:167], v[64:67]
    ds_read_b64_tr_b16 v[210:211], v106 offset:46080
    s_mov_b32 s96, 0x7f000000
    v_mfma_f32_16x16x32_bf16 v[64:67], a[244:247], v[184:187], v[64:67]
    ds_read_b128 v[140:143], v110 offset:51200
    v_mfma_f32_16x16x32_bf16 v[68:71], a[240:243], v[168:171], v[68:71]
    ds_read_b64_tr_b16 v[212:213], v106 offset:51200
    v_mfma_f32_16x16x32_bf16 v[68:71], a[244:247], v[188:191], v[68:71]
    ds_read_b128 v[124:127], v110 offset:41984
    buffer_load_dword v113, v114, s[48:51], s25 offen sc1
    v_mfma_f32_16x16x32_bf16 v[72:75], a[240:243], v[172:175], v[72:75]
    ds_read_b64_tr_b16 v[214:215], v106 offset:56320
    v_mfma_f32_16x16x32_bf16 v[72:75], a[244:247], v[192:195], v[72:75]
    ds_read_b128 v[144:147], v110 offset:52224
    v_mfma_f32_16x16x32_bf16 v[76:79], a[240:243], v[176:179], v[76:79]
    ds_read_b128 v[128:131], v110 offset:43008
    v_mfma_f32_16x16x32_bf16 v[76:79], a[244:247], v[196:199], v[76:79]
    ds_read_b128 v[148:151], v110 offset:53248
    v_mfma_f32_16x16x32_bf16 v[80:83], a[248:251], v[160:163], v[80:83]
    ds_read_b64_tr_b16 v[116:117], v107 offset:40992
    buffer_load_dword v115, v114, s[48:51], s31 offen sc1
    v_mfma_f32_16x16x32_bf16 v[80:83], a[252:255], v[180:183], v[80:83]
    ds_read_b128 v[132:135], v110 offset:44032
    s_add_u32 m0, s12, 20480
    v_mfma_f32_16x16x32_bf16 v[84:87], a[248:251], v[164:167], v[84:87]
    ds_read_b64_tr_b16 v[118:119], v107 offset:46112
    v_mfma_f32_16x16x32_bf16 v[84:87], a[252:255], v[184:187], v[84:87]
    ds_read_b128 v[152:155], v110 offset:54272
    v_mfma_f32_16x16x32_bf16 v[88:91], a[248:251], v[168:171], v[88:91]
    ds_read_b64_tr_b16 v[200:201], v107 offset:51232
    buffer_load_dwordx4 v105, s[48:51], s19 offen offset:0 sc1 lds
    v_mfma_f32_16x16x32_bf16 v[88:91], a[252:255], v[188:191], v[88:91]
    ds_read_b128 v[136:139], v110 offset:45056
    v_mfma_f32_16x16x32_bf16 v[92:95], a[248:251], v[172:175], v[92:95]
    ds_read_b64_tr_b16 v[202:203], v107 offset:56352
    v_mfma_f32_16x16x32_bf16 v[92:95], a[252:255], v[192:195], v[92:95]
    ds_read_b128 v[156:159], v110 offset:55296
    v_mfma_f32_16x16x32_bf16 v[96:99], a[248:251], v[176:179], v[96:99]
    buffer_load_dwordx4 v105, s[48:51], s19 offen offset:1024 sc1 lds
    v_mfma_f32_16x16x32_bf16 v[96:99], a[252:255], v[196:199], v[96:99]
    s_waitcnt lgkmcnt(11)
    v_mfma_f32_16x16x32_bf16 v[0:3], v[208:211], v[120:123], v[0:3]
    ds_read_b64_tr_b16 a[240:241], v106 offset:41024
    v_mfma_f32_16x16x32_bf16 v[0:3], v[212:215], v[140:143], v[0:3]
    v_mfma_f32_16x16x32_bf16 v[4:7], v[208:211], v[124:127], v[4:7]
    ds_read_b64_tr_b16 a[242:243], v106 offset:46144
    buffer_load_dwordx4 v105, s[48:51], s19 offen offset:2048 sc1 lds
    s_waitcnt lgkmcnt(12)
    v_mfma_f32_16x16x32_bf16 v[4:7], v[212:215], v[144:147], v[4:7]
    s_waitcnt lgkmcnt(11)
    v_mfma_f32_16x16x32_bf16 v[8:11], v[208:211], v[128:131], v[8:11]
    ds_read_b64_tr_b16 a[244:245], v106 offset:51264
    s_waitcnt lgkmcnt(11)
    v_mfma_f32_16x16x32_bf16 v[8:11], v[212:215], v[148:151], v[8:11]
    s_waitcnt lgkmcnt(9)
    v_mfma_f32_16x16x32_bf16 v[12:15], v[208:211], v[132:135], v[12:15]
    ds_read_b64_tr_b16 a[246:247], v106 offset:56384
    buffer_load_dwordx4 v105, s[48:51], s19 offen offset:3072 sc1 lds
    s_waitcnt lgkmcnt(8)
    v_mfma_f32_16x16x32_bf16 v[12:15], v[212:215], v[152:155], v[12:15]
    s_add_u32 m0, s12, 24576
    s_waitcnt lgkmcnt(6)
    v_mfma_f32_16x16x32_bf16 v[16:19], v[208:211], v[136:139], v[16:19]
    s_waitcnt lgkmcnt(4)
    v_mfma_f32_16x16x32_bf16 v[16:19], v[212:215], v[156:159], v[16:19]
    v_mfma_f32_16x16x32_bf16 v[20:23], v[116:119], v[120:123], v[20:23]
    ds_read_b64_tr_b16 a[248:249], v107 offset:41056
    buffer_load_dwordx4 v112, s[48:51], s19 offen sc1 lds
    v_mfma_f32_16x16x32_bf16 v[20:23], v[200:203], v[140:143], v[20:23]
    s_add_u32 s19, s19, 81920
    v_mfma_f32_16x16x32_bf16 v[24:27], v[116:119], v[124:127], v[24:27]
    ds_read_b64_tr_b16 a[250:251], v107 offset:46176
    v_mfma_f32_16x16x32_bf16 v[24:27], v[200:203], v[144:147], v[24:27]
    v_mfma_f32_16x16x32_bf16 v[28:31], v[116:119], v[128:131], v[28:31]
    ds_read_b64_tr_b16 a[252:253], v107 offset:51296
    v_mfma_f32_16x16x32_bf16 v[28:31], v[200:203], v[148:151], v[28:31]
    v_mfma_f32_16x16x32_bf16 v[32:35], v[116:119], v[132:135], v[32:35]
    ds_read_b64_tr_b16 a[254:255], v107 offset:56416
    v_mfma_f32_16x16x32_bf16 v[32:35], v[200:203], v[152:155], v[32:35]
    v_mfma_f32_16x16x32_bf16 v[36:39], v[116:119], v[136:139], v[36:39]
    v_mfma_f32_16x16x32_bf16 v[36:39], v[200:203], v[156:159], v[36:39]
    s_waitcnt lgkmcnt(4)
    v_mfma_f32_16x16x32_bf16 v[40:43], a[240:243], v[120:123], v[40:43]
    ds_read_b64_tr_b16 v[208:209], v106 offset:41088
    v_mfma_f32_16x16x32_bf16 v[40:43], a[244:247], v[140:143], v[40:43]
    ds_read_b64_tr_b16 v[210:211], v106 offset:46208
    v_mfma_f32_16x16x32_bf16 v[44:47], a[240:243], v[124:127], v[44:47]
    ds_read_b64_tr_b16 v[212:213], v106 offset:51328
    v_mfma_f32_16x16x32_bf16 v[44:47], a[244:247], v[144:147], v[44:47]
    ds_read_b64_tr_b16 v[214:215], v106 offset:56448
    v_mfma_f32_16x16x32_bf16 v[48:51], a[240:243], v[128:131], v[48:51]
    v_mfma_f32_16x16x32_bf16 v[48:51], a[244:247], v[148:151], v[48:51]
    v_mfma_f32_16x16x32_bf16 v[52:55], a[240:243], v[132:135], v[52:55]
    v_mfma_f32_16x16x32_bf16 v[52:55], a[244:247], v[152:155], v[52:55]
    v_mfma_f32_16x16x32_bf16 v[56:59], a[240:243], v[136:139], v[56:59]
    v_mfma_f32_16x16x32_bf16 v[56:59], a[244:247], v[156:159], v[56:59]
    s_waitcnt lgkmcnt(0)
    s_barrier
    v_mfma_f32_16x16x32_bf16 v[60:63], a[248:251], v[120:123], v[60:63]
    ds_read_b64_tr_b16 v[116:117], v108 offset:40960
    s_add_u32 m0, s12, 81920
    v_mfma_f32_16x16x32_bf16 v[60:63], a[252:255], v[140:143], v[60:63]
    ds_read_b128 v[160:163], v111 offset:40960
    buffer_load_dwordx4 v100, s[88:91], s26 offen offset:0 lds
    v_mfma_f32_16x16x32_bf16 v[64:67], a[248:251], v[124:127], v[64:67]
    ds_read_b64_tr_b16 v[118:119], v108 offset:46080
    v_mfma_f32_16x16x32_bf16 v[64:67], a[252:255], v[144:147], v[64:67]
    ds_read_b128 v[180:183], v111 offset:51200
    v_mfma_f32_16x16x32_bf16 v[68:71], a[248:251], v[128:131], v[68:71]
    ds_read_b64_tr_b16 v[200:201], v108 offset:51200
    v_mfma_f32_16x16x32_bf16 v[68:71], a[252:255], v[148:151], v[68:71]
    ds_read_b128 v[164:167], v111 offset:41984
    buffer_load_dwordx4 v101, s[88:91], s26 offen offset:1024 lds
    v_mfma_f32_16x16x32_bf16 v[72:75], a[248:251], v[132:135], v[72:75]
    ds_read_b64_tr_b16 v[202:203], v108 offset:56320
    v_mfma_f32_16x16x32_bf16 v[72:75], a[252:255], v[152:155], v[72:75]
    ds_read_b128 v[184:187], v111 offset:52224
    v_mfma_f32_16x16x32_bf16 v[76:79], a[248:251], v[136:139], v[76:79]
    ds_read_b128 v[168:171], v111 offset:43008
    v_mfma_f32_16x16x32_bf16 v[76:79], a[252:255], v[156:159], v[76:79]
    ds_read_b128 v[188:191], v111 offset:53248
    v_mfma_f32_16x16x32_bf16 v[80:83], v[208:211], v[120:123], v[80:83]
    ds_read_b64_tr_b16 a[240:241], v109 offset:40992
    buffer_load_dwordx4 v102, s[88:91], s26 offen offset:2048 lds
    v_mfma_f32_16x16x32_bf16 v[80:83], v[212:215], v[140:143], v[80:83]
    ds_read_b128 v[172:175], v111 offset:44032
    v_mfma_f32_16x16x32_bf16 v[84:87], v[208:211], v[124:127], v[84:87]
    ds_read_b64_tr_b16 a[242:243], v109 offset:46112
    v_mfma_f32_16x16x32_bf16 v[84:87], v[212:215], v[144:147], v[84:87]
    ds_read_b128 v[192:195], v111 offset:54272
    v_mfma_f32_16x16x32_bf16 v[88:91], v[208:211], v[128:131], v[88:91]
    ds_read_b64_tr_b16 a[244:245], v109 offset:51232
    buffer_load_dwordx4 v103, s[88:91], s26 offen offset:3072 lds
    v_mfma_f32_16x16x32_bf16 v[88:91], v[212:215], v[148:151], v[88:91]
    ds_read_b128 v[176:179], v111 offset:45056
    s_add_u32 m0, s12, 86016
    v_mfma_f32_16x16x32_bf16 v[92:95], v[208:211], v[132:135], v[92:95]
    ds_read_b64_tr_b16 a[246:247], v109 offset:56352
    v_mfma_f32_16x16x32_bf16 v[92:95], v[212:215], v[152:155], v[92:95]
    ds_read_b128 v[196:199], v111 offset:55296
    v_mfma_f32_16x16x32_bf16 v[96:99], v[208:211], v[136:139], v[96:99]
    buffer_load_dwordx4 v104, s[88:91], s26 offen lds
    s_add_u32 s26, s26, 327680
    v_mfma_f32_16x16x32_bf16 v[96:99], v[212:215], v[156:159], v[96:99]
    s_add_u32 m0, s12, 102400
    s_waitcnt lgkmcnt(11)
    v_mfma_f32_16x16x32_bf16 v[0:3], v[116:119], v[160:163], v[0:3]
    ds_read_b64_tr_b16 a[248:249], v108 offset:41024
    v_mfma_f32_16x16x32_bf16 v[0:3], v[200:203], v[180:183], v[0:3]
    v_mfma_f32_16x16x32_bf16 v[4:7], v[116:119], v[164:167], v[4:7]
    ds_read_b64_tr_b16 a[250:251], v108 offset:46144
    buffer_load_dwordx4 v105, s[48:51], s28 offen offset:0 sc1 lds
    s_waitcnt lgkmcnt(12)
    v_mfma_f32_16x16x32_bf16 v[4:7], v[200:203], v[184:187], v[4:7]
    s_waitcnt lgkmcnt(11)
    v_mfma_f32_16x16x32_bf16 v[8:11], v[116:119], v[168:171], v[8:11]
    ds_read_b64_tr_b16 a[252:253], v108 offset:51264
    s_waitcnt lgkmcnt(11)
    v_mfma_f32_16x16x32_bf16 v[8:11], v[200:203], v[188:191], v[8:11]
    s_waitcnt lgkmcnt(9)
    v_mfma_f32_16x16x32_bf16 v[12:15], v[116:119], v[172:175], v[12:15]
    ds_read_b64_tr_b16 a[254:255], v108 offset:56384
    buffer_load_dwordx4 v105, s[48:51], s28 offen offset:1024 sc1 lds
    s_waitcnt lgkmcnt(8)
    v_mfma_f32_16x16x32_bf16 v[12:15], v[200:203], v[192:195], v[12:15]
    s_waitcnt lgkmcnt(6)
    v_mfma_f32_16x16x32_bf16 v[16:19], v[116:119], v[176:179], v[16:19]
    s_waitcnt lgkmcnt(4)
    v_mfma_f32_16x16x32_bf16 v[16:19], v[200:203], v[196:199], v[16:19]
    v_mfma_f32_16x16x32_bf16 v[20:23], a[240:243], v[160:163], v[20:23]
    ds_read_b64_tr_b16 v[208:209], v109 offset:41056
    buffer_load_dwordx4 v105, s[48:51], s28 offen offset:2048 sc1 lds
    v_mfma_f32_16x16x32_bf16 v[20:23], a[244:247], v[180:183], v[20:23]
    v_mfma_f32_16x16x32_bf16 v[24:27], a[240:243], v[164:167], v[24:27]
    ds_read_b64_tr_b16 v[210:211], v109 offset:46176
    v_mfma_f32_16x16x32_bf16 v[24:27], a[244:247], v[184:187], v[24:27]
    v_mfma_f32_16x16x32_bf16 v[28:31], a[240:243], v[168:171], v[28:31]
    ds_read_b64_tr_b16 v[212:213], v109 offset:51296
    buffer_load_dwordx4 v105, s[48:51], s28 offen offset:3072 sc1 lds
    v_mfma_f32_16x16x32_bf16 v[28:31], a[244:247], v[188:191], v[28:31]
    s_add_u32 m0, s12, 106496
    v_mfma_f32_16x16x32_bf16 v[32:35], a[240:243], v[172:175], v[32:35]
    ds_read_b64_tr_b16 v[214:215], v109 offset:56416
    v_mfma_f32_16x16x32_bf16 v[32:35], a[244:247], v[192:195], v[32:35]
    v_mfma_f32_16x16x32_bf16 v[36:39], a[240:243], v[176:179], v[36:39]
    buffer_load_dwordx4 v112, s[48:51], s28 offen sc1 lds
    s_add_u32 s28, s28, 81920
    v_mfma_f32_16x16x32_bf16 v[36:39], a[244:247], v[196:199], v[36:39]
    s_waitcnt lgkmcnt(4)
    v_mfma_f32_16x16x32_bf16 v[40:43], a[248:251], v[160:163], v[40:43]
    ds_read_b64_tr_b16 v[116:117], v108 offset:41088
    v_mfma_f32_16x16x32_bf16 v[40:43], a[252:255], v[180:183], v[40:43]
    ds_read_b64_tr_b16 v[118:119], v108 offset:46208
    v_mfma_f32_16x16x32_bf16 v[44:47], a[248:251], v[164:167], v[44:47]
    ds_read_b64_tr_b16 v[200:201], v108 offset:51328
    v_mfma_f32_16x16x32_bf16 v[44:47], a[252:255], v[184:187], v[44:47]
    ds_read_b64_tr_b16 v[202:203], v108 offset:56448
    v_mfma_f32_16x16x32_bf16 v[48:51], a[248:251], v[168:171], v[48:51]
    v_mfma_f32_16x16x32_bf16 v[48:51], a[252:255], v[188:191], v[48:51]
    v_mfma_f32_16x16x32_bf16 v[52:55], a[248:251], v[172:175], v[52:55]
    v_mfma_f32_16x16x32_bf16 v[52:55], a[252:255], v[192:195], v[52:55]
    v_mfma_f32_16x16x32_bf16 v[56:59], a[248:251], v[176:179], v[56:59]
    v_mfma_f32_16x16x32_bf16 v[56:59], a[252:255], v[196:199], v[56:59]
    s_waitcnt vmcnt(10) lgkmcnt(0)
    s_barrier
    v_mfma_f32_16x16x32_bf16 v[60:63], v[208:211], v[160:163], v[60:63]
    ds_read_b64_tr_b16 a[240:241], v106 offset:0
    s_add_u32 m0, s12, 40960
    v_mfma_f32_16x16x32_bf16 v[60:63], v[212:215], v[180:183], v[60:63]
    ds_read_b128 v[120:123], v110 offset:0
    buffer_load_dwordx4 v100, s[88:91], s27 offen offset:0 lds
    v_mfma_f32_16x16x32_bf16 v[64:67], v[208:211], v[164:167], v[64:67]
    ds_read_b64_tr_b16 a[242:243], v106 offset:5120
    v_mfma_f32_16x16x32_bf16 v[64:67], v[212:215], v[184:187], v[64:67]
    ds_read_b128 v[140:143], v110 offset:10240
    v_mfma_f32_16x16x32_bf16 v[68:71], v[208:211], v[168:171], v[68:71]
    ds_read_b64_tr_b16 a[244:245], v106 offset:10240
    v_mfma_f32_16x16x32_bf16 v[68:71], v[212:215], v[188:191], v[68:71]
    ds_read_b128 v[124:127], v110 offset:1024
    buffer_load_dwordx4 v101, s[88:91], s27 offen offset:1024 lds
    v_mfma_f32_16x16x32_bf16 v[72:75], v[208:211], v[172:175], v[72:75]
    ds_read_b64_tr_b16 a[246:247], v106 offset:15360
    v_mfma_f32_16x16x32_bf16 v[72:75], v[212:215], v[192:195], v[72:75]
    ds_read_b128 v[144:147], v110 offset:11264
    v_mfma_f32_16x16x32_bf16 v[76:79], v[208:211], v[176:179], v[76:79]
    ds_read_b128 v[128:131], v110 offset:2048
    v_mfma_f32_16x16x32_bf16 v[76:79], v[212:215], v[196:199], v[76:79]
    ds_read_b128 v[148:151], v110 offset:12288
    v_mfma_f32_16x16x32_bf16 v[80:83], v[116:119], v[160:163], v[80:83]
    ds_read_b64_tr_b16 a[248:249], v107 offset:32
    buffer_load_dwordx4 v102, s[88:91], s27 offen offset:2048 lds
    v_mfma_f32_16x16x32_bf16 v[80:83], v[200:203], v[180:183], v[80:83]
    ds_read_b128 v[132:135], v110 offset:3072
    v_mfma_f32_16x16x32_bf16 v[84:87], v[116:119], v[164:167], v[84:87]
    ds_read_b64_tr_b16 a[250:251], v107 offset:5152
    v_mfma_f32_16x16x32_bf16 v[84:87], v[200:203], v[184:187], v[84:87]
    ds_read_b128 v[152:155], v110 offset:13312
    v_mfma_f32_16x16x32_bf16 v[88:91], v[116:119], v[168:171], v[88:91]
    ds_read_b64_tr_b16 a[252:253], v107 offset:10272
    buffer_load_dwordx4 v103, s[88:91], s27 offen offset:3072 lds
    v_mfma_f32_16x16x32_bf16 v[88:91], v[200:203], v[188:191], v[88:91]
    ds_read_b128 v[136:139], v110 offset:4096
    v_mfma_f32_16x16x32_bf16 v[92:95], v[116:119], v[172:175], v[92:95]
    ds_read_b64_tr_b16 a[254:255], v107 offset:15392
    v_mfma_f32_16x16x32_bf16 v[92:95], v[200:203], v[192:195], v[92:95]
    ds_read_b128 v[156:159], v110 offset:14336
    v_mfma_f32_16x16x32_bf16 v[96:99], v[116:119], v[176:179], v[96:99]
    v_mfma_f32_16x16x32_bf16 v[96:99], v[200:203], v[196:199], v[96:99]
    s_mov_b32 s21, 1
    s_nop 6
L_op_loop:
    s_cmp_lg_u32 s21, s22
    s_cbranch_scc1 L_op_go
    s_mov_b32 s78, 0
L_op_spin:
    v_readfirstlane_b32 s3, v113
    s_nop 0
    s_and_b32 s3, s3, s23
    s_cmp_eq_u32 s3, s24
    s_nop 0
    s_cbranch_scc1 L_op_pass
    s_sleep 16
    buffer_load_dword v113, v114, s[48:51], s25 offen sc1
    s_waitcnt vmcnt(0)
    s_add_u32 s78, s78, 1
    s_cmp_lt_u32 s78, 1000000
    s_cbranch_scc1 L_op_spin
L_op_pass:
    s_add_u32 s22, s22, 3
    s_lshl_b32 s23, s23, 4
    s_lshl_b32 s24, s24, 4
L_op_go:
    s_add_u32 s3, s21, 1
    s_cmp_ge_u32 s3, s20
    s_cselect_b32 s13, s5, -1
    s_cselect_b32 s18, 0x7f000000, s18
    s_cselect_b32 s19, 0x7f000000, s19
    s_cselect_b32 s26, 0x7f000000, s26
    s_cselect_b32 s28, 0x7f000000, s28
    s_waitcnt lgkmcnt(11)
    v_mfma_f32_16x16x32_bf16 v[0:3], a[240:243], v[120:123], v[0:3]
    ds_read_b64_tr_b16 v[208:209], v106 offset:64
    s_add_u32 m0, s14, 45056
    v_mfma_f32_16x16x32_bf16 v[0:3], a[244:247], v[140:143], v[0:3]
    buffer_load_dwordx4 v104, s[88:91], s27 offen lds
    s_add_u32 s27, s27, 327680
    v_mfma_f32_16x16x32_bf16 v[4:7], a[240:243], v[124:127], v[4:7]
    ds_read_b64_tr_b16 v[210:211], v106 offset:5184
    s_add_u32 m0, s14, 61440
    s_waitcnt lgkmcnt(12)
    v_mfma_f32_16x16x32_bf16 v[4:7], a[244:247], v[144:147], v[4:7]
    s_waitcnt lgkmcnt(11)
    v_mfma_f32_16x16x32_bf16 v[8:11], a[240:243], v[128:131], v[8:11]
    ds_read_b64_tr_b16 v[212:213], v106 offset:10304
    buffer_load_dwordx4 v105, s[48:51], s29 offen offset:0 sc1 lds
    s_waitcnt lgkmcnt(11)
    v_mfma_f32_16x16x32_bf16 v[8:11], a[244:247], v[148:151], v[8:11]
    s_waitcnt lgkmcnt(9)
    v_mfma_f32_16x16x32_bf16 v[12:15], a[240:243], v[132:135], v[12:15]
    ds_read_b64_tr_b16 v[214:215], v106 offset:15424
    s_waitcnt lgkmcnt(8)
    v_mfma_f32_16x16x32_bf16 v[12:15], a[244:247], v[152:155], v[12:15]
    buffer_load_dwordx4 v105, s[48:51], s29 offen offset:1024 sc1 lds
    s_waitcnt lgkmcnt(6)
    v_mfma_f32_16x16x32_bf16 v[16:19], a[240:243], v[136:139], v[16:19]
    s_waitcnt lgkmcnt(4)
    v_mfma_f32_16x16x32_bf16 v[16:19], a[244:247], v[156:159], v[16:19]
    v_mfma_f32_16x16x32_bf16 v[20:23], a[248:251], v[120:123], v[20:23]
    ds_read_b64_tr_b16 v[116:117], v107 offset:96
    buffer_load_dwordx4 v105, s[48:51], s29 offen offset:2048 sc1 lds
    v_mfma_f32_16x16x32_bf16 v[20:23], a[252:255], v[140:143], v[20:23]
    v_mfma_f32_16x16x32_bf16 v[24:27], a[248:251], v[124:127], v[24:27]
    ds_read_b64_tr_b16 v[118:119], v107 offset:5216
    v_mfma_f32_16x16x32_bf16 v[24:27], a[252:255], v[144:147], v[24:27]
    buffer_load_dwordx4 v105, s[48:51], s29 offen offset:3072 sc1 lds
    s_add_u32 m0, s14, 65536
    v_mfma_f32_16x16x32_bf16 v[28:31], a[248:251], v[128:131], v[28:31]
    ds_read_b64_tr_b16 v[200:201], v107 offset:10336
    v_mfma_f32_16x16x32_bf16 v[28:31], a[252:255], v[148:151], v[28:31]
    v_mfma_f32_16x16x32_bf16 v[32:35], a[248:251], v[132:135], v[32:35]
    ds_read_b64_tr_b16 v[202:203], v107 offset:15456
    buffer_load_dwordx4 v112, s[48:51], s29 offen sc1 lds
    v_mfma_f32_16x16x32_bf16 v[32:35], a[252:255], v[152:155], v[32:35]
    s_add_u32 s29, s29, 81920
    s_add_u32 m0, s14, 122880
    v_mfma_f32_16x16x32_bf16 v[36:39], a[248:251], v[136:139], v[36:39]
    v_mfma_f32_16x16x32_bf16 v[36:39], a[252:255], v[156:159], v[36:39]
    buffer_load_dwordx4 v100, s[88:91], s17 offen offset:0 lds
    s_waitcnt lgkmcnt(4)
    v_mfma_f32_16x16x32_bf16 v[40:43], v[208:211], v[120:123], v[40:43]
    ds_read_b64_tr_b16 a[240:241], v106 offset:128
    v_mfma_f32_16x16x32_bf16 v[40:43], v[212:215], v[140:143], v[40:43]
    ds_read_b64_tr_b16 a[242:243], v106 offset:5248
    v_mfma_f32_16x16x32_bf16 v[44:47], v[208:211], v[124:127], v[44:47]
    ds_read_b64_tr_b16 a[244:245], v106 offset:10368
    buffer_load_dwordx4 v101, s[88:91], s17 offen offset:1024 lds
    v_mfma_f32_16x16x32_bf16 v[44:47], v[212:215], v[144:147], v[44:47]
    ds_read_b64_tr_b16 a[246:247], v106 offset:15488
    v_mfma_f32_16x16x32_bf16 v[48:51], v[208:211], v[128:131], v[48:51]
    v_mfma_f32_16x16x32_bf16 v[48:51], v[212:215], v[148:151], v[48:51]
    buffer_load_dwordx4 v102, s[88:91], s17 offen offset:2048 lds
    v_mfma_f32_16x16x32_bf16 v[52:55], v[208:211], v[132:135], v[52:55]
    v_mfma_f32_16x16x32_bf16 v[52:55], v[212:215], v[152:155], v[52:55]
    v_mfma_f32_16x16x32_bf16 v[56:59], v[208:211], v[136:139], v[56:59]
    buffer_load_dwordx4 v103, s[88:91], s17 offen offset:3072 lds
    s_add_u32 m0, s14, 126976
    v_mfma_f32_16x16x32_bf16 v[56:59], v[212:215], v[156:159], v[56:59]
    buffer_load_dwordx4 v104, s[88:91], s17 offen lds
    s_add_u32 s17, s17, 327680
    s_waitcnt vmcnt(15) lgkmcnt(0)
    s_barrier
    v_mfma_f32_16x16x32_bf16 v[60:63], v[116:119], v[120:123], v[60:63]
    ds_read_b64_tr_b16 a[248:249], v108 offset:0
    s_add_u32 m0, s14, 143360
    v_mfma_f32_16x16x32_bf16 v[60:63], v[200:203], v[140:143], v[60:63]
    ds_read_b128 v[160:163], v111 offset:0
    buffer_load_dwordx4 v105, s[48:51], s15 offen offset:0 sc1 lds
    v_mfma_f32_16x16x32_bf16 v[64:67], v[116:119], v[124:127], v[64:67]
    ds_read_b64_tr_b16 a[250:251], v108 offset:5120
    v_mfma_f32_16x16x32_bf16 v[64:67], v[200:203], v[144:147], v[64:67]
    ds_read_b128 v[180:183], v111 offset:10240
    v_mfma_f32_16x16x32_bf16 v[68:71], v[116:119], v[128:131], v[68:71]
    ds_read_b64_tr_b16 a[252:253], v108 offset:10240
    buffer_load_dwordx4 v105, s[48:51], s15 offen offset:1024 sc1 lds
    v_mfma_f32_16x16x32_bf16 v[68:71], v[200:203], v[148:151], v[68:71]
    ds_read_b128 v[164:167], v111 offset:1024
    v_mfma_f32_16x16x32_bf16 v[72:75], v[116:119], v[132:135], v[72:75]
    ds_read_b64_tr_b16 a[254:255], v108 offset:15360
    v_mfma_f32_16x16x32_bf16 v[72:75], v[200:203], v[152:155], v[72:75]
    ds_read_b128 v[184:187], v111 offset:11264
    buffer_load_dwordx4 v105, s[48:51], s15 offen offset:2048 sc1 lds
    v_mfma_f32_16x16x32_bf16 v[76:79], v[116:119], v[136:139], v[76:79]
    ds_read_b128 v[168:171], v111 offset:2048
    v_mfma_f32_16x16x32_bf16 v[76:79], v[200:203], v[156:159], v[76:79]
    ds_read_b128 v[188:191], v111 offset:12288
    v_mfma_f32_16x16x32_bf16 v[80:83], a[240:243], v[120:123], v[80:83]
    ds_read_b64_tr_b16 v[208:209], v109 offset:32
    buffer_load_dwordx4 v105, s[48:51], s15 offen offset:3072 sc1 lds
    v_mfma_f32_16x16x32_bf16 v[80:83], a[244:247], v[140:143], v[80:83]
    ds_read_b128 v[172:175], v111 offset:3072
    s_add_u32 m0, s14, 147456
    v_mfma_f32_16x16x32_bf16 v[84:87], a[240:243], v[124:127], v[84:87]
    ds_read_b64_tr_b16 v[210:211], v109 offset:5152
    v_mfma_f32_16x16x32_bf16 v[84:87], a[244:247], v[144:147], v[84:87]
    ds_read_b128 v[192:195], v111 offset:13312
    buffer_load_dwordx4 v112, s[48:51], s15 offen sc1 lds
    v_mfma_f32_16x16x32_bf16 v[88:91], a[240:243], v[128:131], v[88:91]
    ds_read_b64_tr_b16 v[212:213], v109 offset:10272
    s_add_u32 s15, s15, 81920
    v_mfma_f32_16x16x32_bf16 v[88:91], a[244:247], v[148:151], v[88:91]
    ds_read_b128 v[176:179], v111 offset:4096
    s_add_u32 m0, s12, 0
    v_mfma_f32_16x16x32_bf16 v[92:95], a[240:243], v[132:135], v[92:95]
    ds_read_b64_tr_b16 v[214:215], v109 offset:15392
    buffer_load_dwordx4 v100, s[88:91], s18 offen offset:0 lds
    v_mfma_f32_16x16x32_bf16 v[92:95], a[244:247], v[152:155], v[92:95]
    ds_read_b128 v[196:199], v111 offset:14336
    v_mfma_f32_16x16x32_bf16 v[96:99], a[240:243], v[136:139], v[96:99]
    v_mfma_f32_16x16x32_bf16 v[96:99], a[244:247], v[156:159], v[96:99]
    buffer_load_dwordx4 v101, s[88:91], s18 offen offset:1024 lds
    s_waitcnt lgkmcnt(11)
    v_mfma_f32_16x16x32_bf16 v[0:3], a[248:251], v[160:163], v[0:3]
    ds_read_b64_tr_b16 v[116:117], v108 offset:64
    v_mfma_f32_16x16x32_bf16 v[0:3], a[252:255], v[180:183], v[0:3]
    v_mfma_f32_16x16x32_bf16 v[4:7], a[248:251], v[164:167], v[4:7]
    ds_read_b64_tr_b16 v[118:119], v108 offset:5184
    s_waitcnt lgkmcnt(12)
    v_mfma_f32_16x16x32_bf16 v[4:7], a[252:255], v[184:187], v[4:7]
    buffer_load_dwordx4 v102, s[88:91], s18 offen offset:2048 lds
    s_waitcnt lgkmcnt(11)
    v_mfma_f32_16x16x32_bf16 v[8:11], a[248:251], v[168:171], v[8:11]
    ds_read_b64_tr_b16 v[200:201], v108 offset:10304
    s_waitcnt lgkmcnt(11)
    v_mfma_f32_16x16x32_bf16 v[8:11], a[252:255], v[188:191], v[8:11]
    s_waitcnt lgkmcnt(9)
    v_mfma_f32_16x16x32_bf16 v[12:15], a[248:251], v[172:175], v[12:15]
    ds_read_b64_tr_b16 v[202:203], v108 offset:15424
    s_waitcnt lgkmcnt(8)
    v_mfma_f32_16x16x32_bf16 v[12:15], a[252:255], v[192:195], v[12:15]
    buffer_load_dwordx4 v103, s[88:91], s18 offen offset:3072 lds
    s_add_u32 m0, s12, 4096
    s_waitcnt lgkmcnt(6)
    v_mfma_f32_16x16x32_bf16 v[16:19], a[248:251], v[176:179], v[16:19]
    s_waitcnt lgkmcnt(4)
    v_mfma_f32_16x16x32_bf16 v[16:19], a[252:255], v[196:199], v[16:19]
    v_mfma_f32_16x16x32_bf16 v[20:23], v[208:211], v[160:163], v[20:23]
    ds_read_b64_tr_b16 a[240:241], v109 offset:96
    v_mfma_f32_16x16x32_bf16 v[20:23], v[212:215], v[180:183], v[20:23]
    buffer_load_dwordx4 v104, s[88:91], s18 offen lds
    s_add_u32 s18, s18, 327680
    v_mfma_f32_16x16x32_bf16 v[24:27], v[208:211], v[164:167], v[24:27]
    ds_read_b64_tr_b16 a[242:243], v109 offset:5216
    v_mfma_f32_16x16x32_bf16 v[24:27], v[212:215], v[184:187], v[24:27]
    v_mfma_f32_16x16x32_bf16 v[28:31], v[208:211], v[168:171], v[28:31]
    ds_read_b64_tr_b16 a[244:245], v109 offset:10336
    v_mfma_f32_16x16x32_bf16 v[28:31], v[212:215], v[188:191], v[28:31]
    v_mfma_f32_16x16x32_bf16 v[32:35], v[208:211], v[172:175], v[32:35]
    ds_read_b64_tr_b16 a[246:247], v109 offset:15456
    v_mfma_f32_16x16x32_bf16 v[32:35], v[212:215], v[192:195], v[32:35]
    v_mfma_f32_16x16x32_bf16 v[36:39], v[208:211], v[176:179], v[36:39]
    v_mfma_f32_16x16x32_bf16 v[36:39], v[212:215], v[196:199], v[36:39]
    s_waitcnt lgkmcnt(4)
    v_mfma_f32_16x16x32_bf16 v[40:43], v[116:119], v[160:163], v[40:43]
    ds_read_b64_tr_b16 a[248:249], v108 offset:128
    v_mfma_f32_16x16x32_bf16 v[40:43], v[200:203], v[180:183], v[40:43]
    ds_read_b64_tr_b16 a[250:251], v108 offset:5248
    v_mfma_f32_16x16x32_bf16 v[44:47], v[116:119], v[164:167], v[44:47]
    ds_read_b64_tr_b16 a[252:253], v108 offset:10368
    v_mfma_f32_16x16x32_bf16 v[44:47], v[200:203], v[184:187], v[44:47]
    ds_read_b64_tr_b16 a[254:255], v108 offset:15488
    v_mfma_f32_16x16x32_bf16 v[48:51], v[116:119], v[168:171], v[48:51]
    v_mfma_f32_16x16x32_bf16 v[48:51], v[200:203], v[188:191], v[48:51]
    v_mfma_f32_16x16x32_bf16 v[52:55], v[116:119], v[172:175], v[52:55]
    v_mfma_f32_16x16x32_bf16 v[52:55], v[200:203], v[192:195], v[52:55]
    v_mfma_f32_16x16x32_bf16 v[56:59], v[116:119], v[176:179], v[56:59]
    v_mfma_f32_16x16x32_bf16 v[56:59], v[200:203], v[196:199], v[56:59]
    s_waitcnt vmcnt(15) lgkmcnt(0)
    s_barrier
    v_readfirstlane_b32 s3, v115
    s_nop 0
    s_and_b32 s3, s3, s4
    s_cmp_eq_u32 s3, s13
    s_nop 0
    s_cbranch_scc0 L_op_nop1
    s_add_u32 s6, s30, 83886080
    buffer_load_dwordx4 a[0:3], v105, s[48:51], s6 offen offset:0 sc1
    buffer_load_dwordx4 a[4:7], v105, s[48:51], s6 offen offset:1024 sc1
    buffer_load_dwordx4 a[8:11], v105, s[48:51], s6 offen offset:2048 sc1
    buffer_load_dwordx4 a[12:15], v105, s[48:51], s6 offen offset:3072 sc1
    s_add_u32 s6, s6, 4096
    buffer_load_dwordx4 a[16:19], v105, s[48:51], s6 offen offset:0 sc1
    buffer_load_dwordx4 a[20:23], v105, s[48:51], s6 offen offset:1024 sc1
    buffer_load_dwordx4 a[24:27], v105, s[48:51], s6 offen offset:2048 sc1
    buffer_load_dwordx4 a[28:31], v105, s[48:51], s6 offen offset:3072 sc1
    s_add_u32 s6, s6, 4096
    buffer_load_dwordx4 a[32:35], v105, s[48:51], s6 offen offset:0 sc1
    buffer_load_dwordx4 a[36:39], v105, s[48:51], s6 offen offset:1024 sc1
    buffer_load_dwordx4 a[40:43], v105, s[48:51], s6 offen offset:2048 sc1
    buffer_load_dwordx4 a[44:47], v105, s[48:51], s6 offen offset:3072 sc1
    s_add_u32 s6, s6, 4096
    buffer_load_dwordx4 a[48:51], v105, s[48:51], s6 offen offset:0 sc1
    buffer_load_dwordx4 a[52:55], v105, s[48:51], s6 offen offset:1024 sc1
    buffer_load_dwordx4 a[56:59], v105, s[48:51], s6 offen offset:2048 sc1
    buffer_load_dwordx4 a[60:63], v105, s[48:51], s6 offen offset:3072 sc1
    s_add_u32 s6, s6, 4096
    buffer_load_dwordx4 a[64:67], v105, s[48:51], s6 offen offset:0 sc1
    buffer_load_dwordx4 a[68:71], v105, s[48:51], s6 offen offset:1024 sc1
    buffer_load_dwordx4 a[72:75], v105, s[48:51], s6 offen offset:2048 sc1
    buffer_load_dwordx4 a[76:79], v105, s[48:51], s6 offen offset:3072 sc1
    s_add_u32 s6, s6, 4096
    buffer_load_dwordx4 a[80:83], v105, s[48:51], s6 offen offset:0 sc1
    buffer_load_dwordx4 a[84:87], v105, s[48:51], s6 offen offset:1024 sc1
    buffer_load_dwordx4 a[88:91], v105, s[48:51], s6 offen offset:2048 sc1
    buffer_load_dwordx4 a[92:95], v105, s[48:51], s6 offen offset:3072 sc1
    s_add_u32 s6, s6, 4096
    buffer_load_dwordx4 a[96:99], v105, s[48:51], s6 offen offset:0 sc1
    s_mov_b32 s64, 1
L_op_nop1:
    v_mfma_f32_16x16x32_bf16 v[60:63], a[240:243], v[160:163], v[60:63]
    ds_read_b64_tr_b16 v[208:209], v106 offset:40960
    buffer_load_dword v113, v114, s[48:51], s25 offen sc1
    v_mfma_f32_16x16x32_bf16 v[60:63], a[244:247], v[180:183], v[60:63]
    ds_read_b128 v[120:123], v110 offset:40960
    v_mfma_f32_16x16x32_bf16 v[64:67], a[240:243], v[164:167], v[64:67]
    ds_read_b64_tr_b16 v[210:211], v106 offset:46080
    v_mfma_f32_16x16x32_bf16 v[64:67], a[244:247], v[184:187], v[64:67]
    ds_read_b128 v[140:143], v110 offset:51200
    v_mfma_f32_16x16x32_bf16 v[68:71], a[240:243], v[168:171], v[68:71]
    ds_read_b64_tr_b16 v[212:213], v106 offset:51200
    buffer_load_dword v115, v114, s[48:51], s31 offen sc1
    v_mfma_f32_16x16x32_bf16 v[68:71], a[244:247], v[188:191], v[68:71]
    ds_read_b128 v[124:127], v110 offset:41984
    s_add_u32 m0, s12, 20480
    v_mfma_f32_16x16x32_bf16 v[72:75], a[240:243], v[172:175], v[72:75]
    ds_read_b64_tr_b16 v[214:215], v106 offset:56320
    v_mfma_f32_16x16x32_bf16 v[72:75], a[244:247], v[192:195], v[72:75]
    ds_read_b128 v[144:147], v110 offset:52224
    v_mfma_f32_16x16x32_bf16 v[76:79], a[240:243], v[176:179], v[76:79]
    ds_read_b128 v[128:131], v110 offset:43008
    buffer_load_dwordx4 v105, s[48:51], s19 offen offset:0 sc1 lds
    v_mfma_f32_16x16x32_bf16 v[76:79], a[244:247], v[196:199], v[76:79]
    ds_read_b128 v[148:151], v110 offset:53248
    v_mfma_f32_16x16x32_bf16 v[80:83], a[248:251], v[160:163], v[80:83]
    ds_read_b64_tr_b16 v[116:117], v107 offset:40992
    v_mfma_f32_16x16x32_bf16 v[80:83], a[252:255], v[180:183], v[80:83]
    ds_read_b128 v[132:135], v110 offset:44032
    v_mfma_f32_16x16x32_bf16 v[84:87], a[248:251], v[164:167], v[84:87]
    ds_read_b64_tr_b16 v[118:119], v107 offset:46112
    buffer_load_dwordx4 v105, s[48:51], s19 offen offset:1024 sc1 lds
    v_mfma_f32_16x16x32_bf16 v[84:87], a[252:255], v[184:187], v[84:87]
    ds_read_b128 v[152:155], v110 offset:54272
    v_mfma_f32_16x16x32_bf16 v[88:91], a[248:251], v[168:171], v[88:91]
    ds_read_b64_tr_b16 v[200:201], v107 offset:51232
    v_mfma_f32_16x16x32_bf16 v[88:91], a[252:255], v[188:191], v[88:91]
    ds_read_b128 v[136:139], v110 offset:45056
    v_mfma_f32_16x16x32_bf16 v[92:95], a[248:251], v[172:175], v[92:95]
    ds_read_b64_tr_b16 v[202:203], v107 offset:56352
    buffer_load_dwordx4 v105, s[48:51], s19 offen offset:2048 sc1 lds
    v_mfma_f32_16x16x32_bf16 v[92:95], a[252:255], v[192:195], v[92:95]
    ds_read_b128 v[156:159], v110 offset:55296
    v_mfma_f32_16x16x32_bf16 v[96:99], a[248:251], v[176:179], v[96:99]
    v_mfma_f32_16x16x32_bf16 v[96:99], a[252:255], v[196:199], v[96:99]
    s_waitcnt lgkmcnt(11)
    v_mfma_f32_16x16x32_bf16 v[0:3], v[208:211], v[120:123], v[0:3]
    ds_read_b64_tr_b16 a[240:241], v106 offset:41024
    buffer_load_dwordx4 v105, s[48:51], s19 offen offset:3072 sc1 lds
    v_mfma_f32_16x16x32_bf16 v[0:3], v[212:215], v[140:143], v[0:3]
    s_add_u32 m0, s12, 24576
    v_mfma_f32_16x16x32_bf16 v[4:7], v[208:211], v[124:127], v[4:7]
    ds_read_b64_tr_b16 a[242:243], v106 offset:46144
    s_waitcnt lgkmcnt(12)
    v_mfma_f32_16x16x32_bf16 v[4:7], v[212:215], v[144:147], v[4:7]
    s_waitcnt lgkmcnt(11)
    v_mfma_f32_16x16x32_bf16 v[8:11], v[208:211], v[128:131], v[8:11]
    ds_read_b64_tr_b16 a[244:245], v106 offset:51264
    buffer_load_dwordx4 v112, s[48:51], s19 offen sc1 lds
    s_waitcnt lgkmcnt(11)
    v_mfma_f32_16x16x32_bf16 v[8:11], v[212:215], v[148:151], v[8:11]
    s_add_u32 s19, s19, 81920
    s_waitcnt lgkmcnt(9)
    v_mfma_f32_16x16x32_bf16 v[12:15], v[208:211], v[132:135], v[12:15]
    ds_read_b64_tr_b16 a[246:247], v106 offset:56384
    s_waitcnt lgkmcnt(8)
    v_mfma_f32_16x16x32_bf16 v[12:15], v[212:215], v[152:155], v[12:15]
    s_waitcnt lgkmcnt(6)
    v_mfma_f32_16x16x32_bf16 v[16:19], v[208:211], v[136:139], v[16:19]
    s_waitcnt lgkmcnt(4)
    v_mfma_f32_16x16x32_bf16 v[16:19], v[212:215], v[156:159], v[16:19]
    v_mfma_f32_16x16x32_bf16 v[20:23], v[116:119], v[120:123], v[20:23]
    ds_read_b64_tr_b16 a[248:249], v107 offset:41056
    v_mfma_f32_16x16x32_bf16 v[20:23], v[200:203], v[140:143], v[20:23]
    v_mfma_f32_16x16x32_bf16 v[24:27], v[116:119], v[124:127], v[24:27]
    ds_read_b64_tr_b16 a[250:251], v107 offset:46176
    v_mfma_f32_16x16x32_bf16 v[24:27], v[200:203], v[144:147], v[24:27]
    v_mfma_f32_16x16x32_bf16 v[28:31], v[116:119], v[128:131], v[28:31]
    ds_read_b64_tr_b16 a[252:253], v107 offset:51296
    v_mfma_f32_16x16x32_bf16 v[28:31], v[200:203], v[148:151], v[28:31]
    v_mfma_f32_16x16x32_bf16 v[32:35], v[116:119], v[132:135], v[32:35]
    ds_read_b64_tr_b16 a[254:255], v107 offset:56416
    v_mfma_f32_16x16x32_bf16 v[32:35], v[200:203], v[152:155], v[32:35]
    v_mfma_f32_16x16x32_bf16 v[36:39], v[116:119], v[136:139], v[36:39]
    v_mfma_f32_16x16x32_bf16 v[36:39], v[200:203], v[156:159], v[36:39]
    s_waitcnt lgkmcnt(4)
    v_mfma_f32_16x16x32_bf16 v[40:43], a[240:243], v[120:123], v[40:43]
    ds_read_b64_tr_b16 v[208:209], v106 offset:41088
    v_mfma_f32_16x16x32_bf16 v[40:43], a[244:247], v[140:143], v[40:43]
    ds_read_b64_tr_b16 v[210:211], v106 offset:46208
    v_mfma_f32_16x16x32_bf16 v[44:47], a[240:243], v[124:127], v[44:47]
    ds_read_b64_tr_b16 v[212:213], v106 offset:51328
    v_mfma_f32_16x16x32_bf16 v[44:47], a[244:247], v[144:147], v[44:47]
    ds_read_b64_tr_b16 v[214:215], v106 offset:56448
    v_mfma_f32_16x16x32_bf16 v[48:51], a[240:243], v[128:131], v[48:51]
    v_mfma_f32_16x16x32_bf16 v[48:51], a[244:247], v[148:151], v[48:51]
    v_mfma_f32_16x16x32_bf16 v[52:55], a[240:243], v[132:135], v[52:55]
    v_mfma_f32_16x16x32_bf16 v[52:55], a[244:247], v[152:155], v[52:55]
    v_mfma_f32_16x16x32_bf16 v[56:59], a[240:243], v[136:139], v[56:59]
    v_mfma_f32_16x16x32_bf16 v[56:59], a[244:247], v[156:159], v[56:59]
    s_waitcnt vmcnt(12) lgkmcnt(0)
    s_barrier
    v_mfma_f32_16x16x32_bf16 v[60:63], a[248:251], v[120:123], v[60:63]
    ds_read_b64_tr_b16 v[116:117], v108 offset:40960
    s_add_u32 m0, s12, 81920
    v_mfma_f32_16x16x32_bf16 v[60:63], a[252:255], v[140:143], v[60:63]
    ds_read_b128 v[160:163], v111 offset:40960
    buffer_load_dwordx4 v100, s[88:91], s26 offen offset:0 lds
    v_mfma_f32_16x16x32_bf16 v[64:67], a[248:251], v[124:127], v[64:67]
    ds_read_b64_tr_b16 v[118:119], v108 offset:46080
    v_mfma_f32_16x16x32_bf16 v[64:67], a[252:255], v[144:147], v[64:67]
    ds_read_b128 v[180:183], v111 offset:51200
    v_mfma_f32_16x16x32_bf16 v[68:71], a[248:251], v[128:131], v[68:71]
    ds_read_b64_tr_b16 v[200:201], v108 offset:51200
    v_mfma_f32_16x16x32_bf16 v[68:71], a[252:255], v[148:151], v[68:71]
    ds_read_b128 v[164:167], v111 offset:41984
    buffer_load_dwordx4 v101, s[88:91], s26 offen offset:1024 lds
    v_mfma_f32_16x16x32_bf16 v[72:75], a[248:251], v[132:135], v[72:75]
    ds_read_b64_tr_b16 v[202:203], v108 offset:56320
    v_mfma_f32_16x16x32_bf16 v[72:75], a[252:255], v[152:155], v[72:75]
    ds_read_b128 v[184:187], v111 offset:52224
    v_mfma_f32_16x16x32_bf16 v[76:79], a[248:251], v[136:139], v[76:79]
    ds_read_b128 v[168:171], v111 offset:43008
    v_mfma_f32_16x16x32_bf16 v[76:79], a[252:255], v[156:159], v[76:79]
    ds_read_b128 v[188:191], v111 offset:53248
    v_mfma_f32_16x16x32_bf16 v[80:83], v[208:211], v[120:123], v[80:83]
    ds_read_b64_tr_b16 a[240:241], v109 offset:40992
    buffer_load_dwordx4 v102, s[88:91], s26 offen offset:2048 lds
    v_mfma_f32_16x16x32_bf16 v[80:83], v[212:215], v[140:143], v[80:83]
    ds_read_b128 v[172:175], v111 offset:44032
    v_mfma_f32_16x16x32_bf16 v[84:87], v[208:211], v[124:127], v[84:87]
    ds_read_b64_tr_b16 a[242:243], v109 offset:46112
    v_mfma_f32_16x16x32_bf16 v[84:87], v[212:215], v[144:147], v[84:87]
    ds_read_b128 v[192:195], v111 offset:54272
    v_mfma_f32_16x16x32_bf16 v[88:91], v[208:211], v[128:131], v[88:91]
    ds_read_b64_tr_b16 a[244:245], v109 offset:51232
    buffer_load_dwordx4 v103, s[88:91], s26 offen offset:3072 lds
    v_mfma_f32_16x16x32_bf16 v[88:91], v[212:215], v[148:151], v[88:91]
    ds_read_b128 v[176:179], v111 offset:45056
    s_add_u32 m0, s12, 86016
    v_mfma_f32_16x16x32_bf16 v[92:95], v[208:211], v[132:135], v[92:95]
    ds_read_b64_tr_b16 a[246:247], v109 offset:56352
    v_mfma_f32_16x16x32_bf16 v[92:95], v[212:215], v[152:155], v[92:95]
    ds_read_b128 v[196:199], v111 offset:55296
    v_mfma_f32_16x16x32_bf16 v[96:99], v[208:211], v[136:139], v[96:99]
    buffer_load_dwordx4 v104, s[88:91], s26 offen lds
    s_add_u32 s26, s26, 327680
    v_mfma_f32_16x16x32_bf16 v[96:99], v[212:215], v[156:159], v[96:99]
    s_add_u32 m0, s12, 102400
    s_waitcnt lgkmcnt(11)
    v_mfma_f32_16x16x32_bf16 v[0:3], v[116:119], v[160:163], v[0:3]
    ds_read_b64_tr_b16 a[248:249], v108 offset:41024
    v_mfma_f32_16x16x32_bf16 v[0:3], v[200:203], v[180:183], v[0:3]
    v_mfma_f32_16x16x32_bf16 v[4:7], v[116:119], v[164:167], v[4:7]
    ds_read_b64_tr_b16 a[250:251], v108 offset:46144
    buffer_load_dwordx4 v105, s[48:51], s28 offen offset:0 sc1 lds
    s_waitcnt lgkmcnt(12)
    v_mfma_f32_16x16x32_bf16 v[4:7], v[200:203], v[184:187], v[4:7]
    s_waitcnt lgkmcnt(11)
    v_mfma_f32_16x16x32_bf16 v[8:11], v[116:119], v[168:171], v[8:11]
    ds_read_b64_tr_b16 a[252:253], v108 offset:51264
    s_waitcnt lgkmcnt(11)
    v_mfma_f32_16x16x32_bf16 v[8:11], v[200:203], v[188:191], v[8:11]
    s_waitcnt lgkmcnt(9)
    v_mfma_f32_16x16x32_bf16 v[12:15], v[116:119], v[172:175], v[12:15]
    ds_read_b64_tr_b16 a[254:255], v108 offset:56384
    buffer_load_dwordx4 v105, s[48:51], s28 offen offset:1024 sc1 lds
    s_waitcnt lgkmcnt(8)
    v_mfma_f32_16x16x32_bf16 v[12:15], v[200:203], v[192:195], v[12:15]
    s_waitcnt lgkmcnt(6)
    v_mfma_f32_16x16x32_bf16 v[16:19], v[116:119], v[176:179], v[16:19]
    s_waitcnt lgkmcnt(4)
    v_mfma_f32_16x16x32_bf16 v[16:19], v[200:203], v[196:199], v[16:19]
    v_mfma_f32_16x16x32_bf16 v[20:23], a[240:243], v[160:163], v[20:23]
    ds_read_b64_tr_b16 v[208:209], v109 offset:41056
    buffer_load_dwordx4 v105, s[48:51], s28 offen offset:2048 sc1 lds
    v_mfma_f32_16x16x32_bf16 v[20:23], a[244:247], v[180:183], v[20:23]
    v_mfma_f32_16x16x32_bf16 v[24:27], a[240:243], v[164:167], v[24:27]
    ds_read_b64_tr_b16 v[210:211], v109 offset:46176
    v_mfma_f32_16x16x32_bf16 v[24:27], a[244:247], v[184:187], v[24:27]
    v_mfma_f32_16x16x32_bf16 v[28:31], a[240:243], v[168:171], v[28:31]
    ds_read_b64_tr_b16 v[212:213], v109 offset:51296
    buffer_load_dwordx4 v105, s[48:51], s28 offen offset:3072 sc1 lds
    v_mfma_f32_16x16x32_bf16 v[28:31], a[244:247], v[188:191], v[28:31]
    s_add_u32 m0, s12, 106496
    v_mfma_f32_16x16x32_bf16 v[32:35], a[240:243], v[172:175], v[32:35]
    ds_read_b64_tr_b16 v[214:215], v109 offset:56416
    v_mfma_f32_16x16x32_bf16 v[32:35], a[244:247], v[192:195], v[32:35]
    v_mfma_f32_16x16x32_bf16 v[36:39], a[240:243], v[176:179], v[36:39]
    buffer_load_dwordx4 v112, s[48:51], s28 offen sc1 lds
    s_add_u32 s28, s28, 81920
    v_mfma_f32_16x16x32_bf16 v[36:39], a[244:247], v[196:199], v[36:39]
    s_waitcnt lgkmcnt(4)
    v_mfma_f32_16x16x32_bf16 v[40:43], a[248:251], v[160:163], v[40:43]
    ds_read_b64_tr_b16 v[116:117], v108 offset:41088
    v_mfma_f32_16x16x32_bf16 v[40:43], a[252:255], v[180:183], v[40:43]
    ds_read_b64_tr_b16 v[118:119], v108 offset:46208
    v_mfma_f32_16x16x32_bf16 v[44:47], a[248:251], v[164:167], v[44:47]
    ds_read_b64_tr_b16 v[200:201], v108 offset:51328
    v_mfma_f32_16x16x32_bf16 v[44:47], a[252:255], v[184:187], v[44:47]
    ds_read_b64_tr_b16 v[202:203], v108 offset:56448
    v_mfma_f32_16x16x32_bf16 v[48:51], a[248:251], v[168:171], v[48:51]
    v_mfma_f32_16x16x32_bf16 v[48:51], a[252:255], v[188:191], v[48:51]
    v_mfma_f32_16x16x32_bf16 v[52:55], a[248:251], v[172:175], v[52:55]
    v_mfma_f32_16x16x32_bf16 v[52:55], a[252:255], v[192:195], v[52:55]
    v_mfma_f32_16x16x32_bf16 v[56:59], a[248:251], v[176:179], v[56:59]
    v_mfma_f32_16x16x32_bf16 v[56:59], a[252:255], v[196:199], v[56:59]
    s_waitcnt vmcnt(10) lgkmcnt(0)
    s_barrier
    v_mfma_f32_16x16x32_bf16 v[60:63], v[208:211], v[160:163], v[60:63]
    ds_read_b64_tr_b16 a[240:241], v106 offset:0
    s_add_u32 m0, s12, 40960
    v_mfma_f32_16x16x32_bf16 v[60:63], v[212:215], v[180:183], v[60:63]
    ds_read_b128 v[120:123], v110 offset:0
    buffer_load_dwordx4 v100, s[88:91], s27 offen offset:0 lds
    v_mfma_f32_16x16x32_bf16 v[64:67], v[208:211], v[164:167], v[64:67]
    ds_read_b64_tr_b16 a[242:243], v106 offset:5120
    v_mfma_f32_16x16x32_bf16 v[64:67], v[212:215], v[184:187], v[64:67]
    ds_read_b128 v[140:143], v110 offset:10240
    v_mfma_f32_16x16x32_bf16 v[68:71], v[208:211], v[168:171], v[68:71]
    ds_read_b64_tr_b16 a[244:245], v106 offset:10240
    v_mfma_f32_16x16x32_bf16 v[68:71], v[212:215], v[188:191], v[68:71]
    ds_read_b128 v[124:127], v110 offset:1024
    buffer_load_dwordx4 v101, s[88:91], s27 offen offset:1024 lds
    v_mfma_f32_16x16x32_bf16 v[72:75], v[208:211], v[172:175], v[72:75]
    ds_read_b64_tr_b16 a[246:247], v106 offset:15360
    v_mfma_f32_16x16x32_bf16 v[72:75], v[212:215], v[192:195], v[72:75]
    ds_read_b128 v[144:147], v110 offset:11264
    v_mfma_f32_16x16x32_bf16 v[76:79], v[208:211], v[176:179], v[76:79]
    ds_read_b128 v[128:131], v110 offset:2048
    v_mfma_f32_16x16x32_bf16 v[76:79], v[212:215], v[196:199], v[76:79]
    ds_read_b128 v[148:151], v110 offset:12288
    v_mfma_f32_16x16x32_bf16 v[80:83], v[116:119], v[160:163], v[80:83]
    ds_read_b64_tr_b16 a[248:249], v107 offset:32
    buffer_load_dwordx4 v102, s[88:91], s27 offen offset:2048 lds
    v_mfma_f32_16x16x32_bf16 v[80:83], v[200:203], v[180:183], v[80:83]
    ds_read_b128 v[132:135], v110 offset:3072
    v_mfma_f32_16x16x32_bf16 v[84:87], v[116:119], v[164:167], v[84:87]
    ds_read_b64_tr_b16 a[250:251], v107 offset:5152
    v_mfma_f32_16x16x32_bf16 v[84:87], v[200:203], v[184:187], v[84:87]
    ds_read_b128 v[152:155], v110 offset:13312
    v_mfma_f32_16x16x32_bf16 v[88:91], v[116:119], v[168:171], v[88:91]
    ds_read_b64_tr_b16 a[252:253], v107 offset:10272
    buffer_load_dwordx4 v103, s[88:91], s27 offen offset:3072 lds
    v_mfma_f32_16x16x32_bf16 v[88:91], v[200:203], v[188:191], v[88:91]
    ds_read_b128 v[136:139], v110 offset:4096
    v_mfma_f32_16x16x32_bf16 v[92:95], v[116:119], v[172:175], v[92:95]
    ds_read_b64_tr_b16 a[254:255], v107 offset:15392
    v_mfma_f32_16x16x32_bf16 v[92:95], v[200:203], v[192:195], v[92:95]
    ds_read_b128 v[156:159], v110 offset:14336
    v_mfma_f32_16x16x32_bf16 v[96:99], v[116:119], v[176:179], v[96:99]
    v_mfma_f32_16x16x32_bf16 v[96:99], v[200:203], v[196:199], v[96:99]
    s_add_u32 s21, s21, 1
    s_cmp_lt_u32 s21, s20
    s_nop 4
    s_cbranch_scc1 L_op_loop
L_op_done:
    s_waitcnt vmcnt(0) lgkmcnt(0)
    s_cmp_eq_u32 s63, 12
    s_cbranch_scc1 L_op_final
    s_add_u32 s6, s30, 83886080
    buffer_store_dwordx4 v[0:3], v105, s[48:51], s6 offen offset:0 sc1
    buffer_store_dwordx4 v[4:7], v105, s[48:51], s6 offen offset:1024 sc1
    buffer_store_dwordx4 v[8:11], v105, s[48:51], s6 offen offset:2048 sc1
    buffer_store_dwordx4 v[12:15], v105, s[48:51], s6 offen offset:3072 sc1
    s_add_u32 s6, s6, 4096
    buffer_store_dwordx4 v[16:19], v105, s[48:51], s6 offen offset:0 sc1
    buffer_store_dwordx4 v[20:23], v105, s[48:51], s6 offen offset:1024 sc1
    buffer_store_dwordx4 v[24:27], v105, s[48:51], s6 offen offset:2048 sc1
    buffer_store_dwordx4 v[28:31], v105, s[48:51], s6 offen offset:3072 sc1
    s_add_u32 s6, s6, 4096
    buffer_store_dwordx4 v[32:35], v105, s[48:51], s6 offen offset:0 sc1
    buffer_store_dwordx4 v[36:39], v105, s[48:51], s6 offen offset:1024 sc1
    buffer_store_dwordx4 v[40:43], v105, s[48:51], s6 offen offset:2048 sc1
    buffer_store_dwordx4 v[44:47], v105, s[48:51], s6 offen offset:3072 sc1
    s_add_u32 s6, s6, 4096
    buffer_store_dwordx4 v[48:51], v105, s[48:51], s6 offen offset:0 sc1
    buffer_store_dwordx4 v[52:55], v105, s[48:51], s6 offen offset:1024 sc1
    buffer_store_dwordx4 v[56:59], v105, s[48:51], s6 offen offset:2048 sc1
    buffer_store_dwordx4 v[60:63], v105, s[48:51], s6 offen offset:3072 sc1
    s_add_u32 s6, s6, 4096
    buffer_store_dwordx4 v[64:67], v105, s[48:51], s6 offen offset:0 sc1
    buffer_store_dwordx4 v[68:71], v105, s[48:51], s6 offen offset:1024 sc1
    buffer_store_dwordx4 v[72:75], v105, s[48:51], s6 offen offset:2048 sc1
    buffer_store_dwordx4 v[76:79], v105, s[48:51], s6 offen offset:3072 sc1
    s_add_u32 s6, s6, 4096
    buffer_store_dwordx4 v[80:83], v105, s[48:51], s6 offen offset:0 sc1
    buffer_store_dwordx4 v[84:87], v105, s[48:51], s6 offen offset:1024 sc1
    buffer_store_dwordx4 v[88:91], v105, s[48:51], s6 offen offset:2048 sc1
    buffer_store_dwordx4 v[92:95], v105, s[48:51], s6 offen offset:3072 sc1
    s_add_u32 s6, s6, 4096
    buffer_store_dwordx4 v[96:99], v105, s[48:51], s6 offen offset:0 sc1
    s_lshl_b32 s3, 16, s11
    v_mov_b32 v206, s3
    s_waitcnt vmcnt(0) lgkmcnt(0)
    buffer_atomic_add v206, v205, s[48:51], s31 offen sc1
    s_endpgm
L_op_final:
    s_cmp_eq_u32 s64, 1
    s_cbranch_scc1 L_op_f2
    s_mov_b32 s78, 0
L_op_f1:
    buffer_load_dword v115, v114, s[48:51], s31 offen sc1
    s_waitcnt vmcnt(0)
    v_readfirstlane_b32 s3, v115
    s_nop 0
    s_and_b32 s3, s3, s4
    s_cmp_eq_u32 s3, s5
    s_nop 0
    s_cbranch_scc1 L_op_f1ok
    s_sleep 8
    s_add_u32 s78, s78, 1
    s_cmp_lt_u32 s78, 1000000
    s_cbranch_scc1 L_op_f1
L_op_f1ok:
    s_add_u32 s6, s30, 83886080
    buffer_load_dwordx4 a[0:3], v105, s[48:51], s6 offen offset:0 sc1
    buffer_load_dwordx4 a[4:7], v105, s[48:51], s6 offen offset:1024 sc1
    buffer_load_dwordx4 a[8:11], v105, s[48:51], s6 offen offset:2048 sc1
    buffer_load_dwordx4 a[12:15], v105, s[48:51], s6 offen offset:3072 sc1
    s_add_u32 s6, s6, 4096
    buffer_load_dwordx4 a[16:19], v105, s[48:51], s6 offen offset:0 sc1
    buffer_load_dwordx4 a[20:23], v105, s[48:51], s6 offen offset:1024 sc1
    buffer_load_dwordx4 a[24:27], v105, s[48:51], s6 offen offset:2048 sc1
    buffer_load_dwordx4 a[28:31], v105, s[48:51], s6 offen offset:3072 sc1
    s_add_u32 s6, s6, 4096
    buffer_load_dwordx4 a[32:35], v105, s[48:51], s6 offen offset:0 sc1
    buffer_load_dwordx4 a[36:39], v105, s[48:51], s6 offen offset:1024 sc1
    buffer_load_dwordx4 a[40:43], v105, s[48:51], s6 offen offset:2048 sc1
    buffer_load_dwordx4 a[44:47], v105, s[48:51], s6 offen offset:3072 sc1
    s_add_u32 s6, s6, 4096
    buffer_load_dwordx4 a[48:51], v105, s[48:51], s6 offen offset:0 sc1
    buffer_load_dwordx4 a[52:55], v105, s[48:51], s6 offen offset:1024 sc1
    buffer_load_dwordx4 a[56:59], v105, s[48:51], s6 offen offset:2048 sc1
    buffer_load_dwordx4 a[60:63], v105, s[48:51], s6 offen offset:3072 sc1
    s_add_u32 s6, s6, 4096
    buffer_load_dwordx4 a[64:67], v105, s[48:51], s6 offen offset:0 sc1
    buffer_load_dwordx4 a[68:71], v105, s[48:51], s6 offen offset:1024 sc1
    buffer_load_dwordx4 a[72:75], v105, s[48:51], s6 offen offset:2048 sc1
    buffer_load_dwordx4 a[76:79], v105, s[48:51], s6 offen offset:3072 sc1
    s_add_u32 s6, s6, 4096
    buffer_load_dwordx4 a[80:83], v105, s[48:51], s6 offen offset:0 sc1
    buffer_load_dwordx4 a[84:87], v105, s[48:51], s6 offen offset:1024 sc1
    buffer_load_dwordx4 a[88:91], v105, s[48:51], s6 offen offset:2048 sc1
    buffer_load_dwordx4 a[92:95], v105, s[48:51], s6 offen offset:3072 sc1
    s_add_u32 s6, s6, 4096
    buffer_load_dwordx4 a[96:99], v105, s[48:51], s6 offen offset:0 sc1
L_op_f2:
    v_and_b32 v247, 15, v235
    v_mul_u32_u24 v246, 2560, v247
    v_lshrrev_b32 v247, 4, v235
    v_lshl_add_u32 v246, v247, 3, v246
    s_and_b32 s6, s100, 15
    s_mul_i32 s15, s6, 409600
    s_lshr_b32 s6, s100, 4
    s_mul_i32 s6, s6, 1280
    s_add_u32 s15, s15, s6
    s_mul_i32 s6, s101, 320
    s_add_u32 s15, s15, s6
    s_mul_i32 s6, s10, 160
    s_add_u32 s15, s15, s6
    s_mul_i32 s6, s9, 204800
    s_add_u32 s15, s15, s6
    s_waitcnt vmcnt(24)
    v_accvgpr_read_b32 v120, a0
    v_accvgpr_read_b32 v121, a1
    v_accvgpr_read_b32 v122, a2
    v_accvgpr_read_b32 v123, a3
    v_pk_add_f32 v[0:1], v[0:1], v[120:121]
    v_pk_add_f32 v[2:3], v[2:3], v[122:123]
    s_add_u32 s3, s15, 0
    v_cvt_pk_bf16_f32 v0, v0, v1
    v_cvt_pk_bf16_f32 v1, v2, v3
    buffer_store_dwordx2 v[0:1], v246, s[92:95], s3 offen offset:0
    s_waitcnt vmcnt(24)
    v_accvgpr_read_b32 v124, a4
    v_accvgpr_read_b32 v125, a5
    v_accvgpr_read_b32 v126, a6
    v_accvgpr_read_b32 v127, a7
    v_pk_add_f32 v[4:5], v[4:5], v[124:125]
    v_pk_add_f32 v[6:7], v[6:7], v[126:127]
    s_add_u32 s3, s15, 40960
    v_cvt_pk_bf16_f32 v4, v4, v5
    v_cvt_pk_bf16_f32 v5, v6, v7
    buffer_store_dwordx2 v[4:5], v246, s[92:95], s3 offen offset:0
    s_waitcnt vmcnt(24)
    v_accvgpr_read_b32 v128, a8
    v_accvgpr_read_b32 v129, a9
    v_accvgpr_read_b32 v130, a10
    v_accvgpr_read_b32 v131, a11
    v_pk_add_f32 v[8:9], v[8:9], v[128:129]
    v_pk_add_f32 v[10:11], v[10:11], v[130:131]
    s_add_u32 s3, s15, 81920
    v_cvt_pk_bf16_f32 v8, v8, v9
    v_cvt_pk_bf16_f32 v9, v10, v11
    buffer_store_dwordx2 v[8:9], v246, s[92:95], s3 offen offset:0
    s_waitcnt vmcnt(24)
    v_accvgpr_read_b32 v132, a12
    v_accvgpr_read_b32 v133, a13
    v_accvgpr_read_b32 v134, a14
    v_accvgpr_read_b32 v135, a15
    v_pk_add_f32 v[12:13], v[12:13], v[132:133]
    v_pk_add_f32 v[14:15], v[14:15], v[134:135]
    s_add_u32 s3, s15, 122880
    v_cvt_pk_bf16_f32 v12, v12, v13
    v_cvt_pk_bf16_f32 v13, v14, v15
    buffer_store_dwordx2 v[12:13], v246, s[92:95], s3 offen offset:0
    s_waitcnt vmcnt(24)
    v_accvgpr_read_b32 v136, a16
    v_accvgpr_read_b32 v137, a17
    v_accvgpr_read_b32 v138, a18
    v_accvgpr_read_b32 v139, a19
    v_pk_add_f32 v[16:17], v[16:17], v[136:137]
    v_pk_add_f32 v[18:19], v[18:19], v[138:139]
    s_add_u32 s3, s15, 163840
    v_cvt_pk_bf16_f32 v16, v16, v17
    v_cvt_pk_bf16_f32 v17, v18, v19
    buffer_store_dwordx2 v[16:17], v246, s[92:95], s3 offen offset:0
    s_waitcnt vmcnt(24)
    v_accvgpr_read_b32 v140, a20
    v_accvgpr_read_b32 v141, a21
    v_accvgpr_read_b32 v142, a22
    v_accvgpr_read_b32 v143, a23
    v_pk_add_f32 v[20:21], v[20:21], v[140:141]
    v_pk_add_f32 v[22:23], v[22:23], v[142:143]
    s_add_u32 s3, s15, 0
    v_cvt_pk_bf16_f32 v20, v20, v21
    v_cvt_pk_bf16_f32 v21, v22, v23
    buffer_store_dwordx2 v[20:21], v246, s[92:95], s3 offen offset:32
    s_waitcnt vmcnt(24)
    v_accvgpr_read_b32 v144, a24
    v_accvgpr_read_b32 v145, a25
    v_accvgpr_read_b32 v146, a26
    v_accvgpr_read_b32 v147, a27
    v_pk_add_f32 v[24:25], v[24:25], v[144:145]
    v_pk_add_f32 v[26:27], v[26:27], v[146:147]
    s_add_u32 s3, s15, 40960
    v_cvt_pk_bf16_f32 v24, v24, v25
    v_cvt_pk_bf16_f32 v25, v26, v27
    buffer_store_dwordx2 v[24:25], v246, s[92:95], s3 offen offset:32
    s_waitcnt vmcnt(24)
    v_accvgpr_read_b32 v148, a28
    v_accvgpr_read_b32 v149, a29
    v_accvgpr_read_b32 v150, a30
    v_accvgpr_read_b32 v151, a31
    v_pk_add_f32 v[28:29], v[28:29], v[148:149]
    v_pk_add_f32 v[30:31], v[30:31], v[150:151]
    s_add_u32 s3, s15, 81920
    v_cvt_pk_bf16_f32 v28, v28, v29
    v_cvt_pk_bf16_f32 v29, v30, v31
    buffer_store_dwordx2 v[28:29], v246, s[92:95], s3 offen offset:32
    s_waitcnt vmcnt(24)
    v_accvgpr_read_b32 v120, a32
    v_accvgpr_read_b32 v121, a33
    v_accvgpr_read_b32 v122, a34
    v_accvgpr_read_b32 v123, a35
    v_pk_add_f32 v[32:33], v[32:33], v[120:121]
    v_pk_add_f32 v[34:35], v[34:35], v[122:123]
    s_add_u32 s3, s15, 122880
    v_cvt_pk_bf16_f32 v32, v32, v33
    v_cvt_pk_bf16_f32 v33, v34, v35
    buffer_store_dwordx2 v[32:33], v246, s[92:95], s3 offen offset:32
    s_waitcnt vmcnt(24)
    v_accvgpr_read_b32 v124, a36
    v_accvgpr_read_b32 v125, a37
    v_accvgpr_read_b32 v126, a38
    v_accvgpr_read_b32 v127, a39
    v_pk_add_f32 v[36:37], v[36:37], v[124:125]
    v_pk_add_f32 v[38:39], v[38:39], v[126:127]
    s_add_u32 s3, s15, 163840
    v_cvt_pk_bf16_f32 v36, v36, v37
    v_cvt_pk_bf16_f32 v37, v38, v39
    buffer_store_dwordx2 v[36:37], v246, s[92:95], s3 offen offset:32
    s_waitcnt vmcnt(24)
    v_accvgpr_read_b32 v128, a40
    v_accvgpr_read_b32 v129, a41
    v_accvgpr_read_b32 v130, a42
    v_accvgpr_read_b32 v131, a43
    v_pk_add_f32 v[40:41], v[40:41], v[128:129]
    v_pk_add_f32 v[42:43], v[42:43], v[130:131]
    s_add_u32 s3, s15, 0
    v_cvt_pk_bf16_f32 v40, v40, v41
    v_cvt_pk_bf16_f32 v41, v42, v43
    buffer_store_dwordx2 v[40:41], v246, s[92:95], s3 offen offset:64
    s_waitcnt vmcnt(24)
    v_accvgpr_read_b32 v132, a44
    v_accvgpr_read_b32 v133, a45
    v_accvgpr_read_b32 v134, a46
    v_accvgpr_read_b32 v135, a47
    v_pk_add_f32 v[44:45], v[44:45], v[132:133]
    v_pk_add_f32 v[46:47], v[46:47], v[134:135]
    s_add_u32 s3, s15, 40960
    v_cvt_pk_bf16_f32 v44, v44, v45
    v_cvt_pk_bf16_f32 v45, v46, v47
    buffer_store_dwordx2 v[44:45], v246, s[92:95], s3 offen offset:64
    s_waitcnt vmcnt(24)
    v_accvgpr_read_b32 v136, a48
    v_accvgpr_read_b32 v137, a49
    v_accvgpr_read_b32 v138, a50
    v_accvgpr_read_b32 v139, a51
    v_pk_add_f32 v[48:49], v[48:49], v[136:137]
    v_pk_add_f32 v[50:51], v[50:51], v[138:139]
    s_add_u32 s3, s15, 81920
    v_cvt_pk_bf16_f32 v48, v48, v49
    v_cvt_pk_bf16_f32 v49, v50, v51
    buffer_store_dwordx2 v[48:49], v246, s[92:95], s3 offen offset:64
    s_waitcnt vmcnt(24)
    v_accvgpr_read_b32 v140, a52
    v_accvgpr_read_b32 v141, a53
    v_accvgpr_read_b32 v142, a54
    v_accvgpr_read_b32 v143, a55
    v_pk_add_f32 v[52:53], v[52:53], v[140:141]
    v_pk_add_f32 v[54:55], v[54:55], v[142:143]
    s_add_u32 s3, s15, 122880
    v_cvt_pk_bf16_f32 v52, v52, v53
    v_cvt_pk_bf16_f32 v53, v54, v55
    buffer_store_dwordx2 v[52:53], v246, s[92:95], s3 offen offset:64
    s_waitcnt vmcnt(24)
    v_accvgpr_read_b32 v144, a56
    v_accvgpr_read_b32 v145, a57
    v_accvgpr_read_b32 v146, a58
    v_accvgpr_read_b32 v147, a59
    v_pk_add_f32 v[56:57], v[56:57], v[144:145]
    v_pk_add_f32 v[58:59], v[58:59], v[146:147]
    s_add_u32 s3, s15, 163840
    v_cvt_pk_bf16_f32 v56, v56, v57
    v_cvt_pk_bf16_f32 v57, v58, v59
    buffer_store_dwordx2 v[56:57], v246, s[92:95], s3 offen offset:64
    s_waitcnt vmcnt(24)
    v_accvgpr_read_b32 v148, a60
    v_accvgpr_read_b32 v149, a61
    v_accvgpr_read_b32 v150, a62
    v_accvgpr_read_b32 v151, a63
    v_pk_add_f32 v[60:61], v[60:61], v[148:149]
    v_pk_add_f32 v[62:63], v[62:63], v[150:151]
    s_add_u32 s3, s15, 0
    v_cvt_pk_bf16_f32 v60, v60, v61
    v_cvt_pk_bf16_f32 v61, v62, v63
    buffer_store_dwordx2 v[60:61], v246, s[92:95], s3 offen offset:96
    s_waitcnt vmcnt(24)
    v_accvgpr_read_b32 v120, a64
    v_accvgpr_read_b32 v121, a65
    v_accvgpr_read_b32 v122, a66
    v_accvgpr_read_b32 v123, a67
    v_pk_add_f32 v[64:65], v[64:65], v[120:121]
    v_pk_add_f32 v[66:67], v[66:67], v[122:123]
    s_add_u32 s3, s15, 40960
    v_cvt_pk_bf16_f32 v64, v64, v65
    v_cvt_pk_bf16_f32 v65, v66, v67
    buffer_store_dwordx2 v[64:65], v246, s[92:95], s3 offen offset:96
    s_waitcnt vmcnt(24)
    v_accvgpr_read_b32 v124, a68
    v_accvgpr_read_b32 v125, a69
    v_accvgpr_read_b32 v126, a70
    v_accvgpr_read_b32 v127, a71
    v_pk_add_f32 v[68:69], v[68:69], v[124:125]
    v_pk_add_f32 v[70:71], v[70:71], v[126:127]
    s_add_u32 s3, s15, 81920
    v_cvt_pk_bf16_f32 v68, v68, v69
    v_cvt_pk_bf16_f32 v69, v70, v71
    buffer_store_dwordx2 v[68:69], v246, s[92:95], s3 offen offset:96
    s_waitcnt vmcnt(24)
    v_accvgpr_read_b32 v128, a72
    v_accvgpr_read_b32 v129, a73
    v_accvgpr_read_b32 v130, a74
    v_accvgpr_read_b32 v131, a75
    v_pk_add_f32 v[72:73], v[72:73], v[128:129]
    v_pk_add_f32 v[74:75], v[74:75], v[130:131]
    s_add_u32 s3, s15, 122880
    v_cvt_pk_bf16_f32 v72, v72, v73
    v_cvt_pk_bf16_f32 v73, v74, v75
    buffer_store_dwordx2 v[72:73], v246, s[92:95], s3 offen offset:96
    s_waitcnt vmcnt(24)
    v_accvgpr_read_b32 v132, a76
    v_accvgpr_read_b32 v133, a77
    v_accvgpr_read_b32 v134, a78
    v_accvgpr_read_b32 v135, a79
    v_pk_add_f32 v[76:77], v[76:77], v[132:133]
    v_pk_add_f32 v[78:79], v[78:79], v[134:135]
    s_add_u32 s3, s15, 163840
    v_cvt_pk_bf16_f32 v76, v76, v77
    v_cvt_pk_bf16_f32 v77, v78, v79
    buffer_store_dwordx2 v[76:77], v246, s[92:95], s3 offen offset:96
    s_waitcnt vmcnt(24)
    v_accvgpr_read_b32 v136, a80
    v_accvgpr_read_b32 v137, a81
    v_accvgpr_read_b32 v138, a82
    v_accvgpr_read_b32 v139, a83
    v_pk_add_f32 v[80:81], v[80:81], v[136:137]
    v_pk_add_f32 v[82:83], v[82:83], v[138:139]
    s_add_u32 s3, s15, 0
    v_cvt_pk_bf16_f32 v80, v80, v81
    v_cvt_pk_bf16_f32 v81, v82, v83
    buffer_store_dwordx2 v[80:81], v246, s[92:95], s3 offen offset:128
    s_waitcnt vmcnt(24)
    v_accvgpr_read_b32 v140, a84
    v_accvgpr_read_b32 v141, a85
    v_accvgpr_read_b32 v142, a86
    v_accvgpr_read_b32 v143, a87
    v_pk_add_f32 v[84:85], v[84:85], v[140:141]
    v_pk_add_f32 v[86:87], v[86:87], v[142:143]
    s_add_u32 s3, s15, 40960
    v_cvt_pk_bf16_f32 v84, v84, v85
    v_cvt_pk_bf16_f32 v85, v86, v87
    buffer_store_dwordx2 v[84:85], v246, s[92:95], s3 offen offset:128
    s_waitcnt vmcnt(24)
    v_accvgpr_read_b32 v144, a88
    v_accvgpr_read_b32 v145, a89
    v_accvgpr_read_b32 v146, a90
    v_accvgpr_read_b32 v147, a91
    v_pk_add_f32 v[88:89], v[88:89], v[144:145]
    v_pk_add_f32 v[90:91], v[90:91], v[146:147]
    s_add_u32 s3, s15, 81920
    v_cvt_pk_bf16_f32 v88, v88, v89
    v_cvt_pk_bf16_f32 v89, v90, v91
    buffer_store_dwordx2 v[88:89], v246, s[92:95], s3 offen offset:128
    s_waitcnt vmcnt(24)
    v_accvgpr_read_b32 v148, a92
    v_accvgpr_read_b32 v149, a93
    v_accvgpr_read_b32 v150, a94
    v_accvgpr_read_b32 v151, a95
    v_pk_add_f32 v[92:93], v[92:93], v[148:149]
    v_pk_add_f32 v[94:95], v[94:95], v[150:151]
    s_add_u32 s3, s15, 122880
    v_cvt_pk_bf16_f32 v92, v92, v93
    v_cvt_pk_bf16_f32 v93, v94, v95
    buffer_store_dwordx2 v[92:93], v246, s[92:95], s3 offen offset:128
    s_waitcnt vmcnt(24)
    v_accvgpr_read_b32 v120, a96
    v_accvgpr_read_b32 v121, a97
    v_accvgpr_read_b32 v122, a98
    v_accvgpr_read_b32 v123, a99
    v_pk_add_f32 v[96:97], v[96:97], v[120:121]
    v_pk_add_f32 v[98:99], v[98:99], v[122:123]
    s_add_u32 s3, s15, 163840
    v_cvt_pk_bf16_f32 v96, v96, v97
    v_cvt_pk_bf16_f32 v97, v98, v99
    buffer_store_dwordx2 v[96:97], v246, s[92:95], s3 offen offset:128
L_exit:
    s_endpgm
.section .rodata,"a"
.p2align 6
.amdhsa_kernel concat_heads__mha_block_cached__gqa_block_cached__near_ridge_kernel
  .amdhsa_next_free_vgpr 512
  .amdhsa_next_free_sgpr 102
  .amdhsa_accum_offset 256
  .amdhsa_group_segment_fixed_size 0
  .amdhsa_kernarg_size 104
  .amdhsa_user_sgpr_count 2
  .amdhsa_user_sgpr_kernarg_segment_ptr 1
  .amdhsa_system_sgpr_workgroup_id_x 1
.end_amdhsa_kernel
```
